```python
import torch

def _softmax(x, axis=-1):
    return torch.softmax(x, dim=axis)
def _gelu(x):
    return torch.nn.functional.gelu(x, approximate="tanh")
def _silu(x):
    return torch.nn.functional.silu(x)
def _sigmoid(x):
    return torch.sigmoid(x)
def _layernorm(x, axis=-1, eps=1e-5):
    m = x.mean(dim=axis, keepdim=True)
    v = x.var(dim=axis, keepdim=True, unbiased=False)
    return (x - m) / torch.sqrt(v + eps)
def _scatter_add(tgt, idx, src, axis=0):
    return tgt.clone().index_add_(axis, idx, src)
def _segment_sum(src, seg, n):
    out = torch.zeros((n,) + src.shape[1:], dtype=src.dtype)
    return out.index_add_(0, seg, src)
def _pad(x, pw):
    flat = tuple(v for pair in reversed(pw) for v in pair)
    return torch.nn.functional.pad(x, flat)

kernel_name = 'parallel_sum__ssm_conv_s5__glu_gated_bilinear__prompt'

def setup_inputs():

    _w = (lambda a: (lambda t: t.to(torch.bfloat16) if t.is_floating_point() else t)(torch.as_tensor(a)))
    def _A_setup():
        B, S, D = 1, 2048, 576
        P = D
        Lambda_re = -0.5 * (lambda _x: torch.exp(torch.as_tensor(_x)))((lambda *s: torch.randn(*s, dtype=torch.bfloat16) * 0.2)(P))
        Lambda_im = (lambda *s: torch.randn(*s, dtype=torch.bfloat16) * 0.8)(P) * 1.0
        B_re = (lambda *s: torch.randn(*s, dtype=torch.bfloat16) * 0.2)(P, D) * (D ** -0.5)
        B_im = (lambda *s: torch.randn(*s, dtype=torch.bfloat16) * 0.2)(P, D) * (D ** -0.5)
        C_re = (lambda *s: torch.randn(*s, dtype=torch.bfloat16) * 0.2)(D, P) * (P ** -0.5)
        C_im = (lambda *s: torch.randn(*s, dtype=torch.bfloat16) * 0.2)(D, P) * (P ** -0.5)
        log_dt = (lambda *s: torch.randn(*s, dtype=torch.bfloat16) * 0.2)(P) * 0.3 - 2.0
        Dskip = (lambda *s: torch.randn(*s, dtype=torch.bfloat16) * 0.05)(D)
        return {
            "x": _w((lambda *s: torch.randn(*s, dtype=torch.bfloat16) * 0.05)(B, S, D)),
            "Lambda_re": _w(Lambda_re),
            "Lambda_im": _w(Lambda_im),
            "B_re": _w(B_re),
            "B_im": _w(B_im),
            "C_re": _w(C_re),
            "C_im": _w(C_im),
            "log_dt": _w(log_dt),
            "Dskip": _w(Dskip),
        }
    _A_in = _A_setup()

    def _B_setup():
        B, S, D, F = 1, 2048, 576, 4608
        return {
            "x": _w((lambda *s: torch.randn(*s, dtype=torch.bfloat16) * 0.05)(B, S, D)),
            "w_gate": _w((lambda *s: torch.randn(*s, dtype=torch.bfloat16) * 0.4)(D, F) * (D ** -0.5)),
            "w_up": _w((lambda *s: torch.randn(*s, dtype=torch.bfloat16) * 0.4)(D, F) * (D ** -0.5)),
            "w_down": _w((lambda *s: torch.randn(*s, dtype=torch.bfloat16) * 0.4)(F, D) * (F ** -0.5)),
        }
    _B_in = _B_setup()

    return {
        "A_x": _A_in["x"],
        "A_Lambda_re": _A_in["Lambda_re"],
        "A_Lambda_im": _A_in["Lambda_im"],
        "A_B_re": _A_in["B_re"],
        "A_B_im": _A_in["B_im"],
        "A_C_re": _A_in["C_re"],
        "A_C_im": _A_in["C_im"],
        "A_log_dt": _A_in["log_dt"],
        "A_Dskip": _A_in["Dskip"],
        "B_x": _B_in["x"],
        "B_w_gate": _B_in["w_gate"],
        "B_w_up": _B_in["w_up"],
        "B_w_down": _B_in["w_down"],
    }

def reference(A_x, A_Lambda_re, A_Lambda_im, A_B_re, A_B_im, A_C_re, A_C_im, A_log_dt, A_Dskip, B_x, B_w_gate, B_w_up, B_w_down):
    def _A_ref(x, Lambda_re, Lambda_im, B_re, B_im, C_re, C_im, log_dt, Dskip):
        Bsz, L, H = x.shape
        Lam = Lambda_re + 1j * Lambda_im
        Bmat = B_re + 1j * B_im
        Cmat = C_re + 1j * C_im
        dt = torch.exp(log_dt)
        Lam_bar = torch.exp(dt * Lam)
        B_bar = ((Lam_bar - 1.0) / Lam)[:, None] * Bmat
        Bu = torch.einsum("bld,pd->blp", x + 0j, B_bar)
        h = torch.zeros_like(Bu[:, 0, :])
        hs = []
        for t in range(L):
            h = Lam_bar[None, :] * h + Bu[:, t, :]
            hs.append(h)
        hseq = torch.stack(hs, 1)
        y = 2.0 * torch.einsum("blp,dp->bld", hseq, Cmat).real + x * Dskip[None, None, :]
        return y

    def _B_ref(x, w_gate, w_up, w_down):
        g = torch.einsum("bsd,df->bsf", x, w_gate)
        u = torch.einsum("bsd,df->bsf", x, w_up)
        h = g * u
        return torch.einsum("bsf,fd->bsd", h, w_down)

    x = A_x
    xn = _layernorm(x, axis=-1)
    return x + _A_ref(xn, A_Lambda_re, A_Lambda_im, A_B_re, A_B_im, A_C_re, A_C_im, A_log_dt, A_Dskip) + _B_ref(xn, B_w_gate, B_w_up, B_w_down)
```

```asm
; @launch grid=(256,1,1) block=(256,1,1) lds=163840
.amdgcn_target "amdgcn-amd-amdhsa--gfx950"
.text
.globl parallel_sum__ssm_conv_s5__glu_gated_bilinear__prompt_kernel
.p2align 8
.type parallel_sum__ssm_conv_s5__glu_gated_bilinear__prompt_kernel,@function
parallel_sum__ssm_conv_s5__glu_gated_bilinear__prompt_kernel:
    s_getpc_b64 s[60:61]
    s_mov_b32 s62, 4096
    s_mov_b32 s63, 0x20000
    v_lshlrev_b32 v110, 7, v0
    s_load_dwordx2 s[16:17], s[0:1], 0
    s_cmp_ge_u32 s2, 256
    s_cbranch_scc1 parallel_end1
    buffer_load_dword v111, v110, s[60:63], 0 offen
    s_load_dwordx2 s[18:19], s[0:1], 64
    s_load_dwordx4 s[20:23], s[0:1], 80
    s_load_dwordx2 s[24:25], s[0:1], 96
    s_load_dwordx2 s[100:101], s[0:1], 104
    s_load_dwordx4 s[72:75], s[0:1], 40
    s_load_dwordx4 s[32:35], s[0:1], 112
    v_lshrrev_b32 v1, 6, v0
    v_and_b32 v2, 63, v0
    v_readfirstlane_b32 s4, v1
    v_and_b32 v6, 31, v0
    v_lshrrev_b32 v7, 5, v0
    s_lshr_b32 s40, s2, 3
    s_bfe_u32 s41, s2, 0x20001
    s_and_b32 s42, s2, 1
    s_lshl_b32 s42, s42, 3
    v_add_u32 v8, s42, v7
    v_lshrrev_b32 v9, 2, v8
    v_lshlrev_b32 v9, 4, v9
    v_and_b32 v10, 3, v8
    v_add_u32 v9, v9, v10
    s_lshl_b32 s43, s41, 2
    s_lshl_b32 s44, s40, 6
    s_add_u32 s43, s43, s44
    v_add_u32 v9, s43, v9
    v_cmp_gt_u32 vcc, 24, v6
    v_mov_b32 v11, 0x7f000000
    v_mul_u32_u24 v10, 1152, v9
    v_lshl_add_u32 v10, v6, 4, v10
    v_cndmask_b32 v10, v11, v10, vcc
    v_cndmask_b32 v12, 0, 1.0, vcc
    s_waitcnt lgkmcnt(0)
    s_mov_b32 s48, s16
    s_mov_b32 s49, s17
    s_mov_b32 s50, 0x240000
    s_mov_b32 s51, 0x20000
    buffer_load_dwordx4 v[16:19], v10, s[48:51], 0 offen offset:0 nt
    buffer_load_dwordx4 v[20:23], v10, s[48:51], 0 offen offset:384 nt
    buffer_load_dwordx4 v[24:27], v10, s[48:51], 0 offen offset:768 nt
    s_mov_b32 s52, s18
    s_mov_b32 s53, s19
    s_mov_b32 s54, 0x480
    s_mov_b32 s55, 0x20000
    s_mov_b32 s56, s32
    s_mov_b32 s57, s33
    s_mov_b32 s58, 0x100
    s_mov_b32 s59, 0x20000
    s_mov_b64 s[32:33], s[34:35]
    v_lshlrev_b32 v10, 4, v6
    v_cndmask_b32 v10, v11, v10, vcc
    s_or_b32 s3, s2, s4
    s_cmp_lg_u32 s3, 0
    s_cbranch_scc1 parallel_n3
    s_memrealtime s[66:67]
    s_waitcnt lgkmcnt(0)
    s_or_b32 s3, s66, 1
    v_mov_b32 v13, s3
    v_mov_b32 v14, 0
    buffer_store_dword v13, v14, s[56:59], 0 offen sc1
parallel_n3:
    buffer_load_dwordx4 v[28:31], v10, s[52:55], 0 offen offset:0
    buffer_load_dwordx4 v[32:35], v10, s[52:55], 0 offen offset:384
    buffer_load_dwordx4 v[36:39], v10, s[52:55], 0 offen offset:768
    v_and_b32 v3, 15, v0
    v_bfe_u32 v4, v0, 4, 2
    s_and_b32 s5, s2, 1
    s_bfe_u32 s6, s2, 0x20001
    s_lshr_b32 s7, s2, 3
    v_lshlrev_b32 v5, 4, v2
    s_getpc_b64 s[60:61]
parallel_pc4:
    s_add_u32 s60, s60, parallel_sum__ssm_conv_s5__glu_gated_bilinear__prompt_kernel-parallel_pc4
    s_addc_u32 s61, s61, -1
    s_mov_b32 s62, code_end-parallel_sum__ssm_conv_s5__glu_gated_bilinear__prompt_kernel
    s_mov_b32 s63, 0x20000
    s_lshl_b32 s64, s7, 2
    s_add_u32 s64, s64, s4
    s_mul_i32 s64, s64, 768
    v_min_u32 v110, 5, v2
    v_lshlrev_b32 v110, 7, v110
    buffer_load_dword v111, v110, s[60:63], s64 offen
    s_cmp_ge_u32 s7, 24
    s_cbranch_scc1 parallel_ssm2
    s_and_b32 s8, s7, 3
    s_lshl_b32 s9, s5, 2
    s_add_u32 s8, s8, s9
    s_lshr_b32 s9, s7, 2
    s_mul_i32 s10, s6, 6
    s_add_u32 s10, s10, s9
    s_lshl_b32 s13, s8, 2
    s_add_u32 s13, s13, s4
    v_lshrrev_b32 v107, 3, v2
    v_and_b32 v108, 7, v2
    s_lshl_b32 s28, s4, 12
    s_cmp_ge_u32 s4, 2
    s_cselect_b32 s26, s22, s20
    s_cselect_b32 s27, s23, s21
    v_min_u32 v104, 35, v2
    v_cmp_lt_u32 s[60:61], 17, v104
    v_mov_b32 v105, 6912
    v_lshlrev_b32 v104, 7, v104
    v_cndmask_b32 v105, 0, v105, s[60:61]
    v_add_u32 v104, v104, v105
    s_mov_b32 s60, s26
    s_mov_b32 s61, s27
    s_mov_b32 s62, 5308416
    s_mov_b32 s63, 0x20000
    s_mul_i32 s94, s5, 96
    s_lshl_b32 s95, s7, 2
    s_add_u32 s94, s94, s95
    s_and_b32 s95, s4, 1
    s_lshl_b32 s95, s95, 1
    s_add_u32 s94, s94, s95
    s_mul_i32 s94, s94, 9216
    s_mul_i32 s95, s6, 2304
    s_add_u32 s94, s94, s95
    buffer_load_dword v111, v104, s[60:63], s94 offen
    s_add_u32 s94, s94, 1769472
    v_and_b32 v109, 2, v107
    v_xor_b32 v108, v108, v109
    v_mul_u32_u24 v107, 9216, v107
    v_lshl_add_u32 v96, v108, 4, v107
    v_xor_b32 v108, 4, v108
    v_lshl_add_u32 v97, v108, 4, v107
    v_add_u32 v97, 72704, v97
    v_add_u32 v98, 145408, v96
    v_add_u32 v99, 145408, v97
    s_and_b32 s12, s4, 1
    s_mul_i32 s14, s12, 294912
    s_mul_i32 s15, s10, 384
    s_add_u32 s14, s14, s15
    s_sub_u32 s15, 5308416, s14
    s_add_u32 s36, s26, s14
    s_addc_u32 s37, s27, 0
    s_mov_b32 s38, s15
    s_mov_b32 s39, 0x20000
    s_and_b32 s11, s7, 3
    s_add_u32 s11, s11, s9
    s_cmp_ge_u32 s11, 3
    s_cselect_b32 s64, 3, 0
    s_sub_u32 s11, s11, s64
    s_cmp_ge_u32 s11, 3
    s_cselect_b32 s64, 3, 0
    s_sub_u32 s11, s11, s64
    s_mul_i32 s76, s11, 589824
    s_add_u32 s79, s76, 1769472
    s_add_u32 s82, s76, 3538944
    s_mul_i32 s85, s11, 8192
    s_add_u32 s88, s85, 24576
    s_add_u32 s91, s85, 49152
    s_add_u32 s11, s11, 1
    s_cmp_eq_u32 s11, 3
    s_cselect_b32 s11, 0, s11
    s_mul_i32 s77, s11, 589824
    s_add_u32 s80, s77, 1769472
    s_add_u32 s83, s77, 3538944
    s_mul_i32 s86, s11, 8192
    s_add_u32 s89, s86, 24576
    s_add_u32 s92, s86, 49152
    s_add_u32 s11, s11, 1
    s_cmp_eq_u32 s11, 3
    s_cselect_b32 s11, 0, s11
    s_mul_i32 s78, s11, 589824
    s_add_u32 s81, s78, 1769472
    s_add_u32 s84, s78, 3538944
    s_mul_i32 s87, s11, 8192
    s_add_u32 s90, s87, 24576
    s_add_u32 s93, s87, 49152
    s_mov_b32 s48, s32
    s_mov_b32 s49, s33
    s_mov_b32 s50, 0x240000
    s_mov_b32 s51, 0x20000
    s_mov_b32 s45, 0xffff0000
    v_lshlrev_b32 v13, 7, v6
    v_lshl_add_u32 v13, v7, 4, v13
    v_add_u32 v13, 147456, v13
    v_add_u32 v14, 6144, v13
    v_cndmask_b32 v13, v14, v13, vcc
    s_waitcnt vmcnt(2)
    v_lshlrev_b32 v40, 16, v16
    v_and_b32 v41, s45, v16
    v_lshlrev_b32 v42, 16, v17
    v_and_b32 v43, s45, v17
    v_lshlrev_b32 v44, 16, v18
    v_and_b32 v45, s45, v18
    v_lshlrev_b32 v46, 16, v19
    v_and_b32 v47, s45, v19
    v_lshlrev_b32 v48, 16, v20
    v_and_b32 v49, s45, v20
    v_lshlrev_b32 v50, 16, v21
    v_and_b32 v51, s45, v21
    v_lshlrev_b32 v52, 16, v22
    v_and_b32 v53, s45, v22
    v_lshlrev_b32 v54, 16, v23
    v_and_b32 v55, s45, v23
    v_lshlrev_b32 v56, 16, v24
    v_and_b32 v57, s45, v24
    v_lshlrev_b32 v58, 16, v25
    v_and_b32 v59, s45, v25
    v_lshlrev_b32 v60, 16, v26
    v_and_b32 v61, s45, v26
    v_lshlrev_b32 v62, 16, v27
    v_and_b32 v63, s45, v27
    v_pk_add_f32 v[92:93], v[40:41], v[42:43]
    v_pk_add_f32 v[94:95], v[44:45], v[46:47]
    v_pk_add_f32 v[92:93], v[92:93], v[48:49]
    v_pk_add_f32 v[94:95], v[94:95], v[50:51]
    v_pk_add_f32 v[92:93], v[92:93], v[52:53]
    v_pk_add_f32 v[94:95], v[94:95], v[54:55]
    v_pk_add_f32 v[92:93], v[92:93], v[56:57]
    v_pk_add_f32 v[94:95], v[94:95], v[58:59]
    v_pk_add_f32 v[92:93], v[92:93], v[60:61]
    v_pk_add_f32 v[94:95], v[94:95], v[62:63]
    v_pk_add_f32 v[92:93], v[92:93], v[94:95]
    v_add_f32 v92, v92, v93
    s_nop 1
    v_add_f32_dpp v92, v92, v92 row_ror:8 row_mask:0xf bank_mask:0xf
    s_nop 1
    v_add_f32_dpp v92, v92, v92 row_ror:4 row_mask:0xf bank_mask:0xf
    s_nop 1
    v_add_f32_dpp v92, v92, v92 row_ror:2 row_mask:0xf bank_mask:0xf
    s_nop 1
    v_add_f32_dpp v92, v92, v92 row_ror:1 row_mask:0xf bank_mask:0xf
    v_mov_b32 v93, v92
    s_nop 1
    v_permlane16_swap_b32 v92, v93
    v_add_f32 v92, v92, v93
    v_mul_f32 v92, 0x3ae38e39, v92
    v_cvt_pk_bf16_f32 v93, v92, v92
    v_lshlrev_b32 v90, 16, v93
    v_sub_f32 v88, v92, v90
    v_pk_add_f32 v[64:65], v[40:41], v[90:91] op_sel_hi:[1,0] neg_lo:[0,1] neg_hi:[0,1]
    v_pk_add_f32 v[66:67], v[42:43], v[90:91] op_sel_hi:[1,0] neg_lo:[0,1] neg_hi:[0,1]
    v_pk_add_f32 v[68:69], v[44:45], v[90:91] op_sel_hi:[1,0] neg_lo:[0,1] neg_hi:[0,1]
    v_pk_add_f32 v[70:71], v[46:47], v[90:91] op_sel_hi:[1,0] neg_lo:[0,1] neg_hi:[0,1]
    v_pk_add_f32 v[72:73], v[48:49], v[90:91] op_sel_hi:[1,0] neg_lo:[0,1] neg_hi:[0,1]
    v_pk_add_f32 v[74:75], v[50:51], v[90:91] op_sel_hi:[1,0] neg_lo:[0,1] neg_hi:[0,1]
    v_pk_add_f32 v[76:77], v[52:53], v[90:91] op_sel_hi:[1,0] neg_lo:[0,1] neg_hi:[0,1]
    v_pk_add_f32 v[78:79], v[54:55], v[90:91] op_sel_hi:[1,0] neg_lo:[0,1] neg_hi:[0,1]
    v_pk_add_f32 v[80:81], v[56:57], v[90:91] op_sel_hi:[1,0] neg_lo:[0,1] neg_hi:[0,1]
    v_pk_add_f32 v[82:83], v[58:59], v[90:91] op_sel_hi:[1,0] neg_lo:[0,1] neg_hi:[0,1]
    v_pk_add_f32 v[84:85], v[60:61], v[90:91] op_sel_hi:[1,0] neg_lo:[0,1] neg_hi:[0,1]
    v_pk_add_f32 v[86:87], v[62:63], v[90:91] op_sel_hi:[1,0] neg_lo:[0,1] neg_hi:[0,1]
    v_pk_mul_f32 v[92:93], v[64:65], v[64:65]
    v_pk_mul_f32 v[94:95], v[66:67], v[66:67]
    v_pk_fma_f32 v[92:93], v[68:69], v[68:69], v[92:93]
    v_pk_fma_f32 v[94:95], v[70:71], v[70:71], v[94:95]
    v_pk_fma_f32 v[92:93], v[72:73], v[72:73], v[92:93]
    v_pk_fma_f32 v[94:95], v[74:75], v[74:75], v[94:95]
    v_pk_fma_f32 v[92:93], v[76:77], v[76:77], v[92:93]
    v_pk_fma_f32 v[94:95], v[78:79], v[78:79], v[94:95]
    v_pk_fma_f32 v[92:93], v[80:81], v[80:81], v[92:93]
    v_pk_fma_f32 v[94:95], v[82:83], v[82:83], v[94:95]
    v_pk_fma_f32 v[92:93], v[84:85], v[84:85], v[92:93]
    v_pk_fma_f32 v[94:95], v[86:87], v[86:87], v[94:95]
    v_pk_add_f32 v[92:93], v[92:93], v[94:95]
    v_add_f32 v92, v92, v93
    v_mul_f32 v92, v92, v12
    v_cvt_pk_bf16_f32 v16, v64, v65
    v_cvt_pk_bf16_f32 v17, v66, v67
    v_cvt_pk_bf16_f32 v18, v68, v69
    v_cvt_pk_bf16_f32 v19, v70, v71
    v_cvt_pk_bf16_f32 v20, v72, v73
    v_cvt_pk_bf16_f32 v21, v74, v75
    v_cvt_pk_bf16_f32 v22, v76, v77
    v_cvt_pk_bf16_f32 v23, v78, v79
    v_cvt_pk_bf16_f32 v24, v80, v81
    v_cvt_pk_bf16_f32 v25, v82, v83
    v_cvt_pk_bf16_f32 v26, v84, v85
    v_cvt_pk_bf16_f32 v27, v86, v87
    v_add_f32_dpp v92, v92, v92 row_ror:8 row_mask:0xf bank_mask:0xf
    s_nop 1
    v_add_f32_dpp v92, v92, v92 row_ror:4 row_mask:0xf bank_mask:0xf
    s_nop 1
    v_add_f32_dpp v92, v92, v92 row_ror:2 row_mask:0xf bank_mask:0xf
    s_nop 1
    v_add_f32_dpp v92, v92, v92 row_ror:1 row_mask:0xf bank_mask:0xf
    v_mov_b32 v93, v92
    s_nop 1
    v_permlane16_swap_b32 v92, v93
    v_add_f32 v92, v92, v93
    v_mul_f32 v92, 0x3ae38e39, v92
    v_fma_f32 v92, -v88, v88, v92
    v_max_f32 v92, 0, v92
    v_cvt_pk_bf16_f32 v92, v92, v92
    v_lshlrev_b32 v92, 16, v92
    v_add_f32 v92, 0x3727c5ac, v92
    v_cvt_pk_bf16_f32 v92, v92, v92
    v_lshlrev_b32 v92, 16, v92
    v_sqrt_f32 v92, v92
    v_lshlrev_b32 v64, 16, v16
    v_and_b32 v65, s45, v16
    v_lshlrev_b32 v66, 16, v17
    v_and_b32 v67, s45, v17
    v_lshlrev_b32 v68, 16, v18
    v_and_b32 v69, s45, v18
    v_lshlrev_b32 v70, 16, v19
    v_and_b32 v71, s45, v19
    v_lshlrev_b32 v72, 16, v20
    v_and_b32 v73, s45, v20
    v_lshlrev_b32 v74, 16, v21
    v_and_b32 v75, s45, v21
    v_lshlrev_b32 v76, 16, v22
    v_and_b32 v77, s45, v22
    v_lshlrev_b32 v78, 16, v23
    v_and_b32 v79, s45, v23
    v_lshlrev_b32 v80, 16, v24
    v_and_b32 v81, s45, v24
    v_lshlrev_b32 v82, 16, v25
    v_and_b32 v83, s45, v25
    v_lshlrev_b32 v84, 16, v26
    v_and_b32 v85, s45, v26
    v_lshlrev_b32 v86, 16, v27
    v_and_b32 v87, s45, v27
    v_cvt_pk_bf16_f32 v92, v92, v92
    v_lshlrev_b32 v92, 16, v92
    v_rcp_f32 v92, v92
    s_nop 0
    v_pk_mul_f32 v[64:65], v[64:65], v[92:93] op_sel_hi:[1,0]
    v_pk_mul_f32 v[66:67], v[66:67], v[92:93] op_sel_hi:[1,0]
    v_pk_mul_f32 v[68:69], v[68:69], v[92:93] op_sel_hi:[1,0]
    v_pk_mul_f32 v[70:71], v[70:71], v[92:93] op_sel_hi:[1,0]
    v_cvt_pk_bf16_f32 v16, v64, v65
    v_cvt_pk_bf16_f32 v17, v66, v67
    v_cvt_pk_bf16_f32 v18, v68, v69
    v_cvt_pk_bf16_f32 v19, v70, v71
    ds_write_b128 v13, v[16:19] offset:0
    v_pk_mul_f32 v[72:73], v[72:73], v[92:93] op_sel_hi:[1,0]
    v_pk_mul_f32 v[74:75], v[74:75], v[92:93] op_sel_hi:[1,0]
    v_pk_mul_f32 v[76:77], v[76:77], v[92:93] op_sel_hi:[1,0]
    v_pk_mul_f32 v[78:79], v[78:79], v[92:93] op_sel_hi:[1,0]
    v_cvt_pk_bf16_f32 v20, v72, v73
    v_cvt_pk_bf16_f32 v21, v74, v75
    v_cvt_pk_bf16_f32 v22, v76, v77
    v_cvt_pk_bf16_f32 v23, v78, v79
    ds_write_b128 v13, v[20:23] offset:3072
    v_pk_mul_f32 v[80:81], v[80:81], v[92:93] op_sel_hi:[1,0]
    v_pk_mul_f32 v[82:83], v[82:83], v[92:93] op_sel_hi:[1,0]
    v_pk_mul_f32 v[84:85], v[84:85], v[92:93] op_sel_hi:[1,0]
    v_pk_mul_f32 v[86:87], v[86:87], v[92:93] op_sel_hi:[1,0]
    v_cvt_pk_bf16_f32 v24, v80, v81
    v_cvt_pk_bf16_f32 v25, v82, v83
    v_cvt_pk_bf16_f32 v26, v84, v85
    v_cvt_pk_bf16_f32 v27, v86, v87
    ds_write_b128 v13, v[24:27] offset:6144
    v_lshrrev_b32 v14, 5, v2
    v_lshlrev_b32 v14, 12, v14
    v_bfe_u32 v15, v0, 3, 2
    v_lshl_add_u32 v14, v15, 8, v14
    v_and_b32 v15, 7, v0
    v_lshl_add_u32 v14, v15, 4, v14
    s_mul_i32 s44, s4, 3072
    s_add_u32 s44, s44, 147456
    v_add_u32 v15, s44, v5
    s_mul_i32 s43, s40, 73728
    s_lshl_b32 s44, s41, 10
    s_add_u32 s43, s43, s44
    s_lshl_b32 s44, s42, 4
    s_add_u32 s43, s43, s44
    s_mul_i32 s44, s4, 24576
    s_add_u32 s43, s43, s44
    s_cmp_eq_u32 s4, 3
    s_cselect_b32 s43, 0x7f000000, s43
    s_add_u32 s44, s43, 8192
    s_add_u32 s46, s43, 16384
    v_mov_b32 v88, 0
    v_mov_b32 v91, 158720
    ds_write_b32 v91, v88
    buffer_load_dword v89, v88, s[56:59], 0 offen sc1
    s_waitcnt lgkmcnt(0)
    s_barrier
    ds_read_b128 v[64:67], v15 offset:0
    ds_read_b128 v[68:71], v15 offset:1024
    ds_read_b128 v[72:75], v15 offset:2048
    s_add_u32 s52, s32, 0x1c00000
    s_addc_u32 s53, s33, 0
    s_mov_b32 s54, 0x240000
    s_mov_b32 s55, 0x20000
    v_mul_u32_u24 v10, 1152, v9
    v_lshl_add_u32 v10, v6, 4, v10
    v_cndmask_b32 v10, v11, v10, vcc
    s_waitcnt lgkmcnt(2)
    buffer_store_dwordx4 v[64:67], v14, s[48:51], s43 offen sc1
    s_waitcnt lgkmcnt(1)
    buffer_store_dwordx4 v[68:71], v14, s[48:51], s44 offen sc1
    s_waitcnt lgkmcnt(0)
    buffer_store_dwordx4 v[72:75], v14, s[48:51], s46 offen sc1
    v_lshlrev_b32 v78, 16, v16
    v_and_b32 v79, s45, v16
    v_lshlrev_b32 v80, 16, v28
    v_and_b32 v81, s45, v28
    v_pk_mul_f32 v[78:79], v[78:79], v[80:81]
    v_cvt_pk_bf16_f32 v80, v78, v79
    v_lshlrev_b32 v78, 16, v80
    v_and_b32 v79, s45, v80
    v_pk_add_f32 v[78:79], v[40:41], v[78:79]
    v_cvt_pk_bf16_f32 v40, v78, v79
    v_lshlrev_b32 v82, 16, v17
    v_and_b32 v83, s45, v17
    v_lshlrev_b32 v84, 16, v29
    v_and_b32 v85, s45, v29
    v_pk_mul_f32 v[82:83], v[82:83], v[84:85]
    v_cvt_pk_bf16_f32 v84, v82, v83
    v_lshlrev_b32 v82, 16, v84
    v_and_b32 v83, s45, v84
    v_pk_add_f32 v[82:83], v[42:43], v[82:83]
    v_cvt_pk_bf16_f32 v41, v82, v83
    v_lshlrev_b32 v78, 16, v18
    v_and_b32 v79, s45, v18
    v_lshlrev_b32 v80, 16, v30
    v_and_b32 v81, s45, v30
    v_pk_mul_f32 v[78:79], v[78:79], v[80:81]
    v_cvt_pk_bf16_f32 v80, v78, v79
    v_lshlrev_b32 v78, 16, v80
    v_and_b32 v79, s45, v80
    v_pk_add_f32 v[78:79], v[44:45], v[78:79]
    v_cvt_pk_bf16_f32 v42, v78, v79
    v_lshlrev_b32 v82, 16, v19
    v_and_b32 v83, s45, v19
    v_lshlrev_b32 v84, 16, v31
    v_and_b32 v85, s45, v31
    v_pk_mul_f32 v[82:83], v[82:83], v[84:85]
    v_cvt_pk_bf16_f32 v84, v82, v83
    v_lshlrev_b32 v82, 16, v84
    v_and_b32 v83, s45, v84
    v_pk_add_f32 v[82:83], v[46:47], v[82:83]
    v_cvt_pk_bf16_f32 v43, v82, v83
    v_lshlrev_b32 v78, 16, v20
    v_and_b32 v79, s45, v20
    v_lshlrev_b32 v80, 16, v32
    v_and_b32 v81, s45, v32
    v_pk_mul_f32 v[78:79], v[78:79], v[80:81]
    v_cvt_pk_bf16_f32 v80, v78, v79
    v_lshlrev_b32 v78, 16, v80
    v_and_b32 v79, s45, v80
    v_pk_add_f32 v[78:79], v[48:49], v[78:79]
    v_cvt_pk_bf16_f32 v44, v78, v79
    v_lshlrev_b32 v82, 16, v21
    v_and_b32 v83, s45, v21
    v_lshlrev_b32 v84, 16, v33
    v_and_b32 v85, s45, v33
    v_pk_mul_f32 v[82:83], v[82:83], v[84:85]
    v_cvt_pk_bf16_f32 v84, v82, v83
    v_lshlrev_b32 v82, 16, v84
    v_and_b32 v83, s45, v84
    v_pk_add_f32 v[82:83], v[50:51], v[82:83]
    v_cvt_pk_bf16_f32 v45, v82, v83
    v_lshlrev_b32 v78, 16, v22
    v_and_b32 v79, s45, v22
    v_lshlrev_b32 v80, 16, v34
    v_and_b32 v81, s45, v34
    v_pk_mul_f32 v[78:79], v[78:79], v[80:81]
    v_cvt_pk_bf16_f32 v80, v78, v79
    v_lshlrev_b32 v78, 16, v80
    v_and_b32 v79, s45, v80
    v_pk_add_f32 v[78:79], v[52:53], v[78:79]
    v_cvt_pk_bf16_f32 v46, v78, v79
    v_lshlrev_b32 v82, 16, v23
    v_and_b32 v83, s45, v23
    v_lshlrev_b32 v84, 16, v35
    v_and_b32 v85, s45, v35
    v_pk_mul_f32 v[82:83], v[82:83], v[84:85]
    v_cvt_pk_bf16_f32 v84, v82, v83
    v_lshlrev_b32 v82, 16, v84
    v_and_b32 v83, s45, v84
    v_pk_add_f32 v[82:83], v[54:55], v[82:83]
    v_cvt_pk_bf16_f32 v47, v82, v83
    v_lshlrev_b32 v78, 16, v24
    v_and_b32 v79, s45, v24
    v_lshlrev_b32 v80, 16, v36
    v_and_b32 v81, s45, v36
    v_pk_mul_f32 v[78:79], v[78:79], v[80:81]
    v_cvt_pk_bf16_f32 v80, v78, v79
    v_lshlrev_b32 v78, 16, v80
    v_and_b32 v79, s45, v80
    v_pk_add_f32 v[78:79], v[56:57], v[78:79]
    v_cvt_pk_bf16_f32 v48, v78, v79
    v_lshlrev_b32 v82, 16, v25
    v_and_b32 v83, s45, v25
    v_lshlrev_b32 v84, 16, v37
    v_and_b32 v85, s45, v37
    v_pk_mul_f32 v[82:83], v[82:83], v[84:85]
    v_cvt_pk_bf16_f32 v84, v82, v83
    v_lshlrev_b32 v82, 16, v84
    v_and_b32 v83, s45, v84
    v_pk_add_f32 v[82:83], v[58:59], v[82:83]
    v_cvt_pk_bf16_f32 v49, v82, v83
    v_lshlrev_b32 v78, 16, v26
    v_and_b32 v79, s45, v26
    v_lshlrev_b32 v80, 16, v38
    v_and_b32 v81, s45, v38
    v_pk_mul_f32 v[78:79], v[78:79], v[80:81]
    v_cvt_pk_bf16_f32 v80, v78, v79
    v_lshlrev_b32 v78, 16, v80
    v_and_b32 v79, s45, v80
    v_pk_add_f32 v[78:79], v[60:61], v[78:79]
    v_cvt_pk_bf16_f32 v50, v78, v79
    v_lshlrev_b32 v82, 16, v27
    v_and_b32 v83, s45, v27
    v_lshlrev_b32 v84, 16, v39
    v_and_b32 v85, s45, v39
    v_pk_mul_f32 v[82:83], v[82:83], v[84:85]
    v_cvt_pk_bf16_f32 v84, v82, v83
    v_lshlrev_b32 v82, 16, v84
    v_and_b32 v83, s45, v84
    v_pk_add_f32 v[82:83], v[62:63], v[82:83]
    v_cvt_pk_bf16_f32 v51, v82, v83
    buffer_store_dwordx4 v[40:43], v10, s[52:55], 0 offen offset:0 sc1
    buffer_store_dwordx4 v[44:47], v10, s[52:55], 0 offen offset:384 sc1
    buffer_store_dwordx4 v[48:51], v10, s[52:55], 0 offen offset:768 sc1
    s_add_u32 s48, s32, 0x2280000
    s_addc_u32 s49, s33, 0
    s_mov_b32 s50, 0x100000
    s_mov_b32 s51, 0x20000
    s_waitcnt vmcnt(3)
    s_mov_b32 s44, 0
parallel_nl5:
    v_readfirstlane_b32 s3, v89
    s_nop 0
    s_cmp_lg_u32 s3, 0
    s_cbranch_scc1 parallel_no6
    s_add_u32 s44, s44, 1
    s_cmp_gt_u32 s44, 131072
    s_cbranch_scc1 parallel_no6
    v_mov_b32 v88, 0
    buffer_load_dword v89, v88, s[56:59], 0 offen sc1
    s_waitcnt vmcnt(0)
    s_branch parallel_nl5
parallel_no6:
    v_mov_b32 v91, s3
    v_mov_b32 v88, 158720
    v_mov_b32 v90, 1
    s_mov_b64 exec, 1
    ds_add_rtn_u32 v90, v88, v90
    s_mov_b64 exec, -1
    s_lshl_b32 s43, s2, 7
    s_add_u32 s43, s43, 131072
    v_lshlrev_b32 v88, 2, v6
    s_waitcnt lgkmcnt(0)
    v_readfirstlane_b32 s29, v90
    s_nop 0
    s_cmp_lg_u32 s29, 3
    s_cbranch_scc1 parallel_pf7
    buffer_store_dword v91, v88, s[48:51], s43 offen sc1
parallel_pf7:
    s_add_u32 m0, s28, 49152
    s_add_u32 s30, s76, 0
    buffer_load_dwordx4 v96, s[36:39], s30 offen offset:0 lds
    buffer_load_dwordx4 v97, s[36:39], s30 offen offset:1024 lds
    buffer_load_dwordx4 v98, s[36:39], s30 offen offset:2048 lds
    buffer_load_dwordx4 v99, s[36:39], s30 offen offset:3072 lds
    s_add_u32 m0, s28, 65536
    s_add_u32 s30, s77, 0
    buffer_load_dwordx4 v96, s[36:39], s30 offen offset:0 lds
    buffer_load_dwordx4 v97, s[36:39], s30 offen offset:1024 lds
    buffer_load_dwordx4 v98, s[36:39], s30 offen offset:2048 lds
    buffer_load_dwordx4 v99, s[36:39], s30 offen offset:3072 lds
    s_add_u32 m0, s28, 81920
    s_add_u32 s30, s78, 0
    buffer_load_dwordx4 v96, s[36:39], s30 offen offset:0 lds
    buffer_load_dwordx4 v97, s[36:39], s30 offen offset:1024 lds
    buffer_load_dwordx4 v98, s[36:39], s30 offen offset:2048 lds
    buffer_load_dwordx4 v99, s[36:39], s30 offen offset:3072 lds
    v_mov_b32 v34, v104
    s_mov_b32 s52, s60
    s_mov_b32 s53, s61
    s_mov_b32 s54, s62
    s_mov_b32 s55, 0x20000
    v_mov_b32 v8, v96
    v_mov_b32 v9, v97
    v_mov_b32 v10, v98
    v_mov_b32 v11, v99
    s_mul_i32 s14, s13, 73728
    s_add_u32 s68, s32, s14
    s_addc_u32 s69, s33, 0
    s_mov_b32 s70, 0x12000
    s_mov_b32 s71, 0x20000
    s_mov_b32 s97, s13
    v_bfe_u32 v30, v0, 2, 2
    v_lshl_add_u32 v31, v4, 3, v30
    v_lshlrev_b32 v31, 7, v31
    v_and_b32 v28, 3, v0
    v_lshl_add_u32 v31, v28, 3, v31
    v_lshrrev_b32 v30, 1, v30
    v_and_b32 v28, 1, v4
    v_lshl_add_u32 v30, v28, 1, v30
    v_xor_b32 v28, 0, v30
    v_lshl_add_u32 v16, v28, 5, v31
    v_xor_b32 v28, 1, v30
    v_lshl_add_u32 v17, v28, 5, v31
    v_xor_b32 v28, 2, v30
    v_lshl_add_u32 v18, v28, 5, v31
    v_xor_b32 v28, 3, v30
    v_lshl_add_u32 v19, v28, 5, v31
    v_add_u32 v20, 0x10000, v16
    v_add_u32 v24, 0x20000, v16
    v_add_u32 v21, 0x10000, v17
    v_add_u32 v25, 0x20000, v17
    v_add_u32 v22, 0x10000, v18
    v_add_u32 v26, 0x20000, v18
    v_add_u32 v23, 0x10000, v19
    v_add_u32 v27, 0x20000, v19
    v_lshlrev_b32 v30, 9, v4
    v_lshl_add_u32 v30, v3, 4, v30
    s_mul_i32 s14, s13, 360
    s_mul_i32 s15, s10, 6
    s_add_u32 s14, s14, s15
    s_lshl_b32 s14, s14, 11
    s_add_u32 s14, s14, 0x300000
    s_add_u32 s44, s32, s14
    s_addc_u32 s45, s33, 0
    s_mov_b32 s46, 380928
    s_mov_b32 s47, 0x20000
    v_mov_b32 v36, s3
    v_mov_b32 v37, 0
    s_lshl_b32 s56, s13, 5
    s_add_u32 s56, s56, s10
    s_lshl_b32 s56, s56, 7
    s_add_u32 s56, s56, 262144
    s_lshl_b32 s57, s2, 7
    s_lshl_b32 s12, s4, 2
    s_add_u32 s57, s57, s12
    s_lshl_b32 s15, s7, 2
    s_add_u32 s15, s15, s4
    s_mul_i32 s62, s15, 13824
    s_mul_i32 s14, s5, 6912
    s_add_u32 s62, s62, s14
    s_mul_i32 s14, s6, 1327104
    s_add_u32 s16, s24, s14
    s_addc_u32 s17, s25, 0
    s_mov_b32 s18, 1327104
    s_mov_b32 s19, 0x20000
    s_cmp_ge_u32 s5, 1
    s_cselect_b32 s20, s74, s72
    s_cselect_b32 s21, s75, s73
    s_mul_i32 s63, s6, 96
    s_add_u32 s63, s63, s15
    s_mul_i32 s63, s63, 1792
    s_mov_b32 s22, 663552
    s_mov_b32 s23, 0x20000
    s_and_b32 s8, s7, 7
    s_lshl_b32 s9, s5, 3
    s_add_u32 s8, s8, s9
    s_lshr_b32 s9, s7, 3
    s_mul_i32 s14, s8, 3
    s_add_u32 s14, s14, s9
    s_mul_i32 s12, s14, 196608
    s_mul_i32 s15, s4, 3072
    s_add_u32 s12, s12, s15
    s_add_u32 s12, s12, 0x2400000
    s_add_u32 s72, s32, s12
    s_addc_u32 s73, s33, 0
    s_mov_b32 s74, 187392
    s_mov_b32 s75, 0x20000
    s_xor_b32 s12, s6, 1
    s_mul_i32 s12, s12, 49152
    s_add_u32 s64, s12, 0
    s_xor_b32 s12, s6, 2
    s_mul_i32 s12, s12, 49152
    s_add_u32 s65, s12, 12288
    s_xor_b32 s12, s6, 3
    s_mul_i32 s12, s12, 49152
    s_add_u32 s66, s12, 24576
    s_and_b32 s12, s4, 1
    s_lshl_b32 s13, s8, 1
    s_add_u32 s13, s13, s12
    s_lshr_b32 s10, s4, 1
    s_lshl_b32 s14, s13, 5
    s_mul_i32 s15, s6, 6
    s_add_u32 s14, s14, s15
    s_mul_i32 s15, s10, 3
    s_add_u32 s14, s14, s15
    s_lshl_b32 s58, s14, 7
    s_add_u32 s58, s58, 262144
    v_min_u32 v38, 2, v2
    v_lshlrev_b32 v38, 7, v38
    v_min_u32 v6, 17, v2
    v_lshlrev_b32 v6, 7, v6
    s_mov_b32 s96, s44
    s_lshl_b32 s43, s97, 10
    s_add_u32 s43, s43, 131072
    v_and_b32 v15, 7, v0
    v_lshlrev_b32 v15, 7, v15
    s_mov_b32 s44, 0
parallel_poll9:
    buffer_load_dwordx4 v[92:95], v15, s[48:51], s43 offen sc1
    s_add_u32 s44, s44, 1
    s_cmp_gt_u32 s44, 131072
    s_waitcnt vmcnt(0)
    s_cbranch_scc1 parallel_lw8
    v_xor_b32 v92, s3, v92
    v_xor_b32 v93, s3, v93
    v_xor_b32 v94, s3, v94
    v_or3_b32 v92, v92, v93, v94
    v_cmp_ne_u32 vcc, 0, v92
    s_cbranch_vccnz parallel_poll9
parallel_lw8:
    s_mov_b32 s44, s96
    v_mov_b32 v12, -1
    v_mov_b32 v13, -1
    v_mov_b32 v14, -1
    v_mov_b32 v15, -1
    s_add_u32 s31, s85, 0
    buffer_load_dwordx4 a[0:3], v5, s[68:71], s31 offen offset:0 sc1
    buffer_load_dwordx4 a[4:7], v5, s[68:71], s31 offen offset:1024 sc1
    buffer_load_dwordx4 a[8:11], v5, s[68:71], s31 offen offset:2048 sc1
    buffer_load_dwordx4 a[12:15], v5, s[68:71], s31 offen offset:3072 sc1
    s_add_u32 s31, s85, 4096
    buffer_load_dwordx4 a[16:19], v5, s[68:71], s31 offen offset:0 sc1
    buffer_load_dwordx4 a[20:23], v5, s[68:71], s31 offen offset:1024 sc1
    buffer_load_dwordx4 a[24:27], v5, s[68:71], s31 offen offset:2048 sc1
    buffer_load_dwordx4 a[28:31], v5, s[68:71], s31 offen offset:3072 sc1
    s_add_u32 s31, s86, 0
    buffer_load_dwordx4 a[32:35], v5, s[68:71], s31 offen offset:0 sc1
    buffer_load_dwordx4 a[36:39], v5, s[68:71], s31 offen offset:1024 sc1
    buffer_load_dwordx4 a[40:43], v5, s[68:71], s31 offen offset:2048 sc1
    buffer_load_dwordx4 a[44:47], v5, s[68:71], s31 offen offset:3072 sc1
    s_add_u32 s31, s86, 4096
    buffer_load_dwordx4 a[48:51], v5, s[68:71], s31 offen offset:0 sc1
    buffer_load_dwordx4 a[52:55], v5, s[68:71], s31 offen offset:1024 sc1
    buffer_load_dwordx4 a[56:59], v5, s[68:71], s31 offen offset:2048 sc1
    buffer_load_dwordx4 a[60:63], v5, s[68:71], s31 offen offset:3072 sc1
    s_add_u32 m0, s28, 98304
    s_add_u32 s30, s79, 0
    buffer_load_dwordx4 v8, s[36:39], s30 offen offset:0 lds
    buffer_load_dwordx4 v9, s[36:39], s30 offen offset:1024 lds
    buffer_load_dwordx4 v10, s[36:39], s30 offen offset:2048 lds
    buffer_load_dwordx4 v11, s[36:39], s30 offen offset:3072 lds
    s_add_u32 m0, s28, 114688
    s_add_u32 s30, s80, 0
    buffer_load_dwordx4 v8, s[36:39], s30 offen offset:0 lds
    buffer_load_dwordx4 v9, s[36:39], s30 offen offset:1024 lds
    buffer_load_dwordx4 v10, s[36:39], s30 offen offset:2048 lds
    buffer_load_dwordx4 v11, s[36:39], s30 offen offset:3072 lds
    s_waitcnt vmcnt(24)
    s_barrier
    ds_read_b64_tr_b16 v[64:65], v16 offset:49152
    ds_read_b64_tr_b16 v[66:67], v16 offset:49664
    ds_read_b64_tr_b16 v[68:69], v16 offset:53248
    ds_read_b64_tr_b16 v[70:71], v16 offset:53760
    ds_read_b64_tr_b16 v[72:73], v16 offset:57344
    ds_read_b64_tr_b16 v[74:75], v16 offset:57856
    ds_read_b64_tr_b16 v[76:77], v16 offset:61440
    ds_read_b64_tr_b16 v[78:79], v16 offset:61952
    ds_read_b64_tr_b16 v[80:81], v17 offset:49152
    ds_read_b64_tr_b16 v[82:83], v17 offset:49664
    ds_read_b64_tr_b16 v[84:85], v17 offset:53248
    ds_read_b64_tr_b16 v[86:87], v17 offset:53760
    s_waitcnt vmcnt(16) lgkmcnt(8)
    v_mfma_f32_16x16x32_bf16 v[96:99], v[64:67], a[0:3], 0
    ds_read_b64_tr_b16 v[88:89], v17 offset:57344
    v_mfma_f32_16x16x32_bf16 v[96:99], v[68:71], a[16:19], v[96:99]
    ds_read_b64_tr_b16 v[90:91], v17 offset:57856
    s_add_u32 s31, s87, 0
    v_mfma_f32_16x16x32_bf16 v[100:103], v[64:67], a[4:7], 0
    buffer_load_dwordx4 a[64:67], v5, s[68:71], s31 offen offset:0 sc1
    v_mfma_f32_16x16x32_bf16 v[100:103], v[68:71], a[20:23], v[100:103]
    v_mfma_f32_16x16x32_bf16 v[104:107], v[64:67], a[8:11], 0
    ds_read_b64_tr_b16 v[92:93], v17 offset:61440
    v_mfma_f32_16x16x32_bf16 v[104:107], v[68:71], a[24:27], v[104:107]
    ds_read_b64_tr_b16 v[94:95], v17 offset:61952
    v_mfma_f32_16x16x32_bf16 v[108:111], v[64:67], a[12:15], 0
    buffer_load_dwordx4 a[68:71], v5, s[68:71], s31 offen offset:1024 sc1
    v_mfma_f32_16x16x32_bf16 v[108:111], v[68:71], a[28:31], v[108:111]
    s_waitcnt lgkmcnt(8)
    v_mfma_f32_16x16x32_bf16 v[160:163], v[72:75], a[0:3], 0
    ds_read_b64_tr_b16 v[64:65], v18 offset:49152
    v_mfma_f32_16x16x32_bf16 v[160:163], v[76:79], a[16:19], v[160:163]
    ds_read_b64_tr_b16 v[66:67], v18 offset:49664
    s_add_u32 s29, s94, 0
    v_mfma_f32_16x16x32_bf16 v[164:167], v[72:75], a[4:7], 0
    buffer_load_dword v35, v34, s[52:55], s29 offen
    v_mfma_f32_16x16x32_bf16 v[164:167], v[76:79], a[20:23], v[164:167]
    v_mfma_f32_16x16x32_bf16 v[168:171], v[72:75], a[8:11], 0
    ds_read_b64_tr_b16 v[68:69], v18 offset:53248
    v_mfma_f32_16x16x32_bf16 v[168:171], v[76:79], a[24:27], v[168:171]
    ds_read_b64_tr_b16 v[70:71], v18 offset:53760
    v_mfma_f32_16x16x32_bf16 v[172:175], v[72:75], a[12:15], 0
    buffer_load_dwordx4 a[72:75], v5, s[68:71], s31 offen offset:2048 sc1
    v_mfma_f32_16x16x32_bf16 v[172:175], v[76:79], a[28:31], v[172:175]
    s_waitcnt lgkmcnt(8)
    v_mfma_f32_16x16x32_bf16 v[112:115], v[80:83], a[0:3], 0
    ds_read_b64_tr_b16 v[72:73], v18 offset:57344
    v_mfma_f32_16x16x32_bf16 v[112:115], v[84:87], a[16:19], v[112:115]
    ds_read_b64_tr_b16 v[74:75], v18 offset:57856
    v_mfma_f32_16x16x32_bf16 v[116:119], v[80:83], a[4:7], 0
    buffer_load_dwordx4 a[76:79], v5, s[68:71], s31 offen offset:3072 sc1
    v_mfma_f32_16x16x32_bf16 v[116:119], v[84:87], a[20:23], v[116:119]
    v_mfma_f32_16x16x32_bf16 v[120:123], v[80:83], a[8:11], 0
    ds_read_b64_tr_b16 v[76:77], v18 offset:61440
    v_mfma_f32_16x16x32_bf16 v[120:123], v[84:87], a[24:27], v[120:123]
    ds_read_b64_tr_b16 v[78:79], v18 offset:61952
    s_add_u32 s31, s87, 4096
    v_mfma_f32_16x16x32_bf16 v[124:127], v[80:83], a[12:15], 0
    buffer_load_dwordx4 a[80:83], v5, s[68:71], s31 offen offset:0 sc1
    v_mfma_f32_16x16x32_bf16 v[124:127], v[84:87], a[28:31], v[124:127]
    s_waitcnt lgkmcnt(8)
    v_mfma_f32_16x16x32_bf16 v[176:179], v[88:91], a[0:3], 0
    ds_read_b64_tr_b16 v[80:81], v19 offset:49152
    v_mfma_f32_16x16x32_bf16 v[176:179], v[92:95], a[16:19], v[176:179]
    ds_read_b64_tr_b16 v[82:83], v19 offset:49664
    v_mfma_f32_16x16x32_bf16 v[180:183], v[88:91], a[4:7], 0
    buffer_load_dwordx4 a[84:87], v5, s[68:71], s31 offen offset:1024 sc1
    v_mfma_f32_16x16x32_bf16 v[180:183], v[92:95], a[20:23], v[180:183]
    v_mfma_f32_16x16x32_bf16 v[184:187], v[88:91], a[8:11], 0
    ds_read_b64_tr_b16 v[84:85], v19 offset:53248
    v_mfma_f32_16x16x32_bf16 v[184:187], v[92:95], a[24:27], v[184:187]
    ds_read_b64_tr_b16 v[86:87], v19 offset:53760
    v_mfma_f32_16x16x32_bf16 v[188:191], v[88:91], a[12:15], 0
    buffer_load_dwordx4 a[88:91], v5, s[68:71], s31 offen offset:2048 sc1
    v_mfma_f32_16x16x32_bf16 v[188:191], v[92:95], a[28:31], v[188:191]
    s_waitcnt lgkmcnt(8)
    v_mfma_f32_16x16x32_bf16 v[128:131], v[64:67], a[0:3], 0
    ds_read_b64_tr_b16 v[88:89], v19 offset:57344
    v_mfma_f32_16x16x32_bf16 v[128:131], v[68:71], a[16:19], v[128:131]
    ds_read_b64_tr_b16 v[90:91], v19 offset:57856
    v_mfma_f32_16x16x32_bf16 v[132:135], v[64:67], a[4:7], 0
    buffer_load_dwordx4 a[92:95], v5, s[68:71], s31 offen offset:3072 sc1
    v_mfma_f32_16x16x32_bf16 v[132:135], v[68:71], a[20:23], v[132:135]
    v_mfma_f32_16x16x32_bf16 v[136:139], v[64:67], a[8:11], 0
    ds_read_b64_tr_b16 v[92:93], v19 offset:61440
    v_mfma_f32_16x16x32_bf16 v[136:139], v[68:71], a[24:27], v[136:139]
    ds_read_b64_tr_b16 v[94:95], v19 offset:61952
    s_add_u32 s31, s88, 0
    v_mfma_f32_16x16x32_bf16 v[140:143], v[64:67], a[12:15], 0
    buffer_load_dwordx4 a[96:99], v5, s[68:71], s31 offen offset:0 sc1
    v_mfma_f32_16x16x32_bf16 v[140:143], v[68:71], a[28:31], v[140:143]
    s_waitcnt lgkmcnt(8)
    v_mfma_f32_16x16x32_bf16 v[192:195], v[72:75], a[0:3], 0
    ds_read_b64_tr_b16 v[64:65], v20 offset:0
    v_mfma_f32_16x16x32_bf16 v[192:195], v[76:79], a[16:19], v[192:195]
    ds_read_b64_tr_b16 v[66:67], v20 offset:512
    v_mfma_f32_16x16x32_bf16 v[196:199], v[72:75], a[4:7], 0
    buffer_load_dwordx4 a[100:103], v5, s[68:71], s31 offen offset:1024 sc1
    v_mfma_f32_16x16x32_bf16 v[196:199], v[76:79], a[20:23], v[196:199]
    v_mfma_f32_16x16x32_bf16 v[200:203], v[72:75], a[8:11], 0
    ds_read_b64_tr_b16 v[68:69], v20 offset:4096
    v_mfma_f32_16x16x32_bf16 v[200:203], v[76:79], a[24:27], v[200:203]
    ds_read_b64_tr_b16 v[70:71], v20 offset:4608
    v_mfma_f32_16x16x32_bf16 v[204:207], v[72:75], a[12:15], 0
    buffer_load_dwordx4 a[104:107], v5, s[68:71], s31 offen offset:2048 sc1
    v_mfma_f32_16x16x32_bf16 v[204:207], v[76:79], a[28:31], v[204:207]
    s_waitcnt lgkmcnt(8)
    v_mfma_f32_16x16x32_bf16 v[144:147], v[80:83], a[0:3], 0
    ds_read_b64_tr_b16 v[72:73], v20 offset:8192
    v_mfma_f32_16x16x32_bf16 v[144:147], v[84:87], a[16:19], v[144:147]
    ds_read_b64_tr_b16 v[74:75], v20 offset:8704
    v_mfma_f32_16x16x32_bf16 v[148:151], v[80:83], a[4:7], 0
    buffer_load_dwordx4 a[108:111], v5, s[68:71], s31 offen offset:3072 sc1
    v_mfma_f32_16x16x32_bf16 v[148:151], v[84:87], a[20:23], v[148:151]
    v_mfma_f32_16x16x32_bf16 v[152:155], v[80:83], a[8:11], 0
    ds_read_b64_tr_b16 v[76:77], v20 offset:12288
    v_mfma_f32_16x16x32_bf16 v[152:155], v[84:87], a[24:27], v[152:155]
    ds_read_b64_tr_b16 v[78:79], v20 offset:12800
    s_add_u32 s31, s88, 4096
    v_mfma_f32_16x16x32_bf16 v[156:159], v[80:83], a[12:15], 0
    buffer_load_dwordx4 a[112:115], v5, s[68:71], s31 offen offset:0 sc1
    v_mfma_f32_16x16x32_bf16 v[156:159], v[84:87], a[28:31], v[156:159]
    s_waitcnt lgkmcnt(8)
    v_mfma_f32_16x16x32_bf16 v[208:211], v[88:91], a[0:3], 0
    ds_read_b64_tr_b16 v[80:81], v21 offset:0
    v_mfma_f32_16x16x32_bf16 v[208:211], v[92:95], a[16:19], v[208:211]
    ds_read_b64_tr_b16 v[82:83], v21 offset:512
    v_mfma_f32_16x16x32_bf16 v[212:215], v[88:91], a[4:7], 0
    buffer_load_dwordx4 a[116:119], v5, s[68:71], s31 offen offset:1024 sc1
    v_mfma_f32_16x16x32_bf16 v[212:215], v[92:95], a[20:23], v[212:215]
    v_mfma_f32_16x16x32_bf16 v[216:219], v[88:91], a[8:11], 0
    ds_read_b64_tr_b16 v[84:85], v21 offset:4096
    v_mfma_f32_16x16x32_bf16 v[216:219], v[92:95], a[24:27], v[216:219]
    ds_read_b64_tr_b16 v[86:87], v21 offset:4608
    v_mfma_f32_16x16x32_bf16 v[220:223], v[88:91], a[12:15], 0
    buffer_load_dwordx4 a[120:123], v5, s[68:71], s31 offen offset:2048 sc1
    v_mfma_f32_16x16x32_bf16 v[220:223], v[92:95], a[28:31], v[220:223]
    s_waitcnt vmcnt(24) lgkmcnt(8)
    v_mfma_f32_16x16x32_bf16 v[96:99], v[64:67], a[32:35], v[96:99]
    ds_read_b64_tr_b16 v[88:89], v21 offset:8192
    v_mfma_f32_16x16x32_bf16 v[96:99], v[68:71], a[48:51], v[96:99]
    ds_read_b64_tr_b16 v[90:91], v21 offset:8704
    v_mfma_f32_16x16x32_bf16 v[100:103], v[64:67], a[36:39], v[100:103]
    buffer_load_dwordx4 a[124:127], v5, s[68:71], s31 offen offset:3072 sc1
    v_mfma_f32_16x16x32_bf16 v[100:103], v[68:71], a[52:55], v[100:103]
    v_mfma_f32_16x16x32_bf16 v[104:107], v[64:67], a[40:43], v[104:107]
    ds_read_b64_tr_b16 v[92:93], v21 offset:12288
    v_mfma_f32_16x16x32_bf16 v[104:107], v[68:71], a[56:59], v[104:107]
    ds_read_b64_tr_b16 v[94:95], v21 offset:12800
    s_add_u32 m0, s28, 131072
    s_add_u32 s30, s81, 0
    v_mfma_f32_16x16x32_bf16 v[108:111], v[64:67], a[44:47], v[108:111]
    buffer_load_dwordx4 v8, s[36:39], s30 offen offset:0 lds
    v_mfma_f32_16x16x32_bf16 v[108:111], v[68:71], a[60:63], v[108:111]
    s_waitcnt lgkmcnt(8)
    v_mfma_f32_16x16x32_bf16 v[160:163], v[72:75], a[32:35], v[160:163]
    ds_read_b64_tr_b16 v[64:65], v22 offset:0
    v_mfma_f32_16x16x32_bf16 v[160:163], v[76:79], a[48:51], v[160:163]
    ds_read_b64_tr_b16 v[66:67], v22 offset:512
    v_mfma_f32_16x16x32_bf16 v[164:167], v[72:75], a[36:39], v[164:167]
    v_mfma_f32_16x16x32_bf16 v[164:167], v[76:79], a[52:55], v[164:167]
    v_mfma_f32_16x16x32_bf16 v[168:171], v[72:75], a[40:43], v[168:171]
    ds_read_b64_tr_b16 v[68:69], v22 offset:4096
    v_mfma_f32_16x16x32_bf16 v[168:171], v[76:79], a[56:59], v[168:171]
    ds_read_b64_tr_b16 v[70:71], v22 offset:4608
    v_mfma_f32_16x16x32_bf16 v[172:175], v[72:75], a[44:47], v[172:175]
    buffer_load_dwordx4 v9, s[36:39], s30 offen offset:1024 lds
    v_mfma_f32_16x16x32_bf16 v[172:175], v[76:79], a[60:63], v[172:175]
    s_waitcnt lgkmcnt(8)
    v_mfma_f32_16x16x32_bf16 v[112:115], v[80:83], a[32:35], v[112:115]
    ds_read_b64_tr_b16 v[72:73], v22 offset:8192
    v_mfma_f32_16x16x32_bf16 v[112:115], v[84:87], a[48:51], v[112:115]
    ds_read_b64_tr_b16 v[74:75], v22 offset:8704
    s_add_u32 s29, s94, 1769472
    v_mfma_f32_16x16x32_bf16 v[116:119], v[80:83], a[36:39], v[116:119]
    buffer_load_dword v35, v34, s[52:55], s29 offen
    v_mfma_f32_16x16x32_bf16 v[116:119], v[84:87], a[52:55], v[116:119]
    v_mfma_f32_16x16x32_bf16 v[120:123], v[80:83], a[40:43], v[120:123]
    ds_read_b64_tr_b16 v[76:77], v22 offset:12288
    v_mfma_f32_16x16x32_bf16 v[120:123], v[84:87], a[56:59], v[120:123]
    ds_read_b64_tr_b16 v[78:79], v22 offset:12800
    v_mfma_f32_16x16x32_bf16 v[124:127], v[80:83], a[44:47], v[124:127]
    buffer_load_dwordx4 v10, s[36:39], s30 offen offset:2048 lds
    v_mfma_f32_16x16x32_bf16 v[124:127], v[84:87], a[60:63], v[124:127]
    s_waitcnt lgkmcnt(8)
    v_mfma_f32_16x16x32_bf16 v[176:179], v[88:91], a[32:35], v[176:179]
    ds_read_b64_tr_b16 v[80:81], v23 offset:0
    v_mfma_f32_16x16x32_bf16 v[176:179], v[92:95], a[48:51], v[176:179]
    ds_read_b64_tr_b16 v[82:83], v23 offset:512
    v_mfma_f32_16x16x32_bf16 v[180:183], v[88:91], a[36:39], v[180:183]
    v_mfma_f32_16x16x32_bf16 v[180:183], v[92:95], a[52:55], v[180:183]
    v_mfma_f32_16x16x32_bf16 v[184:187], v[88:91], a[40:43], v[184:187]
    ds_read_b64_tr_b16 v[84:85], v23 offset:4096
    v_mfma_f32_16x16x32_bf16 v[184:187], v[92:95], a[56:59], v[184:187]
    ds_read_b64_tr_b16 v[86:87], v23 offset:4608
    v_mfma_f32_16x16x32_bf16 v[188:191], v[88:91], a[44:47], v[188:191]
    buffer_load_dwordx4 v11, s[36:39], s30 offen offset:3072 lds
    v_mfma_f32_16x16x32_bf16 v[188:191], v[92:95], a[60:63], v[188:191]
    s_waitcnt lgkmcnt(8)
    v_mfma_f32_16x16x32_bf16 v[128:131], v[64:67], a[32:35], v[128:131]
    ds_read_b64_tr_b16 v[88:89], v23 offset:8192
    v_mfma_f32_16x16x32_bf16 v[128:131], v[68:71], a[48:51], v[128:131]
    ds_read_b64_tr_b16 v[90:91], v23 offset:8704
    s_add_u32 s31, s89, 0
    v_mfma_f32_16x16x32_bf16 v[132:135], v[64:67], a[36:39], v[132:135]
    buffer_load_dwordx4 a[128:131], v5, s[68:71], s31 offen offset:0 sc1
    v_mfma_f32_16x16x32_bf16 v[132:135], v[68:71], a[52:55], v[132:135]
    v_mfma_f32_16x16x32_bf16 v[136:139], v[64:67], a[40:43], v[136:139]
    ds_read_b64_tr_b16 v[92:93], v23 offset:12288
    v_mfma_f32_16x16x32_bf16 v[136:139], v[68:71], a[56:59], v[136:139]
    ds_read_b64_tr_b16 v[94:95], v23 offset:12800
    v_mfma_f32_16x16x32_bf16 v[140:143], v[64:67], a[44:47], v[140:143]
    v_mfma_f32_16x16x32_bf16 v[140:143], v[68:71], a[60:63], v[140:143]
    s_waitcnt lgkmcnt(8)
    v_mfma_f32_16x16x32_bf16 v[192:195], v[72:75], a[32:35], v[192:195]
    ds_read_b64_tr_b16 v[64:65], v20 offset:16384
    v_mfma_f32_16x16x32_bf16 v[192:195], v[76:79], a[48:51], v[192:195]
    ds_read_b64_tr_b16 v[66:67], v20 offset:16896
    v_mfma_f32_16x16x32_bf16 v[196:199], v[72:75], a[36:39], v[196:199]
    buffer_load_dwordx4 a[132:135], v5, s[68:71], s31 offen offset:1024 sc1
    v_mfma_f32_16x16x32_bf16 v[196:199], v[76:79], a[52:55], v[196:199]
    v_mfma_f32_16x16x32_bf16 v[200:203], v[72:75], a[40:43], v[200:203]
    ds_read_b64_tr_b16 v[68:69], v20 offset:20480
    v_mfma_f32_16x16x32_bf16 v[200:203], v[76:79], a[56:59], v[200:203]
    ds_read_b64_tr_b16 v[70:71], v20 offset:20992
    v_mfma_f32_16x16x32_bf16 v[204:207], v[72:75], a[44:47], v[204:207]
    v_mfma_f32_16x16x32_bf16 v[204:207], v[76:79], a[60:63], v[204:207]
    s_waitcnt lgkmcnt(8)
    v_mfma_f32_16x16x32_bf16 v[144:147], v[80:83], a[32:35], v[144:147]
    ds_read_b64_tr_b16 v[72:73], v20 offset:24576
    v_mfma_f32_16x16x32_bf16 v[144:147], v[84:87], a[48:51], v[144:147]
    ds_read_b64_tr_b16 v[74:75], v20 offset:25088
    v_mfma_f32_16x16x32_bf16 v[148:151], v[80:83], a[36:39], v[148:151]
    buffer_load_dwordx4 a[136:139], v5, s[68:71], s31 offen offset:2048 sc1
    v_mfma_f32_16x16x32_bf16 v[148:151], v[84:87], a[52:55], v[148:151]
    v_mfma_f32_16x16x32_bf16 v[152:155], v[80:83], a[40:43], v[152:155]
    ds_read_b64_tr_b16 v[76:77], v20 offset:28672
    v_mfma_f32_16x16x32_bf16 v[152:155], v[84:87], a[56:59], v[152:155]
    ds_read_b64_tr_b16 v[78:79], v20 offset:29184
    v_mfma_f32_16x16x32_bf16 v[156:159], v[80:83], a[44:47], v[156:159]
    v_mfma_f32_16x16x32_bf16 v[156:159], v[84:87], a[60:63], v[156:159]
    s_waitcnt lgkmcnt(8)
    v_mfma_f32_16x16x32_bf16 v[208:211], v[88:91], a[32:35], v[208:211]
    ds_read_b64_tr_b16 v[80:81], v21 offset:16384
    v_mfma_f32_16x16x32_bf16 v[208:211], v[92:95], a[48:51], v[208:211]
    ds_read_b64_tr_b16 v[82:83], v21 offset:16896
    v_mfma_f32_16x16x32_bf16 v[212:215], v[88:91], a[36:39], v[212:215]
    buffer_load_dwordx4 a[140:143], v5, s[68:71], s31 offen offset:3072 sc1
    v_mfma_f32_16x16x32_bf16 v[212:215], v[92:95], a[52:55], v[212:215]
    v_mfma_f32_16x16x32_bf16 v[216:219], v[88:91], a[40:43], v[216:219]
    ds_read_b64_tr_b16 v[84:85], v21 offset:20480
    v_mfma_f32_16x16x32_bf16 v[216:219], v[92:95], a[56:59], v[216:219]
    ds_read_b64_tr_b16 v[86:87], v21 offset:20992
    v_mfma_f32_16x16x32_bf16 v[220:223], v[88:91], a[44:47], v[220:223]
    v_mfma_f32_16x16x32_bf16 v[220:223], v[92:95], a[60:63], v[220:223]
    s_waitcnt vmcnt(17) lgkmcnt(8)
    v_mfma_f32_16x16x32_bf16 v[96:99], v[64:67], a[64:67], v[96:99]
    ds_read_b64_tr_b16 v[88:89], v21 offset:24576
    v_mfma_f32_16x16x32_bf16 v[96:99], v[68:71], a[80:83], v[96:99]
    ds_read_b64_tr_b16 v[90:91], v21 offset:25088
    s_add_u32 s31, s89, 4096
    v_mfma_f32_16x16x32_bf16 v[100:103], v[64:67], a[68:71], v[100:103]
    buffer_load_dwordx4 a[144:147], v5, s[68:71], s31 offen offset:0 sc1
    v_mfma_f32_16x16x32_bf16 v[100:103], v[68:71], a[84:87], v[100:103]
    v_mfma_f32_16x16x32_bf16 v[104:107], v[64:67], a[72:75], v[104:107]
    ds_read_b64_tr_b16 v[92:93], v21 offset:28672
    v_mfma_f32_16x16x32_bf16 v[104:107], v[68:71], a[88:91], v[104:107]
    ds_read_b64_tr_b16 v[94:95], v21 offset:29184
    v_mfma_f32_16x16x32_bf16 v[108:111], v[64:67], a[76:79], v[108:111]
    buffer_load_dwordx4 a[148:151], v5, s[68:71], s31 offen offset:1024 sc1
    v_mfma_f32_16x16x32_bf16 v[108:111], v[68:71], a[92:95], v[108:111]
    s_waitcnt lgkmcnt(8)
    v_mfma_f32_16x16x32_bf16 v[160:163], v[72:75], a[64:67], v[160:163]
    ds_read_b64_tr_b16 v[64:65], v22 offset:16384
    v_mfma_f32_16x16x32_bf16 v[160:163], v[76:79], a[80:83], v[160:163]
    ds_read_b64_tr_b16 v[66:67], v22 offset:16896
    v_mfma_f32_16x16x32_bf16 v[164:167], v[72:75], a[68:71], v[164:167]
    buffer_load_dwordx4 a[152:155], v5, s[68:71], s31 offen offset:2048 sc1
    v_mfma_f32_16x16x32_bf16 v[164:167], v[76:79], a[84:87], v[164:167]
    v_mfma_f32_16x16x32_bf16 v[168:171], v[72:75], a[72:75], v[168:171]
    ds_read_b64_tr_b16 v[68:69], v22 offset:20480
    v_mfma_f32_16x16x32_bf16 v[168:171], v[76:79], a[88:91], v[168:171]
    ds_read_b64_tr_b16 v[70:71], v22 offset:20992
    v_mfma_f32_16x16x32_bf16 v[172:175], v[72:75], a[76:79], v[172:175]
    buffer_load_dwordx4 a[156:159], v5, s[68:71], s31 offen offset:3072 sc1
    v_mfma_f32_16x16x32_bf16 v[172:175], v[76:79], a[92:95], v[172:175]
    s_waitcnt lgkmcnt(8)
    v_mfma_f32_16x16x32_bf16 v[112:115], v[80:83], a[64:67], v[112:115]
    ds_read_b64_tr_b16 v[72:73], v22 offset:24576
    v_mfma_f32_16x16x32_bf16 v[112:115], v[84:87], a[80:83], v[112:115]
    ds_read_b64_tr_b16 v[74:75], v22 offset:25088
    v_mfma_f32_16x16x32_bf16 v[116:119], v[80:83], a[68:71], v[116:119]
    v_mfma_f32_16x16x32_bf16 v[116:119], v[84:87], a[84:87], v[116:119]
    v_mfma_f32_16x16x32_bf16 v[120:123], v[80:83], a[72:75], v[120:123]
    ds_read_b64_tr_b16 v[76:77], v22 offset:28672
    v_mfma_f32_16x16x32_bf16 v[120:123], v[84:87], a[88:91], v[120:123]
    ds_read_b64_tr_b16 v[78:79], v22 offset:29184
    v_mfma_f32_16x16x32_bf16 v[124:127], v[80:83], a[76:79], v[124:127]
    v_mfma_f32_16x16x32_bf16 v[124:127], v[84:87], a[92:95], v[124:127]
    s_waitcnt lgkmcnt(8)
    v_mfma_f32_16x16x32_bf16 v[176:179], v[88:91], a[64:67], v[176:179]
    ds_read_b64_tr_b16 v[80:81], v23 offset:16384
    v_mfma_f32_16x16x32_bf16 v[176:179], v[92:95], a[80:83], v[176:179]
    ds_read_b64_tr_b16 v[82:83], v23 offset:16896
    v_mfma_f32_16x16x32_bf16 v[180:183], v[88:91], a[68:71], v[180:183]
    v_mfma_f32_16x16x32_bf16 v[180:183], v[92:95], a[84:87], v[180:183]
    v_mfma_f32_16x16x32_bf16 v[184:187], v[88:91], a[72:75], v[184:187]
    ds_read_b64_tr_b16 v[84:85], v23 offset:20480
    v_mfma_f32_16x16x32_bf16 v[184:187], v[92:95], a[88:91], v[184:187]
    ds_read_b64_tr_b16 v[86:87], v23 offset:20992
    v_mfma_f32_16x16x32_bf16 v[188:191], v[88:91], a[76:79], v[188:191]
    v_mfma_f32_16x16x32_bf16 v[188:191], v[92:95], a[92:95], v[188:191]
    s_waitcnt lgkmcnt(8)
    v_mfma_f32_16x16x32_bf16 v[128:131], v[64:67], a[64:67], v[128:131]
    ds_read_b64_tr_b16 v[88:89], v23 offset:24576
    v_mfma_f32_16x16x32_bf16 v[128:131], v[68:71], a[80:83], v[128:131]
    ds_read_b64_tr_b16 v[90:91], v23 offset:25088
    s_add_u32 s31, s90, 0
    v_mfma_f32_16x16x32_bf16 v[132:135], v[64:67], a[68:71], v[132:135]
    buffer_load_dwordx4 a[160:163], v5, s[68:71], s31 offen offset:0 sc1
    v_mfma_f32_16x16x32_bf16 v[132:135], v[68:71], a[84:87], v[132:135]
    v_mfma_f32_16x16x32_bf16 v[136:139], v[64:67], a[72:75], v[136:139]
    ds_read_b64_tr_b16 v[92:93], v23 offset:28672
    v_mfma_f32_16x16x32_bf16 v[136:139], v[68:71], a[88:91], v[136:139]
    ds_read_b64_tr_b16 v[94:95], v23 offset:29184
    v_mfma_f32_16x16x32_bf16 v[140:143], v[64:67], a[76:79], v[140:143]
    v_mfma_f32_16x16x32_bf16 v[140:143], v[68:71], a[92:95], v[140:143]
    s_waitcnt vmcnt(9)
    s_barrier
    s_waitcnt lgkmcnt(8)
    v_mfma_f32_16x16x32_bf16 v[192:195], v[72:75], a[64:67], v[192:195]
    ds_read_b64_tr_b16 v[64:65], v20 offset:32768
    v_mfma_f32_16x16x32_bf16 v[192:195], v[76:79], a[80:83], v[192:195]
    ds_read_b64_tr_b16 v[66:67], v20 offset:33280
    v_mfma_f32_16x16x32_bf16 v[196:199], v[72:75], a[68:71], v[196:199]
    buffer_load_dwordx4 a[164:167], v5, s[68:71], s31 offen offset:1024 sc1
    v_mfma_f32_16x16x32_bf16 v[196:199], v[76:79], a[84:87], v[196:199]
    v_mfma_f32_16x16x32_bf16 v[200:203], v[72:75], a[72:75], v[200:203]
    ds_read_b64_tr_b16 v[68:69], v20 offset:36864
    v_mfma_f32_16x16x32_bf16 v[200:203], v[76:79], a[88:91], v[200:203]
    ds_read_b64_tr_b16 v[70:71], v20 offset:37376
    v_mfma_f32_16x16x32_bf16 v[204:207], v[72:75], a[76:79], v[204:207]
    v_mfma_f32_16x16x32_bf16 v[204:207], v[76:79], a[92:95], v[204:207]
    s_waitcnt lgkmcnt(8)
    v_mfma_f32_16x16x32_bf16 v[144:147], v[80:83], a[64:67], v[144:147]
    ds_read_b64_tr_b16 v[72:73], v20 offset:40960
    v_mfma_f32_16x16x32_bf16 v[144:147], v[84:87], a[80:83], v[144:147]
    ds_read_b64_tr_b16 v[74:75], v20 offset:41472
    v_mfma_f32_16x16x32_bf16 v[148:151], v[80:83], a[68:71], v[148:151]
    buffer_load_dwordx4 a[168:171], v5, s[68:71], s31 offen offset:2048 sc1
    v_mfma_f32_16x16x32_bf16 v[148:151], v[84:87], a[84:87], v[148:151]
    v_mfma_f32_16x16x32_bf16 v[152:155], v[80:83], a[72:75], v[152:155]
    ds_read_b64_tr_b16 v[76:77], v20 offset:45056
    v_mfma_f32_16x16x32_bf16 v[152:155], v[84:87], a[88:91], v[152:155]
    ds_read_b64_tr_b16 v[78:79], v20 offset:45568
    s_add_u32 m0, s28, 0
    s_add_u32 s30, s82, 0
    v_mfma_f32_16x16x32_bf16 v[156:159], v[80:83], a[76:79], v[156:159]
    buffer_load_dwordx4 v8, s[36:39], s30 offen offset:0 lds
    v_mfma_f32_16x16x32_bf16 v[156:159], v[84:87], a[92:95], v[156:159]
    s_waitcnt lgkmcnt(8)
    v_mfma_f32_16x16x32_bf16 v[208:211], v[88:91], a[64:67], v[208:211]
    ds_read_b64_tr_b16 v[80:81], v21 offset:32768
    v_mfma_f32_16x16x32_bf16 v[208:211], v[92:95], a[80:83], v[208:211]
    ds_read_b64_tr_b16 v[82:83], v21 offset:33280
    v_mfma_f32_16x16x32_bf16 v[212:215], v[88:91], a[68:71], v[212:215]
    buffer_load_dwordx4 a[172:175], v5, s[68:71], s31 offen offset:3072 sc1
    v_mfma_f32_16x16x32_bf16 v[212:215], v[92:95], a[84:87], v[212:215]
    v_mfma_f32_16x16x32_bf16 v[216:219], v[88:91], a[72:75], v[216:219]
    ds_read_b64_tr_b16 v[84:85], v21 offset:36864
    v_mfma_f32_16x16x32_bf16 v[216:219], v[92:95], a[88:91], v[216:219]
    ds_read_b64_tr_b16 v[86:87], v21 offset:37376
    v_mfma_f32_16x16x32_bf16 v[220:223], v[88:91], a[76:79], v[220:223]
    buffer_load_dwordx4 v9, s[36:39], s30 offen offset:1024 lds
    v_mfma_f32_16x16x32_bf16 v[220:223], v[92:95], a[92:95], v[220:223]
    s_waitcnt vmcnt(19) lgkmcnt(8)
    v_mfma_f32_16x16x32_bf16 v[96:99], v[64:67], a[96:99], v[96:99]
    ds_read_b64_tr_b16 v[88:89], v21 offset:40960
    v_mfma_f32_16x16x32_bf16 v[96:99], v[68:71], a[112:115], v[96:99]
    ds_read_b64_tr_b16 v[90:91], v21 offset:41472
    s_add_u32 s31, s90, 4096
    v_mfma_f32_16x16x32_bf16 v[100:103], v[64:67], a[100:103], v[100:103]
    buffer_load_dwordx4 a[176:179], v5, s[68:71], s31 offen offset:0 sc1
    v_mfma_f32_16x16x32_bf16 v[100:103], v[68:71], a[116:119], v[100:103]
    v_mfma_f32_16x16x32_bf16 v[104:107], v[64:67], a[104:107], v[104:107]
    ds_read_b64_tr_b16 v[92:93], v21 offset:45056
    v_mfma_f32_16x16x32_bf16 v[104:107], v[68:71], a[120:123], v[104:107]
    ds_read_b64_tr_b16 v[94:95], v21 offset:45568
    v_mfma_f32_16x16x32_bf16 v[108:111], v[64:67], a[108:111], v[108:111]
    buffer_load_dwordx4 a[180:183], v5, s[68:71], s31 offen offset:1024 sc1
    v_mfma_f32_16x16x32_bf16 v[108:111], v[68:71], a[124:127], v[108:111]
    s_waitcnt lgkmcnt(8)
    v_mfma_f32_16x16x32_bf16 v[160:163], v[72:75], a[96:99], v[160:163]
    ds_read_b64_tr_b16 v[64:65], v22 offset:32768
    v_mfma_f32_16x16x32_bf16 v[160:163], v[76:79], a[112:115], v[160:163]
    ds_read_b64_tr_b16 v[66:67], v22 offset:33280
    v_mfma_f32_16x16x32_bf16 v[164:167], v[72:75], a[100:103], v[164:167]
    buffer_load_dwordx4 a[184:187], v5, s[68:71], s31 offen offset:2048 sc1
    v_mfma_f32_16x16x32_bf16 v[164:167], v[76:79], a[116:119], v[164:167]
    v_mfma_f32_16x16x32_bf16 v[168:171], v[72:75], a[104:107], v[168:171]
    ds_read_b64_tr_b16 v[68:69], v22 offset:36864
    v_mfma_f32_16x16x32_bf16 v[168:171], v[76:79], a[120:123], v[168:171]
    ds_read_b64_tr_b16 v[70:71], v22 offset:37376
    v_mfma_f32_16x16x32_bf16 v[172:175], v[72:75], a[108:111], v[172:175]
    buffer_load_dwordx4 a[188:191], v5, s[68:71], s31 offen offset:3072 sc1
    v_mfma_f32_16x16x32_bf16 v[172:175], v[76:79], a[124:127], v[172:175]
    s_waitcnt lgkmcnt(8)
    v_mfma_f32_16x16x32_bf16 v[112:115], v[80:83], a[96:99], v[112:115]
    ds_read_b64_tr_b16 v[72:73], v22 offset:40960
    v_mfma_f32_16x16x32_bf16 v[112:115], v[84:87], a[112:115], v[112:115]
    ds_read_b64_tr_b16 v[74:75], v22 offset:41472
    v_mfma_f32_16x16x32_bf16 v[116:119], v[80:83], a[100:103], v[116:119]
    buffer_load_dwordx4 v10, s[36:39], s30 offen offset:2048 lds
    v_mfma_f32_16x16x32_bf16 v[116:119], v[84:87], a[116:119], v[116:119]
    v_mfma_f32_16x16x32_bf16 v[120:123], v[80:83], a[104:107], v[120:123]
    ds_read_b64_tr_b16 v[76:77], v22 offset:45056
    v_mfma_f32_16x16x32_bf16 v[120:123], v[84:87], a[120:123], v[120:123]
    ds_read_b64_tr_b16 v[78:79], v22 offset:45568
    v_mfma_f32_16x16x32_bf16 v[124:127], v[80:83], a[108:111], v[124:127]
    v_mfma_f32_16x16x32_bf16 v[124:127], v[84:87], a[124:127], v[124:127]
    s_waitcnt lgkmcnt(8)
    v_mfma_f32_16x16x32_bf16 v[176:179], v[88:91], a[96:99], v[176:179]
    ds_read_b64_tr_b16 v[80:81], v23 offset:32768
    v_mfma_f32_16x16x32_bf16 v[176:179], v[92:95], a[112:115], v[176:179]
    ds_read_b64_tr_b16 v[82:83], v23 offset:33280
    v_mfma_f32_16x16x32_bf16 v[180:183], v[88:91], a[100:103], v[180:183]
    buffer_load_dwordx4 v11, s[36:39], s30 offen offset:3072 lds
    v_mfma_f32_16x16x32_bf16 v[180:183], v[92:95], a[116:119], v[180:183]
    v_mfma_f32_16x16x32_bf16 v[184:187], v[88:91], a[104:107], v[184:187]
    ds_read_b64_tr_b16 v[84:85], v23 offset:36864
    v_mfma_f32_16x16x32_bf16 v[184:187], v[92:95], a[120:123], v[184:187]
    ds_read_b64_tr_b16 v[86:87], v23 offset:37376
    v_mfma_f32_16x16x32_bf16 v[188:191], v[88:91], a[108:111], v[188:191]
    v_mfma_f32_16x16x32_bf16 v[188:191], v[92:95], a[124:127], v[188:191]
    s_waitcnt lgkmcnt(8)
    v_mfma_f32_16x16x32_bf16 v[128:131], v[64:67], a[96:99], v[128:131]
    ds_read_b64_tr_b16 v[88:89], v23 offset:40960
    v_mfma_f32_16x16x32_bf16 v[128:131], v[68:71], a[112:115], v[128:131]
    ds_read_b64_tr_b16 v[90:91], v23 offset:41472
    s_add_u32 s31, s91, 0
    v_mfma_f32_16x16x32_bf16 v[132:135], v[64:67], a[100:103], v[132:135]
    buffer_load_dwordx4 a[192:195], v5, s[68:71], s31 offen offset:0 sc1
    v_mfma_f32_16x16x32_bf16 v[132:135], v[68:71], a[116:119], v[132:135]
    v_mfma_f32_16x16x32_bf16 v[136:139], v[64:67], a[104:107], v[136:139]
    ds_read_b64_tr_b16 v[92:93], v23 offset:45056
    v_mfma_f32_16x16x32_bf16 v[136:139], v[68:71], a[120:123], v[136:139]
    ds_read_b64_tr_b16 v[94:95], v23 offset:45568
    s_add_u32 m0, s28, 16384
    s_add_u32 s30, s83, 0
    v_mfma_f32_16x16x32_bf16 v[140:143], v[64:67], a[108:111], v[140:143]
    buffer_load_dwordx4 v8, s[36:39], s30 offen offset:0 lds
    v_mfma_f32_16x16x32_bf16 v[140:143], v[68:71], a[124:127], v[140:143]
    s_waitcnt lgkmcnt(8)
    v_mfma_f32_16x16x32_bf16 v[192:195], v[72:75], a[96:99], v[192:195]
    ds_read_b64_tr_b16 v[64:65], v20 offset:49152
    v_mfma_f32_16x16x32_bf16 v[192:195], v[76:79], a[112:115], v[192:195]
    ds_read_b64_tr_b16 v[66:67], v20 offset:49664
    v_mfma_f32_16x16x32_bf16 v[196:199], v[72:75], a[100:103], v[196:199]
    buffer_load_dwordx4 a[196:199], v5, s[68:71], s31 offen offset:1024 sc1
    v_mfma_f32_16x16x32_bf16 v[196:199], v[76:79], a[116:119], v[196:199]
    v_mfma_f32_16x16x32_bf16 v[200:203], v[72:75], a[104:107], v[200:203]
    ds_read_b64_tr_b16 v[68:69], v20 offset:53248
    v_mfma_f32_16x16x32_bf16 v[200:203], v[76:79], a[120:123], v[200:203]
    ds_read_b64_tr_b16 v[70:71], v20 offset:53760
    v_mfma_f32_16x16x32_bf16 v[204:207], v[72:75], a[108:111], v[204:207]
    buffer_load_dwordx4 v9, s[36:39], s30 offen offset:1024 lds
    v_mfma_f32_16x16x32_bf16 v[204:207], v[76:79], a[124:127], v[204:207]
    s_waitcnt lgkmcnt(8)
    v_mfma_f32_16x16x32_bf16 v[144:147], v[80:83], a[96:99], v[144:147]
    ds_read_b64_tr_b16 v[72:73], v20 offset:57344
    v_mfma_f32_16x16x32_bf16 v[144:147], v[84:87], a[112:115], v[144:147]
    ds_read_b64_tr_b16 v[74:75], v20 offset:57856
    v_mfma_f32_16x16x32_bf16 v[148:151], v[80:83], a[100:103], v[148:151]
    buffer_load_dwordx4 a[200:203], v5, s[68:71], s31 offen offset:2048 sc1
    v_mfma_f32_16x16x32_bf16 v[148:151], v[84:87], a[116:119], v[148:151]
    v_mfma_f32_16x16x32_bf16 v[152:155], v[80:83], a[104:107], v[152:155]
    ds_read_b64_tr_b16 v[76:77], v20 offset:61440
    v_mfma_f32_16x16x32_bf16 v[152:155], v[84:87], a[120:123], v[152:155]
    ds_read_b64_tr_b16 v[78:79], v20 offset:61952
    v_mfma_f32_16x16x32_bf16 v[156:159], v[80:83], a[108:111], v[156:159]
    buffer_load_dwordx4 v10, s[36:39], s30 offen offset:2048 lds
    v_mfma_f32_16x16x32_bf16 v[156:159], v[84:87], a[124:127], v[156:159]
    s_waitcnt lgkmcnt(8)
    v_mfma_f32_16x16x32_bf16 v[208:211], v[88:91], a[96:99], v[208:211]
    ds_read_b64_tr_b16 v[80:81], v21 offset:49152
    v_mfma_f32_16x16x32_bf16 v[208:211], v[92:95], a[112:115], v[208:211]
    ds_read_b64_tr_b16 v[82:83], v21 offset:49664
    v_mfma_f32_16x16x32_bf16 v[212:215], v[88:91], a[100:103], v[212:215]
    buffer_load_dwordx4 a[204:207], v5, s[68:71], s31 offen offset:3072 sc1
    v_mfma_f32_16x16x32_bf16 v[212:215], v[92:95], a[116:119], v[212:215]
    v_mfma_f32_16x16x32_bf16 v[216:219], v[88:91], a[104:107], v[216:219]
    ds_read_b64_tr_b16 v[84:85], v21 offset:53248
    v_mfma_f32_16x16x32_bf16 v[216:219], v[92:95], a[120:123], v[216:219]
    ds_read_b64_tr_b16 v[86:87], v21 offset:53760
    v_mfma_f32_16x16x32_bf16 v[220:223], v[88:91], a[108:111], v[220:223]
    buffer_load_dwordx4 v11, s[36:39], s30 offen offset:3072 lds
    v_mfma_f32_16x16x32_bf16 v[220:223], v[92:95], a[124:127], v[220:223]
    s_waitcnt vmcnt(20) lgkmcnt(8)
    v_mfma_f32_16x16x32_bf16 v[96:99], v[64:67], a[128:131], v[96:99]
    ds_read_b64_tr_b16 v[88:89], v21 offset:57344
    v_mfma_f32_16x16x32_bf16 v[96:99], v[68:71], a[144:147], v[96:99]
    ds_read_b64_tr_b16 v[90:91], v21 offset:57856
    s_add_u32 s31, s91, 4096
    v_mfma_f32_16x16x32_bf16 v[100:103], v[64:67], a[132:135], v[100:103]
    buffer_load_dwordx4 a[208:211], v5, s[68:71], s31 offen offset:0 sc1
    v_mfma_f32_16x16x32_bf16 v[100:103], v[68:71], a[148:151], v[100:103]
    v_mfma_f32_16x16x32_bf16 v[104:107], v[64:67], a[136:139], v[104:107]
    ds_read_b64_tr_b16 v[92:93], v21 offset:61440
    v_mfma_f32_16x16x32_bf16 v[104:107], v[68:71], a[152:155], v[104:107]
    ds_read_b64_tr_b16 v[94:95], v21 offset:61952
    v_mfma_f32_16x16x32_bf16 v[108:111], v[64:67], a[140:143], v[108:111]
    buffer_load_dwordx4 a[212:215], v5, s[68:71], s31 offen offset:1024 sc1
    v_mfma_f32_16x16x32_bf16 v[108:111], v[68:71], a[156:159], v[108:111]
    s_waitcnt lgkmcnt(8)
    v_mfma_f32_16x16x32_bf16 v[160:163], v[72:75], a[128:131], v[160:163]
    ds_read_b64_tr_b16 v[64:65], v22 offset:49152
    v_mfma_f32_16x16x32_bf16 v[160:163], v[76:79], a[144:147], v[160:163]
    ds_read_b64_tr_b16 v[66:67], v22 offset:49664
    v_mfma_f32_16x16x32_bf16 v[164:167], v[72:75], a[132:135], v[164:167]
    buffer_load_dwordx4 a[216:219], v5, s[68:71], s31 offen offset:2048 sc1
    v_mfma_f32_16x16x32_bf16 v[164:167], v[76:79], a[148:151], v[164:167]
    v_mfma_f32_16x16x32_bf16 v[168:171], v[72:75], a[136:139], v[168:171]
    ds_read_b64_tr_b16 v[68:69], v22 offset:53248
    v_mfma_f32_16x16x32_bf16 v[168:171], v[76:79], a[152:155], v[168:171]
    ds_read_b64_tr_b16 v[70:71], v22 offset:53760
    v_mfma_f32_16x16x32_bf16 v[172:175], v[72:75], a[140:143], v[172:175]
    buffer_load_dwordx4 a[220:223], v5, s[68:71], s31 offen offset:3072 sc1
    v_mfma_f32_16x16x32_bf16 v[172:175], v[76:79], a[156:159], v[172:175]
    s_waitcnt lgkmcnt(8)
    v_mfma_f32_16x16x32_bf16 v[112:115], v[80:83], a[128:131], v[112:115]
    ds_read_b64_tr_b16 v[72:73], v22 offset:57344
    v_mfma_f32_16x16x32_bf16 v[112:115], v[84:87], a[144:147], v[112:115]
    ds_read_b64_tr_b16 v[74:75], v22 offset:57856
    s_add_u32 m0, s28, 32768
    s_add_u32 s30, s84, 0
    v_mfma_f32_16x16x32_bf16 v[116:119], v[80:83], a[132:135], v[116:119]
    buffer_load_dwordx4 v8, s[36:39], s30 offen offset:0 lds
    v_mfma_f32_16x16x32_bf16 v[116:119], v[84:87], a[148:151], v[116:119]
    v_mfma_f32_16x16x32_bf16 v[120:123], v[80:83], a[136:139], v[120:123]
    ds_read_b64_tr_b16 v[76:77], v22 offset:61440
    v_mfma_f32_16x16x32_bf16 v[120:123], v[84:87], a[152:155], v[120:123]
    ds_read_b64_tr_b16 v[78:79], v22 offset:61952
    v_mfma_f32_16x16x32_bf16 v[124:127], v[80:83], a[140:143], v[124:127]
    v_mfma_f32_16x16x32_bf16 v[124:127], v[84:87], a[156:159], v[124:127]
    s_waitcnt lgkmcnt(8)
    v_mfma_f32_16x16x32_bf16 v[176:179], v[88:91], a[128:131], v[176:179]
    ds_read_b64_tr_b16 v[80:81], v23 offset:49152
    v_mfma_f32_16x16x32_bf16 v[176:179], v[92:95], a[144:147], v[176:179]
    ds_read_b64_tr_b16 v[82:83], v23 offset:49664
    v_mfma_f32_16x16x32_bf16 v[180:183], v[88:91], a[132:135], v[180:183]
    buffer_load_dwordx4 v9, s[36:39], s30 offen offset:1024 lds
    v_mfma_f32_16x16x32_bf16 v[180:183], v[92:95], a[148:151], v[180:183]
    v_mfma_f32_16x16x32_bf16 v[184:187], v[88:91], a[136:139], v[184:187]
    ds_read_b64_tr_b16 v[84:85], v23 offset:53248
    v_mfma_f32_16x16x32_bf16 v[184:187], v[92:95], a[152:155], v[184:187]
    ds_read_b64_tr_b16 v[86:87], v23 offset:53760
    v_mfma_f32_16x16x32_bf16 v[188:191], v[88:91], a[140:143], v[188:191]
    v_mfma_f32_16x16x32_bf16 v[188:191], v[92:95], a[156:159], v[188:191]
    s_waitcnt lgkmcnt(8)
    v_mfma_f32_16x16x32_bf16 v[128:131], v[64:67], a[128:131], v[128:131]
    ds_read_b64_tr_b16 v[88:89], v23 offset:57344
    v_mfma_f32_16x16x32_bf16 v[128:131], v[68:71], a[144:147], v[128:131]
    ds_read_b64_tr_b16 v[90:91], v23 offset:57856
    s_add_u32 s31, s92, 0
    v_mfma_f32_16x16x32_bf16 v[132:135], v[64:67], a[132:135], v[132:135]
    buffer_load_dwordx4 a[224:227], v5, s[68:71], s31 offen offset:0 sc1
    v_mfma_f32_16x16x32_bf16 v[132:135], v[68:71], a[148:151], v[132:135]
    v_mfma_f32_16x16x32_bf16 v[136:139], v[64:67], a[136:139], v[136:139]
    ds_read_b64_tr_b16 v[92:93], v23 offset:61440
    v_mfma_f32_16x16x32_bf16 v[136:139], v[68:71], a[152:155], v[136:139]
    ds_read_b64_tr_b16 v[94:95], v23 offset:61952
    v_mfma_f32_16x16x32_bf16 v[140:143], v[64:67], a[140:143], v[140:143]
    buffer_load_dwordx4 v10, s[36:39], s30 offen offset:2048 lds
    v_mfma_f32_16x16x32_bf16 v[140:143], v[68:71], a[156:159], v[140:143]
    s_waitcnt lgkmcnt(8)
    v_mfma_f32_16x16x32_bf16 v[192:195], v[72:75], a[128:131], v[192:195]
    ds_read_b64_tr_b16 v[64:65], v24 offset:0
    v_mfma_f32_16x16x32_bf16 v[192:195], v[76:79], a[144:147], v[192:195]
    ds_read_b64_tr_b16 v[66:67], v24 offset:512
    v_mfma_f32_16x16x32_bf16 v[196:199], v[72:75], a[132:135], v[196:199]
    buffer_load_dwordx4 a[228:231], v5, s[68:71], s31 offen offset:1024 sc1
    v_mfma_f32_16x16x32_bf16 v[196:199], v[76:79], a[148:151], v[196:199]
    v_mfma_f32_16x16x32_bf16 v[200:203], v[72:75], a[136:139], v[200:203]
    ds_read_b64_tr_b16 v[68:69], v24 offset:4096
    v_mfma_f32_16x16x32_bf16 v[200:203], v[76:79], a[152:155], v[200:203]
    ds_read_b64_tr_b16 v[70:71], v24 offset:4608
    v_mfma_f32_16x16x32_bf16 v[204:207], v[72:75], a[140:143], v[204:207]
    buffer_load_dwordx4 v11, s[36:39], s30 offen offset:3072 lds
    v_mfma_f32_16x16x32_bf16 v[204:207], v[76:79], a[156:159], v[204:207]
    s_waitcnt lgkmcnt(8)
    v_mfma_f32_16x16x32_bf16 v[144:147], v[80:83], a[128:131], v[144:147]
    ds_read_b64_tr_b16 v[72:73], v24 offset:8192
    v_mfma_f32_16x16x32_bf16 v[144:147], v[84:87], a[144:147], v[144:147]
    ds_read_b64_tr_b16 v[74:75], v24 offset:8704
    v_mfma_f32_16x16x32_bf16 v[148:151], v[80:83], a[132:135], v[148:151]
    buffer_load_dwordx4 a[232:235], v5, s[68:71], s31 offen offset:2048 sc1
    v_mfma_f32_16x16x32_bf16 v[148:151], v[84:87], a[148:151], v[148:151]
    v_mfma_f32_16x16x32_bf16 v[152:155], v[80:83], a[136:139], v[152:155]
    ds_read_b64_tr_b16 v[76:77], v24 offset:12288
    v_mfma_f32_16x16x32_bf16 v[152:155], v[84:87], a[152:155], v[152:155]
    ds_read_b64_tr_b16 v[78:79], v24 offset:12800
    s_add_u32 m0, s28, 49152
    s_add_u32 s30, s76, 128
    v_mfma_f32_16x16x32_bf16 v[156:159], v[80:83], a[140:143], v[156:159]
    buffer_load_dwordx4 v8, s[36:39], s30 offen offset:0 lds
    v_mfma_f32_16x16x32_bf16 v[156:159], v[84:87], a[156:159], v[156:159]
    s_waitcnt lgkmcnt(8)
    v_mfma_f32_16x16x32_bf16 v[208:211], v[88:91], a[128:131], v[208:211]
    ds_read_b64_tr_b16 v[80:81], v25 offset:0
    v_mfma_f32_16x16x32_bf16 v[208:211], v[92:95], a[144:147], v[208:211]
    ds_read_b64_tr_b16 v[82:83], v25 offset:512
    v_mfma_f32_16x16x32_bf16 v[212:215], v[88:91], a[132:135], v[212:215]
    buffer_load_dwordx4 a[236:239], v5, s[68:71], s31 offen offset:3072 sc1
    v_mfma_f32_16x16x32_bf16 v[212:215], v[92:95], a[148:151], v[212:215]
    v_mfma_f32_16x16x32_bf16 v[216:219], v[88:91], a[136:139], v[216:219]
    ds_read_b64_tr_b16 v[84:85], v25 offset:4096
    v_mfma_f32_16x16x32_bf16 v[216:219], v[92:95], a[152:155], v[216:219]
    ds_read_b64_tr_b16 v[86:87], v25 offset:4608
    v_mfma_f32_16x16x32_bf16 v[220:223], v[88:91], a[140:143], v[220:223]
    buffer_load_dwordx4 v9, s[36:39], s30 offen offset:1024 lds
    v_mfma_f32_16x16x32_bf16 v[220:223], v[92:95], a[156:159], v[220:223]
    s_waitcnt vmcnt(24) lgkmcnt(8)
    v_mfma_f32_16x16x32_bf16 v[96:99], v[64:67], a[160:163], v[96:99]
    ds_read_b64_tr_b16 v[88:89], v25 offset:8192
    v_mfma_f32_16x16x32_bf16 v[96:99], v[68:71], a[176:179], v[96:99]
    ds_read_b64_tr_b16 v[90:91], v25 offset:8704
    s_add_u32 s31, s92, 4096
    v_mfma_f32_16x16x32_bf16 v[100:103], v[64:67], a[164:167], v[100:103]
    buffer_load_dwordx4 a[240:243], v5, s[68:71], s31 offen offset:0 sc1
    v_mfma_f32_16x16x32_bf16 v[100:103], v[68:71], a[180:183], v[100:103]
    v_mfma_f32_16x16x32_bf16 v[104:107], v[64:67], a[168:171], v[104:107]
    ds_read_b64_tr_b16 v[92:93], v25 offset:12288
    v_mfma_f32_16x16x32_bf16 v[104:107], v[68:71], a[184:187], v[104:107]
    ds_read_b64_tr_b16 v[94:95], v25 offset:12800
    v_mfma_f32_16x16x32_bf16 v[108:111], v[64:67], a[172:175], v[108:111]
    buffer_load_dwordx4 a[244:247], v5, s[68:71], s31 offen offset:1024 sc1
    v_mfma_f32_16x16x32_bf16 v[108:111], v[68:71], a[188:191], v[108:111]
    s_waitcnt lgkmcnt(8)
    v_mfma_f32_16x16x32_bf16 v[160:163], v[72:75], a[160:163], v[160:163]
    ds_read_b64_tr_b16 v[64:65], v26 offset:0
    v_mfma_f32_16x16x32_bf16 v[160:163], v[76:79], a[176:179], v[160:163]
    ds_read_b64_tr_b16 v[66:67], v26 offset:512
    v_mfma_f32_16x16x32_bf16 v[164:167], v[72:75], a[164:167], v[164:167]
    buffer_load_dwordx4 a[248:251], v5, s[68:71], s31 offen offset:2048 sc1
    v_mfma_f32_16x16x32_bf16 v[164:167], v[76:79], a[180:183], v[164:167]
    v_mfma_f32_16x16x32_bf16 v[168:171], v[72:75], a[168:171], v[168:171]
    ds_read_b64_tr_b16 v[68:69], v26 offset:4096
    v_mfma_f32_16x16x32_bf16 v[168:171], v[76:79], a[184:187], v[168:171]
    ds_read_b64_tr_b16 v[70:71], v26 offset:4608
    v_mfma_f32_16x16x32_bf16 v[172:175], v[72:75], a[172:175], v[172:175]
    buffer_load_dwordx4 a[252:255], v5, s[68:71], s31 offen offset:3072 sc1
    v_mfma_f32_16x16x32_bf16 v[172:175], v[76:79], a[188:191], v[172:175]
    s_waitcnt lgkmcnt(8)
    v_mfma_f32_16x16x32_bf16 v[112:115], v[80:83], a[160:163], v[112:115]
    ds_read_b64_tr_b16 v[72:73], v26 offset:8192
    v_mfma_f32_16x16x32_bf16 v[112:115], v[84:87], a[176:179], v[112:115]
    ds_read_b64_tr_b16 v[74:75], v26 offset:8704
    s_add_u32 s31, s93, 0
    v_mfma_f32_16x16x32_bf16 v[116:119], v[80:83], a[164:167], v[116:119]
    buffer_load_dwordx4 v[224:227], v5, s[68:71], s31 offen offset:0 sc1
    v_mfma_f32_16x16x32_bf16 v[116:119], v[84:87], a[180:183], v[116:119]
    v_mfma_f32_16x16x32_bf16 v[120:123], v[80:83], a[168:171], v[120:123]
    ds_read_b64_tr_b16 v[76:77], v26 offset:12288
    v_mfma_f32_16x16x32_bf16 v[120:123], v[84:87], a[184:187], v[120:123]
    ds_read_b64_tr_b16 v[78:79], v26 offset:12800
    v_mfma_f32_16x16x32_bf16 v[124:127], v[80:83], a[172:175], v[124:127]
    buffer_load_dwordx4 v[228:231], v5, s[68:71], s31 offen offset:1024 sc1
    v_mfma_f32_16x16x32_bf16 v[124:127], v[84:87], a[188:191], v[124:127]
    s_waitcnt lgkmcnt(8)
    v_mfma_f32_16x16x32_bf16 v[176:179], v[88:91], a[160:163], v[176:179]
    ds_read_b64_tr_b16 v[80:81], v27 offset:0
    v_mfma_f32_16x16x32_bf16 v[176:179], v[92:95], a[176:179], v[176:179]
    ds_read_b64_tr_b16 v[82:83], v27 offset:512
    v_mfma_f32_16x16x32_bf16 v[180:183], v[88:91], a[164:167], v[180:183]
    buffer_load_dwordx4 v[232:235], v5, s[68:71], s31 offen offset:2048 sc1
    v_mfma_f32_16x16x32_bf16 v[180:183], v[92:95], a[180:183], v[180:183]
    v_mfma_f32_16x16x32_bf16 v[184:187], v[88:91], a[168:171], v[184:187]
    ds_read_b64_tr_b16 v[84:85], v27 offset:4096
    v_mfma_f32_16x16x32_bf16 v[184:187], v[92:95], a[184:187], v[184:187]
    ds_read_b64_tr_b16 v[86:87], v27 offset:4608
    v_mfma_f32_16x16x32_bf16 v[188:191], v[88:91], a[172:175], v[188:191]
    buffer_load_dwordx4 v[236:239], v5, s[68:71], s31 offen offset:3072 sc1
    v_mfma_f32_16x16x32_bf16 v[188:191], v[92:95], a[188:191], v[188:191]
    s_waitcnt lgkmcnt(8)
    v_mfma_f32_16x16x32_bf16 v[128:131], v[64:67], a[160:163], v[128:131]
    ds_read_b64_tr_b16 v[88:89], v27 offset:8192
    v_mfma_f32_16x16x32_bf16 v[128:131], v[68:71], a[176:179], v[128:131]
    ds_read_b64_tr_b16 v[90:91], v27 offset:8704
    s_add_u32 s31, s93, 4096
    v_mfma_f32_16x16x32_bf16 v[132:135], v[64:67], a[164:167], v[132:135]
    buffer_load_dwordx4 v[240:243], v5, s[68:71], s31 offen offset:0 sc1
    v_mfma_f32_16x16x32_bf16 v[132:135], v[68:71], a[180:183], v[132:135]
    v_mfma_f32_16x16x32_bf16 v[136:139], v[64:67], a[168:171], v[136:139]
    ds_read_b64_tr_b16 v[92:93], v27 offset:12288
    v_mfma_f32_16x16x32_bf16 v[136:139], v[68:71], a[184:187], v[136:139]
    ds_read_b64_tr_b16 v[94:95], v27 offset:12800
    v_mfma_f32_16x16x32_bf16 v[140:143], v[64:67], a[172:175], v[140:143]
    buffer_load_dwordx4 v[244:247], v5, s[68:71], s31 offen offset:1024 sc1
    v_mfma_f32_16x16x32_bf16 v[140:143], v[68:71], a[188:191], v[140:143]
    s_waitcnt vmcnt(14)
    s_barrier
    s_waitcnt lgkmcnt(8)
    v_mfma_f32_16x16x32_bf16 v[192:195], v[72:75], a[160:163], v[192:195]
    ds_read_b64_tr_b16 v[64:65], v16 offset:0
    v_mfma_f32_16x16x32_bf16 v[192:195], v[76:79], a[176:179], v[192:195]
    ds_read_b64_tr_b16 v[66:67], v16 offset:512
    v_mfma_f32_16x16x32_bf16 v[196:199], v[72:75], a[164:167], v[196:199]
    buffer_load_dwordx4 v[248:251], v5, s[68:71], s31 offen offset:2048 sc1
    v_mfma_f32_16x16x32_bf16 v[196:199], v[76:79], a[180:183], v[196:199]
    v_mfma_f32_16x16x32_bf16 v[200:203], v[72:75], a[168:171], v[200:203]
    ds_read_b64_tr_b16 v[68:69], v16 offset:4096
    v_mfma_f32_16x16x32_bf16 v[200:203], v[76:79], a[184:187], v[200:203]
    ds_read_b64_tr_b16 v[70:71], v16 offset:4608
    v_mfma_f32_16x16x32_bf16 v[204:207], v[72:75], a[172:175], v[204:207]
    buffer_load_dwordx4 v[252:255], v5, s[68:71], s31 offen offset:3072 sc1
    v_mfma_f32_16x16x32_bf16 v[204:207], v[76:79], a[188:191], v[204:207]
    s_waitcnt lgkmcnt(8)
    v_mfma_f32_16x16x32_bf16 v[144:147], v[80:83], a[160:163], v[144:147]
    ds_read_b64_tr_b16 v[72:73], v16 offset:8192
    v_mfma_f32_16x16x32_bf16 v[144:147], v[84:87], a[176:179], v[144:147]
    ds_read_b64_tr_b16 v[74:75], v16 offset:8704
    v_mfma_f32_16x16x32_bf16 v[148:151], v[80:83], a[164:167], v[148:151]
    buffer_load_dwordx4 v10, s[36:39], s30 offen offset:2048 lds
    v_mfma_f32_16x16x32_bf16 v[148:151], v[84:87], a[180:183], v[148:151]
    v_mfma_f32_16x16x32_bf16 v[152:155], v[80:83], a[168:171], v[152:155]
    ds_read_b64_tr_b16 v[76:77], v16 offset:12288
    v_mfma_f32_16x16x32_bf16 v[152:155], v[84:87], a[184:187], v[152:155]
    ds_read_b64_tr_b16 v[78:79], v16 offset:12800
    v_mfma_f32_16x16x32_bf16 v[156:159], v[80:83], a[172:175], v[156:159]
    v_mfma_f32_16x16x32_bf16 v[156:159], v[84:87], a[188:191], v[156:159]
    s_waitcnt lgkmcnt(8)
    v_mfma_f32_16x16x32_bf16 v[208:211], v[88:91], a[160:163], v[208:211]
    ds_read_b64_tr_b16 v[80:81], v17 offset:0
    v_mfma_f32_16x16x32_bf16 v[208:211], v[92:95], a[176:179], v[208:211]
    ds_read_b64_tr_b16 v[82:83], v17 offset:512
    v_mfma_f32_16x16x32_bf16 v[212:215], v[88:91], a[164:167], v[212:215]
    buffer_load_dwordx4 v11, s[36:39], s30 offen offset:3072 lds
    v_mfma_f32_16x16x32_bf16 v[212:215], v[92:95], a[180:183], v[212:215]
    v_mfma_f32_16x16x32_bf16 v[216:219], v[88:91], a[168:171], v[216:219]
    ds_read_b64_tr_b16 v[84:85], v17 offset:4096
    v_mfma_f32_16x16x32_bf16 v[216:219], v[92:95], a[184:187], v[216:219]
    ds_read_b64_tr_b16 v[86:87], v17 offset:4608
    v_mfma_f32_16x16x32_bf16 v[220:223], v[88:91], a[172:175], v[220:223]
    v_mfma_f32_16x16x32_bf16 v[220:223], v[92:95], a[188:191], v[220:223]
    s_waitcnt vmcnt(24) lgkmcnt(8)
    v_mfma_f32_16x16x32_bf16 v[96:99], v[64:67], a[192:195], v[96:99]
    ds_read_b64_tr_b16 v[88:89], v17 offset:8192
    v_mfma_f32_16x16x32_bf16 v[96:99], v[68:71], a[208:211], v[96:99]
    ds_read_b64_tr_b16 v[90:91], v17 offset:8704
    s_add_u32 m0, s28, 65536
    s_add_u32 s30, s77, 128
    v_mfma_f32_16x16x32_bf16 v[100:103], v[64:67], a[196:199], v[100:103]
    buffer_load_dwordx4 v8, s[36:39], s30 offen offset:0 lds
    v_mfma_f32_16x16x32_bf16 v[100:103], v[68:71], a[212:215], v[100:103]
    v_mfma_f32_16x16x32_bf16 v[104:107], v[64:67], a[200:203], v[104:107]
    ds_read_b64_tr_b16 v[92:93], v17 offset:12288
    v_mfma_f32_16x16x32_bf16 v[104:107], v[68:71], a[216:219], v[104:107]
    ds_read_b64_tr_b16 v[94:95], v17 offset:12800
    v_mfma_f32_16x16x32_bf16 v[108:111], v[64:67], a[204:207], v[108:111]
    buffer_store_dwordx4 v[12:15], v5, s[72:75], s64 offen offset:0 sc1
    v_mfma_f32_16x16x32_bf16 v[108:111], v[68:71], a[220:223], v[108:111]
    s_waitcnt lgkmcnt(8)
    v_mfma_f32_16x16x32_bf16 v[160:163], v[72:75], a[192:195], v[160:163]
    ds_read_b64_tr_b16 v[64:65], v18 offset:0
    v_mfma_f32_16x16x32_bf16 v[160:163], v[76:79], a[208:211], v[160:163]
    ds_read_b64_tr_b16 v[66:67], v18 offset:512
    v_mfma_f32_16x16x32_bf16 v[164:167], v[72:75], a[196:199], v[164:167]
    buffer_load_dwordx4 v9, s[36:39], s30 offen offset:1024 lds
    v_mfma_f32_16x16x32_bf16 v[164:167], v[76:79], a[212:215], v[164:167]
    v_mfma_f32_16x16x32_bf16 v[168:171], v[72:75], a[200:203], v[168:171]
    ds_read_b64_tr_b16 v[68:69], v18 offset:4096
    v_mfma_f32_16x16x32_bf16 v[168:171], v[76:79], a[216:219], v[168:171]
    ds_read_b64_tr_b16 v[70:71], v18 offset:4608
    v_mfma_f32_16x16x32_bf16 v[172:175], v[72:75], a[204:207], v[172:175]
    v_mfma_f32_16x16x32_bf16 v[172:175], v[76:79], a[220:223], v[172:175]
    s_waitcnt lgkmcnt(8)
    v_mfma_f32_16x16x32_bf16 v[112:115], v[80:83], a[192:195], v[112:115]
    ds_read_b64_tr_b16 v[72:73], v18 offset:8192
    v_mfma_f32_16x16x32_bf16 v[112:115], v[84:87], a[208:211], v[112:115]
    ds_read_b64_tr_b16 v[74:75], v18 offset:8704
    v_mfma_f32_16x16x32_bf16 v[116:119], v[80:83], a[196:199], v[116:119]
    buffer_load_dwordx4 v10, s[36:39], s30 offen offset:2048 lds
    v_mfma_f32_16x16x32_bf16 v[116:119], v[84:87], a[212:215], v[116:119]
    v_mfma_f32_16x16x32_bf16 v[120:123], v[80:83], a[200:203], v[120:123]
    ds_read_b64_tr_b16 v[76:77], v18 offset:12288
    v_mfma_f32_16x16x32_bf16 v[120:123], v[84:87], a[216:219], v[120:123]
    ds_read_b64_tr_b16 v[78:79], v18 offset:12800
    v_mfma_f32_16x16x32_bf16 v[124:127], v[80:83], a[204:207], v[124:127]
    buffer_store_dwordx4 v[12:15], v5, s[72:75], s64 offen offset:1024 sc1
    v_mfma_f32_16x16x32_bf16 v[124:127], v[84:87], a[220:223], v[124:127]
    s_waitcnt lgkmcnt(8)
    v_mfma_f32_16x16x32_bf16 v[176:179], v[88:91], a[192:195], v[176:179]
    ds_read_b64_tr_b16 v[80:81], v19 offset:0
    v_mfma_f32_16x16x32_bf16 v[176:179], v[92:95], a[208:211], v[176:179]
    ds_read_b64_tr_b16 v[82:83], v19 offset:512
    v_mfma_f32_16x16x32_bf16 v[180:183], v[88:91], a[196:199], v[180:183]
    buffer_load_dwordx4 v11, s[36:39], s30 offen offset:3072 lds
    v_mfma_f32_16x16x32_bf16 v[180:183], v[92:95], a[212:215], v[180:183]
    v_mfma_f32_16x16x32_bf16 v[184:187], v[88:91], a[200:203], v[184:187]
    ds_read_b64_tr_b16 v[84:85], v19 offset:4096
    v_mfma_f32_16x16x32_bf16 v[184:187], v[92:95], a[216:219], v[184:187]
    ds_read_b64_tr_b16 v[86:87], v19 offset:4608
    v_mfma_f32_16x16x32_bf16 v[188:191], v[88:91], a[204:207], v[188:191]
    v_mfma_f32_16x16x32_bf16 v[188:191], v[92:95], a[220:223], v[188:191]
    s_waitcnt lgkmcnt(8)
    v_mfma_f32_16x16x32_bf16 v[128:131], v[64:67], a[192:195], v[128:131]
    ds_read_b64_tr_b16 v[88:89], v19 offset:8192
    v_mfma_f32_16x16x32_bf16 v[128:131], v[68:71], a[208:211], v[128:131]
    ds_read_b64_tr_b16 v[90:91], v19 offset:8704
    s_add_u32 m0, s28, 81920
    s_add_u32 s30, s78, 128
    v_mfma_f32_16x16x32_bf16 v[132:135], v[64:67], a[196:199], v[132:135]
    buffer_load_dwordx4 v8, s[36:39], s30 offen offset:0 lds
    v_mfma_f32_16x16x32_bf16 v[132:135], v[68:71], a[212:215], v[132:135]
    v_mfma_f32_16x16x32_bf16 v[136:139], v[64:67], a[200:203], v[136:139]
    ds_read_b64_tr_b16 v[92:93], v19 offset:12288
    v_mfma_f32_16x16x32_bf16 v[136:139], v[68:71], a[216:219], v[136:139]
    ds_read_b64_tr_b16 v[94:95], v19 offset:12800
    v_mfma_f32_16x16x32_bf16 v[140:143], v[64:67], a[204:207], v[140:143]
    buffer_store_dwordx4 v[12:15], v5, s[72:75], s64 offen offset:2048 sc1
    v_mfma_f32_16x16x32_bf16 v[140:143], v[68:71], a[220:223], v[140:143]
    s_waitcnt lgkmcnt(8)
    v_mfma_f32_16x16x32_bf16 v[192:195], v[72:75], a[192:195], v[192:195]
    ds_read_b64_tr_b16 v[64:65], v16 offset:16384
    v_mfma_f32_16x16x32_bf16 v[192:195], v[76:79], a[208:211], v[192:195]
    ds_read_b64_tr_b16 v[66:67], v16 offset:16896
    v_mfma_f32_16x16x32_bf16 v[196:199], v[72:75], a[196:199], v[196:199]
    buffer_load_dwordx4 v9, s[36:39], s30 offen offset:1024 lds
    v_mfma_f32_16x16x32_bf16 v[196:199], v[76:79], a[212:215], v[196:199]
    v_mfma_f32_16x16x32_bf16 v[200:203], v[72:75], a[200:203], v[200:203]
    ds_read_b64_tr_b16 v[68:69], v16 offset:20480
    v_mfma_f32_16x16x32_bf16 v[200:203], v[76:79], a[216:219], v[200:203]
    ds_read_b64_tr_b16 v[70:71], v16 offset:20992
    v_mfma_f32_16x16x32_bf16 v[204:207], v[72:75], a[204:207], v[204:207]
    v_mfma_f32_16x16x32_bf16 v[204:207], v[76:79], a[220:223], v[204:207]
    s_waitcnt lgkmcnt(8)
    v_mfma_f32_16x16x32_bf16 v[144:147], v[80:83], a[192:195], v[144:147]
    ds_read_b64_tr_b16 v[72:73], v16 offset:24576
    v_mfma_f32_16x16x32_bf16 v[144:147], v[84:87], a[208:211], v[144:147]
    ds_read_b64_tr_b16 v[74:75], v16 offset:25088
    v_mfma_f32_16x16x32_bf16 v[148:151], v[80:83], a[196:199], v[148:151]
    buffer_load_dwordx4 v10, s[36:39], s30 offen offset:2048 lds
    v_mfma_f32_16x16x32_bf16 v[148:151], v[84:87], a[212:215], v[148:151]
    v_mfma_f32_16x16x32_bf16 v[152:155], v[80:83], a[200:203], v[152:155]
    ds_read_b64_tr_b16 v[76:77], v16 offset:28672
    v_mfma_f32_16x16x32_bf16 v[152:155], v[84:87], a[216:219], v[152:155]
    ds_read_b64_tr_b16 v[78:79], v16 offset:29184
    v_mfma_f32_16x16x32_bf16 v[156:159], v[80:83], a[204:207], v[156:159]
    buffer_store_dwordx4 v[12:15], v5, s[72:75], s65 offen offset:0 sc1
    v_mfma_f32_16x16x32_bf16 v[156:159], v[84:87], a[220:223], v[156:159]
    s_waitcnt lgkmcnt(8)
    v_mfma_f32_16x16x32_bf16 v[208:211], v[88:91], a[192:195], v[208:211]
    ds_read_b64_tr_b16 v[80:81], v16 offset:32768
    v_mfma_f32_16x16x32_bf16 v[208:211], v[92:95], a[208:211], v[208:211]
    ds_read_b64_tr_b16 v[82:83], v16 offset:33280
    v_mfma_f32_16x16x32_bf16 v[212:215], v[88:91], a[196:199], v[212:215]
    buffer_load_dwordx4 v11, s[36:39], s30 offen offset:3072 lds
    v_mfma_f32_16x16x32_bf16 v[212:215], v[92:95], a[212:215], v[212:215]
    v_mfma_f32_16x16x32_bf16 v[216:219], v[88:91], a[200:203], v[216:219]
    ds_read_b64_tr_b16 v[84:85], v16 offset:36864
    v_mfma_f32_16x16x32_bf16 v[216:219], v[92:95], a[216:219], v[216:219]
    ds_read_b64_tr_b16 v[86:87], v16 offset:37376
    v_mfma_f32_16x16x32_bf16 v[220:223], v[88:91], a[204:207], v[220:223]
    v_mfma_f32_16x16x32_bf16 v[220:223], v[92:95], a[220:223], v[220:223]
    s_waitcnt vmcnt(22) lgkmcnt(8)
    v_mfma_f32_16x16x32_bf16 v[96:99], v[64:67], a[224:227], v[96:99]
    ds_read_b64_tr_b16 v[88:89], v16 offset:40960
    v_mfma_f32_16x16x32_bf16 v[96:99], v[68:71], a[240:243], v[96:99]
    ds_read_b64_tr_b16 v[90:91], v16 offset:41472
    s_add_u32 m0, s28, 98304
    s_add_u32 s30, s79, 128
    v_mfma_f32_16x16x32_bf16 v[100:103], v[64:67], a[228:231], v[100:103]
    buffer_load_dwordx4 v8, s[36:39], s30 offen offset:0 lds
    v_mfma_f32_16x16x32_bf16 v[100:103], v[68:71], a[244:247], v[100:103]
    v_mfma_f32_16x16x32_bf16 v[104:107], v[64:67], a[232:235], v[104:107]
    ds_read_b64_tr_b16 v[92:93], v16 offset:45056
    v_mfma_f32_16x16x32_bf16 v[104:107], v[68:71], a[248:251], v[104:107]
    ds_read_b64_tr_b16 v[94:95], v16 offset:45568
    v_mfma_f32_16x16x32_bf16 v[108:111], v[64:67], a[236:239], v[108:111]
    buffer_store_dwordx4 v[12:15], v5, s[72:75], s65 offen offset:1024 sc1
    v_mfma_f32_16x16x32_bf16 v[108:111], v[68:71], a[252:255], v[108:111]
    s_waitcnt lgkmcnt(8)
    v_mfma_f32_16x16x32_bf16 v[160:163], v[72:75], a[224:227], v[160:163]
    ds_read_b64_tr_b16 v[64:65], v17 offset:16384
    v_mfma_f32_16x16x32_bf16 v[160:163], v[76:79], a[240:243], v[160:163]
    ds_read_b64_tr_b16 v[66:67], v17 offset:16896
    v_mfma_f32_16x16x32_bf16 v[164:167], v[72:75], a[228:231], v[164:167]
    buffer_load_dwordx4 v9, s[36:39], s30 offen offset:1024 lds
    v_mfma_f32_16x16x32_bf16 v[164:167], v[76:79], a[244:247], v[164:167]
    v_mfma_f32_16x16x32_bf16 v[168:171], v[72:75], a[232:235], v[168:171]
    ds_read_b64_tr_b16 v[68:69], v17 offset:20480
    v_mfma_f32_16x16x32_bf16 v[168:171], v[76:79], a[248:251], v[168:171]
    ds_read_b64_tr_b16 v[70:71], v17 offset:20992
    v_mfma_f32_16x16x32_bf16 v[172:175], v[72:75], a[236:239], v[172:175]
    v_mfma_f32_16x16x32_bf16 v[172:175], v[76:79], a[252:255], v[172:175]
    s_waitcnt vmcnt(17) lgkmcnt(8)
    v_mfma_f32_16x16x32_bf16 v[96:99], v[80:83], v[224:227], v[96:99]
    ds_read_b64_tr_b16 v[72:73], v17 offset:24576
    v_mfma_f32_16x16x32_bf16 v[96:99], v[84:87], v[240:243], v[96:99]
    ds_read_b64_tr_b16 v[74:75], v17 offset:25088
    v_mfma_f32_16x16x32_bf16 v[100:103], v[80:83], v[228:231], v[100:103]
    buffer_load_dwordx4 v10, s[36:39], s30 offen offset:2048 lds
    v_mfma_f32_16x16x32_bf16 v[100:103], v[84:87], v[244:247], v[100:103]
    v_mfma_f32_16x16x32_bf16 v[104:107], v[80:83], v[232:235], v[104:107]
    ds_read_b64_tr_b16 v[76:77], v17 offset:28672
    v_mfma_f32_16x16x32_bf16 v[104:107], v[84:87], v[248:251], v[104:107]
    ds_read_b64_tr_b16 v[78:79], v17 offset:29184
    v_mfma_f32_16x16x32_bf16 v[108:111], v[80:83], v[236:239], v[108:111]
    buffer_store_dwordx4 v[12:15], v5, s[72:75], s65 offen offset:2048 sc1
    v_mfma_f32_16x16x32_bf16 v[108:111], v[84:87], v[252:255], v[108:111]
    s_waitcnt lgkmcnt(8)
    v_mfma_f32_16x16x32_bf16 v[160:163], v[88:91], v[224:227], v[160:163]
    ds_read_b64_tr_b16 v[80:81], v17 offset:32768
    v_mfma_f32_16x16x32_bf16 v[160:163], v[92:95], v[240:243], v[160:163]
    ds_read_b64_tr_b16 v[82:83], v17 offset:33280
    v_mfma_f32_16x16x32_bf16 v[164:167], v[88:91], v[228:231], v[164:167]
    buffer_load_dwordx4 v11, s[36:39], s30 offen offset:3072 lds
    v_mfma_f32_16x16x32_bf16 v[164:167], v[92:95], v[244:247], v[164:167]
    v_mfma_f32_16x16x32_bf16 v[168:171], v[88:91], v[232:235], v[168:171]
    ds_read_b64_tr_b16 v[84:85], v17 offset:36864
    v_mfma_f32_16x16x32_bf16 v[168:171], v[92:95], v[248:251], v[168:171]
    ds_read_b64_tr_b16 v[86:87], v17 offset:37376
    v_mfma_f32_16x16x32_bf16 v[172:175], v[88:91], v[236:239], v[172:175]
    v_mfma_f32_16x16x32_bf16 v[172:175], v[92:95], v[252:255], v[172:175]
    s_waitcnt lgkmcnt(8)
    v_mfma_f32_16x16x32_bf16 v[112:115], v[64:67], a[224:227], v[112:115]
    ds_read_b64_tr_b16 v[88:89], v17 offset:40960
    v_mul_f32 v96, v96, v160
    v_mfma_f32_16x16x32_bf16 v[112:115], v[68:71], a[240:243], v[112:115]
    ds_read_b64_tr_b16 v[90:91], v17 offset:41472
    s_add_u32 m0, s28, 114688
    s_add_u32 s30, s80, 128
    v_mfma_f32_16x16x32_bf16 v[116:119], v[64:67], a[228:231], v[116:119]
    buffer_load_dwordx4 v8, s[36:39], s30 offen offset:0 lds
    v_mfma_f32_16x16x32_bf16 v[116:119], v[68:71], a[244:247], v[116:119]
    v_mul_f32 v97, v97, v161
    v_mul_f32 v98, v98, v162
    v_mfma_f32_16x16x32_bf16 v[120:123], v[64:67], a[232:235], v[120:123]
    ds_read_b64_tr_b16 v[92:93], v17 offset:45056
    v_mul_f32 v99, v99, v163
    v_mfma_f32_16x16x32_bf16 v[120:123], v[68:71], a[248:251], v[120:123]
    ds_read_b64_tr_b16 v[94:95], v17 offset:45568
    v_cvt_pk_bf16_f32 v160, v96, v97
    v_mfma_f32_16x16x32_bf16 v[124:127], v[64:67], a[236:239], v[124:127]
    buffer_store_dwordx4 v[12:15], v5, s[72:75], s66 offen offset:0 sc1
    v_mfma_f32_16x16x32_bf16 v[124:127], v[68:71], a[252:255], v[124:127]
    v_cvt_pk_bf16_f32 v161, v98, v99
    v_mul_f32 v100, v100, v164
    s_waitcnt lgkmcnt(8)
    v_mfma_f32_16x16x32_bf16 v[176:179], v[72:75], a[224:227], v[176:179]
    ds_read_b64_tr_b16 v[64:65], v18 offset:16384
    v_mul_f32 v101, v101, v165
    v_mfma_f32_16x16x32_bf16 v[176:179], v[76:79], a[240:243], v[176:179]
    ds_read_b64_tr_b16 v[66:67], v18 offset:16896
    v_mul_f32 v102, v102, v166
    v_mfma_f32_16x16x32_bf16 v[180:183], v[72:75], a[228:231], v[180:183]
    buffer_load_dwordx4 v9, s[36:39], s30 offen offset:1024 lds
    v_mfma_f32_16x16x32_bf16 v[180:183], v[76:79], a[244:247], v[180:183]
    v_mul_f32 v103, v103, v167
    v_cvt_pk_bf16_f32 v164, v100, v101
    v_mfma_f32_16x16x32_bf16 v[184:187], v[72:75], a[232:235], v[184:187]
    ds_read_b64_tr_b16 v[68:69], v18 offset:20480
    v_cvt_pk_bf16_f32 v165, v102, v103
    v_mfma_f32_16x16x32_bf16 v[184:187], v[76:79], a[248:251], v[184:187]
    ds_read_b64_tr_b16 v[70:71], v18 offset:20992
    v_mul_f32 v104, v104, v168
    v_mfma_f32_16x16x32_bf16 v[188:191], v[72:75], a[236:239], v[188:191]
    v_mul_f32 v105, v105, v169
    v_mul_f32 v106, v106, v170
    v_mfma_f32_16x16x32_bf16 v[188:191], v[76:79], a[252:255], v[188:191]
    v_mul_f32 v107, v107, v171
    v_cvt_pk_bf16_f32 v168, v104, v105
    s_waitcnt lgkmcnt(8)
    v_mfma_f32_16x16x32_bf16 v[112:115], v[80:83], v[224:227], v[112:115]
    ds_read_b64_tr_b16 v[72:73], v18 offset:24576
    v_cvt_pk_bf16_f32 v169, v106, v107
    v_mfma_f32_16x16x32_bf16 v[112:115], v[84:87], v[240:243], v[112:115]
    ds_read_b64_tr_b16 v[74:75], v18 offset:25088
    v_mul_f32 v108, v108, v172
    v_mfma_f32_16x16x32_bf16 v[116:119], v[80:83], v[228:231], v[116:119]
    buffer_load_dwordx4 v10, s[36:39], s30 offen offset:2048 lds
    v_mfma_f32_16x16x32_bf16 v[116:119], v[84:87], v[244:247], v[116:119]
    v_mul_f32 v109, v109, v173
    v_mul_f32 v110, v110, v174
    v_mfma_f32_16x16x32_bf16 v[120:123], v[80:83], v[232:235], v[120:123]
    ds_read_b64_tr_b16 v[76:77], v18 offset:28672
    v_mul_f32 v111, v111, v175
    v_mfma_f32_16x16x32_bf16 v[120:123], v[84:87], v[248:251], v[120:123]
    ds_read_b64_tr_b16 v[78:79], v18 offset:29184
    v_cvt_pk_bf16_f32 v172, v108, v109
    v_mfma_f32_16x16x32_bf16 v[124:127], v[80:83], v[236:239], v[124:127]
    buffer_store_dwordx4 v[12:15], v5, s[72:75], s66 offen offset:1024 sc1
    v_mfma_f32_16x16x32_bf16 v[124:127], v[84:87], v[252:255], v[124:127]
    v_cvt_pk_bf16_f32 v173, v110, v111
    s_waitcnt lgkmcnt(8)
    v_mfma_f32_16x16x32_bf16 v[176:179], v[88:91], v[224:227], v[176:179]
    ds_read_b64_tr_b16 v[80:81], v18 offset:32768
    v_mfma_f32_16x16x32_bf16 v[176:179], v[92:95], v[240:243], v[176:179]
    ds_read_b64_tr_b16 v[82:83], v18 offset:33280
    v_mfma_f32_16x16x32_bf16 v[180:183], v[88:91], v[228:231], v[180:183]
    buffer_load_dwordx4 v11, s[36:39], s30 offen offset:3072 lds
    v_mfma_f32_16x16x32_bf16 v[180:183], v[92:95], v[244:247], v[180:183]
    v_mfma_f32_16x16x32_bf16 v[184:187], v[88:91], v[232:235], v[184:187]
    ds_read_b64_tr_b16 v[84:85], v18 offset:36864
    v_mfma_f32_16x16x32_bf16 v[184:187], v[92:95], v[248:251], v[184:187]
    ds_read_b64_tr_b16 v[86:87], v18 offset:37376
    v_mfma_f32_16x16x32_bf16 v[188:191], v[88:91], v[236:239], v[188:191]
    v_mfma_f32_16x16x32_bf16 v[188:191], v[92:95], v[252:255], v[188:191]
    s_waitcnt lgkmcnt(8)
    v_mfma_f32_16x16x32_bf16 v[128:131], v[64:67], a[224:227], v[128:131]
    ds_read_b64_tr_b16 v[88:89], v18 offset:40960
    v_mul_f32 v112, v112, v176
    v_mfma_f32_16x16x32_bf16 v[128:131], v[68:71], a[240:243], v[128:131]
    ds_read_b64_tr_b16 v[90:91], v18 offset:41472
    s_add_u32 m0, s28, 131072
    s_add_u32 s30, s81, 128
    v_mfma_f32_16x16x32_bf16 v[132:135], v[64:67], a[228:231], v[132:135]
    buffer_load_dwordx4 v8, s[36:39], s30 offen offset:0 lds
    v_mfma_f32_16x16x32_bf16 v[132:135], v[68:71], a[244:247], v[132:135]
    v_mul_f32 v113, v113, v177
    v_mul_f32 v114, v114, v178
    v_mfma_f32_16x16x32_bf16 v[136:139], v[64:67], a[232:235], v[136:139]
    ds_read_b64_tr_b16 v[92:93], v18 offset:45056
    v_mul_f32 v115, v115, v179
    v_mfma_f32_16x16x32_bf16 v[136:139], v[68:71], a[248:251], v[136:139]
    ds_read_b64_tr_b16 v[94:95], v18 offset:45568
    v_cvt_pk_bf16_f32 v162, v112, v113
    v_mfma_f32_16x16x32_bf16 v[140:143], v[64:67], a[236:239], v[140:143]
    buffer_store_dwordx4 v[12:15], v5, s[72:75], s66 offen offset:2048 sc1
    v_mfma_f32_16x16x32_bf16 v[140:143], v[68:71], a[252:255], v[140:143]
    v_cvt_pk_bf16_f32 v163, v114, v115
    s_mov_b32 s67, 0
    buffer_store_dwordx4 v[160:163], v30, s[44:47], s67 offen offset:0 sc1
    s_waitcnt lgkmcnt(8)
    v_mfma_f32_16x16x32_bf16 v[192:195], v[72:75], a[224:227], v[192:195]
    ds_read_b64_tr_b16 v[64:65], v19 offset:16384
    v_mul_f32 v116, v116, v180
    v_mfma_f32_16x16x32_bf16 v[192:195], v[76:79], a[240:243], v[192:195]
    ds_read_b64_tr_b16 v[66:67], v19 offset:16896
    v_mul_f32 v117, v117, v181
    v_mfma_f32_16x16x32_bf16 v[196:199], v[72:75], a[228:231], v[196:199]
    buffer_load_dwordx4 v9, s[36:39], s30 offen offset:1024 lds
    v_mfma_f32_16x16x32_bf16 v[196:199], v[76:79], a[244:247], v[196:199]
    v_mul_f32 v118, v118, v182
    v_mul_f32 v119, v119, v183
    v_mfma_f32_16x16x32_bf16 v[200:203], v[72:75], a[232:235], v[200:203]
    ds_read_b64_tr_b16 v[68:69], v19 offset:20480
    v_cvt_pk_bf16_f32 v166, v116, v117
    v_mfma_f32_16x16x32_bf16 v[200:203], v[76:79], a[248:251], v[200:203]
    ds_read_b64_tr_b16 v[70:71], v19 offset:20992
    v_cvt_pk_bf16_f32 v167, v118, v119
    v_mfma_f32_16x16x32_bf16 v[204:207], v[72:75], a[236:239], v[204:207]
    s_mov_b32 s67, 0
    buffer_store_dwordx4 v[164:167], v30, s[44:47], s67 offen offset:256 sc1
    v_mul_f32 v120, v120, v184
    v_mfma_f32_16x16x32_bf16 v[204:207], v[76:79], a[252:255], v[204:207]
    v_mul_f32 v121, v121, v185
    v_mul_f32 v122, v122, v186
    s_waitcnt lgkmcnt(8)
    v_mfma_f32_16x16x32_bf16 v[128:131], v[80:83], v[224:227], v[128:131]
    ds_read_b64_tr_b16 v[72:73], v19 offset:24576
    v_mul_f32 v123, v123, v187
    v_mfma_f32_16x16x32_bf16 v[128:131], v[84:87], v[240:243], v[128:131]
    ds_read_b64_tr_b16 v[74:75], v19 offset:25088
    v_cvt_pk_bf16_f32 v170, v120, v121
    v_mfma_f32_16x16x32_bf16 v[132:135], v[80:83], v[228:231], v[132:135]
    buffer_load_dwordx4 v10, s[36:39], s30 offen offset:2048 lds
    v_mfma_f32_16x16x32_bf16 v[132:135], v[84:87], v[244:247], v[132:135]
    v_cvt_pk_bf16_f32 v171, v122, v123
    s_mov_b32 s67, 368640
    buffer_store_dwordx4 v[168:171], v30, s[44:47], s67 offen offset:0 sc1
    v_mfma_f32_16x16x32_bf16 v[136:139], v[80:83], v[232:235], v[136:139]
    ds_read_b64_tr_b16 v[76:77], v19 offset:28672
    v_mul_f32 v124, v124, v188
    v_mfma_f32_16x16x32_bf16 v[136:139], v[84:87], v[248:251], v[136:139]
    ds_read_b64_tr_b16 v[78:79], v19 offset:29184
    v_mul_f32 v125, v125, v189
    v_mfma_f32_16x16x32_bf16 v[140:143], v[80:83], v[236:239], v[140:143]
    v_mul_f32 v126, v126, v190
    v_mul_f32 v127, v127, v191
    v_mfma_f32_16x16x32_bf16 v[140:143], v[84:87], v[252:255], v[140:143]
    v_cvt_pk_bf16_f32 v174, v124, v125
    v_cvt_pk_bf16_f32 v175, v126, v127
    s_waitcnt lgkmcnt(8)
    v_mfma_f32_16x16x32_bf16 v[192:195], v[88:91], v[224:227], v[192:195]
    ds_read_b64_tr_b16 v[80:81], v19 offset:32768
    s_mov_b32 s67, 368640
    buffer_store_dwordx4 v[172:175], v30, s[44:47], s67 offen offset:256 sc1
    v_mfma_f32_16x16x32_bf16 v[192:195], v[92:95], v[240:243], v[192:195]
    ds_read_b64_tr_b16 v[82:83], v19 offset:33280
    v_mfma_f32_16x16x32_bf16 v[196:199], v[88:91], v[228:231], v[196:199]
    buffer_load_dwordx4 v11, s[36:39], s30 offen offset:3072 lds
    v_mfma_f32_16x16x32_bf16 v[196:199], v[92:95], v[244:247], v[196:199]
    v_mfma_f32_16x16x32_bf16 v[200:203], v[88:91], v[232:235], v[200:203]
    ds_read_b64_tr_b16 v[84:85], v19 offset:36864
    v_mfma_f32_16x16x32_bf16 v[200:203], v[92:95], v[248:251], v[200:203]
    ds_read_b64_tr_b16 v[86:87], v19 offset:37376
    v_mfma_f32_16x16x32_bf16 v[204:207], v[88:91], v[236:239], v[204:207]
    v_mfma_f32_16x16x32_bf16 v[204:207], v[92:95], v[252:255], v[204:207]
    s_waitcnt lgkmcnt(8)
    v_mfma_f32_16x16x32_bf16 v[144:147], v[64:67], a[224:227], v[144:147]
    ds_read_b64_tr_b16 v[88:89], v19 offset:40960
    v_mul_f32 v128, v128, v192
    v_mfma_f32_16x16x32_bf16 v[144:147], v[68:71], a[240:243], v[144:147]
    ds_read_b64_tr_b16 v[90:91], v19 offset:41472
    v_mul_f32 v129, v129, v193
    v_mfma_f32_16x16x32_bf16 v[148:151], v[64:67], a[228:231], v[148:151]
    v_mul_f32 v130, v130, v194
    v_mul_f32 v131, v131, v195
    v_mfma_f32_16x16x32_bf16 v[148:151], v[68:71], a[244:247], v[148:151]
    v_cvt_pk_bf16_f32 v192, v128, v129
    v_cvt_pk_bf16_f32 v193, v130, v131
    v_mfma_f32_16x16x32_bf16 v[152:155], v[64:67], a[232:235], v[152:155]
    ds_read_b64_tr_b16 v[92:93], v19 offset:45056
    v_mul_f32 v132, v132, v196
    v_mfma_f32_16x16x32_bf16 v[152:155], v[68:71], a[248:251], v[152:155]
    ds_read_b64_tr_b16 v[94:95], v19 offset:45568
    v_mul_f32 v133, v133, v197
    v_mfma_f32_16x16x32_bf16 v[156:159], v[64:67], a[236:239], v[156:159]
    v_mul_f32 v134, v134, v198
    v_mul_f32 v135, v135, v199
    v_mfma_f32_16x16x32_bf16 v[156:159], v[68:71], a[252:255], v[156:159]
    v_cvt_pk_bf16_f32 v196, v132, v133
    v_cvt_pk_bf16_f32 v197, v134, v135
    s_waitcnt vmcnt(21)
    s_barrier
    s_waitcnt lgkmcnt(8)
    v_mfma_f32_16x16x32_bf16 v[208:211], v[72:75], a[224:227], v[208:211]
    ds_read_b64_tr_b16 v[64:65], v16 offset:49152
    v_mul_f32 v136, v136, v200
    v_mfma_f32_16x16x32_bf16 v[208:211], v[76:79], a[240:243], v[208:211]
    ds_read_b64_tr_b16 v[66:67], v16 offset:49664
    v_mul_f32 v137, v137, v201
    v_mfma_f32_16x16x32_bf16 v[212:215], v[72:75], a[228:231], v[212:215]
    v_mul_f32 v138, v138, v202
    v_mul_f32 v139, v139, v203
    v_mfma_f32_16x16x32_bf16 v[212:215], v[76:79], a[244:247], v[212:215]
    v_cvt_pk_bf16_f32 v200, v136, v137
    v_cvt_pk_bf16_f32 v201, v138, v139
    v_mfma_f32_16x16x32_bf16 v[216:219], v[72:75], a[232:235], v[216:219]
    ds_read_b64_tr_b16 v[68:69], v16 offset:53248
    v_mul_f32 v140, v140, v204
    v_mfma_f32_16x16x32_bf16 v[216:219], v[76:79], a[248:251], v[216:219]
    ds_read_b64_tr_b16 v[70:71], v16 offset:53760
    v_mul_f32 v141, v141, v205
    v_mfma_f32_16x16x32_bf16 v[220:223], v[72:75], a[236:239], v[220:223]
    v_mul_f32 v142, v142, v206
    v_mul_f32 v143, v143, v207
    v_mfma_f32_16x16x32_bf16 v[220:223], v[76:79], a[252:255], v[220:223]
    v_cvt_pk_bf16_f32 v204, v140, v141
    v_cvt_pk_bf16_f32 v205, v142, v143
    s_waitcnt lgkmcnt(8)
    v_mfma_f32_16x16x32_bf16 v[144:147], v[80:83], v[224:227], v[144:147]
    ds_read_b64_tr_b16 v[72:73], v16 offset:57344
    v_mfma_f32_16x16x32_bf16 v[144:147], v[84:87], v[240:243], v[144:147]
    ds_read_b64_tr_b16 v[74:75], v16 offset:57856
    v_mfma_f32_16x16x32_bf16 v[148:151], v[80:83], v[228:231], v[148:151]
    buffer_load_dword v7, v6, s[20:23], s63 offen
    v_mfma_f32_16x16x32_bf16 v[148:151], v[84:87], v[244:247], v[148:151]
    v_mfma_f32_16x16x32_bf16 v[152:155], v[80:83], v[232:235], v[152:155]
    ds_read_b64_tr_b16 v[76:77], v16 offset:61440
    v_mfma_f32_16x16x32_bf16 v[152:155], v[84:87], v[248:251], v[152:155]
    ds_read_b64_tr_b16 v[78:79], v16 offset:61952
    v_mfma_f32_16x16x32_bf16 v[156:159], v[80:83], v[236:239], v[156:159]
    v_mfma_f32_16x16x32_bf16 v[156:159], v[84:87], v[252:255], v[156:159]
    s_waitcnt lgkmcnt(8)
    v_mfma_f32_16x16x32_bf16 v[208:211], v[88:91], v[224:227], v[208:211]
    ds_read_b64_tr_b16 v[80:81], v17 offset:49152
    v_mfma_f32_16x16x32_bf16 v[208:211], v[92:95], v[240:243], v[208:211]
    ds_read_b64_tr_b16 v[82:83], v17 offset:49664
    v_mfma_f32_16x16x32_bf16 v[212:215], v[88:91], v[228:231], v[212:215]
    v_mfma_f32_16x16x32_bf16 v[212:215], v[92:95], v[244:247], v[212:215]
    v_mfma_f32_16x16x32_bf16 v[216:219], v[88:91], v[232:235], v[216:219]
    ds_read_b64_tr_b16 v[84:85], v17 offset:53248
    v_mfma_f32_16x16x32_bf16 v[216:219], v[92:95], v[248:251], v[216:219]
    ds_read_b64_tr_b16 v[86:87], v17 offset:53760
    v_mfma_f32_16x16x32_bf16 v[220:223], v[88:91], v[236:239], v[220:223]
    v_mfma_f32_16x16x32_bf16 v[220:223], v[92:95], v[252:255], v[220:223]
    s_waitcnt lgkmcnt(8)
    v_mfma_f32_16x16x32_bf16 v[96:99], v[64:67], a[0:3], 0
    ds_read_b64_tr_b16 v[88:89], v17 offset:57344
    v_mul_f32 v144, v144, v208
    v_mfma_f32_16x16x32_bf16 v[96:99], v[68:71], a[16:19], v[96:99]
    ds_read_b64_tr_b16 v[90:91], v17 offset:57856
    s_add_u32 m0, s28, 0
    s_add_u32 s30, s82, 128
    v_mfma_f32_16x16x32_bf16 v[100:103], v[64:67], a[4:7], 0
    buffer_load_dwordx4 v8, s[36:39], s30 offen offset:0 lds
    v_mfma_f32_16x16x32_bf16 v[100:103], v[68:71], a[20:23], v[100:103]
    v_mul_f32 v145, v145, v209
    v_mul_f32 v146, v146, v210
    v_mfma_f32_16x16x32_bf16 v[104:107], v[64:67], a[8:11], 0
    ds_read_b64_tr_b16 v[92:93], v17 offset:61440
    v_mul_f32 v147, v147, v211
    v_mfma_f32_16x16x32_bf16 v[104:107], v[68:71], a[24:27], v[104:107]
    ds_read_b64_tr_b16 v[94:95], v17 offset:61952
    v_cvt_pk_bf16_f32 v194, v144, v145
    v_mfma_f32_16x16x32_bf16 v[108:111], v[64:67], a[12:15], 0
    v_cvt_pk_bf16_f32 v195, v146, v147
    s_mov_b32 s67, 2048
    buffer_store_dwordx4 v[192:195], v30, s[44:47], s67 offen offset:0 sc1
    v_mfma_f32_16x16x32_bf16 v[108:111], v[68:71], a[28:31], v[108:111]
    v_mul_f32 v148, v148, v212
    v_mul_f32 v149, v149, v213
    s_waitcnt lgkmcnt(8)
    v_mfma_f32_16x16x32_bf16 v[160:163], v[72:75], a[0:3], 0
    ds_read_b64_tr_b16 v[64:65], v18 offset:49152
    v_mul_f32 v150, v150, v214
    v_mfma_f32_16x16x32_bf16 v[160:163], v[76:79], a[16:19], v[160:163]
    ds_read_b64_tr_b16 v[66:67], v18 offset:49664
    v_mul_f32 v151, v151, v215
    v_mfma_f32_16x16x32_bf16 v[164:167], v[72:75], a[4:7], 0
    v_cvt_pk_bf16_f32 v198, v148, v149
    v_cvt_pk_bf16_f32 v199, v150, v151
    v_mfma_f32_16x16x32_bf16 v[164:167], v[76:79], a[20:23], v[164:167]
    s_mov_b32 s67, 2048
    buffer_store_dwordx4 v[196:199], v30, s[44:47], s67 offen offset:256 sc1
    v_mul_f32 v152, v152, v216
    v_mfma_f32_16x16x32_bf16 v[168:171], v[72:75], a[8:11], 0
    ds_read_b64_tr_b16 v[68:69], v18 offset:53248
    v_mul_f32 v153, v153, v217
    v_mfma_f32_16x16x32_bf16 v[168:171], v[76:79], a[24:27], v[168:171]
    ds_read_b64_tr_b16 v[70:71], v18 offset:53760
    v_mul_f32 v154, v154, v218
    v_mfma_f32_16x16x32_bf16 v[172:175], v[72:75], a[12:15], 0
    buffer_load_dwordx4 v9, s[36:39], s30 offen offset:1024 lds
    v_mfma_f32_16x16x32_bf16 v[172:175], v[76:79], a[28:31], v[172:175]
    v_mul_f32 v155, v155, v219
    v_cvt_pk_bf16_f32 v202, v152, v153
    s_waitcnt lgkmcnt(8)
    v_mfma_f32_16x16x32_bf16 v[112:115], v[80:83], a[0:3], 0
    ds_read_b64_tr_b16 v[72:73], v18 offset:57344
    v_cvt_pk_bf16_f32 v203, v154, v155
    v_mfma_f32_16x16x32_bf16 v[112:115], v[84:87], a[16:19], v[112:115]
    ds_read_b64_tr_b16 v[74:75], v18 offset:57856
    s_mov_b32 s67, 370688
    buffer_store_dwordx4 v[200:203], v30, s[44:47], s67 offen offset:0 sc1
    v_mfma_f32_16x16x32_bf16 v[116:119], v[80:83], a[4:7], 0
    v_mul_f32 v156, v156, v220
    v_mul_f32 v157, v157, v221
    v_mfma_f32_16x16x32_bf16 v[116:119], v[84:87], a[20:23], v[116:119]
    v_mul_f32 v158, v158, v222
    v_mul_f32 v159, v159, v223
    v_mfma_f32_16x16x32_bf16 v[120:123], v[80:83], a[8:11], 0
    ds_read_b64_tr_b16 v[76:77], v18 offset:61440
    v_cvt_pk_bf16_f32 v206, v156, v157
    v_mfma_f32_16x16x32_bf16 v[120:123], v[84:87], a[24:27], v[120:123]
    ds_read_b64_tr_b16 v[78:79], v18 offset:61952
    v_cvt_pk_bf16_f32 v207, v158, v159
    v_mfma_f32_16x16x32_bf16 v[124:127], v[80:83], a[12:15], 0
    s_mov_b32 s67, 370688
    buffer_store_dwordx4 v[204:207], v30, s[44:47], s67 offen offset:256 sc1
    v_mfma_f32_16x16x32_bf16 v[124:127], v[84:87], a[28:31], v[124:127]
    s_waitcnt lgkmcnt(8)
    v_mfma_f32_16x16x32_bf16 v[176:179], v[88:91], a[0:3], 0
    ds_read_b64_tr_b16 v[80:81], v19 offset:49152
    v_mfma_f32_16x16x32_bf16 v[176:179], v[92:95], a[16:19], v[176:179]
    ds_read_b64_tr_b16 v[82:83], v19 offset:49664
    v_mfma_f32_16x16x32_bf16 v[180:183], v[88:91], a[4:7], 0
    buffer_load_dwordx4 v10, s[36:39], s30 offen offset:2048 lds
    v_mfma_f32_16x16x32_bf16 v[180:183], v[92:95], a[20:23], v[180:183]
    v_mfma_f32_16x16x32_bf16 v[184:187], v[88:91], a[8:11], 0
    ds_read_b64_tr_b16 v[84:85], v19 offset:53248
    v_mfma_f32_16x16x32_bf16 v[184:187], v[92:95], a[24:27], v[184:187]
    ds_read_b64_tr_b16 v[86:87], v19 offset:53760
    v_mfma_f32_16x16x32_bf16 v[188:191], v[88:91], a[12:15], 0
    v_mfma_f32_16x16x32_bf16 v[188:191], v[92:95], a[28:31], v[188:191]
    s_waitcnt lgkmcnt(8)
    v_mfma_f32_16x16x32_bf16 v[128:131], v[64:67], a[0:3], 0
    ds_read_b64_tr_b16 v[88:89], v19 offset:57344
    v_mfma_f32_16x16x32_bf16 v[128:131], v[68:71], a[16:19], v[128:131]
    ds_read_b64_tr_b16 v[90:91], v19 offset:57856
    v_mfma_f32_16x16x32_bf16 v[132:135], v[64:67], a[4:7], 0
    v_mfma_f32_16x16x32_bf16 v[132:135], v[68:71], a[20:23], v[132:135]
    v_mfma_f32_16x16x32_bf16 v[136:139], v[64:67], a[8:11], 0
    ds_read_b64_tr_b16 v[92:93], v19 offset:61440
    v_mfma_f32_16x16x32_bf16 v[136:139], v[68:71], a[24:27], v[136:139]
    ds_read_b64_tr_b16 v[94:95], v19 offset:61952
    v_mfma_f32_16x16x32_bf16 v[140:143], v[64:67], a[12:15], 0
    buffer_load_dwordx4 v11, s[36:39], s30 offen offset:3072 lds
    v_mfma_f32_16x16x32_bf16 v[140:143], v[68:71], a[28:31], v[140:143]
    s_waitcnt lgkmcnt(8)
    v_mfma_f32_16x16x32_bf16 v[192:195], v[72:75], a[0:3], 0
    ds_read_b64_tr_b16 v[64:65], v20 offset:0
    v_mfma_f32_16x16x32_bf16 v[192:195], v[76:79], a[16:19], v[192:195]
    ds_read_b64_tr_b16 v[66:67], v20 offset:512
    v_mfma_f32_16x16x32_bf16 v[196:199], v[72:75], a[4:7], 0
    v_mfma_f32_16x16x32_bf16 v[196:199], v[76:79], a[20:23], v[196:199]
    v_mfma_f32_16x16x32_bf16 v[200:203], v[72:75], a[8:11], 0
    ds_read_b64_tr_b16 v[68:69], v20 offset:4096
    v_mfma_f32_16x16x32_bf16 v[200:203], v[76:79], a[24:27], v[200:203]
    ds_read_b64_tr_b16 v[70:71], v20 offset:4608
    v_mfma_f32_16x16x32_bf16 v[204:207], v[72:75], a[12:15], 0
    v_mfma_f32_16x16x32_bf16 v[204:207], v[76:79], a[28:31], v[204:207]
    s_waitcnt lgkmcnt(8)
    v_mfma_f32_16x16x32_bf16 v[144:147], v[80:83], a[0:3], 0
    ds_read_b64_tr_b16 v[72:73], v20 offset:8192
    v_mfma_f32_16x16x32_bf16 v[144:147], v[84:87], a[16:19], v[144:147]
    ds_read_b64_tr_b16 v[74:75], v20 offset:8704
    s_add_u32 m0, s28, 16384
    s_add_u32 s30, s83, 128
    v_mfma_f32_16x16x32_bf16 v[148:151], v[80:83], a[4:7], 0
    buffer_load_dwordx4 v8, s[36:39], s30 offen offset:0 lds
    v_mfma_f32_16x16x32_bf16 v[148:151], v[84:87], a[20:23], v[148:151]
    v_mfma_f32_16x16x32_bf16 v[152:155], v[80:83], a[8:11], 0
    ds_read_b64_tr_b16 v[76:77], v20 offset:12288
    v_mfma_f32_16x16x32_bf16 v[152:155], v[84:87], a[24:27], v[152:155]
    ds_read_b64_tr_b16 v[78:79], v20 offset:12800
    v_mfma_f32_16x16x32_bf16 v[156:159], v[80:83], a[12:15], 0
    v_mfma_f32_16x16x32_bf16 v[156:159], v[84:87], a[28:31], v[156:159]
    s_waitcnt lgkmcnt(8)
    v_mfma_f32_16x16x32_bf16 v[208:211], v[88:91], a[0:3], 0
    ds_read_b64_tr_b16 v[80:81], v21 offset:0
    v_mfma_f32_16x16x32_bf16 v[208:211], v[92:95], a[16:19], v[208:211]
    ds_read_b64_tr_b16 v[82:83], v21 offset:512
    v_mfma_f32_16x16x32_bf16 v[212:215], v[88:91], a[4:7], 0
    v_mfma_f32_16x16x32_bf16 v[212:215], v[92:95], a[20:23], v[212:215]
    v_mfma_f32_16x16x32_bf16 v[216:219], v[88:91], a[8:11], 0
    ds_read_b64_tr_b16 v[84:85], v21 offset:4096
    v_mfma_f32_16x16x32_bf16 v[216:219], v[92:95], a[24:27], v[216:219]
    ds_read_b64_tr_b16 v[86:87], v21 offset:4608
    v_mfma_f32_16x16x32_bf16 v[220:223], v[88:91], a[12:15], 0
    buffer_load_dwordx4 v9, s[36:39], s30 offen offset:1024 lds
    v_mfma_f32_16x16x32_bf16 v[220:223], v[92:95], a[28:31], v[220:223]
    s_waitcnt lgkmcnt(8)
    v_mfma_f32_16x16x32_bf16 v[96:99], v[64:67], a[32:35], v[96:99]
    ds_read_b64_tr_b16 v[88:89], v21 offset:8192
    v_mfma_f32_16x16x32_bf16 v[96:99], v[68:71], a[48:51], v[96:99]
    ds_read_b64_tr_b16 v[90:91], v21 offset:8704
    s_add_u32 s29, s62, 0
    v_mfma_f32_16x16x32_bf16 v[100:103], v[64:67], a[36:39], v[100:103]
    buffer_load_dword v7, v6, s[16:19], s29 offen
    v_mfma_f32_16x16x32_bf16 v[100:103], v[68:71], a[52:55], v[100:103]
    v_mfma_f32_16x16x32_bf16 v[104:107], v[64:67], a[40:43], v[104:107]
    ds_read_b64_tr_b16 v[92:93], v21 offset:12288
    v_mfma_f32_16x16x32_bf16 v[104:107], v[68:71], a[56:59], v[104:107]
    ds_read_b64_tr_b16 v[94:95], v21 offset:12800
    v_mfma_f32_16x16x32_bf16 v[108:111], v[64:67], a[44:47], v[108:111]
    v_mfma_f32_16x16x32_bf16 v[108:111], v[68:71], a[60:63], v[108:111]
    s_waitcnt lgkmcnt(8)
    v_mfma_f32_16x16x32_bf16 v[160:163], v[72:75], a[32:35], v[160:163]
    ds_read_b64_tr_b16 v[64:65], v22 offset:0
    v_mfma_f32_16x16x32_bf16 v[160:163], v[76:79], a[48:51], v[160:163]
    ds_read_b64_tr_b16 v[66:67], v22 offset:512
    v_mfma_f32_16x16x32_bf16 v[164:167], v[72:75], a[36:39], v[164:167]
    buffer_load_dwordx4 v10, s[36:39], s30 offen offset:2048 lds
    v_mfma_f32_16x16x32_bf16 v[164:167], v[76:79], a[52:55], v[164:167]
    v_mfma_f32_16x16x32_bf16 v[168:171], v[72:75], a[40:43], v[168:171]
    ds_read_b64_tr_b16 v[68:69], v22 offset:4096
    v_mfma_f32_16x16x32_bf16 v[168:171], v[76:79], a[56:59], v[168:171]
    ds_read_b64_tr_b16 v[70:71], v22 offset:4608
    v_mfma_f32_16x16x32_bf16 v[172:175], v[72:75], a[44:47], v[172:175]
    v_mfma_f32_16x16x32_bf16 v[172:175], v[76:79], a[60:63], v[172:175]
    s_waitcnt lgkmcnt(8)
    v_mfma_f32_16x16x32_bf16 v[112:115], v[80:83], a[32:35], v[112:115]
    ds_read_b64_tr_b16 v[72:73], v22 offset:8192
    v_mfma_f32_16x16x32_bf16 v[112:115], v[84:87], a[48:51], v[112:115]
    ds_read_b64_tr_b16 v[74:75], v22 offset:8704
    v_mfma_f32_16x16x32_bf16 v[116:119], v[80:83], a[36:39], v[116:119]
    v_mfma_f32_16x16x32_bf16 v[116:119], v[84:87], a[52:55], v[116:119]
    v_mfma_f32_16x16x32_bf16 v[120:123], v[80:83], a[40:43], v[120:123]
    ds_read_b64_tr_b16 v[76:77], v22 offset:12288
    v_mfma_f32_16x16x32_bf16 v[120:123], v[84:87], a[56:59], v[120:123]
    ds_read_b64_tr_b16 v[78:79], v22 offset:12800
    v_mfma_f32_16x16x32_bf16 v[124:127], v[80:83], a[44:47], v[124:127]
    buffer_load_dwordx4 v11, s[36:39], s30 offen offset:3072 lds
    v_mfma_f32_16x16x32_bf16 v[124:127], v[84:87], a[60:63], v[124:127]
    s_waitcnt lgkmcnt(8)
    v_mfma_f32_16x16x32_bf16 v[176:179], v[88:91], a[32:35], v[176:179]
    ds_read_b64_tr_b16 v[80:81], v23 offset:0
    v_mfma_f32_16x16x32_bf16 v[176:179], v[92:95], a[48:51], v[176:179]
    ds_read_b64_tr_b16 v[82:83], v23 offset:512
    v_mfma_f32_16x16x32_bf16 v[180:183], v[88:91], a[36:39], v[180:183]
    v_mfma_f32_16x16x32_bf16 v[180:183], v[92:95], a[52:55], v[180:183]
    v_mfma_f32_16x16x32_bf16 v[184:187], v[88:91], a[40:43], v[184:187]
    ds_read_b64_tr_b16 v[84:85], v23 offset:4096
    v_mfma_f32_16x16x32_bf16 v[184:187], v[92:95], a[56:59], v[184:187]
    ds_read_b64_tr_b16 v[86:87], v23 offset:4608
    v_mfma_f32_16x16x32_bf16 v[188:191], v[88:91], a[44:47], v[188:191]
    v_mfma_f32_16x16x32_bf16 v[188:191], v[92:95], a[60:63], v[188:191]
    s_waitcnt lgkmcnt(8)
    v_mfma_f32_16x16x32_bf16 v[128:131], v[64:67], a[32:35], v[128:131]
    ds_read_b64_tr_b16 v[88:89], v23 offset:8192
    v_mfma_f32_16x16x32_bf16 v[128:131], v[68:71], a[48:51], v[128:131]
    ds_read_b64_tr_b16 v[90:91], v23 offset:8704
    s_add_u32 m0, s28, 32768
    s_add_u32 s30, s84, 128
    v_mfma_f32_16x16x32_bf16 v[132:135], v[64:67], a[36:39], v[132:135]
    buffer_load_dwordx4 v8, s[36:39], s30 offen offset:0 lds
    v_mfma_f32_16x16x32_bf16 v[132:135], v[68:71], a[52:55], v[132:135]
    v_mfma_f32_16x16x32_bf16 v[136:139], v[64:67], a[40:43], v[136:139]
    ds_read_b64_tr_b16 v[92:93], v23 offset:12288
    v_mfma_f32_16x16x32_bf16 v[136:139], v[68:71], a[56:59], v[136:139]
    ds_read_b64_tr_b16 v[94:95], v23 offset:12800
    v_mfma_f32_16x16x32_bf16 v[140:143], v[64:67], a[44:47], v[140:143]
    v_mfma_f32_16x16x32_bf16 v[140:143], v[68:71], a[60:63], v[140:143]
    s_waitcnt lgkmcnt(8)
    v_mfma_f32_16x16x32_bf16 v[192:195], v[72:75], a[32:35], v[192:195]
    ds_read_b64_tr_b16 v[64:65], v20 offset:16384
    v_mfma_f32_16x16x32_bf16 v[192:195], v[76:79], a[48:51], v[192:195]
    ds_read_b64_tr_b16 v[66:67], v20 offset:16896
    v_mfma_f32_16x16x32_bf16 v[196:199], v[72:75], a[36:39], v[196:199]
    v_mfma_f32_16x16x32_bf16 v[196:199], v[76:79], a[52:55], v[196:199]
    v_mfma_f32_16x16x32_bf16 v[200:203], v[72:75], a[40:43], v[200:203]
    ds_read_b64_tr_b16 v[68:69], v20 offset:20480
    v_mfma_f32_16x16x32_bf16 v[200:203], v[76:79], a[56:59], v[200:203]
    ds_read_b64_tr_b16 v[70:71], v20 offset:20992
    v_mfma_f32_16x16x32_bf16 v[204:207], v[72:75], a[44:47], v[204:207]
    buffer_load_dwordx4 v9, s[36:39], s30 offen offset:1024 lds
    v_mfma_f32_16x16x32_bf16 v[204:207], v[76:79], a[60:63], v[204:207]
    s_waitcnt lgkmcnt(8)
    v_mfma_f32_16x16x32_bf16 v[144:147], v[80:83], a[32:35], v[144:147]
    ds_read_b64_tr_b16 v[72:73], v20 offset:24576
    v_mfma_f32_16x16x32_bf16 v[144:147], v[84:87], a[48:51], v[144:147]
    ds_read_b64_tr_b16 v[74:75], v20 offset:25088
    v_mfma_f32_16x16x32_bf16 v[148:151], v[80:83], a[36:39], v[148:151]
    v_mfma_f32_16x16x32_bf16 v[148:151], v[84:87], a[52:55], v[148:151]
    v_mfma_f32_16x16x32_bf16 v[152:155], v[80:83], a[40:43], v[152:155]
    ds_read_b64_tr_b16 v[76:77], v20 offset:28672
    v_mfma_f32_16x16x32_bf16 v[152:155], v[84:87], a[56:59], v[152:155]
    ds_read_b64_tr_b16 v[78:79], v20 offset:29184
    v_mfma_f32_16x16x32_bf16 v[156:159], v[80:83], a[44:47], v[156:159]
    v_mfma_f32_16x16x32_bf16 v[156:159], v[84:87], a[60:63], v[156:159]
    s_waitcnt lgkmcnt(8)
    v_mfma_f32_16x16x32_bf16 v[208:211], v[88:91], a[32:35], v[208:211]
    ds_read_b64_tr_b16 v[80:81], v21 offset:16384
    v_mfma_f32_16x16x32_bf16 v[208:211], v[92:95], a[48:51], v[208:211]
    ds_read_b64_tr_b16 v[82:83], v21 offset:16896
    v_mfma_f32_16x16x32_bf16 v[212:215], v[88:91], a[36:39], v[212:215]
    buffer_load_dwordx4 v10, s[36:39], s30 offen offset:2048 lds
    v_mfma_f32_16x16x32_bf16 v[212:215], v[92:95], a[52:55], v[212:215]
    v_mfma_f32_16x16x32_bf16 v[216:219], v[88:91], a[40:43], v[216:219]
    ds_read_b64_tr_b16 v[84:85], v21 offset:20480
    v_mfma_f32_16x16x32_bf16 v[216:219], v[92:95], a[56:59], v[216:219]
    ds_read_b64_tr_b16 v[86:87], v21 offset:20992
    v_mfma_f32_16x16x32_bf16 v[220:223], v[88:91], a[44:47], v[220:223]
    v_mfma_f32_16x16x32_bf16 v[220:223], v[92:95], a[60:63], v[220:223]
    s_waitcnt lgkmcnt(8)
    v_mfma_f32_16x16x32_bf16 v[96:99], v[64:67], a[64:67], v[96:99]
    ds_read_b64_tr_b16 v[88:89], v21 offset:24576
    v_mfma_f32_16x16x32_bf16 v[96:99], v[68:71], a[80:83], v[96:99]
    ds_read_b64_tr_b16 v[90:91], v21 offset:25088
    v_mfma_f32_16x16x32_bf16 v[100:103], v[64:67], a[68:71], v[100:103]
    v_mfma_f32_16x16x32_bf16 v[100:103], v[68:71], a[84:87], v[100:103]
    v_mfma_f32_16x16x32_bf16 v[104:107], v[64:67], a[72:75], v[104:107]
    ds_read_b64_tr_b16 v[92:93], v21 offset:28672
    v_mfma_f32_16x16x32_bf16 v[104:107], v[68:71], a[88:91], v[104:107]
    ds_read_b64_tr_b16 v[94:95], v21 offset:29184
    v_mfma_f32_16x16x32_bf16 v[108:111], v[64:67], a[76:79], v[108:111]
    buffer_load_dwordx4 v11, s[36:39], s30 offen offset:3072 lds
    v_mfma_f32_16x16x32_bf16 v[108:111], v[68:71], a[92:95], v[108:111]
    s_waitcnt lgkmcnt(8)
    v_mfma_f32_16x16x32_bf16 v[160:163], v[72:75], a[64:67], v[160:163]
    ds_read_b64_tr_b16 v[64:65], v22 offset:16384
    v_mfma_f32_16x16x32_bf16 v[160:163], v[76:79], a[80:83], v[160:163]
    ds_read_b64_tr_b16 v[66:67], v22 offset:16896
    v_mfma_f32_16x16x32_bf16 v[164:167], v[72:75], a[68:71], v[164:167]
    v_mfma_f32_16x16x32_bf16 v[164:167], v[76:79], a[84:87], v[164:167]
    v_mfma_f32_16x16x32_bf16 v[168:171], v[72:75], a[72:75], v[168:171]
    ds_read_b64_tr_b16 v[68:69], v22 offset:20480
    v_mfma_f32_16x16x32_bf16 v[168:171], v[76:79], a[88:91], v[168:171]
    ds_read_b64_tr_b16 v[70:71], v22 offset:20992
    v_mfma_f32_16x16x32_bf16 v[172:175], v[72:75], a[76:79], v[172:175]
    v_mfma_f32_16x16x32_bf16 v[172:175], v[76:79], a[92:95], v[172:175]
    s_waitcnt lgkmcnt(8)
    v_mfma_f32_16x16x32_bf16 v[112:115], v[80:83], a[64:67], v[112:115]
    ds_read_b64_tr_b16 v[72:73], v22 offset:24576
    v_mfma_f32_16x16x32_bf16 v[112:115], v[84:87], a[80:83], v[112:115]
    ds_read_b64_tr_b16 v[74:75], v22 offset:25088
    s_add_u32 s29, s62, 2304
    v_mfma_f32_16x16x32_bf16 v[116:119], v[80:83], a[68:71], v[116:119]
    buffer_load_dword v7, v6, s[16:19], s29 offen
    v_mfma_f32_16x16x32_bf16 v[116:119], v[84:87], a[84:87], v[116:119]
    v_mfma_f32_16x16x32_bf16 v[120:123], v[80:83], a[72:75], v[120:123]
    ds_read_b64_tr_b16 v[76:77], v22 offset:28672
    v_mfma_f32_16x16x32_bf16 v[120:123], v[84:87], a[88:91], v[120:123]
    ds_read_b64_tr_b16 v[78:79], v22 offset:29184
    v_mfma_f32_16x16x32_bf16 v[124:127], v[80:83], a[76:79], v[124:127]
    v_mfma_f32_16x16x32_bf16 v[124:127], v[84:87], a[92:95], v[124:127]
    s_waitcnt lgkmcnt(8)
    v_mfma_f32_16x16x32_bf16 v[176:179], v[88:91], a[64:67], v[176:179]
    ds_read_b64_tr_b16 v[80:81], v23 offset:16384
    v_mfma_f32_16x16x32_bf16 v[176:179], v[92:95], a[80:83], v[176:179]
    ds_read_b64_tr_b16 v[82:83], v23 offset:16896
    v_mfma_f32_16x16x32_bf16 v[180:183], v[88:91], a[68:71], v[180:183]
    v_mfma_f32_16x16x32_bf16 v[180:183], v[92:95], a[84:87], v[180:183]
    v_mfma_f32_16x16x32_bf16 v[184:187], v[88:91], a[72:75], v[184:187]
    ds_read_b64_tr_b16 v[84:85], v23 offset:20480
    v_mfma_f32_16x16x32_bf16 v[184:187], v[92:95], a[88:91], v[184:187]
    ds_read_b64_tr_b16 v[86:87], v23 offset:20992
    v_mfma_f32_16x16x32_bf16 v[188:191], v[88:91], a[76:79], v[188:191]
    v_mfma_f32_16x16x32_bf16 v[188:191], v[92:95], a[92:95], v[188:191]
    s_waitcnt lgkmcnt(8)
    v_mfma_f32_16x16x32_bf16 v[128:131], v[64:67], a[64:67], v[128:131]
    ds_read_b64_tr_b16 v[88:89], v23 offset:24576
    v_mfma_f32_16x16x32_bf16 v[128:131], v[68:71], a[80:83], v[128:131]
    ds_read_b64_tr_b16 v[90:91], v23 offset:25088
    v_mfma_f32_16x16x32_bf16 v[132:135], v[64:67], a[68:71], v[132:135]
    v_mfma_f32_16x16x32_bf16 v[132:135], v[68:71], a[84:87], v[132:135]
    v_mfma_f32_16x16x32_bf16 v[136:139], v[64:67], a[72:75], v[136:139]
    ds_read_b64_tr_b16 v[92:93], v23 offset:28672
    v_mfma_f32_16x16x32_bf16 v[136:139], v[68:71], a[88:91], v[136:139]
    ds_read_b64_tr_b16 v[94:95], v23 offset:29184
    v_mfma_f32_16x16x32_bf16 v[140:143], v[64:67], a[76:79], v[140:143]
    v_mfma_f32_16x16x32_bf16 v[140:143], v[68:71], a[92:95], v[140:143]
    s_waitcnt vmcnt(19)
    s_barrier
    s_waitcnt lgkmcnt(8)
    v_mfma_f32_16x16x32_bf16 v[192:195], v[72:75], a[64:67], v[192:195]
    ds_read_b64_tr_b16 v[64:65], v20 offset:32768
    v_mfma_f32_16x16x32_bf16 v[192:195], v[76:79], a[80:83], v[192:195]
    ds_read_b64_tr_b16 v[66:67], v20 offset:33280
    v_mfma_f32_16x16x32_bf16 v[196:199], v[72:75], a[68:71], v[196:199]
    v_mfma_f32_16x16x32_bf16 v[196:199], v[76:79], a[84:87], v[196:199]
    v_mfma_f32_16x16x32_bf16 v[200:203], v[72:75], a[72:75], v[200:203]
    ds_read_b64_tr_b16 v[68:69], v20 offset:36864
    v_mfma_f32_16x16x32_bf16 v[200:203], v[76:79], a[88:91], v[200:203]
    ds_read_b64_tr_b16 v[70:71], v20 offset:37376
    v_mfma_f32_16x16x32_bf16 v[204:207], v[72:75], a[76:79], v[204:207]
    v_mfma_f32_16x16x32_bf16 v[204:207], v[76:79], a[92:95], v[204:207]
    s_waitcnt lgkmcnt(8)
    v_mfma_f32_16x16x32_bf16 v[144:147], v[80:83], a[64:67], v[144:147]
    ds_read_b64_tr_b16 v[72:73], v20 offset:40960
    v_mfma_f32_16x16x32_bf16 v[144:147], v[84:87], a[80:83], v[144:147]
    ds_read_b64_tr_b16 v[74:75], v20 offset:41472
    v_mfma_f32_16x16x32_bf16 v[148:151], v[80:83], a[68:71], v[148:151]
    v_mfma_f32_16x16x32_bf16 v[148:151], v[84:87], a[84:87], v[148:151]
    v_mfma_f32_16x16x32_bf16 v[152:155], v[80:83], a[72:75], v[152:155]
    ds_read_b64_tr_b16 v[76:77], v20 offset:45056
    v_mfma_f32_16x16x32_bf16 v[152:155], v[84:87], a[88:91], v[152:155]
    ds_read_b64_tr_b16 v[78:79], v20 offset:45568
    v_mfma_f32_16x16x32_bf16 v[156:159], v[80:83], a[76:79], v[156:159]
    v_mfma_f32_16x16x32_bf16 v[156:159], v[84:87], a[92:95], v[156:159]
    s_waitcnt lgkmcnt(8)
    v_mfma_f32_16x16x32_bf16 v[208:211], v[88:91], a[64:67], v[208:211]
    ds_read_b64_tr_b16 v[80:81], v21 offset:32768
    v_mfma_f32_16x16x32_bf16 v[208:211], v[92:95], a[80:83], v[208:211]
    ds_read_b64_tr_b16 v[82:83], v21 offset:33280
    v_mfma_f32_16x16x32_bf16 v[212:215], v[88:91], a[68:71], v[212:215]
    v_mfma_f32_16x16x32_bf16 v[212:215], v[92:95], a[84:87], v[212:215]
    v_mfma_f32_16x16x32_bf16 v[216:219], v[88:91], a[72:75], v[216:219]
    ds_read_b64_tr_b16 v[84:85], v21 offset:36864
    v_mfma_f32_16x16x32_bf16 v[216:219], v[92:95], a[88:91], v[216:219]
    ds_read_b64_tr_b16 v[86:87], v21 offset:37376
    s_add_u32 m0, s28, 49152
    s_add_u32 s30, s76, 256
    v_mfma_f32_16x16x32_bf16 v[220:223], v[88:91], a[76:79], v[220:223]
    buffer_load_dwordx4 v8, s[36:39], s30 offen offset:0 lds
    v_mfma_f32_16x16x32_bf16 v[220:223], v[92:95], a[92:95], v[220:223]
    s_waitcnt lgkmcnt(8)
    v_mfma_f32_16x16x32_bf16 v[96:99], v[64:67], a[96:99], v[96:99]
    ds_read_b64_tr_b16 v[88:89], v21 offset:40960
    v_mfma_f32_16x16x32_bf16 v[96:99], v[68:71], a[112:115], v[96:99]
    ds_read_b64_tr_b16 v[90:91], v21 offset:41472
    v_mfma_f32_16x16x32_bf16 v[100:103], v[64:67], a[100:103], v[100:103]
    v_mfma_f32_16x16x32_bf16 v[100:103], v[68:71], a[116:119], v[100:103]
    v_mfma_f32_16x16x32_bf16 v[104:107], v[64:67], a[104:107], v[104:107]
    ds_read_b64_tr_b16 v[92:93], v21 offset:45056
    v_mfma_f32_16x16x32_bf16 v[104:107], v[68:71], a[120:123], v[104:107]
    ds_read_b64_tr_b16 v[94:95], v21 offset:45568
    v_mfma_f32_16x16x32_bf16 v[108:111], v[64:67], a[108:111], v[108:111]
    v_mfma_f32_16x16x32_bf16 v[108:111], v[68:71], a[124:127], v[108:111]
    s_waitcnt lgkmcnt(8)
    v_mfma_f32_16x16x32_bf16 v[160:163], v[72:75], a[96:99], v[160:163]
    ds_read_b64_tr_b16 v[64:65], v22 offset:32768
    v_mfma_f32_16x16x32_bf16 v[160:163], v[76:79], a[112:115], v[160:163]
    ds_read_b64_tr_b16 v[66:67], v22 offset:33280
    v_mfma_f32_16x16x32_bf16 v[164:167], v[72:75], a[100:103], v[164:167]
    buffer_load_dwordx4 v9, s[36:39], s30 offen offset:1024 lds
    v_mfma_f32_16x16x32_bf16 v[164:167], v[76:79], a[116:119], v[164:167]
    v_mfma_f32_16x16x32_bf16 v[168:171], v[72:75], a[104:107], v[168:171]
    ds_read_b64_tr_b16 v[68:69], v22 offset:36864
    v_mfma_f32_16x16x32_bf16 v[168:171], v[76:79], a[120:123], v[168:171]
    ds_read_b64_tr_b16 v[70:71], v22 offset:37376
    v_mfma_f32_16x16x32_bf16 v[172:175], v[72:75], a[108:111], v[172:175]
    v_mfma_f32_16x16x32_bf16 v[172:175], v[76:79], a[124:127], v[172:175]
    s_waitcnt lgkmcnt(8)
    v_mfma_f32_16x16x32_bf16 v[112:115], v[80:83], a[96:99], v[112:115]
    ds_read_b64_tr_b16 v[72:73], v22 offset:40960
    v_mfma_f32_16x16x32_bf16 v[112:115], v[84:87], a[112:115], v[112:115]
    ds_read_b64_tr_b16 v[74:75], v22 offset:41472
    v_mfma_f32_16x16x32_bf16 v[116:119], v[80:83], a[100:103], v[116:119]
    v_mfma_f32_16x16x32_bf16 v[116:119], v[84:87], a[116:119], v[116:119]
    v_mfma_f32_16x16x32_bf16 v[120:123], v[80:83], a[104:107], v[120:123]
    ds_read_b64_tr_b16 v[76:77], v22 offset:45056
    v_mfma_f32_16x16x32_bf16 v[120:123], v[84:87], a[120:123], v[120:123]
    ds_read_b64_tr_b16 v[78:79], v22 offset:45568
    v_mfma_f32_16x16x32_bf16 v[124:127], v[80:83], a[108:111], v[124:127]
    buffer_load_dwordx4 v10, s[36:39], s30 offen offset:2048 lds
    v_mfma_f32_16x16x32_bf16 v[124:127], v[84:87], a[124:127], v[124:127]
    s_waitcnt lgkmcnt(8)
    v_mfma_f32_16x16x32_bf16 v[176:179], v[88:91], a[96:99], v[176:179]
    ds_read_b64_tr_b16 v[80:81], v23 offset:32768
    v_mfma_f32_16x16x32_bf16 v[176:179], v[92:95], a[112:115], v[176:179]
    ds_read_b64_tr_b16 v[82:83], v23 offset:33280
    v_mfma_f32_16x16x32_bf16 v[180:183], v[88:91], a[100:103], v[180:183]
    v_mfma_f32_16x16x32_bf16 v[180:183], v[92:95], a[116:119], v[180:183]
    v_mfma_f32_16x16x32_bf16 v[184:187], v[88:91], a[104:107], v[184:187]
    ds_read_b64_tr_b16 v[84:85], v23 offset:36864
    v_mfma_f32_16x16x32_bf16 v[184:187], v[92:95], a[120:123], v[184:187]
    ds_read_b64_tr_b16 v[86:87], v23 offset:37376
    v_mfma_f32_16x16x32_bf16 v[188:191], v[88:91], a[108:111], v[188:191]
    v_mfma_f32_16x16x32_bf16 v[188:191], v[92:95], a[124:127], v[188:191]
    s_waitcnt lgkmcnt(8)
    v_mfma_f32_16x16x32_bf16 v[128:131], v[64:67], a[96:99], v[128:131]
    ds_read_b64_tr_b16 v[88:89], v23 offset:40960
    v_mfma_f32_16x16x32_bf16 v[128:131], v[68:71], a[112:115], v[128:131]
    ds_read_b64_tr_b16 v[90:91], v23 offset:41472
    v_mfma_f32_16x16x32_bf16 v[132:135], v[64:67], a[100:103], v[132:135]
    buffer_load_dwordx4 v11, s[36:39], s30 offen offset:3072 lds
    v_mfma_f32_16x16x32_bf16 v[132:135], v[68:71], a[116:119], v[132:135]
    v_mfma_f32_16x16x32_bf16 v[136:139], v[64:67], a[104:107], v[136:139]
    ds_read_b64_tr_b16 v[92:93], v23 offset:45056
    v_mfma_f32_16x16x32_bf16 v[136:139], v[68:71], a[120:123], v[136:139]
    ds_read_b64_tr_b16 v[94:95], v23 offset:45568
    s_add_u32 s29, s62, 4608
    v_mfma_f32_16x16x32_bf16 v[140:143], v[64:67], a[108:111], v[140:143]
    buffer_load_dword v7, v6, s[16:19], s29 offen
    v_mfma_f32_16x16x32_bf16 v[140:143], v[68:71], a[124:127], v[140:143]
    s_waitcnt lgkmcnt(8)
    v_mfma_f32_16x16x32_bf16 v[192:195], v[72:75], a[96:99], v[192:195]
    ds_read_b64_tr_b16 v[64:65], v20 offset:49152
    v_mfma_f32_16x16x32_bf16 v[192:195], v[76:79], a[112:115], v[192:195]
    ds_read_b64_tr_b16 v[66:67], v20 offset:49664
    v_mfma_f32_16x16x32_bf16 v[196:199], v[72:75], a[100:103], v[196:199]
    v_mfma_f32_16x16x32_bf16 v[196:199], v[76:79], a[116:119], v[196:199]
    v_mfma_f32_16x16x32_bf16 v[200:203], v[72:75], a[104:107], v[200:203]
    ds_read_b64_tr_b16 v[68:69], v20 offset:53248
    v_mfma_f32_16x16x32_bf16 v[200:203], v[76:79], a[120:123], v[200:203]
    ds_read_b64_tr_b16 v[70:71], v20 offset:53760
    s_add_u32 m0, s28, 65536
    s_add_u32 s30, s77, 256
    v_mfma_f32_16x16x32_bf16 v[204:207], v[72:75], a[108:111], v[204:207]
    buffer_load_dwordx4 v8, s[36:39], s30 offen offset:0 lds
    v_mfma_f32_16x16x32_bf16 v[204:207], v[76:79], a[124:127], v[204:207]
    s_waitcnt lgkmcnt(8)
    v_mfma_f32_16x16x32_bf16 v[144:147], v[80:83], a[96:99], v[144:147]
    ds_read_b64_tr_b16 v[72:73], v20 offset:57344
    v_mfma_f32_16x16x32_bf16 v[144:147], v[84:87], a[112:115], v[144:147]
    ds_read_b64_tr_b16 v[74:75], v20 offset:57856
    v_mfma_f32_16x16x32_bf16 v[148:151], v[80:83], a[100:103], v[148:151]
    v_mfma_f32_16x16x32_bf16 v[148:151], v[84:87], a[116:119], v[148:151]
    v_mfma_f32_16x16x32_bf16 v[152:155], v[80:83], a[104:107], v[152:155]
    ds_read_b64_tr_b16 v[76:77], v20 offset:61440
    v_mfma_f32_16x16x32_bf16 v[152:155], v[84:87], a[120:123], v[152:155]
    ds_read_b64_tr_b16 v[78:79], v20 offset:61952
    v_mfma_f32_16x16x32_bf16 v[156:159], v[80:83], a[108:111], v[156:159]
    v_mfma_f32_16x16x32_bf16 v[156:159], v[84:87], a[124:127], v[156:159]
    s_waitcnt lgkmcnt(8)
    v_mfma_f32_16x16x32_bf16 v[208:211], v[88:91], a[96:99], v[208:211]
    ds_read_b64_tr_b16 v[80:81], v21 offset:49152
    v_mfma_f32_16x16x32_bf16 v[208:211], v[92:95], a[112:115], v[208:211]
    ds_read_b64_tr_b16 v[82:83], v21 offset:49664
    v_mfma_f32_16x16x32_bf16 v[212:215], v[88:91], a[100:103], v[212:215]
    buffer_load_dwordx4 v9, s[36:39], s30 offen offset:1024 lds
    v_mfma_f32_16x16x32_bf16 v[212:215], v[92:95], a[116:119], v[212:215]
    v_mfma_f32_16x16x32_bf16 v[216:219], v[88:91], a[104:107], v[216:219]
    ds_read_b64_tr_b16 v[84:85], v21 offset:53248
    v_mfma_f32_16x16x32_bf16 v[216:219], v[92:95], a[120:123], v[216:219]
    ds_read_b64_tr_b16 v[86:87], v21 offset:53760
    v_mfma_f32_16x16x32_bf16 v[220:223], v[88:91], a[108:111], v[220:223]
    v_mfma_f32_16x16x32_bf16 v[220:223], v[92:95], a[124:127], v[220:223]
    s_waitcnt lgkmcnt(8)
    v_mfma_f32_16x16x32_bf16 v[96:99], v[64:67], a[128:131], v[96:99]
    ds_read_b64_tr_b16 v[88:89], v21 offset:57344
    v_mfma_f32_16x16x32_bf16 v[96:99], v[68:71], a[144:147], v[96:99]
    ds_read_b64_tr_b16 v[90:91], v21 offset:57856
    v_mfma_f32_16x16x32_bf16 v[100:103], v[64:67], a[132:135], v[100:103]
    v_mfma_f32_16x16x32_bf16 v[100:103], v[68:71], a[148:151], v[100:103]
    v_mfma_f32_16x16x32_bf16 v[104:107], v[64:67], a[136:139], v[104:107]
    ds_read_b64_tr_b16 v[92:93], v21 offset:61440
    v_mfma_f32_16x16x32_bf16 v[104:107], v[68:71], a[152:155], v[104:107]
    ds_read_b64_tr_b16 v[94:95], v21 offset:61952
    v_mfma_f32_16x16x32_bf16 v[108:111], v[64:67], a[140:143], v[108:111]
    buffer_load_dwordx4 v10, s[36:39], s30 offen offset:2048 lds
    v_mfma_f32_16x16x32_bf16 v[108:111], v[68:71], a[156:159], v[108:111]
    s_waitcnt lgkmcnt(8)
    v_mfma_f32_16x16x32_bf16 v[160:163], v[72:75], a[128:131], v[160:163]
    ds_read_b64_tr_b16 v[64:65], v22 offset:49152
    v_mfma_f32_16x16x32_bf16 v[160:163], v[76:79], a[144:147], v[160:163]
    ds_read_b64_tr_b16 v[66:67], v22 offset:49664
    v_mfma_f32_16x16x32_bf16 v[164:167], v[72:75], a[132:135], v[164:167]
    v_mfma_f32_16x16x32_bf16 v[164:167], v[76:79], a[148:151], v[164:167]
    v_mfma_f32_16x16x32_bf16 v[168:171], v[72:75], a[136:139], v[168:171]
    ds_read_b64_tr_b16 v[68:69], v22 offset:53248
    v_mfma_f32_16x16x32_bf16 v[168:171], v[76:79], a[152:155], v[168:171]
    ds_read_b64_tr_b16 v[70:71], v22 offset:53760
    v_mfma_f32_16x16x32_bf16 v[172:175], v[72:75], a[140:143], v[172:175]
    v_mfma_f32_16x16x32_bf16 v[172:175], v[76:79], a[156:159], v[172:175]
    s_waitcnt lgkmcnt(8)
    v_mfma_f32_16x16x32_bf16 v[112:115], v[80:83], a[128:131], v[112:115]
    ds_read_b64_tr_b16 v[72:73], v22 offset:57344
    v_mfma_f32_16x16x32_bf16 v[112:115], v[84:87], a[144:147], v[112:115]
    ds_read_b64_tr_b16 v[74:75], v22 offset:57856
    v_mfma_f32_16x16x32_bf16 v[116:119], v[80:83], a[132:135], v[116:119]
    buffer_load_dwordx4 v11, s[36:39], s30 offen offset:3072 lds
    v_mfma_f32_16x16x32_bf16 v[116:119], v[84:87], a[148:151], v[116:119]
    v_mfma_f32_16x16x32_bf16 v[120:123], v[80:83], a[136:139], v[120:123]
    ds_read_b64_tr_b16 v[76:77], v22 offset:61440
    v_mfma_f32_16x16x32_bf16 v[120:123], v[84:87], a[152:155], v[120:123]
    ds_read_b64_tr_b16 v[78:79], v22 offset:61952
    v_mfma_f32_16x16x32_bf16 v[124:127], v[80:83], a[140:143], v[124:127]
    v_mfma_f32_16x16x32_bf16 v[124:127], v[84:87], a[156:159], v[124:127]
    s_waitcnt lgkmcnt(8)
    v_mfma_f32_16x16x32_bf16 v[176:179], v[88:91], a[128:131], v[176:179]
    ds_read_b64_tr_b16 v[80:81], v23 offset:49152
    v_mfma_f32_16x16x32_bf16 v[176:179], v[92:95], a[144:147], v[176:179]
    ds_read_b64_tr_b16 v[82:83], v23 offset:49664
    v_mfma_f32_16x16x32_bf16 v[180:183], v[88:91], a[132:135], v[180:183]
    v_mfma_f32_16x16x32_bf16 v[180:183], v[92:95], a[148:151], v[180:183]
    s_waitcnt vmcnt(21)
    buffer_store_dword v36, v37, s[48:51], s56 offen offset:0 sc1
    v_mfma_f32_16x16x32_bf16 v[184:187], v[88:91], a[136:139], v[184:187]
    ds_read_b64_tr_b16 v[84:85], v23 offset:53248
    v_mfma_f32_16x16x32_bf16 v[184:187], v[92:95], a[152:155], v[184:187]
    ds_read_b64_tr_b16 v[86:87], v23 offset:53760
    s_add_u32 m0, s28, 81920
    s_add_u32 s30, s78, 256
    v_mfma_f32_16x16x32_bf16 v[188:191], v[88:91], a[140:143], v[188:191]
    buffer_load_dwordx4 v8, s[36:39], s30 offen offset:0 lds
    v_mfma_f32_16x16x32_bf16 v[188:191], v[92:95], a[156:159], v[188:191]
    s_waitcnt lgkmcnt(8)
    v_mfma_f32_16x16x32_bf16 v[128:131], v[64:67], a[128:131], v[128:131]
    ds_read_b64_tr_b16 v[88:89], v23 offset:57344
    v_mfma_f32_16x16x32_bf16 v[128:131], v[68:71], a[144:147], v[128:131]
    ds_read_b64_tr_b16 v[90:91], v23 offset:57856
    v_mfma_f32_16x16x32_bf16 v[132:135], v[64:67], a[132:135], v[132:135]
    v_mfma_f32_16x16x32_bf16 v[132:135], v[68:71], a[148:151], v[132:135]
    v_mfma_f32_16x16x32_bf16 v[136:139], v[64:67], a[136:139], v[136:139]
    ds_read_b64_tr_b16 v[92:93], v23 offset:61440
    v_mfma_f32_16x16x32_bf16 v[136:139], v[68:71], a[152:155], v[136:139]
    ds_read_b64_tr_b16 v[94:95], v23 offset:61952
    v_mfma_f32_16x16x32_bf16 v[140:143], v[64:67], a[140:143], v[140:143]
    v_mfma_f32_16x16x32_bf16 v[140:143], v[68:71], a[156:159], v[140:143]
    s_waitcnt lgkmcnt(8)
    v_mfma_f32_16x16x32_bf16 v[192:195], v[72:75], a[128:131], v[192:195]
    ds_read_b64_tr_b16 v[64:65], v24 offset:0
    v_mfma_f32_16x16x32_bf16 v[192:195], v[76:79], a[144:147], v[192:195]
    ds_read_b64_tr_b16 v[66:67], v24 offset:512
    v_mfma_f32_16x16x32_bf16 v[196:199], v[72:75], a[132:135], v[196:199]
    buffer_load_dwordx4 v9, s[36:39], s30 offen offset:1024 lds
    v_mfma_f32_16x16x32_bf16 v[196:199], v[76:79], a[148:151], v[196:199]
    v_mfma_f32_16x16x32_bf16 v[200:203], v[72:75], a[136:139], v[200:203]
    ds_read_b64_tr_b16 v[68:69], v24 offset:4096
    v_mfma_f32_16x16x32_bf16 v[200:203], v[76:79], a[152:155], v[200:203]
    ds_read_b64_tr_b16 v[70:71], v24 offset:4608
    v_mfma_f32_16x16x32_bf16 v[204:207], v[72:75], a[140:143], v[204:207]
    v_mfma_f32_16x16x32_bf16 v[204:207], v[76:79], a[156:159], v[204:207]
    s_waitcnt lgkmcnt(8)
    v_mfma_f32_16x16x32_bf16 v[144:147], v[80:83], a[128:131], v[144:147]
    ds_read_b64_tr_b16 v[72:73], v24 offset:8192
    v_mfma_f32_16x16x32_bf16 v[144:147], v[84:87], a[144:147], v[144:147]
    ds_read_b64_tr_b16 v[74:75], v24 offset:8704
    v_mfma_f32_16x16x32_bf16 v[148:151], v[80:83], a[132:135], v[148:151]
    v_mfma_f32_16x16x32_bf16 v[148:151], v[84:87], a[148:151], v[148:151]
    v_mfma_f32_16x16x32_bf16 v[152:155], v[80:83], a[136:139], v[152:155]
    ds_read_b64_tr_b16 v[76:77], v24 offset:12288
    v_mfma_f32_16x16x32_bf16 v[152:155], v[84:87], a[152:155], v[152:155]
    ds_read_b64_tr_b16 v[78:79], v24 offset:12800
    v_mfma_f32_16x16x32_bf16 v[156:159], v[80:83], a[140:143], v[156:159]
    buffer_load_dwordx4 v10, s[36:39], s30 offen offset:2048 lds
    v_mfma_f32_16x16x32_bf16 v[156:159], v[84:87], a[156:159], v[156:159]
    s_waitcnt lgkmcnt(8)
    v_mfma_f32_16x16x32_bf16 v[208:211], v[88:91], a[128:131], v[208:211]
    ds_read_b64_tr_b16 v[80:81], v25 offset:0
    v_mfma_f32_16x16x32_bf16 v[208:211], v[92:95], a[144:147], v[208:211]
    ds_read_b64_tr_b16 v[82:83], v25 offset:512
    v_mfma_f32_16x16x32_bf16 v[212:215], v[88:91], a[132:135], v[212:215]
    v_mfma_f32_16x16x32_bf16 v[212:215], v[92:95], a[148:151], v[212:215]
    v_mfma_f32_16x16x32_bf16 v[216:219], v[88:91], a[136:139], v[216:219]
    ds_read_b64_tr_b16 v[84:85], v25 offset:4096
    v_mfma_f32_16x16x32_bf16 v[216:219], v[92:95], a[152:155], v[216:219]
    ds_read_b64_tr_b16 v[86:87], v25 offset:4608
    v_mfma_f32_16x16x32_bf16 v[220:223], v[88:91], a[140:143], v[220:223]
    v_mfma_f32_16x16x32_bf16 v[220:223], v[92:95], a[156:159], v[220:223]
    s_waitcnt lgkmcnt(8)
    v_mfma_f32_16x16x32_bf16 v[96:99], v[64:67], a[160:163], v[96:99]
    ds_read_b64_tr_b16 v[88:89], v25 offset:8192
    v_mfma_f32_16x16x32_bf16 v[96:99], v[68:71], a[176:179], v[96:99]
    ds_read_b64_tr_b16 v[90:91], v25 offset:8704
    v_mfma_f32_16x16x32_bf16 v[100:103], v[64:67], a[164:167], v[100:103]
    buffer_load_dwordx4 v11, s[36:39], s30 offen offset:3072 lds
    v_mfma_f32_16x16x32_bf16 v[100:103], v[68:71], a[180:183], v[100:103]
    v_mfma_f32_16x16x32_bf16 v[104:107], v[64:67], a[168:171], v[104:107]
    ds_read_b64_tr_b16 v[92:93], v25 offset:12288
    v_mfma_f32_16x16x32_bf16 v[104:107], v[68:71], a[184:187], v[104:107]
    ds_read_b64_tr_b16 v[94:95], v25 offset:12800
    v_mfma_f32_16x16x32_bf16 v[108:111], v[64:67], a[172:175], v[108:111]
    v_mfma_f32_16x16x32_bf16 v[108:111], v[68:71], a[188:191], v[108:111]
    s_waitcnt lgkmcnt(8)
    v_mfma_f32_16x16x32_bf16 v[160:163], v[72:75], a[160:163], v[160:163]
    ds_read_b64_tr_b16 v[64:65], v26 offset:0
    v_mfma_f32_16x16x32_bf16 v[160:163], v[76:79], a[176:179], v[160:163]
    ds_read_b64_tr_b16 v[66:67], v26 offset:512
    v_mfma_f32_16x16x32_bf16 v[164:167], v[72:75], a[164:167], v[164:167]
    v_mfma_f32_16x16x32_bf16 v[164:167], v[76:79], a[180:183], v[164:167]
    v_mfma_f32_16x16x32_bf16 v[168:171], v[72:75], a[168:171], v[168:171]
    ds_read_b64_tr_b16 v[68:69], v26 offset:4096
    v_mfma_f32_16x16x32_bf16 v[168:171], v[76:79], a[184:187], v[168:171]
    ds_read_b64_tr_b16 v[70:71], v26 offset:4608
    v_mfma_f32_16x16x32_bf16 v[172:175], v[72:75], a[172:175], v[172:175]
    v_mfma_f32_16x16x32_bf16 v[172:175], v[76:79], a[188:191], v[172:175]
    s_waitcnt lgkmcnt(8)
    v_mfma_f32_16x16x32_bf16 v[112:115], v[80:83], a[160:163], v[112:115]
    ds_read_b64_tr_b16 v[72:73], v26 offset:8192
    v_mfma_f32_16x16x32_bf16 v[112:115], v[84:87], a[176:179], v[112:115]
    ds_read_b64_tr_b16 v[74:75], v26 offset:8704
    v_mfma_f32_16x16x32_bf16 v[116:119], v[80:83], a[164:167], v[116:119]
    v_mfma_f32_16x16x32_bf16 v[116:119], v[84:87], a[180:183], v[116:119]
    v_mfma_f32_16x16x32_bf16 v[120:123], v[80:83], a[168:171], v[120:123]
    ds_read_b64_tr_b16 v[76:77], v26 offset:12288
    v_mfma_f32_16x16x32_bf16 v[120:123], v[84:87], a[184:187], v[120:123]
    ds_read_b64_tr_b16 v[78:79], v26 offset:12800
    v_mfma_f32_16x16x32_bf16 v[124:127], v[80:83], a[172:175], v[124:127]
    v_mfma_f32_16x16x32_bf16 v[124:127], v[84:87], a[188:191], v[124:127]
    s_waitcnt lgkmcnt(8)
    v_mfma_f32_16x16x32_bf16 v[176:179], v[88:91], a[160:163], v[176:179]
    ds_read_b64_tr_b16 v[80:81], v27 offset:0
    v_mfma_f32_16x16x32_bf16 v[176:179], v[92:95], a[176:179], v[176:179]
    ds_read_b64_tr_b16 v[82:83], v27 offset:512
    v_mfma_f32_16x16x32_bf16 v[180:183], v[88:91], a[164:167], v[180:183]
    v_mfma_f32_16x16x32_bf16 v[180:183], v[92:95], a[180:183], v[180:183]
    v_mfma_f32_16x16x32_bf16 v[184:187], v[88:91], a[168:171], v[184:187]
    ds_read_b64_tr_b16 v[84:85], v27 offset:4096
    v_mfma_f32_16x16x32_bf16 v[184:187], v[92:95], a[184:187], v[184:187]
    ds_read_b64_tr_b16 v[86:87], v27 offset:4608
    v_mfma_f32_16x16x32_bf16 v[188:191], v[88:91], a[172:175], v[188:191]
    v_mfma_f32_16x16x32_bf16 v[188:191], v[92:95], a[188:191], v[188:191]
    s_waitcnt lgkmcnt(8)
    v_mfma_f32_16x16x32_bf16 v[128:131], v[64:67], a[160:163], v[128:131]
    ds_read_b64_tr_b16 v[88:89], v27 offset:8192
    v_mfma_f32_16x16x32_bf16 v[128:131], v[68:71], a[176:179], v[128:131]
    ds_read_b64_tr_b16 v[90:91], v27 offset:8704
    v_mfma_f32_16x16x32_bf16 v[132:135], v[64:67], a[164:167], v[132:135]
    v_mfma_f32_16x16x32_bf16 v[132:135], v[68:71], a[180:183], v[132:135]
    v_mfma_f32_16x16x32_bf16 v[136:139], v[64:67], a[168:171], v[136:139]
    ds_read_b64_tr_b16 v[92:93], v27 offset:12288
    v_mfma_f32_16x16x32_bf16 v[136:139], v[68:71], a[184:187], v[136:139]
    ds_read_b64_tr_b16 v[94:95], v27 offset:12800
    v_mfma_f32_16x16x32_bf16 v[140:143], v[64:67], a[172:175], v[140:143]
    v_mfma_f32_16x16x32_bf16 v[140:143], v[68:71], a[188:191], v[140:143]
    s_waitcnt vmcnt(15)
    s_barrier
    s_waitcnt lgkmcnt(8)
    v_mfma_f32_16x16x32_bf16 v[192:195], v[72:75], a[160:163], v[192:195]
    ds_read_b64_tr_b16 v[64:65], v16 offset:0
    v_mfma_f32_16x16x32_bf16 v[192:195], v[76:79], a[176:179], v[192:195]
    ds_read_b64_tr_b16 v[66:67], v16 offset:512
    v_mfma_f32_16x16x32_bf16 v[196:199], v[72:75], a[164:167], v[196:199]
    v_mfma_f32_16x16x32_bf16 v[196:199], v[76:79], a[180:183], v[196:199]
    v_mfma_f32_16x16x32_bf16 v[200:203], v[72:75], a[168:171], v[200:203]
    ds_read_b64_tr_b16 v[68:69], v16 offset:4096
    v_mfma_f32_16x16x32_bf16 v[200:203], v[76:79], a[184:187], v[200:203]
    ds_read_b64_tr_b16 v[70:71], v16 offset:4608
    v_mfma_f32_16x16x32_bf16 v[204:207], v[72:75], a[172:175], v[204:207]
    v_mfma_f32_16x16x32_bf16 v[204:207], v[76:79], a[188:191], v[204:207]
    s_waitcnt lgkmcnt(8)
    v_mfma_f32_16x16x32_bf16 v[144:147], v[80:83], a[160:163], v[144:147]
    ds_read_b64_tr_b16 v[72:73], v16 offset:8192
    v_mfma_f32_16x16x32_bf16 v[144:147], v[84:87], a[176:179], v[144:147]
    ds_read_b64_tr_b16 v[74:75], v16 offset:8704
    v_mfma_f32_16x16x32_bf16 v[148:151], v[80:83], a[164:167], v[148:151]
    v_mfma_f32_16x16x32_bf16 v[148:151], v[84:87], a[180:183], v[148:151]
    v_mfma_f32_16x16x32_bf16 v[152:155], v[80:83], a[168:171], v[152:155]
    ds_read_b64_tr_b16 v[76:77], v16 offset:12288
    v_mfma_f32_16x16x32_bf16 v[152:155], v[84:87], a[184:187], v[152:155]
    ds_read_b64_tr_b16 v[78:79], v16 offset:12800
    v_mfma_f32_16x16x32_bf16 v[156:159], v[80:83], a[172:175], v[156:159]
    v_mfma_f32_16x16x32_bf16 v[156:159], v[84:87], a[188:191], v[156:159]
    s_waitcnt lgkmcnt(8)
    v_mfma_f32_16x16x32_bf16 v[208:211], v[88:91], a[160:163], v[208:211]
    ds_read_b64_tr_b16 v[80:81], v17 offset:0
    v_mfma_f32_16x16x32_bf16 v[208:211], v[92:95], a[176:179], v[208:211]
    ds_read_b64_tr_b16 v[82:83], v17 offset:512
    v_mfma_f32_16x16x32_bf16 v[212:215], v[88:91], a[164:167], v[212:215]
    v_mfma_f32_16x16x32_bf16 v[212:215], v[92:95], a[180:183], v[212:215]
    v_mfma_f32_16x16x32_bf16 v[216:219], v[88:91], a[168:171], v[216:219]
    ds_read_b64_tr_b16 v[84:85], v17 offset:4096
    v_mfma_f32_16x16x32_bf16 v[216:219], v[92:95], a[184:187], v[216:219]
    ds_read_b64_tr_b16 v[86:87], v17 offset:4608
    s_add_u32 m0, s28, 98304
    s_add_u32 s30, s79, 256
    v_mfma_f32_16x16x32_bf16 v[220:223], v[88:91], a[172:175], v[220:223]
    buffer_load_dwordx4 v8, s[36:39], s30 offen offset:0 lds
    v_mfma_f32_16x16x32_bf16 v[220:223], v[92:95], a[188:191], v[220:223]
    s_waitcnt lgkmcnt(8)
    v_mfma_f32_16x16x32_bf16 v[96:99], v[64:67], a[192:195], v[96:99]
    ds_read_b64_tr_b16 v[88:89], v17 offset:8192
    v_mfma_f32_16x16x32_bf16 v[96:99], v[68:71], a[208:211], v[96:99]
    ds_read_b64_tr_b16 v[90:91], v17 offset:8704
    v_mfma_f32_16x16x32_bf16 v[100:103], v[64:67], a[196:199], v[100:103]
    v_mfma_f32_16x16x32_bf16 v[100:103], v[68:71], a[212:215], v[100:103]
    v_mfma_f32_16x16x32_bf16 v[104:107], v[64:67], a[200:203], v[104:107]
    ds_read_b64_tr_b16 v[92:93], v17 offset:12288
    v_mfma_f32_16x16x32_bf16 v[104:107], v[68:71], a[216:219], v[104:107]
    ds_read_b64_tr_b16 v[94:95], v17 offset:12800
    v_mfma_f32_16x16x32_bf16 v[108:111], v[64:67], a[204:207], v[108:111]
    v_mfma_f32_16x16x32_bf16 v[108:111], v[68:71], a[220:223], v[108:111]
    s_waitcnt lgkmcnt(8)
    v_mfma_f32_16x16x32_bf16 v[160:163], v[72:75], a[192:195], v[160:163]
    ds_read_b64_tr_b16 v[64:65], v18 offset:0
    v_mfma_f32_16x16x32_bf16 v[160:163], v[76:79], a[208:211], v[160:163]
    ds_read_b64_tr_b16 v[66:67], v18 offset:512
    v_mfma_f32_16x16x32_bf16 v[164:167], v[72:75], a[196:199], v[164:167]
    buffer_load_dwordx4 v9, s[36:39], s30 offen offset:1024 lds
    v_mfma_f32_16x16x32_bf16 v[164:167], v[76:79], a[212:215], v[164:167]
    v_mfma_f32_16x16x32_bf16 v[168:171], v[72:75], a[200:203], v[168:171]
    ds_read_b64_tr_b16 v[68:69], v18 offset:4096
    v_mfma_f32_16x16x32_bf16 v[168:171], v[76:79], a[216:219], v[168:171]
    ds_read_b64_tr_b16 v[70:71], v18 offset:4608
    v_mfma_f32_16x16x32_bf16 v[172:175], v[72:75], a[204:207], v[172:175]
    v_mfma_f32_16x16x32_bf16 v[172:175], v[76:79], a[220:223], v[172:175]
    s_waitcnt lgkmcnt(8)
    v_mfma_f32_16x16x32_bf16 v[112:115], v[80:83], a[192:195], v[112:115]
    ds_read_b64_tr_b16 v[72:73], v18 offset:8192
    v_mfma_f32_16x16x32_bf16 v[112:115], v[84:87], a[208:211], v[112:115]
    ds_read_b64_tr_b16 v[74:75], v18 offset:8704
    v_mfma_f32_16x16x32_bf16 v[116:119], v[80:83], a[196:199], v[116:119]
    v_mfma_f32_16x16x32_bf16 v[116:119], v[84:87], a[212:215], v[116:119]
    v_mfma_f32_16x16x32_bf16 v[120:123], v[80:83], a[200:203], v[120:123]
    ds_read_b64_tr_b16 v[76:77], v18 offset:12288
    v_mfma_f32_16x16x32_bf16 v[120:123], v[84:87], a[216:219], v[120:123]
    ds_read_b64_tr_b16 v[78:79], v18 offset:12800
    v_mfma_f32_16x16x32_bf16 v[124:127], v[80:83], a[204:207], v[124:127]
    buffer_load_dwordx4 v10, s[36:39], s30 offen offset:2048 lds
    v_mfma_f32_16x16x32_bf16 v[124:127], v[84:87], a[220:223], v[124:127]
    s_waitcnt lgkmcnt(8)
    v_mfma_f32_16x16x32_bf16 v[176:179], v[88:91], a[192:195], v[176:179]
    ds_read_b64_tr_b16 v[80:81], v19 offset:0
    v_mfma_f32_16x16x32_bf16 v[176:179], v[92:95], a[208:211], v[176:179]
    ds_read_b64_tr_b16 v[82:83], v19 offset:512
    v_mfma_f32_16x16x32_bf16 v[180:183], v[88:91], a[196:199], v[180:183]
    v_mfma_f32_16x16x32_bf16 v[180:183], v[92:95], a[212:215], v[180:183]
    v_mfma_f32_16x16x32_bf16 v[184:187], v[88:91], a[200:203], v[184:187]
    ds_read_b64_tr_b16 v[84:85], v19 offset:4096
    v_mfma_f32_16x16x32_bf16 v[184:187], v[92:95], a[216:219], v[184:187]
    ds_read_b64_tr_b16 v[86:87], v19 offset:4608
    v_mfma_f32_16x16x32_bf16 v[188:191], v[88:91], a[204:207], v[188:191]
    v_mfma_f32_16x16x32_bf16 v[188:191], v[92:95], a[220:223], v[188:191]
    s_waitcnt lgkmcnt(8)
    v_mfma_f32_16x16x32_bf16 v[128:131], v[64:67], a[192:195], v[128:131]
    ds_read_b64_tr_b16 v[88:89], v19 offset:8192
    v_mfma_f32_16x16x32_bf16 v[128:131], v[68:71], a[208:211], v[128:131]
    ds_read_b64_tr_b16 v[90:91], v19 offset:8704
    v_mfma_f32_16x16x32_bf16 v[132:135], v[64:67], a[196:199], v[132:135]
    buffer_load_dwordx4 v11, s[36:39], s30 offen offset:3072 lds
    v_mfma_f32_16x16x32_bf16 v[132:135], v[68:71], a[212:215], v[132:135]
    v_mfma_f32_16x16x32_bf16 v[136:139], v[64:67], a[200:203], v[136:139]
    ds_read_b64_tr_b16 v[92:93], v19 offset:12288
    v_mfma_f32_16x16x32_bf16 v[136:139], v[68:71], a[216:219], v[136:139]
    ds_read_b64_tr_b16 v[94:95], v19 offset:12800
    v_mfma_f32_16x16x32_bf16 v[140:143], v[64:67], a[204:207], v[140:143]
    v_mfma_f32_16x16x32_bf16 v[140:143], v[68:71], a[220:223], v[140:143]
    s_waitcnt lgkmcnt(8)
    v_mfma_f32_16x16x32_bf16 v[192:195], v[72:75], a[192:195], v[192:195]
    ds_read_b64_tr_b16 v[64:65], v16 offset:16384
    v_mfma_f32_16x16x32_bf16 v[192:195], v[76:79], a[208:211], v[192:195]
    ds_read_b64_tr_b16 v[66:67], v16 offset:16896
    v_mfma_f32_16x16x32_bf16 v[196:199], v[72:75], a[196:199], v[196:199]
    v_mfma_f32_16x16x32_bf16 v[196:199], v[76:79], a[212:215], v[196:199]
    v_mfma_f32_16x16x32_bf16 v[200:203], v[72:75], a[200:203], v[200:203]
    ds_read_b64_tr_b16 v[68:69], v16 offset:20480
    v_mfma_f32_16x16x32_bf16 v[200:203], v[76:79], a[216:219], v[200:203]
    ds_read_b64_tr_b16 v[70:71], v16 offset:20992
    s_add_u32 m0, s28, 114688
    s_add_u32 s30, s80, 256
    v_mfma_f32_16x16x32_bf16 v[204:207], v[72:75], a[204:207], v[204:207]
    buffer_load_dwordx4 v8, s[36:39], s30 offen offset:0 lds
    v_mfma_f32_16x16x32_bf16 v[204:207], v[76:79], a[220:223], v[204:207]
    s_waitcnt lgkmcnt(8)
    v_mfma_f32_16x16x32_bf16 v[144:147], v[80:83], a[192:195], v[144:147]
    ds_read_b64_tr_b16 v[72:73], v16 offset:24576
    v_mfma_f32_16x16x32_bf16 v[144:147], v[84:87], a[208:211], v[144:147]
    ds_read_b64_tr_b16 v[74:75], v16 offset:25088
    v_mfma_f32_16x16x32_bf16 v[148:151], v[80:83], a[196:199], v[148:151]
    v_mfma_f32_16x16x32_bf16 v[148:151], v[84:87], a[212:215], v[148:151]
    v_mfma_f32_16x16x32_bf16 v[152:155], v[80:83], a[200:203], v[152:155]
    ds_read_b64_tr_b16 v[76:77], v16 offset:28672
    v_mfma_f32_16x16x32_bf16 v[152:155], v[84:87], a[216:219], v[152:155]
    ds_read_b64_tr_b16 v[78:79], v16 offset:29184
    v_mfma_f32_16x16x32_bf16 v[156:159], v[80:83], a[204:207], v[156:159]
    v_mfma_f32_16x16x32_bf16 v[156:159], v[84:87], a[220:223], v[156:159]
    s_waitcnt lgkmcnt(8)
    v_mfma_f32_16x16x32_bf16 v[208:211], v[88:91], a[192:195], v[208:211]
    ds_read_b64_tr_b16 v[80:81], v16 offset:32768
    v_mfma_f32_16x16x32_bf16 v[208:211], v[92:95], a[208:211], v[208:211]
    ds_read_b64_tr_b16 v[82:83], v16 offset:33280
    v_mfma_f32_16x16x32_bf16 v[212:215], v[88:91], a[196:199], v[212:215]
    buffer_load_dwordx4 v9, s[36:39], s30 offen offset:1024 lds
    v_mfma_f32_16x16x32_bf16 v[212:215], v[92:95], a[212:215], v[212:215]
    v_mfma_f32_16x16x32_bf16 v[216:219], v[88:91], a[200:203], v[216:219]
    ds_read_b64_tr_b16 v[84:85], v16 offset:36864
    v_mfma_f32_16x16x32_bf16 v[216:219], v[92:95], a[216:219], v[216:219]
    ds_read_b64_tr_b16 v[86:87], v16 offset:37376
    v_mfma_f32_16x16x32_bf16 v[220:223], v[88:91], a[204:207], v[220:223]
    v_mfma_f32_16x16x32_bf16 v[220:223], v[92:95], a[220:223], v[220:223]
    s_waitcnt lgkmcnt(8)
    v_mfma_f32_16x16x32_bf16 v[96:99], v[64:67], a[224:227], v[96:99]
    ds_read_b64_tr_b16 v[88:89], v16 offset:40960
    v_mfma_f32_16x16x32_bf16 v[96:99], v[68:71], a[240:243], v[96:99]
    ds_read_b64_tr_b16 v[90:91], v16 offset:41472
    v_mfma_f32_16x16x32_bf16 v[100:103], v[64:67], a[228:231], v[100:103]
    v_mfma_f32_16x16x32_bf16 v[100:103], v[68:71], a[244:247], v[100:103]
    v_mfma_f32_16x16x32_bf16 v[104:107], v[64:67], a[232:235], v[104:107]
    ds_read_b64_tr_b16 v[92:93], v16 offset:45056
    v_mfma_f32_16x16x32_bf16 v[104:107], v[68:71], a[248:251], v[104:107]
    ds_read_b64_tr_b16 v[94:95], v16 offset:45568
    v_mfma_f32_16x16x32_bf16 v[108:111], v[64:67], a[236:239], v[108:111]
    buffer_load_dwordx4 v10, s[36:39], s30 offen offset:2048 lds
    v_mfma_f32_16x16x32_bf16 v[108:111], v[68:71], a[252:255], v[108:111]
    s_waitcnt lgkmcnt(8)
    v_mfma_f32_16x16x32_bf16 v[160:163], v[72:75], a[224:227], v[160:163]
    ds_read_b64_tr_b16 v[64:65], v17 offset:16384
    v_mfma_f32_16x16x32_bf16 v[160:163], v[76:79], a[240:243], v[160:163]
    ds_read_b64_tr_b16 v[66:67], v17 offset:16896
    v_mfma_f32_16x16x32_bf16 v[164:167], v[72:75], a[228:231], v[164:167]
    v_mfma_f32_16x16x32_bf16 v[164:167], v[76:79], a[244:247], v[164:167]
    v_mfma_f32_16x16x32_bf16 v[168:171], v[72:75], a[232:235], v[168:171]
    ds_read_b64_tr_b16 v[68:69], v17 offset:20480
    v_mfma_f32_16x16x32_bf16 v[168:171], v[76:79], a[248:251], v[168:171]
    ds_read_b64_tr_b16 v[70:71], v17 offset:20992
    v_mfma_f32_16x16x32_bf16 v[172:175], v[72:75], a[236:239], v[172:175]
    v_mfma_f32_16x16x32_bf16 v[172:175], v[76:79], a[252:255], v[172:175]
    s_waitcnt lgkmcnt(8)
    v_mfma_f32_16x16x32_bf16 v[96:99], v[80:83], v[224:227], v[96:99]
    ds_read_b64_tr_b16 v[72:73], v17 offset:24576
    v_mfma_f32_16x16x32_bf16 v[96:99], v[84:87], v[240:243], v[96:99]
    ds_read_b64_tr_b16 v[74:75], v17 offset:25088
    v_mfma_f32_16x16x32_bf16 v[100:103], v[80:83], v[228:231], v[100:103]
    buffer_load_dwordx4 v11, s[36:39], s30 offen offset:3072 lds
    v_mfma_f32_16x16x32_bf16 v[100:103], v[84:87], v[244:247], v[100:103]
    v_mfma_f32_16x16x32_bf16 v[104:107], v[80:83], v[232:235], v[104:107]
    ds_read_b64_tr_b16 v[76:77], v17 offset:28672
    v_mfma_f32_16x16x32_bf16 v[104:107], v[84:87], v[248:251], v[104:107]
    ds_read_b64_tr_b16 v[78:79], v17 offset:29184
    v_mfma_f32_16x16x32_bf16 v[108:111], v[80:83], v[236:239], v[108:111]
    v_mfma_f32_16x16x32_bf16 v[108:111], v[84:87], v[252:255], v[108:111]
    s_waitcnt lgkmcnt(8)
    v_mfma_f32_16x16x32_bf16 v[160:163], v[88:91], v[224:227], v[160:163]
    ds_read_b64_tr_b16 v[80:81], v17 offset:32768
    v_mfma_f32_16x16x32_bf16 v[160:163], v[92:95], v[240:243], v[160:163]
    ds_read_b64_tr_b16 v[82:83], v17 offset:33280
    v_mfma_f32_16x16x32_bf16 v[164:167], v[88:91], v[228:231], v[164:167]
    v_mfma_f32_16x16x32_bf16 v[164:167], v[92:95], v[244:247], v[164:167]
    v_mfma_f32_16x16x32_bf16 v[168:171], v[88:91], v[232:235], v[168:171]
    ds_read_b64_tr_b16 v[84:85], v17 offset:36864
    v_mfma_f32_16x16x32_bf16 v[168:171], v[92:95], v[248:251], v[168:171]
    ds_read_b64_tr_b16 v[86:87], v17 offset:37376
    s_add_u32 m0, s28, 131072
    s_add_u32 s30, s81, 256
    v_mfma_f32_16x16x32_bf16 v[172:175], v[88:91], v[236:239], v[172:175]
    buffer_load_dwordx4 v8, s[36:39], s30 offen offset:0 lds
    v_mfma_f32_16x16x32_bf16 v[172:175], v[92:95], v[252:255], v[172:175]
    s_waitcnt lgkmcnt(8)
    v_mfma_f32_16x16x32_bf16 v[112:115], v[64:67], a[224:227], v[112:115]
    ds_read_b64_tr_b16 v[88:89], v17 offset:40960
    v_mul_f32 v96, v96, v160
    v_mfma_f32_16x16x32_bf16 v[112:115], v[68:71], a[240:243], v[112:115]
    ds_read_b64_tr_b16 v[90:91], v17 offset:41472
    v_mul_f32 v97, v97, v161
    v_mfma_f32_16x16x32_bf16 v[116:119], v[64:67], a[228:231], v[116:119]
    v_mul_f32 v98, v98, v162
    v_mul_f32 v99, v99, v163
    v_mfma_f32_16x16x32_bf16 v[116:119], v[68:71], a[244:247], v[116:119]
    v_cvt_pk_bf16_f32 v160, v96, v97
    v_cvt_pk_bf16_f32 v161, v98, v99
    v_mfma_f32_16x16x32_bf16 v[120:123], v[64:67], a[232:235], v[120:123]
    ds_read_b64_tr_b16 v[92:93], v17 offset:45056
    v_mul_f32 v100, v100, v164
    v_mfma_f32_16x16x32_bf16 v[120:123], v[68:71], a[248:251], v[120:123]
    ds_read_b64_tr_b16 v[94:95], v17 offset:45568
    v_mul_f32 v101, v101, v165
    v_mfma_f32_16x16x32_bf16 v[124:127], v[64:67], a[236:239], v[124:127]
    v_mul_f32 v102, v102, v166
    v_mul_f32 v103, v103, v167
    v_mfma_f32_16x16x32_bf16 v[124:127], v[68:71], a[252:255], v[124:127]
    v_cvt_pk_bf16_f32 v164, v100, v101
    v_cvt_pk_bf16_f32 v165, v102, v103
    s_waitcnt lgkmcnt(8)
    v_mfma_f32_16x16x32_bf16 v[176:179], v[72:75], a[224:227], v[176:179]
    ds_read_b64_tr_b16 v[64:65], v18 offset:16384
    v_mul_f32 v104, v104, v168
    v_mfma_f32_16x16x32_bf16 v[176:179], v[76:79], a[240:243], v[176:179]
    ds_read_b64_tr_b16 v[66:67], v18 offset:16896
    v_mul_f32 v105, v105, v169
    v_mfma_f32_16x16x32_bf16 v[180:183], v[72:75], a[228:231], v[180:183]
    buffer_load_dwordx4 v9, s[36:39], s30 offen offset:1024 lds
    v_mfma_f32_16x16x32_bf16 v[180:183], v[76:79], a[244:247], v[180:183]
    v_mul_f32 v106, v106, v170
    v_mul_f32 v107, v107, v171
    v_mfma_f32_16x16x32_bf16 v[184:187], v[72:75], a[232:235], v[184:187]
    ds_read_b64_tr_b16 v[68:69], v18 offset:20480
    v_cvt_pk_bf16_f32 v168, v104, v105
    v_mfma_f32_16x16x32_bf16 v[184:187], v[76:79], a[248:251], v[184:187]
    ds_read_b64_tr_b16 v[70:71], v18 offset:20992
    v_cvt_pk_bf16_f32 v169, v106, v107
    v_mfma_f32_16x16x32_bf16 v[188:191], v[72:75], a[236:239], v[188:191]
    v_mul_f32 v108, v108, v172
    v_mul_f32 v109, v109, v173
    v_mfma_f32_16x16x32_bf16 v[188:191], v[76:79], a[252:255], v[188:191]
    v_mul_f32 v110, v110, v174
    v_mul_f32 v111, v111, v175
    s_waitcnt lgkmcnt(8)
    v_mfma_f32_16x16x32_bf16 v[112:115], v[80:83], v[224:227], v[112:115]
    ds_read_b64_tr_b16 v[72:73], v18 offset:24576
    v_cvt_pk_bf16_f32 v172, v108, v109
    v_mfma_f32_16x16x32_bf16 v[112:115], v[84:87], v[240:243], v[112:115]
    ds_read_b64_tr_b16 v[74:75], v18 offset:25088
    v_cvt_pk_bf16_f32 v173, v110, v111
    v_mfma_f32_16x16x32_bf16 v[116:119], v[80:83], v[228:231], v[116:119]
    v_mfma_f32_16x16x32_bf16 v[116:119], v[84:87], v[244:247], v[116:119]
    v_mfma_f32_16x16x32_bf16 v[120:123], v[80:83], v[232:235], v[120:123]
    ds_read_b64_tr_b16 v[76:77], v18 offset:28672
    v_mfma_f32_16x16x32_bf16 v[120:123], v[84:87], v[248:251], v[120:123]
    ds_read_b64_tr_b16 v[78:79], v18 offset:29184
    v_mfma_f32_16x16x32_bf16 v[124:127], v[80:83], v[236:239], v[124:127]
    buffer_load_dwordx4 v10, s[36:39], s30 offen offset:2048 lds
    v_mfma_f32_16x16x32_bf16 v[124:127], v[84:87], v[252:255], v[124:127]
    s_waitcnt lgkmcnt(8)
    v_mfma_f32_16x16x32_bf16 v[176:179], v[88:91], v[224:227], v[176:179]
    ds_read_b64_tr_b16 v[80:81], v18 offset:32768
    v_mfma_f32_16x16x32_bf16 v[176:179], v[92:95], v[240:243], v[176:179]
    ds_read_b64_tr_b16 v[82:83], v18 offset:33280
    v_mfma_f32_16x16x32_bf16 v[180:183], v[88:91], v[228:231], v[180:183]
    v_mfma_f32_16x16x32_bf16 v[180:183], v[92:95], v[244:247], v[180:183]
    v_mfma_f32_16x16x32_bf16 v[184:187], v[88:91], v[232:235], v[184:187]
    ds_read_b64_tr_b16 v[84:85], v18 offset:36864
    v_mfma_f32_16x16x32_bf16 v[184:187], v[92:95], v[248:251], v[184:187]
    ds_read_b64_tr_b16 v[86:87], v18 offset:37376
    v_mfma_f32_16x16x32_bf16 v[188:191], v[88:91], v[236:239], v[188:191]
    v_mfma_f32_16x16x32_bf16 v[188:191], v[92:95], v[252:255], v[188:191]
    s_waitcnt lgkmcnt(8)
    v_mfma_f32_16x16x32_bf16 v[128:131], v[64:67], a[224:227], v[128:131]
    ds_read_b64_tr_b16 v[88:89], v18 offset:40960
    v_mul_f32 v112, v112, v176
    v_mfma_f32_16x16x32_bf16 v[128:131], v[68:71], a[240:243], v[128:131]
    ds_read_b64_tr_b16 v[90:91], v18 offset:41472
    v_mul_f32 v113, v113, v177
    v_mfma_f32_16x16x32_bf16 v[132:135], v[64:67], a[228:231], v[132:135]
    buffer_load_dwordx4 v11, s[36:39], s30 offen offset:3072 lds
    v_mfma_f32_16x16x32_bf16 v[132:135], v[68:71], a[244:247], v[132:135]
    v_mul_f32 v114, v114, v178
    v_mul_f32 v115, v115, v179
    v_mfma_f32_16x16x32_bf16 v[136:139], v[64:67], a[232:235], v[136:139]
    ds_read_b64_tr_b16 v[92:93], v18 offset:45056
    v_cvt_pk_bf16_f32 v162, v112, v113
    v_mfma_f32_16x16x32_bf16 v[136:139], v[68:71], a[248:251], v[136:139]
    ds_read_b64_tr_b16 v[94:95], v18 offset:45568
    v_cvt_pk_bf16_f32 v163, v114, v115
    v_mfma_f32_16x16x32_bf16 v[140:143], v[64:67], a[236:239], v[140:143]
    s_mov_b32 s67, 4096
    buffer_store_dwordx4 v[160:163], v30, s[44:47], s67 offen offset:0 sc1
    v_mul_f32 v116, v116, v180
    v_mfma_f32_16x16x32_bf16 v[140:143], v[68:71], a[252:255], v[140:143]
    v_mul_f32 v117, v117, v181
    v_mul_f32 v118, v118, v182
    s_waitcnt lgkmcnt(8)
    v_mfma_f32_16x16x32_bf16 v[192:195], v[72:75], a[224:227], v[192:195]
    ds_read_b64_tr_b16 v[64:65], v19 offset:16384
    v_mul_f32 v119, v119, v183
    v_mfma_f32_16x16x32_bf16 v[192:195], v[76:79], a[240:243], v[192:195]
    ds_read_b64_tr_b16 v[66:67], v19 offset:16896
    v_cvt_pk_bf16_f32 v166, v116, v117
    v_mfma_f32_16x16x32_bf16 v[196:199], v[72:75], a[228:231], v[196:199]
    v_cvt_pk_bf16_f32 v167, v118, v119
    s_mov_b32 s67, 4096
    buffer_store_dwordx4 v[164:167], v30, s[44:47], s67 offen offset:256 sc1
    v_mfma_f32_16x16x32_bf16 v[196:199], v[76:79], a[244:247], v[196:199]
    v_mul_f32 v120, v120, v184
    v_mul_f32 v121, v121, v185
    v_mfma_f32_16x16x32_bf16 v[200:203], v[72:75], a[232:235], v[200:203]
    ds_read_b64_tr_b16 v[68:69], v19 offset:20480
    v_mul_f32 v122, v122, v186
    v_mfma_f32_16x16x32_bf16 v[200:203], v[76:79], a[248:251], v[200:203]
    ds_read_b64_tr_b16 v[70:71], v19 offset:20992
    v_mul_f32 v123, v123, v187
    v_mfma_f32_16x16x32_bf16 v[204:207], v[72:75], a[236:239], v[204:207]
    v_cvt_pk_bf16_f32 v170, v120, v121
    v_cvt_pk_bf16_f32 v171, v122, v123
    v_mfma_f32_16x16x32_bf16 v[204:207], v[76:79], a[252:255], v[204:207]
    s_mov_b32 s67, 372736
    buffer_store_dwordx4 v[168:171], v30, s[44:47], s67 offen offset:0 sc1
    v_mul_f32 v124, v124, v188
    s_waitcnt lgkmcnt(8)
    v_mfma_f32_16x16x32_bf16 v[128:131], v[80:83], v[224:227], v[128:131]
    ds_read_b64_tr_b16 v[72:73], v19 offset:24576
    v_mul_f32 v125, v125, v189
    v_mfma_f32_16x16x32_bf16 v[128:131], v[84:87], v[240:243], v[128:131]
    ds_read_b64_tr_b16 v[74:75], v19 offset:25088
    v_mul_f32 v126, v126, v190
    v_mfma_f32_16x16x32_bf16 v[132:135], v[80:83], v[228:231], v[132:135]
    v_mul_f32 v127, v127, v191
    v_cvt_pk_bf16_f32 v174, v124, v125
    v_mfma_f32_16x16x32_bf16 v[132:135], v[84:87], v[244:247], v[132:135]
    v_cvt_pk_bf16_f32 v175, v126, v127
    s_mov_b32 s67, 372736
    buffer_store_dwordx4 v[172:175], v30, s[44:47], s67 offen offset:256 sc1
    v_mfma_f32_16x16x32_bf16 v[136:139], v[80:83], v[232:235], v[136:139]
    ds_read_b64_tr_b16 v[76:77], v19 offset:28672
    v_mfma_f32_16x16x32_bf16 v[136:139], v[84:87], v[248:251], v[136:139]
    ds_read_b64_tr_b16 v[78:79], v19 offset:29184
    v_mfma_f32_16x16x32_bf16 v[140:143], v[80:83], v[236:239], v[140:143]
    v_mfma_f32_16x16x32_bf16 v[140:143], v[84:87], v[252:255], v[140:143]
    s_waitcnt lgkmcnt(8)
    v_mfma_f32_16x16x32_bf16 v[192:195], v[88:91], v[224:227], v[192:195]
    ds_read_b64_tr_b16 v[80:81], v19 offset:32768
    v_mfma_f32_16x16x32_bf16 v[192:195], v[92:95], v[240:243], v[192:195]
    ds_read_b64_tr_b16 v[82:83], v19 offset:33280
    v_mfma_f32_16x16x32_bf16 v[196:199], v[88:91], v[228:231], v[196:199]
    v_mfma_f32_16x16x32_bf16 v[196:199], v[92:95], v[244:247], v[196:199]
    v_mfma_f32_16x16x32_bf16 v[200:203], v[88:91], v[232:235], v[200:203]
    ds_read_b64_tr_b16 v[84:85], v19 offset:36864
    v_mfma_f32_16x16x32_bf16 v[200:203], v[92:95], v[248:251], v[200:203]
    ds_read_b64_tr_b16 v[86:87], v19 offset:37376
    v_mfma_f32_16x16x32_bf16 v[204:207], v[88:91], v[236:239], v[204:207]
    v_mfma_f32_16x16x32_bf16 v[204:207], v[92:95], v[252:255], v[204:207]
    s_waitcnt lgkmcnt(8)
    v_mfma_f32_16x16x32_bf16 v[144:147], v[64:67], a[224:227], v[144:147]
    ds_read_b64_tr_b16 v[88:89], v19 offset:40960
    v_mul_f32 v128, v128, v192
    v_mfma_f32_16x16x32_bf16 v[144:147], v[68:71], a[240:243], v[144:147]
    ds_read_b64_tr_b16 v[90:91], v19 offset:41472
    v_mul_f32 v129, v129, v193
    v_mfma_f32_16x16x32_bf16 v[148:151], v[64:67], a[228:231], v[148:151]
    v_mul_f32 v130, v130, v194
    v_mul_f32 v131, v131, v195
    v_mfma_f32_16x16x32_bf16 v[148:151], v[68:71], a[244:247], v[148:151]
    v_cvt_pk_bf16_f32 v192, v128, v129
    v_cvt_pk_bf16_f32 v193, v130, v131
    v_mfma_f32_16x16x32_bf16 v[152:155], v[64:67], a[232:235], v[152:155]
    ds_read_b64_tr_b16 v[92:93], v19 offset:45056
    v_mul_f32 v132, v132, v196
    v_mfma_f32_16x16x32_bf16 v[152:155], v[68:71], a[248:251], v[152:155]
    ds_read_b64_tr_b16 v[94:95], v19 offset:45568
    v_mul_f32 v133, v133, v197
    v_mfma_f32_16x16x32_bf16 v[156:159], v[64:67], a[236:239], v[156:159]
    v_mul_f32 v134, v134, v198
    v_mul_f32 v135, v135, v199
    v_mfma_f32_16x16x32_bf16 v[156:159], v[68:71], a[252:255], v[156:159]
    v_cvt_pk_bf16_f32 v196, v132, v133
    v_cvt_pk_bf16_f32 v197, v134, v135
    s_waitcnt vmcnt(16)
    s_barrier
    s_waitcnt lgkmcnt(8)
    v_mfma_f32_16x16x32_bf16 v[208:211], v[72:75], a[224:227], v[208:211]
    ds_read_b64_tr_b16 v[64:65], v16 offset:49152
    v_mul_f32 v136, v136, v200
    v_mfma_f32_16x16x32_bf16 v[208:211], v[76:79], a[240:243], v[208:211]
    ds_read_b64_tr_b16 v[66:67], v16 offset:49664
    v_mul_f32 v137, v137, v201
    v_mfma_f32_16x16x32_bf16 v[212:215], v[72:75], a[228:231], v[212:215]
    v_mul_f32 v138, v138, v202
    v_mul_f32 v139, v139, v203
    v_mfma_f32_16x16x32_bf16 v[212:215], v[76:79], a[244:247], v[212:215]
    v_cvt_pk_bf16_f32 v200, v136, v137
    v_cvt_pk_bf16_f32 v201, v138, v139
    v_mfma_f32_16x16x32_bf16 v[216:219], v[72:75], a[232:235], v[216:219]
    ds_read_b64_tr_b16 v[68:69], v16 offset:53248
    v_mul_f32 v140, v140, v204
    v_mfma_f32_16x16x32_bf16 v[216:219], v[76:79], a[248:251], v[216:219]
    ds_read_b64_tr_b16 v[70:71], v16 offset:53760
    v_mul_f32 v141, v141, v205
    v_mfma_f32_16x16x32_bf16 v[220:223], v[72:75], a[236:239], v[220:223]
    v_mul_f32 v142, v142, v206
    v_mul_f32 v143, v143, v207
    v_mfma_f32_16x16x32_bf16 v[220:223], v[76:79], a[252:255], v[220:223]
    v_cvt_pk_bf16_f32 v204, v140, v141
    v_cvt_pk_bf16_f32 v205, v142, v143
    s_waitcnt lgkmcnt(8)
    v_mfma_f32_16x16x32_bf16 v[144:147], v[80:83], v[224:227], v[144:147]
    ds_read_b64_tr_b16 v[72:73], v16 offset:57344
    v_mfma_f32_16x16x32_bf16 v[144:147], v[84:87], v[240:243], v[144:147]
    ds_read_b64_tr_b16 v[74:75], v16 offset:57856
    v_mfma_f32_16x16x32_bf16 v[148:151], v[80:83], v[228:231], v[148:151]
    v_mfma_f32_16x16x32_bf16 v[148:151], v[84:87], v[244:247], v[148:151]
    v_mfma_f32_16x16x32_bf16 v[152:155], v[80:83], v[232:235], v[152:155]
    ds_read_b64_tr_b16 v[76:77], v16 offset:61440
    v_mfma_f32_16x16x32_bf16 v[152:155], v[84:87], v[248:251], v[152:155]
    ds_read_b64_tr_b16 v[78:79], v16 offset:61952
    v_mfma_f32_16x16x32_bf16 v[156:159], v[80:83], v[236:239], v[156:159]
    v_mfma_f32_16x16x32_bf16 v[156:159], v[84:87], v[252:255], v[156:159]
    s_waitcnt lgkmcnt(8)
    v_mfma_f32_16x16x32_bf16 v[208:211], v[88:91], v[224:227], v[208:211]
    ds_read_b64_tr_b16 v[80:81], v17 offset:49152
    v_mfma_f32_16x16x32_bf16 v[208:211], v[92:95], v[240:243], v[208:211]
    ds_read_b64_tr_b16 v[82:83], v17 offset:49664
    v_mfma_f32_16x16x32_bf16 v[212:215], v[88:91], v[228:231], v[212:215]
    v_mfma_f32_16x16x32_bf16 v[212:215], v[92:95], v[244:247], v[212:215]
    v_mfma_f32_16x16x32_bf16 v[216:219], v[88:91], v[232:235], v[216:219]
    ds_read_b64_tr_b16 v[84:85], v17 offset:53248
    v_mfma_f32_16x16x32_bf16 v[216:219], v[92:95], v[248:251], v[216:219]
    ds_read_b64_tr_b16 v[86:87], v17 offset:53760
    v_mfma_f32_16x16x32_bf16 v[220:223], v[88:91], v[236:239], v[220:223]
    v_mfma_f32_16x16x32_bf16 v[220:223], v[92:95], v[252:255], v[220:223]
    s_waitcnt lgkmcnt(8)
    v_mfma_f32_16x16x32_bf16 v[96:99], v[64:67], a[0:3], 0
    ds_read_b64_tr_b16 v[88:89], v17 offset:57344
    v_mul_f32 v144, v144, v208
    v_mfma_f32_16x16x32_bf16 v[96:99], v[68:71], a[16:19], v[96:99]
    ds_read_b64_tr_b16 v[90:91], v17 offset:57856
    s_add_u32 m0, s28, 0
    s_add_u32 s30, s82, 256
    v_mfma_f32_16x16x32_bf16 v[100:103], v[64:67], a[4:7], 0
    buffer_load_dwordx4 v8, s[36:39], s30 offen offset:0 lds
    v_mfma_f32_16x16x32_bf16 v[100:103], v[68:71], a[20:23], v[100:103]
    v_mul_f32 v145, v145, v209
    v_mul_f32 v146, v146, v210
    v_mfma_f32_16x16x32_bf16 v[104:107], v[64:67], a[8:11], 0
    ds_read_b64_tr_b16 v[92:93], v17 offset:61440
    v_mul_f32 v147, v147, v211
    v_mfma_f32_16x16x32_bf16 v[104:107], v[68:71], a[24:27], v[104:107]
    ds_read_b64_tr_b16 v[94:95], v17 offset:61952
    v_cvt_pk_bf16_f32 v194, v144, v145
    v_mfma_f32_16x16x32_bf16 v[108:111], v[64:67], a[12:15], 0
    v_cvt_pk_bf16_f32 v195, v146, v147
    s_mov_b32 s67, 6144
    buffer_store_dwordx4 v[192:195], v30, s[44:47], s67 offen offset:0 sc1
    v_mfma_f32_16x16x32_bf16 v[108:111], v[68:71], a[28:31], v[108:111]
    v_mul_f32 v148, v148, v212
    v_mul_f32 v149, v149, v213
    s_waitcnt lgkmcnt(8)
    v_mfma_f32_16x16x32_bf16 v[160:163], v[72:75], a[0:3], 0
    ds_read_b64_tr_b16 v[64:65], v18 offset:49152
    v_mul_f32 v150, v150, v214
    v_mfma_f32_16x16x32_bf16 v[160:163], v[76:79], a[16:19], v[160:163]
    ds_read_b64_tr_b16 v[66:67], v18 offset:49664
    v_mul_f32 v151, v151, v215
    v_mfma_f32_16x16x32_bf16 v[164:167], v[72:75], a[4:7], 0
    buffer_load_dwordx4 v9, s[36:39], s30 offen offset:1024 lds
    v_mfma_f32_16x16x32_bf16 v[164:167], v[76:79], a[20:23], v[164:167]
    v_cvt_pk_bf16_f32 v198, v148, v149
    v_cvt_pk_bf16_f32 v199, v150, v151
    v_mfma_f32_16x16x32_bf16 v[168:171], v[72:75], a[8:11], 0
    ds_read_b64_tr_b16 v[68:69], v18 offset:53248
    s_mov_b32 s67, 6144
    buffer_store_dwordx4 v[196:199], v30, s[44:47], s67 offen offset:256 sc1
    v_mfma_f32_16x16x32_bf16 v[168:171], v[76:79], a[24:27], v[168:171]
    ds_read_b64_tr_b16 v[70:71], v18 offset:53760
    v_mul_f32 v152, v152, v216
    v_mfma_f32_16x16x32_bf16 v[172:175], v[72:75], a[12:15], 0
    v_mul_f32 v153, v153, v217
    v_mul_f32 v154, v154, v218
    v_mfma_f32_16x16x32_bf16 v[172:175], v[76:79], a[28:31], v[172:175]
    v_mul_f32 v155, v155, v219
    v_cvt_pk_bf16_f32 v202, v152, v153
    s_waitcnt lgkmcnt(8)
    v_mfma_f32_16x16x32_bf16 v[112:115], v[80:83], a[0:3], 0
    ds_read_b64_tr_b16 v[72:73], v18 offset:57344
    v_cvt_pk_bf16_f32 v203, v154, v155
    v_mfma_f32_16x16x32_bf16 v[112:115], v[84:87], a[16:19], v[112:115]
    ds_read_b64_tr_b16 v[74:75], v18 offset:57856
    s_mov_b32 s67, 374784
    buffer_store_dwordx4 v[200:203], v30, s[44:47], s67 offen offset:0 sc1
    v_mfma_f32_16x16x32_bf16 v[116:119], v[80:83], a[4:7], 0
    buffer_load_dwordx4 v10, s[36:39], s30 offen offset:2048 lds
    v_mfma_f32_16x16x32_bf16 v[116:119], v[84:87], a[20:23], v[116:119]
    v_mul_f32 v156, v156, v220
    v_mul_f32 v157, v157, v221
    v_mfma_f32_16x16x32_bf16 v[120:123], v[80:83], a[8:11], 0
    ds_read_b64_tr_b16 v[76:77], v18 offset:61440
    v_mul_f32 v158, v158, v222
    v_mfma_f32_16x16x32_bf16 v[120:123], v[84:87], a[24:27], v[120:123]
    ds_read_b64_tr_b16 v[78:79], v18 offset:61952
    v_mul_f32 v159, v159, v223
    v_mfma_f32_16x16x32_bf16 v[124:127], v[80:83], a[12:15], 0
    v_cvt_pk_bf16_f32 v206, v156, v157
    v_cvt_pk_bf16_f32 v207, v158, v159
    v_mfma_f32_16x16x32_bf16 v[124:127], v[84:87], a[28:31], v[124:127]
    s_mov_b32 s67, 374784
    buffer_store_dwordx4 v[204:207], v30, s[44:47], s67 offen offset:256 sc1
    s_waitcnt lgkmcnt(8)
    v_mfma_f32_16x16x32_bf16 v[176:179], v[88:91], a[0:3], 0
    ds_read_b64_tr_b16 v[80:81], v19 offset:49152
    v_mfma_f32_16x16x32_bf16 v[176:179], v[92:95], a[16:19], v[176:179]
    ds_read_b64_tr_b16 v[82:83], v19 offset:49664
    v_mfma_f32_16x16x32_bf16 v[180:183], v[88:91], a[4:7], 0
    buffer_load_dwordx4 v11, s[36:39], s30 offen offset:3072 lds
    v_mfma_f32_16x16x32_bf16 v[180:183], v[92:95], a[20:23], v[180:183]
    v_mfma_f32_16x16x32_bf16 v[184:187], v[88:91], a[8:11], 0
    ds_read_b64_tr_b16 v[84:85], v19 offset:53248
    v_mfma_f32_16x16x32_bf16 v[184:187], v[92:95], a[24:27], v[184:187]
    ds_read_b64_tr_b16 v[86:87], v19 offset:53760
    v_mfma_f32_16x16x32_bf16 v[188:191], v[88:91], a[12:15], 0
    v_mfma_f32_16x16x32_bf16 v[188:191], v[92:95], a[28:31], v[188:191]
    s_waitcnt lgkmcnt(8)
    v_mfma_f32_16x16x32_bf16 v[128:131], v[64:67], a[0:3], 0
    ds_read_b64_tr_b16 v[88:89], v19 offset:57344
    v_mfma_f32_16x16x32_bf16 v[128:131], v[68:71], a[16:19], v[128:131]
    ds_read_b64_tr_b16 v[90:91], v19 offset:57856
    s_add_u32 m0, s28, 16384
    s_add_u32 s30, s83, 256
    v_mfma_f32_16x16x32_bf16 v[132:135], v[64:67], a[4:7], 0
    buffer_load_dwordx4 v8, s[36:39], s30 offen offset:0 lds
    v_mfma_f32_16x16x32_bf16 v[132:135], v[68:71], a[20:23], v[132:135]
    v_mfma_f32_16x16x32_bf16 v[136:139], v[64:67], a[8:11], 0
    ds_read_b64_tr_b16 v[92:93], v19 offset:61440
    v_mfma_f32_16x16x32_bf16 v[136:139], v[68:71], a[24:27], v[136:139]
    ds_read_b64_tr_b16 v[94:95], v19 offset:61952
    v_mfma_f32_16x16x32_bf16 v[140:143], v[64:67], a[12:15], 0
    v_mfma_f32_16x16x32_bf16 v[140:143], v[68:71], a[28:31], v[140:143]
    s_waitcnt lgkmcnt(8)
    v_mfma_f32_16x16x32_bf16 v[192:195], v[72:75], a[0:3], 0
    ds_read_b64_tr_b16 v[64:65], v20 offset:0
    v_mfma_f32_16x16x32_bf16 v[192:195], v[76:79], a[16:19], v[192:195]
    ds_read_b64_tr_b16 v[66:67], v20 offset:512
    v_mfma_f32_16x16x32_bf16 v[196:199], v[72:75], a[4:7], 0
    buffer_load_dwordx4 v9, s[36:39], s30 offen offset:1024 lds
    v_mfma_f32_16x16x32_bf16 v[196:199], v[76:79], a[20:23], v[196:199]
    v_mfma_f32_16x16x32_bf16 v[200:203], v[72:75], a[8:11], 0
    ds_read_b64_tr_b16 v[68:69], v20 offset:4096
    v_mfma_f32_16x16x32_bf16 v[200:203], v[76:79], a[24:27], v[200:203]
    ds_read_b64_tr_b16 v[70:71], v20 offset:4608
    v_mfma_f32_16x16x32_bf16 v[204:207], v[72:75], a[12:15], 0
    v_mfma_f32_16x16x32_bf16 v[204:207], v[76:79], a[28:31], v[204:207]
    s_waitcnt lgkmcnt(8)
    v_mfma_f32_16x16x32_bf16 v[144:147], v[80:83], a[0:3], 0
    ds_read_b64_tr_b16 v[72:73], v20 offset:8192
    v_mfma_f32_16x16x32_bf16 v[144:147], v[84:87], a[16:19], v[144:147]
    ds_read_b64_tr_b16 v[74:75], v20 offset:8704
    v_mfma_f32_16x16x32_bf16 v[148:151], v[80:83], a[4:7], 0
    buffer_load_dwordx4 v10, s[36:39], s30 offen offset:2048 lds
    v_mfma_f32_16x16x32_bf16 v[148:151], v[84:87], a[20:23], v[148:151]
    v_mfma_f32_16x16x32_bf16 v[152:155], v[80:83], a[8:11], 0
    ds_read_b64_tr_b16 v[76:77], v20 offset:12288
    v_mfma_f32_16x16x32_bf16 v[152:155], v[84:87], a[24:27], v[152:155]
    ds_read_b64_tr_b16 v[78:79], v20 offset:12800
    v_mfma_f32_16x16x32_bf16 v[156:159], v[80:83], a[12:15], 0
    v_mfma_f32_16x16x32_bf16 v[156:159], v[84:87], a[28:31], v[156:159]
    s_waitcnt lgkmcnt(8)
    v_mfma_f32_16x16x32_bf16 v[208:211], v[88:91], a[0:3], 0
    ds_read_b64_tr_b16 v[80:81], v21 offset:0
    v_mfma_f32_16x16x32_bf16 v[208:211], v[92:95], a[16:19], v[208:211]
    ds_read_b64_tr_b16 v[82:83], v21 offset:512
    v_mfma_f32_16x16x32_bf16 v[212:215], v[88:91], a[4:7], 0
    buffer_load_dwordx4 v11, s[36:39], s30 offen offset:3072 lds
    v_mfma_f32_16x16x32_bf16 v[212:215], v[92:95], a[20:23], v[212:215]
    v_mfma_f32_16x16x32_bf16 v[216:219], v[88:91], a[8:11], 0
    ds_read_b64_tr_b16 v[84:85], v21 offset:4096
    v_mfma_f32_16x16x32_bf16 v[216:219], v[92:95], a[24:27], v[216:219]
    ds_read_b64_tr_b16 v[86:87], v21 offset:4608
    v_mfma_f32_16x16x32_bf16 v[220:223], v[88:91], a[12:15], 0
    v_mfma_f32_16x16x32_bf16 v[220:223], v[92:95], a[28:31], v[220:223]
    s_waitcnt lgkmcnt(8)
    v_mfma_f32_16x16x32_bf16 v[96:99], v[64:67], a[32:35], v[96:99]
    ds_read_b64_tr_b16 v[88:89], v21 offset:8192
    v_mfma_f32_16x16x32_bf16 v[96:99], v[68:71], a[48:51], v[96:99]
    ds_read_b64_tr_b16 v[90:91], v21 offset:8704
    s_add_u32 m0, s28, 32768
    s_add_u32 s30, s84, 256
    v_mfma_f32_16x16x32_bf16 v[100:103], v[64:67], a[36:39], v[100:103]
    buffer_load_dwordx4 v8, s[36:39], s30 offen offset:0 lds
    v_mfma_f32_16x16x32_bf16 v[100:103], v[68:71], a[52:55], v[100:103]
    v_mfma_f32_16x16x32_bf16 v[104:107], v[64:67], a[40:43], v[104:107]
    ds_read_b64_tr_b16 v[92:93], v21 offset:12288
    v_mfma_f32_16x16x32_bf16 v[104:107], v[68:71], a[56:59], v[104:107]
    ds_read_b64_tr_b16 v[94:95], v21 offset:12800
    v_mfma_f32_16x16x32_bf16 v[108:111], v[64:67], a[44:47], v[108:111]
    v_mfma_f32_16x16x32_bf16 v[108:111], v[68:71], a[60:63], v[108:111]
    s_waitcnt lgkmcnt(8)
    v_mfma_f32_16x16x32_bf16 v[160:163], v[72:75], a[32:35], v[160:163]
    ds_read_b64_tr_b16 v[64:65], v22 offset:0
    v_mfma_f32_16x16x32_bf16 v[160:163], v[76:79], a[48:51], v[160:163]
    ds_read_b64_tr_b16 v[66:67], v22 offset:512
    v_mfma_f32_16x16x32_bf16 v[164:167], v[72:75], a[36:39], v[164:167]
    buffer_load_dwordx4 v9, s[36:39], s30 offen offset:1024 lds
    v_mfma_f32_16x16x32_bf16 v[164:167], v[76:79], a[52:55], v[164:167]
    v_mfma_f32_16x16x32_bf16 v[168:171], v[72:75], a[40:43], v[168:171]
    ds_read_b64_tr_b16 v[68:69], v22 offset:4096
    v_mfma_f32_16x16x32_bf16 v[168:171], v[76:79], a[56:59], v[168:171]
    ds_read_b64_tr_b16 v[70:71], v22 offset:4608
    v_mfma_f32_16x16x32_bf16 v[172:175], v[72:75], a[44:47], v[172:175]
    v_mfma_f32_16x16x32_bf16 v[172:175], v[76:79], a[60:63], v[172:175]
    s_waitcnt lgkmcnt(8)
    v_mfma_f32_16x16x32_bf16 v[112:115], v[80:83], a[32:35], v[112:115]
    ds_read_b64_tr_b16 v[72:73], v22 offset:8192
    v_mfma_f32_16x16x32_bf16 v[112:115], v[84:87], a[48:51], v[112:115]
    ds_read_b64_tr_b16 v[74:75], v22 offset:8704
    v_mfma_f32_16x16x32_bf16 v[116:119], v[80:83], a[36:39], v[116:119]
    buffer_load_dwordx4 v10, s[36:39], s30 offen offset:2048 lds
    v_mfma_f32_16x16x32_bf16 v[116:119], v[84:87], a[52:55], v[116:119]
    v_mfma_f32_16x16x32_bf16 v[120:123], v[80:83], a[40:43], v[120:123]
    ds_read_b64_tr_b16 v[76:77], v22 offset:12288
    v_mfma_f32_16x16x32_bf16 v[120:123], v[84:87], a[56:59], v[120:123]
    ds_read_b64_tr_b16 v[78:79], v22 offset:12800
    v_mfma_f32_16x16x32_bf16 v[124:127], v[80:83], a[44:47], v[124:127]
    v_mfma_f32_16x16x32_bf16 v[124:127], v[84:87], a[60:63], v[124:127]
    s_waitcnt lgkmcnt(8)
    v_mfma_f32_16x16x32_bf16 v[176:179], v[88:91], a[32:35], v[176:179]
    ds_read_b64_tr_b16 v[80:81], v23 offset:0
    v_mfma_f32_16x16x32_bf16 v[176:179], v[92:95], a[48:51], v[176:179]
    ds_read_b64_tr_b16 v[82:83], v23 offset:512
    v_mfma_f32_16x16x32_bf16 v[180:183], v[88:91], a[36:39], v[180:183]
    buffer_load_dwordx4 v11, s[36:39], s30 offen offset:3072 lds
    v_mfma_f32_16x16x32_bf16 v[180:183], v[92:95], a[52:55], v[180:183]
    v_mfma_f32_16x16x32_bf16 v[184:187], v[88:91], a[40:43], v[184:187]
    ds_read_b64_tr_b16 v[84:85], v23 offset:4096
    v_mfma_f32_16x16x32_bf16 v[184:187], v[92:95], a[56:59], v[184:187]
    ds_read_b64_tr_b16 v[86:87], v23 offset:4608
    v_mfma_f32_16x16x32_bf16 v[188:191], v[88:91], a[44:47], v[188:191]
    v_mfma_f32_16x16x32_bf16 v[188:191], v[92:95], a[60:63], v[188:191]
    s_waitcnt lgkmcnt(8)
    v_mfma_f32_16x16x32_bf16 v[128:131], v[64:67], a[32:35], v[128:131]
    ds_read_b64_tr_b16 v[88:89], v23 offset:8192
    v_mfma_f32_16x16x32_bf16 v[128:131], v[68:71], a[48:51], v[128:131]
    ds_read_b64_tr_b16 v[90:91], v23 offset:8704
    v_mfma_f32_16x16x32_bf16 v[132:135], v[64:67], a[36:39], v[132:135]
    v_mfma_f32_16x16x32_bf16 v[132:135], v[68:71], a[52:55], v[132:135]
    v_mfma_f32_16x16x32_bf16 v[136:139], v[64:67], a[40:43], v[136:139]
    ds_read_b64_tr_b16 v[92:93], v23 offset:12288
    v_mfma_f32_16x16x32_bf16 v[136:139], v[68:71], a[56:59], v[136:139]
    ds_read_b64_tr_b16 v[94:95], v23 offset:12800
    v_mfma_f32_16x16x32_bf16 v[140:143], v[64:67], a[44:47], v[140:143]
    v_mfma_f32_16x16x32_bf16 v[140:143], v[68:71], a[60:63], v[140:143]
    s_waitcnt vmcnt(41)
    s_waitcnt lgkmcnt(8)
    v_mfma_f32_16x16x32_bf16 v[192:195], v[72:75], a[32:35], v[192:195]
    ds_read_b64_tr_b16 v[64:65], v20 offset:16384
    v_lshrrev_b32 v6, 3, v2
    v_mfma_f32_16x16x32_bf16 v[192:195], v[76:79], a[48:51], v[192:195]
    ds_read_b64_tr_b16 v[66:67], v20 offset:16896
    v_and_b32 v7, 7, v2
    v_mfma_f32_16x16x32_bf16 v[196:199], v[72:75], a[36:39], v[196:199]
    v_and_b32 v8, 2, v6
    v_xor_b32 v7, v7, v8
    v_mfma_f32_16x16x32_bf16 v[196:199], v[76:79], a[52:55], v[196:199]
    s_and_b32 s12, s6, 1
    s_lshl_b32 s12, s12, 2
    v_mfma_f32_16x16x32_bf16 v[200:203], v[72:75], a[40:43], v[200:203]
    ds_read_b64_tr_b16 v[68:69], v20 offset:20480
    v_xor_b32 v7, s12, v7
    v_mfma_f32_16x16x32_bf16 v[200:203], v[76:79], a[56:59], v[200:203]
    ds_read_b64_tr_b16 v[70:71], v20 offset:20992
    v_lshrrev_b32 v8, 2, v6
    v_mfma_f32_16x16x32_bf16 v[204:207], v[72:75], a[44:47], v[204:207]
    v_lshlrev_b32 v8, 4, v8
    v_and_b32 v6, 3, v6
    v_mfma_f32_16x16x32_bf16 v[204:207], v[76:79], a[60:63], v[204:207]
    v_add_u32 v6, v6, v8
    v_mul_u32_u24 v6, 1152, v6
    s_waitcnt lgkmcnt(8)
    v_mfma_f32_16x16x32_bf16 v[144:147], v[80:83], a[32:35], v[144:147]
    ds_read_b64_tr_b16 v[72:73], v20 offset:24576
    v_lshl_add_u32 v8, v7, 4, v6
    v_mfma_f32_16x16x32_bf16 v[144:147], v[84:87], a[48:51], v[144:147]
    ds_read_b64_tr_b16 v[74:75], v20 offset:25088
    v_xor_b32 v7, 4, v7
    v_mfma_f32_16x16x32_bf16 v[148:151], v[80:83], a[36:39], v[148:151]
    v_lshl_add_u32 v9, v7, 4, v6
    v_add_u32 v9, 3584, v9
    v_mfma_f32_16x16x32_bf16 v[148:151], v[84:87], a[52:55], v[148:151]
    v_add_u32 v10, 7168, v8
    v_add_u32 v11, 7168, v9
    v_mfma_f32_16x16x32_bf16 v[152:155], v[80:83], a[40:43], v[152:155]
    ds_read_b64_tr_b16 v[76:77], v20 offset:28672
    s_mul_i32 s12, s6, 1152
    v_mfma_f32_16x16x32_bf16 v[152:155], v[84:87], a[56:59], v[152:155]
    ds_read_b64_tr_b16 v[78:79], v20 offset:29184
    s_mul_i32 s14, s10, 576
    v_mfma_f32_16x16x32_bf16 v[156:159], v[80:83], a[44:47], v[156:159]
    s_add_u32 s12, s12, s14
    s_and_b32 s14, s4, 1
    v_mfma_f32_16x16x32_bf16 v[156:159], v[84:87], a[60:63], v[156:159]
    s_lshl_b32 s14, s14, 5
    s_add_u32 s12, s12, s14
    s_waitcnt lgkmcnt(8)
    v_mfma_f32_16x16x32_bf16 v[208:211], v[88:91], a[32:35], v[208:211]
    ds_read_b64_tr_b16 v[80:81], v21 offset:16384
    s_mul_i32 s12, s12, 1152
    v_mfma_f32_16x16x32_bf16 v[208:211], v[92:95], a[48:51], v[208:211]
    ds_read_b64_tr_b16 v[82:83], v21 offset:16896
    s_mul_i32 s14, s9, 384
    v_mfma_f32_16x16x32_bf16 v[212:215], v[88:91], a[36:39], v[212:215]
    s_add_u32 s12, s12, s14
    s_sub_u32 s38, 5308416, s12
    v_mfma_f32_16x16x32_bf16 v[212:215], v[92:95], a[52:55], v[212:215]
    s_add_u32 s36, s24, s12
    s_addc_u32 s37, s25, 0
    s_lshr_b32 s11, s6, 1
    v_mfma_f32_16x16x32_bf16 v[216:219], v[88:91], a[40:43], v[216:219]
    ds_read_b64_tr_b16 v[84:85], v21 offset:20480
    s_lshl_b32 s92, s11, 7
    v_mfma_f32_16x16x32_bf16 v[216:219], v[92:95], a[56:59], v[216:219]
    ds_read_b64_tr_b16 v[86:87], v21 offset:20992
    s_xor_b32 s93, s92, 128
    v_mfma_f32_16x16x32_bf16 v[220:223], v[88:91], a[44:47], v[220:223]
    s_mul_i32 s12, s13, 360
    s_mul_i32 s14, s6, 36
    v_mfma_f32_16x16x32_bf16 v[220:223], v[92:95], a[60:63], v[220:223]
    s_add_u32 s12, s12, s14
    s_mul_i32 s14, s10, 18
    s_waitcnt lgkmcnt(8)
    v_mfma_f32_16x16x32_bf16 v[96:99], v[64:67], a[64:67], v[96:99]
    ds_read_b64_tr_b16 v[88:89], v21 offset:24576
    s_add_u32 s12, s12, s14
    v_mfma_f32_16x16x32_bf16 v[96:99], v[68:71], a[80:83], v[96:99]
    ds_read_b64_tr_b16 v[90:91], v21 offset:25088
    s_lshl_b32 s12, s12, 11
    v_mfma_f32_16x16x32_bf16 v[100:103], v[64:67], a[68:71], v[100:103]
    s_add_u32 s12, s12, 0x300000
    s_add_u32 s68, s32, s12
    s_addc_u32 s69, s33, 0
    v_mfma_f32_16x16x32_bf16 v[100:103], v[68:71], a[84:87], v[100:103]
    s_mov_b32 s70, 405504
    s_mul_i32 s90, s10, 368640
    v_mfma_f32_16x16x32_bf16 v[104:107], v[64:67], a[72:75], v[104:107]
    ds_read_b64_tr_b16 v[92:93], v21 offset:28672
    s_sub_u32 s91, 368640, s90
    v_mfma_f32_16x16x32_bf16 v[104:107], v[68:71], a[88:91], v[104:107]
    ds_read_b64_tr_b16 v[94:95], v21 offset:29184
    s_mov_b32 s12, 0
    v_mfma_f32_16x16x32_bf16 v[108:111], v[64:67], a[76:79], v[108:111]
    s_mul_i32 s94, s12, 221184
    s_add_u32 s22, s94, s92
    v_mfma_f32_16x16x32_bf16 v[108:111], v[68:71], a[92:95], v[108:111]
    s_add_u32 s25, s94, s93
    s_mul_i32 s14, s12, 12288
    s_waitcnt lgkmcnt(8)
    v_mfma_f32_16x16x32_bf16 v[160:163], v[72:75], a[64:67], v[160:163]
    ds_read_b64_tr_b16 v[64:65], v22 offset:16384
    s_add_u32 s16, s14, s90
    v_mfma_f32_16x16x32_bf16 v[160:163], v[76:79], a[80:83], v[160:163]
    ds_read_b64_tr_b16 v[66:67], v22 offset:16896
    s_add_u32 s19, s14, s91
    v_mfma_f32_16x16x32_bf16 v[164:167], v[72:75], a[68:71], v[164:167]
    s_add_u32 s12, s12, 1
    s_cmp_eq_u32 s12, 3
    s_cselect_b32 s12, 0, s12
    s_mul_i32 s95, s12, 221184
    v_mfma_f32_16x16x32_bf16 v[164:167], v[76:79], a[84:87], v[164:167]
    s_add_u32 s23, s95, s92
    s_add_u32 s26, s95, s93
    v_mfma_f32_16x16x32_bf16 v[168:171], v[72:75], a[72:75], v[168:171]
    ds_read_b64_tr_b16 v[68:69], v22 offset:20480
    s_mul_i32 s14, s12, 12288
    v_mfma_f32_16x16x32_bf16 v[168:171], v[76:79], a[88:91], v[168:171]
    ds_read_b64_tr_b16 v[70:71], v22 offset:20992
    s_add_u32 s17, s14, s90
    v_mfma_f32_16x16x32_bf16 v[172:175], v[72:75], a[76:79], v[172:175]
    s_add_u32 s20, s14, s91
    s_add_u32 s12, s12, 1
    s_cmp_eq_u32 s12, 3
    s_cselect_b32 s12, 0, s12
    v_mfma_f32_16x16x32_bf16 v[172:175], v[76:79], a[92:95], v[172:175]
    s_mul_i32 s96, s12, 221184
    s_add_u32 s24, s96, s92
    s_waitcnt lgkmcnt(8)
    v_mfma_f32_16x16x32_bf16 v[112:115], v[80:83], a[64:67], v[112:115]
    ds_read_b64_tr_b16 v[72:73], v22 offset:24576
    s_add_u32 s27, s96, s93
    v_mfma_f32_16x16x32_bf16 v[112:115], v[84:87], a[80:83], v[112:115]
    ds_read_b64_tr_b16 v[74:75], v22 offset:25088
    s_mul_i32 s14, s12, 12288
    v_mfma_f32_16x16x32_bf16 v[116:119], v[80:83], a[68:71], v[116:119]
    s_add_u32 s18, s14, s90
    s_add_u32 s21, s14, s91
    v_mfma_f32_16x16x32_bf16 v[116:119], v[84:87], a[84:87], v[116:119]
    s_lshl_b32 s12, s11, 8
    v_add_u32 v32, s12, v30
    v_mfma_f32_16x16x32_bf16 v[120:123], v[80:83], a[72:75], v[120:123]
    ds_read_b64_tr_b16 v[76:77], v22 offset:28672
    v_xor_b32 v33, 256, v32
    v_mfma_f32_16x16x32_bf16 v[120:123], v[84:87], a[88:91], v[120:123]
    ds_read_b64_tr_b16 v[78:79], v22 offset:29184
    s_lshl_b32 s43, s10, 13
    v_mfma_f32_16x16x32_bf16 v[124:127], v[80:83], a[76:79], v[124:127]
    v_mfma_f32_16x16x32_bf16 v[124:127], v[84:87], a[92:95], v[124:127]
    s_waitcnt lgkmcnt(8)
    v_mfma_f32_16x16x32_bf16 v[176:179], v[88:91], a[64:67], v[176:179]
    ds_read_b64_tr_b16 v[80:81], v23 offset:16384
    v_mfma_f32_16x16x32_bf16 v[176:179], v[92:95], a[80:83], v[176:179]
    ds_read_b64_tr_b16 v[82:83], v23 offset:16896
    v_mfma_f32_16x16x32_bf16 v[180:183], v[88:91], a[68:71], v[180:183]
    v_mfma_f32_16x16x32_bf16 v[180:183], v[92:95], a[84:87], v[180:183]
    v_mfma_f32_16x16x32_bf16 v[184:187], v[88:91], a[72:75], v[184:187]
    ds_read_b64_tr_b16 v[84:85], v23 offset:20480
    v_mfma_f32_16x16x32_bf16 v[184:187], v[92:95], a[88:91], v[184:187]
    ds_read_b64_tr_b16 v[86:87], v23 offset:20992
    v_mfma_f32_16x16x32_bf16 v[188:191], v[88:91], a[76:79], v[188:191]
    v_mfma_f32_16x16x32_bf16 v[188:191], v[92:95], a[92:95], v[188:191]
    s_waitcnt lgkmcnt(8)
    v_mfma_f32_16x16x32_bf16 v[128:131], v[64:67], a[64:67], v[128:131]
    ds_read_b64_tr_b16 v[88:89], v23 offset:24576
    v_mfma_f32_16x16x32_bf16 v[128:131], v[68:71], a[80:83], v[128:131]
    ds_read_b64_tr_b16 v[90:91], v23 offset:25088
    v_mfma_f32_16x16x32_bf16 v[132:135], v[64:67], a[68:71], v[132:135]
    v_mfma_f32_16x16x32_bf16 v[132:135], v[68:71], a[84:87], v[132:135]
    v_mfma_f32_16x16x32_bf16 v[136:139], v[64:67], a[72:75], v[136:139]
    ds_read_b64_tr_b16 v[92:93], v23 offset:28672
    v_mfma_f32_16x16x32_bf16 v[136:139], v[68:71], a[88:91], v[136:139]
    ds_read_b64_tr_b16 v[94:95], v23 offset:29184
    v_mfma_f32_16x16x32_bf16 v[140:143], v[64:67], a[76:79], v[140:143]
    v_mfma_f32_16x16x32_bf16 v[140:143], v[68:71], a[92:95], v[140:143]
    s_waitcnt vmcnt(20)
    s_barrier
    s_waitcnt lgkmcnt(8)
    v_mfma_f32_16x16x32_bf16 v[192:195], v[72:75], a[64:67], v[192:195]
    ds_read_b64_tr_b16 v[64:65], v20 offset:32768
    v_mfma_f32_16x16x32_bf16 v[192:195], v[76:79], a[80:83], v[192:195]
    ds_read_b64_tr_b16 v[66:67], v20 offset:33280
    v_mfma_f32_16x16x32_bf16 v[196:199], v[72:75], a[68:71], v[196:199]
    buffer_load_dwordx4 v[44:47], v38, s[48:51], s58 offen sc1
    v_mfma_f32_16x16x32_bf16 v[196:199], v[76:79], a[84:87], v[196:199]
    v_mfma_f32_16x16x32_bf16 v[200:203], v[72:75], a[72:75], v[200:203]
    ds_read_b64_tr_b16 v[68:69], v20 offset:36864
    v_mfma_f32_16x16x32_bf16 v[200:203], v[76:79], a[88:91], v[200:203]
    ds_read_b64_tr_b16 v[70:71], v20 offset:37376
    v_mfma_f32_16x16x32_bf16 v[204:207], v[72:75], a[76:79], v[204:207]
    v_mfma_f32_16x16x32_bf16 v[204:207], v[76:79], a[92:95], v[204:207]
    s_waitcnt lgkmcnt(8)
    v_mfma_f32_16x16x32_bf16 v[144:147], v[80:83], a[64:67], v[144:147]
    ds_read_b64_tr_b16 v[72:73], v20 offset:40960
    v_mfma_f32_16x16x32_bf16 v[144:147], v[84:87], a[80:83], v[144:147]
    ds_read_b64_tr_b16 v[74:75], v20 offset:41472
    v_mfma_f32_16x16x32_bf16 v[148:151], v[80:83], a[68:71], v[148:151]
    v_mfma_f32_16x16x32_bf16 v[148:151], v[84:87], a[84:87], v[148:151]
    v_mfma_f32_16x16x32_bf16 v[152:155], v[80:83], a[72:75], v[152:155]
    ds_read_b64_tr_b16 v[76:77], v20 offset:45056
    v_mfma_f32_16x16x32_bf16 v[152:155], v[84:87], a[88:91], v[152:155]
    ds_read_b64_tr_b16 v[78:79], v20 offset:45568
    v_mfma_f32_16x16x32_bf16 v[156:159], v[80:83], a[76:79], v[156:159]
    v_mfma_f32_16x16x32_bf16 v[156:159], v[84:87], a[92:95], v[156:159]
    s_waitcnt lgkmcnt(8)
    v_mfma_f32_16x16x32_bf16 v[208:211], v[88:91], a[64:67], v[208:211]
    ds_read_b64_tr_b16 v[80:81], v21 offset:32768
    v_mfma_f32_16x16x32_bf16 v[208:211], v[92:95], a[80:83], v[208:211]
    ds_read_b64_tr_b16 v[82:83], v21 offset:33280
    v_mfma_f32_16x16x32_bf16 v[212:215], v[88:91], a[68:71], v[212:215]
    v_mfma_f32_16x16x32_bf16 v[212:215], v[92:95], a[84:87], v[212:215]
    v_mfma_f32_16x16x32_bf16 v[216:219], v[88:91], a[72:75], v[216:219]
    ds_read_b64_tr_b16 v[84:85], v21 offset:36864
    v_mfma_f32_16x16x32_bf16 v[216:219], v[92:95], a[88:91], v[216:219]
    ds_read_b64_tr_b16 v[86:87], v21 offset:37376
    s_add_u32 m0, s28, 49152
    s_add_u32 s30, s22, 0
    v_mfma_f32_16x16x32_bf16 v[220:223], v[88:91], a[76:79], v[220:223]
    buffer_load_dwordx4 v8, s[36:39], s30 offen offset:0 lds
    v_mfma_f32_16x16x32_bf16 v[220:223], v[92:95], a[92:95], v[220:223]
    s_waitcnt lgkmcnt(8)
    v_mfma_f32_16x16x32_bf16 v[96:99], v[64:67], a[96:99], v[96:99]
    ds_read_b64_tr_b16 v[88:89], v21 offset:40960
    v_mfma_f32_16x16x32_bf16 v[96:99], v[68:71], a[112:115], v[96:99]
    ds_read_b64_tr_b16 v[90:91], v21 offset:41472
    v_mfma_f32_16x16x32_bf16 v[100:103], v[64:67], a[100:103], v[100:103]
    v_mfma_f32_16x16x32_bf16 v[100:103], v[68:71], a[116:119], v[100:103]
    v_mfma_f32_16x16x32_bf16 v[104:107], v[64:67], a[104:107], v[104:107]
    ds_read_b64_tr_b16 v[92:93], v21 offset:45056
    v_mfma_f32_16x16x32_bf16 v[104:107], v[68:71], a[120:123], v[104:107]
    ds_read_b64_tr_b16 v[94:95], v21 offset:45568
    v_mfma_f32_16x16x32_bf16 v[108:111], v[64:67], a[108:111], v[108:111]
    buffer_load_dwordx4 v9, s[36:39], s30 offen offset:1024 lds
    v_mfma_f32_16x16x32_bf16 v[108:111], v[68:71], a[124:127], v[108:111]
    s_waitcnt lgkmcnt(8)
    v_mfma_f32_16x16x32_bf16 v[160:163], v[72:75], a[96:99], v[160:163]
    ds_read_b64_tr_b16 v[64:65], v22 offset:32768
    v_mfma_f32_16x16x32_bf16 v[160:163], v[76:79], a[112:115], v[160:163]
    ds_read_b64_tr_b16 v[66:67], v22 offset:33280
    v_mfma_f32_16x16x32_bf16 v[164:167], v[72:75], a[100:103], v[164:167]
    v_mfma_f32_16x16x32_bf16 v[164:167], v[76:79], a[116:119], v[164:167]
    v_mfma_f32_16x16x32_bf16 v[168:171], v[72:75], a[104:107], v[168:171]
    ds_read_b64_tr_b16 v[68:69], v22 offset:36864
    v_mfma_f32_16x16x32_bf16 v[168:171], v[76:79], a[120:123], v[168:171]
    ds_read_b64_tr_b16 v[70:71], v22 offset:37376
    v_mfma_f32_16x16x32_bf16 v[172:175], v[72:75], a[108:111], v[172:175]
    buffer_load_dwordx4 v10, s[36:39], s30 offen offset:2048 lds
    v_mfma_f32_16x16x32_bf16 v[172:175], v[76:79], a[124:127], v[172:175]
    s_waitcnt lgkmcnt(8)
    v_mfma_f32_16x16x32_bf16 v[112:115], v[80:83], a[96:99], v[112:115]
    ds_read_b64_tr_b16 v[72:73], v22 offset:40960
    v_mfma_f32_16x16x32_bf16 v[112:115], v[84:87], a[112:115], v[112:115]
    ds_read_b64_tr_b16 v[74:75], v22 offset:41472
    v_mfma_f32_16x16x32_bf16 v[116:119], v[80:83], a[100:103], v[116:119]
    v_mfma_f32_16x16x32_bf16 v[116:119], v[84:87], a[116:119], v[116:119]
    v_mfma_f32_16x16x32_bf16 v[120:123], v[80:83], a[104:107], v[120:123]
    ds_read_b64_tr_b16 v[76:77], v22 offset:45056
    v_mfma_f32_16x16x32_bf16 v[120:123], v[84:87], a[120:123], v[120:123]
    ds_read_b64_tr_b16 v[78:79], v22 offset:45568
    v_mfma_f32_16x16x32_bf16 v[124:127], v[80:83], a[108:111], v[124:127]
    buffer_load_dwordx4 v11, s[36:39], s30 offen offset:3072 lds
    v_mfma_f32_16x16x32_bf16 v[124:127], v[84:87], a[124:127], v[124:127]
    s_waitcnt lgkmcnt(8)
    v_mfma_f32_16x16x32_bf16 v[176:179], v[88:91], a[96:99], v[176:179]
    ds_read_b64_tr_b16 v[80:81], v23 offset:32768
    v_mfma_f32_16x16x32_bf16 v[176:179], v[92:95], a[112:115], v[176:179]
    ds_read_b64_tr_b16 v[82:83], v23 offset:33280
    v_mfma_f32_16x16x32_bf16 v[180:183], v[88:91], a[100:103], v[180:183]
    v_mfma_f32_16x16x32_bf16 v[180:183], v[92:95], a[116:119], v[180:183]
    v_mfma_f32_16x16x32_bf16 v[184:187], v[88:91], a[104:107], v[184:187]
    ds_read_b64_tr_b16 v[84:85], v23 offset:36864
    v_mfma_f32_16x16x32_bf16 v[184:187], v[92:95], a[120:123], v[184:187]
    ds_read_b64_tr_b16 v[86:87], v23 offset:37376
    s_add_u32 m0, s28, 65536
    s_add_u32 s30, s25, 0
    v_mfma_f32_16x16x32_bf16 v[188:191], v[88:91], a[108:111], v[188:191]
    buffer_load_dwordx4 v8, s[36:39], s30 offen offset:0 lds
    v_mfma_f32_16x16x32_bf16 v[188:191], v[92:95], a[124:127], v[188:191]
    s_waitcnt vmcnt(5)
    s_mov_b32 s61, 0
parallel_fc10:
    v_xor_b32 v47, s3, v44
    v_cmp_ne_u32 vcc, 0, v47
    s_cbranch_vccz parallel_fx11
    s_add_u32 s61, s61, 1
    s_cmp_gt_u32 s61, 131072
    s_cbranch_scc1 parallel_fx11
    buffer_load_dwordx4 v[44:47], v38, s[48:51], s58 offen sc1
    s_waitcnt vmcnt(0)
    s_branch parallel_fc10
parallel_fx11:
    s_waitcnt lgkmcnt(8)
    v_mfma_f32_16x16x32_bf16 v[128:131], v[64:67], a[96:99], v[128:131]
    ds_read_b64_tr_b16 v[88:89], v23 offset:40960
    v_mfma_f32_16x16x32_bf16 v[128:131], v[68:71], a[112:115], v[128:131]
    ds_read_b64_tr_b16 v[90:91], v23 offset:41472
    s_add_u32 s31, s16, 0
    v_mfma_f32_16x16x32_bf16 v[132:135], v[64:67], a[100:103], v[132:135]
    buffer_load_dwordx4 a[0:3], v32, s[68:71], s31 offen sc1
    v_mfma_f32_16x16x32_bf16 v[132:135], v[68:71], a[116:119], v[132:135]
    v_mfma_f32_16x16x32_bf16 v[136:139], v[64:67], a[104:107], v[136:139]
    ds_read_b64_tr_b16 v[92:93], v23 offset:45056
    v_mfma_f32_16x16x32_bf16 v[136:139], v[68:71], a[120:123], v[136:139]
    ds_read_b64_tr_b16 v[94:95], v23 offset:45568
    v_mfma_f32_16x16x32_bf16 v[140:143], v[64:67], a[108:111], v[140:143]
    buffer_load_dwordx4 v9, s[36:39], s30 offen offset:1024 lds
    v_mfma_f32_16x16x32_bf16 v[140:143], v[68:71], a[124:127], v[140:143]
    s_waitcnt lgkmcnt(8)
    v_mfma_f32_16x16x32_bf16 v[192:195], v[72:75], a[96:99], v[192:195]
    ds_read_b64_tr_b16 v[64:65], v20 offset:49152
    v_mfma_f32_16x16x32_bf16 v[192:195], v[76:79], a[112:115], v[192:195]
    ds_read_b64_tr_b16 v[66:67], v20 offset:49664
    v_mfma_f32_16x16x32_bf16 v[196:199], v[72:75], a[100:103], v[196:199]
    buffer_load_dwordx4 a[4:7], v33, s[68:71], s31 offen sc1
    v_mfma_f32_16x16x32_bf16 v[196:199], v[76:79], a[116:119], v[196:199]
    v_mfma_f32_16x16x32_bf16 v[200:203], v[72:75], a[104:107], v[200:203]
    ds_read_b64_tr_b16 v[68:69], v20 offset:53248
    v_mfma_f32_16x16x32_bf16 v[200:203], v[76:79], a[120:123], v[200:203]
    ds_read_b64_tr_b16 v[70:71], v20 offset:53760
    v_mfma_f32_16x16x32_bf16 v[204:207], v[72:75], a[108:111], v[204:207]
    buffer_load_dwordx4 v10, s[36:39], s30 offen offset:2048 lds
    v_mfma_f32_16x16x32_bf16 v[204:207], v[76:79], a[124:127], v[204:207]
    s_waitcnt lgkmcnt(8)
    v_mfma_f32_16x16x32_bf16 v[144:147], v[80:83], a[96:99], v[144:147]
    ds_read_b64_tr_b16 v[72:73], v20 offset:57344
    v_mfma_f32_16x16x32_bf16 v[144:147], v[84:87], a[112:115], v[144:147]
    ds_read_b64_tr_b16 v[74:75], v20 offset:57856
    s_add_u32 s31, s19, 0
    v_mfma_f32_16x16x32_bf16 v[148:151], v[80:83], a[100:103], v[148:151]
    buffer_load_dwordx4 a[8:11], v32, s[68:71], s31 offen sc1
    v_mfma_f32_16x16x32_bf16 v[148:151], v[84:87], a[116:119], v[148:151]
    v_mfma_f32_16x16x32_bf16 v[152:155], v[80:83], a[104:107], v[152:155]
    ds_read_b64_tr_b16 v[76:77], v20 offset:61440
    v_mfma_f32_16x16x32_bf16 v[152:155], v[84:87], a[120:123], v[152:155]
    ds_read_b64_tr_b16 v[78:79], v20 offset:61952
    v_mfma_f32_16x16x32_bf16 v[156:159], v[80:83], a[108:111], v[156:159]
    buffer_load_dwordx4 v11, s[36:39], s30 offen offset:3072 lds
    v_mfma_f32_16x16x32_bf16 v[156:159], v[84:87], a[124:127], v[156:159]
    s_waitcnt lgkmcnt(8)
    v_mfma_f32_16x16x32_bf16 v[208:211], v[88:91], a[96:99], v[208:211]
    ds_read_b64_tr_b16 v[80:81], v21 offset:49152
    v_mfma_f32_16x16x32_bf16 v[208:211], v[92:95], a[112:115], v[208:211]
    ds_read_b64_tr_b16 v[82:83], v21 offset:49664
    v_mfma_f32_16x16x32_bf16 v[212:215], v[88:91], a[100:103], v[212:215]
    buffer_load_dwordx4 a[12:15], v33, s[68:71], s31 offen sc1
    v_mfma_f32_16x16x32_bf16 v[212:215], v[92:95], a[116:119], v[212:215]
    v_mfma_f32_16x16x32_bf16 v[216:219], v[88:91], a[104:107], v[216:219]
    ds_read_b64_tr_b16 v[84:85], v21 offset:53248
    v_mfma_f32_16x16x32_bf16 v[216:219], v[92:95], a[120:123], v[216:219]
    ds_read_b64_tr_b16 v[86:87], v21 offset:53760
    s_add_u32 m0, s28, 81920
    s_add_u32 s30, s23, 0
    v_mfma_f32_16x16x32_bf16 v[220:223], v[88:91], a[108:111], v[220:223]
    buffer_load_dwordx4 v8, s[36:39], s30 offen offset:0 lds
    v_mfma_f32_16x16x32_bf16 v[220:223], v[92:95], a[124:127], v[220:223]
    s_waitcnt lgkmcnt(8)
    v_mfma_f32_16x16x32_bf16 v[96:99], v[64:67], a[128:131], v[96:99]
    ds_read_b64_tr_b16 v[88:89], v21 offset:57344
    v_mfma_f32_16x16x32_bf16 v[96:99], v[68:71], a[144:147], v[96:99]
    ds_read_b64_tr_b16 v[90:91], v21 offset:57856
    s_add_u32 s31, s16, 2048
    v_mfma_f32_16x16x32_bf16 v[100:103], v[64:67], a[132:135], v[100:103]
    buffer_load_dwordx4 a[16:19], v32, s[68:71], s31 offen sc1
    v_mfma_f32_16x16x32_bf16 v[100:103], v[68:71], a[148:151], v[100:103]
    v_mfma_f32_16x16x32_bf16 v[104:107], v[64:67], a[136:139], v[104:107]
    ds_read_b64_tr_b16 v[92:93], v21 offset:61440
    v_mfma_f32_16x16x32_bf16 v[104:107], v[68:71], a[152:155], v[104:107]
    ds_read_b64_tr_b16 v[94:95], v21 offset:61952
    v_mfma_f32_16x16x32_bf16 v[108:111], v[64:67], a[140:143], v[108:111]
    buffer_load_dwordx4 v9, s[36:39], s30 offen offset:1024 lds
    v_mfma_f32_16x16x32_bf16 v[108:111], v[68:71], a[156:159], v[108:111]
    s_waitcnt lgkmcnt(8)
    v_mfma_f32_16x16x32_bf16 v[160:163], v[72:75], a[128:131], v[160:163]
    ds_read_b64_tr_b16 v[64:65], v22 offset:49152
    v_mfma_f32_16x16x32_bf16 v[160:163], v[76:79], a[144:147], v[160:163]
    ds_read_b64_tr_b16 v[66:67], v22 offset:49664
    v_mfma_f32_16x16x32_bf16 v[164:167], v[72:75], a[132:135], v[164:167]
    buffer_load_dwordx4 a[20:23], v33, s[68:71], s31 offen sc1
    v_mfma_f32_16x16x32_bf16 v[164:167], v[76:79], a[148:151], v[164:167]
    v_mfma_f32_16x16x32_bf16 v[168:171], v[72:75], a[136:139], v[168:171]
    ds_read_b64_tr_b16 v[68:69], v22 offset:53248
    v_mfma_f32_16x16x32_bf16 v[168:171], v[76:79], a[152:155], v[168:171]
    ds_read_b64_tr_b16 v[70:71], v22 offset:53760
    v_mfma_f32_16x16x32_bf16 v[172:175], v[72:75], a[140:143], v[172:175]
    buffer_load_dwordx4 v10, s[36:39], s30 offen offset:2048 lds
    v_mfma_f32_16x16x32_bf16 v[172:175], v[76:79], a[156:159], v[172:175]
    s_waitcnt lgkmcnt(8)
    v_mfma_f32_16x16x32_bf16 v[112:115], v[80:83], a[128:131], v[112:115]
    ds_read_b64_tr_b16 v[72:73], v22 offset:57344
    v_mfma_f32_16x16x32_bf16 v[112:115], v[84:87], a[144:147], v[112:115]
    ds_read_b64_tr_b16 v[74:75], v22 offset:57856
    s_add_u32 s31, s19, 2048
    v_mfma_f32_16x16x32_bf16 v[116:119], v[80:83], a[132:135], v[116:119]
    buffer_load_dwordx4 a[24:27], v32, s[68:71], s31 offen sc1
    v_mfma_f32_16x16x32_bf16 v[116:119], v[84:87], a[148:151], v[116:119]
    v_mfma_f32_16x16x32_bf16 v[120:123], v[80:83], a[136:139], v[120:123]
    ds_read_b64_tr_b16 v[76:77], v22 offset:61440
    v_mfma_f32_16x16x32_bf16 v[120:123], v[84:87], a[152:155], v[120:123]
    ds_read_b64_tr_b16 v[78:79], v22 offset:61952
    v_mfma_f32_16x16x32_bf16 v[124:127], v[80:83], a[140:143], v[124:127]
    buffer_load_dwordx4 v11, s[36:39], s30 offen offset:3072 lds
    v_mfma_f32_16x16x32_bf16 v[124:127], v[84:87], a[156:159], v[124:127]
    s_waitcnt lgkmcnt(8)
    v_mfma_f32_16x16x32_bf16 v[176:179], v[88:91], a[128:131], v[176:179]
    ds_read_b64_tr_b16 v[80:81], v23 offset:49152
    v_mfma_f32_16x16x32_bf16 v[176:179], v[92:95], a[144:147], v[176:179]
    ds_read_b64_tr_b16 v[82:83], v23 offset:49664
    v_mfma_f32_16x16x32_bf16 v[180:183], v[88:91], a[132:135], v[180:183]
    buffer_load_dwordx4 a[28:31], v33, s[68:71], s31 offen sc1
    v_mfma_f32_16x16x32_bf16 v[180:183], v[92:95], a[148:151], v[180:183]
    s_waitcnt vmcnt(30)
    buffer_store_dword v36, v37, s[48:51], s56 offen offset:4 sc1
    v_mfma_f32_16x16x32_bf16 v[184:187], v[88:91], a[136:139], v[184:187]
    ds_read_b64_tr_b16 v[84:85], v23 offset:53248
    v_mfma_f32_16x16x32_bf16 v[184:187], v[92:95], a[152:155], v[184:187]
    ds_read_b64_tr_b16 v[86:87], v23 offset:53760
    v_mfma_f32_16x16x32_bf16 v[188:191], v[88:91], a[140:143], v[188:191]
    v_mfma_f32_16x16x32_bf16 v[188:191], v[92:95], a[156:159], v[188:191]
    s_waitcnt lgkmcnt(8)
    v_mfma_f32_16x16x32_bf16 v[128:131], v[64:67], a[128:131], v[128:131]
    ds_read_b64_tr_b16 v[88:89], v23 offset:57344
    v_mfma_f32_16x16x32_bf16 v[128:131], v[68:71], a[144:147], v[128:131]
    ds_read_b64_tr_b16 v[90:91], v23 offset:57856
    s_add_u32 s31, s17, 0
    v_mfma_f32_16x16x32_bf16 v[132:135], v[64:67], a[132:135], v[132:135]
    buffer_load_dwordx4 a[32:35], v32, s[68:71], s31 offen sc1
    v_mfma_f32_16x16x32_bf16 v[132:135], v[68:71], a[148:151], v[132:135]
    v_mfma_f32_16x16x32_bf16 v[136:139], v[64:67], a[136:139], v[136:139]
    ds_read_b64_tr_b16 v[92:93], v23 offset:61440
    v_mfma_f32_16x16x32_bf16 v[136:139], v[68:71], a[152:155], v[136:139]
    ds_read_b64_tr_b16 v[94:95], v23 offset:61952
    v_mfma_f32_16x16x32_bf16 v[140:143], v[64:67], a[140:143], v[140:143]
    v_mfma_f32_16x16x32_bf16 v[140:143], v[68:71], a[156:159], v[140:143]
    s_waitcnt lgkmcnt(8)
    v_mfma_f32_16x16x32_bf16 v[192:195], v[72:75], a[128:131], v[192:195]
    ds_read_b64_tr_b16 v[64:65], v24 offset:0
    v_mfma_f32_16x16x32_bf16 v[192:195], v[76:79], a[144:147], v[192:195]
    ds_read_b64_tr_b16 v[66:67], v24 offset:512
    v_mfma_f32_16x16x32_bf16 v[196:199], v[72:75], a[132:135], v[196:199]
    buffer_load_dwordx4 a[36:39], v33, s[68:71], s31 offen sc1
    v_mfma_f32_16x16x32_bf16 v[196:199], v[76:79], a[148:151], v[196:199]
    v_mfma_f32_16x16x32_bf16 v[200:203], v[72:75], a[136:139], v[200:203]
    ds_read_b64_tr_b16 v[68:69], v24 offset:4096
    v_mfma_f32_16x16x32_bf16 v[200:203], v[76:79], a[152:155], v[200:203]
    ds_read_b64_tr_b16 v[70:71], v24 offset:4608
    v_mfma_f32_16x16x32_bf16 v[204:207], v[72:75], a[140:143], v[204:207]
    v_mfma_f32_16x16x32_bf16 v[204:207], v[76:79], a[156:159], v[204:207]
    s_waitcnt lgkmcnt(8)
    v_mfma_f32_16x16x32_bf16 v[144:147], v[80:83], a[128:131], v[144:147]
    ds_read_b64_tr_b16 v[72:73], v24 offset:8192
    v_mfma_f32_16x16x32_bf16 v[144:147], v[84:87], a[144:147], v[144:147]
    ds_read_b64_tr_b16 v[74:75], v24 offset:8704
    s_add_u32 s31, s20, 0
    v_mfma_f32_16x16x32_bf16 v[148:151], v[80:83], a[132:135], v[148:151]
    buffer_load_dwordx4 a[40:43], v32, s[68:71], s31 offen sc1
    v_mfma_f32_16x16x32_bf16 v[148:151], v[84:87], a[148:151], v[148:151]
    v_mfma_f32_16x16x32_bf16 v[152:155], v[80:83], a[136:139], v[152:155]
    ds_read_b64_tr_b16 v[76:77], v24 offset:12288
    v_mfma_f32_16x16x32_bf16 v[152:155], v[84:87], a[152:155], v[152:155]
    ds_read_b64_tr_b16 v[78:79], v24 offset:12800
    v_mfma_f32_16x16x32_bf16 v[156:159], v[80:83], a[140:143], v[156:159]
    v_mfma_f32_16x16x32_bf16 v[156:159], v[84:87], a[156:159], v[156:159]
    s_waitcnt lgkmcnt(8)
    v_mfma_f32_16x16x32_bf16 v[208:211], v[88:91], a[128:131], v[208:211]
    ds_read_b64_tr_b16 v[80:81], v25 offset:0
    v_mfma_f32_16x16x32_bf16 v[208:211], v[92:95], a[144:147], v[208:211]
    ds_read_b64_tr_b16 v[82:83], v25 offset:512
    v_mfma_f32_16x16x32_bf16 v[212:215], v[88:91], a[132:135], v[212:215]
    buffer_load_dwordx4 a[44:47], v33, s[68:71], s31 offen sc1
    v_mfma_f32_16x16x32_bf16 v[212:215], v[92:95], a[148:151], v[212:215]
    v_mfma_f32_16x16x32_bf16 v[216:219], v[88:91], a[136:139], v[216:219]
    ds_read_b64_tr_b16 v[84:85], v25 offset:4096
    v_mfma_f32_16x16x32_bf16 v[216:219], v[92:95], a[152:155], v[216:219]
    ds_read_b64_tr_b16 v[86:87], v25 offset:4608
    v_mfma_f32_16x16x32_bf16 v[220:223], v[88:91], a[140:143], v[220:223]
    v_mfma_f32_16x16x32_bf16 v[220:223], v[92:95], a[156:159], v[220:223]
    s_waitcnt lgkmcnt(8)
    v_mfma_f32_16x16x32_bf16 v[96:99], v[64:67], a[160:163], v[96:99]
    ds_read_b64_tr_b16 v[88:89], v25 offset:8192
    v_mfma_f32_16x16x32_bf16 v[96:99], v[68:71], a[176:179], v[96:99]
    ds_read_b64_tr_b16 v[90:91], v25 offset:8704
    s_add_u32 s31, s17, 2048
    v_mfma_f32_16x16x32_bf16 v[100:103], v[64:67], a[164:167], v[100:103]
    buffer_load_dwordx4 a[48:51], v32, s[68:71], s31 offen sc1
    v_mfma_f32_16x16x32_bf16 v[100:103], v[68:71], a[180:183], v[100:103]
    v_mfma_f32_16x16x32_bf16 v[104:107], v[64:67], a[168:171], v[104:107]
    ds_read_b64_tr_b16 v[92:93], v25 offset:12288
    v_mfma_f32_16x16x32_bf16 v[104:107], v[68:71], a[184:187], v[104:107]
    ds_read_b64_tr_b16 v[94:95], v25 offset:12800
    v_mfma_f32_16x16x32_bf16 v[108:111], v[64:67], a[172:175], v[108:111]
    v_mfma_f32_16x16x32_bf16 v[108:111], v[68:71], a[188:191], v[108:111]
    s_waitcnt lgkmcnt(8)
    v_mfma_f32_16x16x32_bf16 v[160:163], v[72:75], a[160:163], v[160:163]
    ds_read_b64_tr_b16 v[64:65], v26 offset:0
    v_mfma_f32_16x16x32_bf16 v[160:163], v[76:79], a[176:179], v[160:163]
    ds_read_b64_tr_b16 v[66:67], v26 offset:512
    v_mfma_f32_16x16x32_bf16 v[164:167], v[72:75], a[164:167], v[164:167]
    buffer_load_dwordx4 a[52:55], v33, s[68:71], s31 offen sc1
    v_mfma_f32_16x16x32_bf16 v[164:167], v[76:79], a[180:183], v[164:167]
    v_mfma_f32_16x16x32_bf16 v[168:171], v[72:75], a[168:171], v[168:171]
    ds_read_b64_tr_b16 v[68:69], v26 offset:4096
    v_mfma_f32_16x16x32_bf16 v[168:171], v[76:79], a[184:187], v[168:171]
    ds_read_b64_tr_b16 v[70:71], v26 offset:4608
    v_mfma_f32_16x16x32_bf16 v[172:175], v[72:75], a[172:175], v[172:175]
    v_mfma_f32_16x16x32_bf16 v[172:175], v[76:79], a[188:191], v[172:175]
    s_waitcnt lgkmcnt(8)
    v_mfma_f32_16x16x32_bf16 v[112:115], v[80:83], a[160:163], v[112:115]
    ds_read_b64_tr_b16 v[72:73], v26 offset:8192
    v_mfma_f32_16x16x32_bf16 v[112:115], v[84:87], a[176:179], v[112:115]
    ds_read_b64_tr_b16 v[74:75], v26 offset:8704
    s_add_u32 s31, s20, 2048
    v_mfma_f32_16x16x32_bf16 v[116:119], v[80:83], a[164:167], v[116:119]
    buffer_load_dwordx4 a[56:59], v32, s[68:71], s31 offen sc1
    v_mfma_f32_16x16x32_bf16 v[116:119], v[84:87], a[180:183], v[116:119]
    v_mfma_f32_16x16x32_bf16 v[120:123], v[80:83], a[168:171], v[120:123]
    ds_read_b64_tr_b16 v[76:77], v26 offset:12288
    v_mfma_f32_16x16x32_bf16 v[120:123], v[84:87], a[184:187], v[120:123]
    ds_read_b64_tr_b16 v[78:79], v26 offset:12800
    v_mfma_f32_16x16x32_bf16 v[124:127], v[80:83], a[172:175], v[124:127]
    v_mfma_f32_16x16x32_bf16 v[124:127], v[84:87], a[188:191], v[124:127]
    s_waitcnt lgkmcnt(8)
    v_mfma_f32_16x16x32_bf16 v[176:179], v[88:91], a[160:163], v[176:179]
    ds_read_b64_tr_b16 v[80:81], v27 offset:0
    v_mfma_f32_16x16x32_bf16 v[176:179], v[92:95], a[176:179], v[176:179]
    ds_read_b64_tr_b16 v[82:83], v27 offset:512
    v_mfma_f32_16x16x32_bf16 v[180:183], v[88:91], a[164:167], v[180:183]
    buffer_load_dwordx4 a[60:63], v33, s[68:71], s31 offen sc1
    v_mfma_f32_16x16x32_bf16 v[180:183], v[92:95], a[180:183], v[180:183]
    v_mfma_f32_16x16x32_bf16 v[184:187], v[88:91], a[168:171], v[184:187]
    ds_read_b64_tr_b16 v[84:85], v27 offset:4096
    v_mfma_f32_16x16x32_bf16 v[184:187], v[92:95], a[184:187], v[184:187]
    ds_read_b64_tr_b16 v[86:87], v27 offset:4608
    v_mfma_f32_16x16x32_bf16 v[188:191], v[88:91], a[172:175], v[188:191]
    v_mfma_f32_16x16x32_bf16 v[188:191], v[92:95], a[188:191], v[188:191]
    s_waitcnt lgkmcnt(8)
    v_mfma_f32_16x16x32_bf16 v[128:131], v[64:67], a[160:163], v[128:131]
    ds_read_b64_tr_b16 v[88:89], v27 offset:8192
    v_mfma_f32_16x16x32_bf16 v[128:131], v[68:71], a[176:179], v[128:131]
    ds_read_b64_tr_b16 v[90:91], v27 offset:8704
    s_add_u32 s31, s18, 0
    v_mfma_f32_16x16x32_bf16 v[132:135], v[64:67], a[164:167], v[132:135]
    buffer_load_dwordx4 a[64:67], v32, s[68:71], s31 offen sc1
    v_mfma_f32_16x16x32_bf16 v[132:135], v[68:71], a[180:183], v[132:135]
    v_mfma_f32_16x16x32_bf16 v[136:139], v[64:67], a[168:171], v[136:139]
    ds_read_b64_tr_b16 v[92:93], v27 offset:12288
    v_mfma_f32_16x16x32_bf16 v[136:139], v[68:71], a[184:187], v[136:139]
    ds_read_b64_tr_b16 v[94:95], v27 offset:12800
    v_mfma_f32_16x16x32_bf16 v[140:143], v[64:67], a[172:175], v[140:143]
    v_mfma_f32_16x16x32_bf16 v[140:143], v[68:71], a[188:191], v[140:143]
    s_waitcnt vmcnt(31)
    s_barrier
    s_waitcnt lgkmcnt(8)
    v_mfma_f32_16x16x32_bf16 v[192:195], v[72:75], a[160:163], v[192:195]
    ds_read_b64_tr_b16 v[64:65], v16 offset:0
    v_mfma_f32_16x16x32_bf16 v[192:195], v[76:79], a[176:179], v[192:195]
    ds_read_b64_tr_b16 v[66:67], v16 offset:512
    v_mfma_f32_16x16x32_bf16 v[196:199], v[72:75], a[164:167], v[196:199]
    buffer_load_dwordx4 a[68:71], v33, s[68:71], s31 offen sc1
    v_mfma_f32_16x16x32_bf16 v[196:199], v[76:79], a[180:183], v[196:199]
    v_mfma_f32_16x16x32_bf16 v[200:203], v[72:75], a[168:171], v[200:203]
    ds_read_b64_tr_b16 v[68:69], v16 offset:4096
    v_mfma_f32_16x16x32_bf16 v[200:203], v[76:79], a[184:187], v[200:203]
    ds_read_b64_tr_b16 v[70:71], v16 offset:4608
    v_mfma_f32_16x16x32_bf16 v[204:207], v[72:75], a[172:175], v[204:207]
    v_mfma_f32_16x16x32_bf16 v[204:207], v[76:79], a[188:191], v[204:207]
    s_waitcnt lgkmcnt(8)
    v_mfma_f32_16x16x32_bf16 v[144:147], v[80:83], a[160:163], v[144:147]
    ds_read_b64_tr_b16 v[72:73], v16 offset:8192
    v_mfma_f32_16x16x32_bf16 v[144:147], v[84:87], a[176:179], v[144:147]
    ds_read_b64_tr_b16 v[74:75], v16 offset:8704
    s_add_u32 s31, s21, 0
    v_mfma_f32_16x16x32_bf16 v[148:151], v[80:83], a[164:167], v[148:151]
    buffer_load_dwordx4 a[72:75], v32, s[68:71], s31 offen sc1
    v_mfma_f32_16x16x32_bf16 v[148:151], v[84:87], a[180:183], v[148:151]
    v_mfma_f32_16x16x32_bf16 v[152:155], v[80:83], a[168:171], v[152:155]
    ds_read_b64_tr_b16 v[76:77], v16 offset:12288
    v_mfma_f32_16x16x32_bf16 v[152:155], v[84:87], a[184:187], v[152:155]
    ds_read_b64_tr_b16 v[78:79], v16 offset:12800
    v_mfma_f32_16x16x32_bf16 v[156:159], v[80:83], a[172:175], v[156:159]
    v_mfma_f32_16x16x32_bf16 v[156:159], v[84:87], a[188:191], v[156:159]
    s_waitcnt lgkmcnt(8)
    v_mfma_f32_16x16x32_bf16 v[208:211], v[88:91], a[160:163], v[208:211]
    ds_read_b64_tr_b16 v[80:81], v17 offset:0
    v_mfma_f32_16x16x32_bf16 v[208:211], v[92:95], a[176:179], v[208:211]
    ds_read_b64_tr_b16 v[82:83], v17 offset:512
    v_mfma_f32_16x16x32_bf16 v[212:215], v[88:91], a[164:167], v[212:215]
    buffer_load_dwordx4 a[76:79], v33, s[68:71], s31 offen sc1
    v_mfma_f32_16x16x32_bf16 v[212:215], v[92:95], a[180:183], v[212:215]
    v_mfma_f32_16x16x32_bf16 v[216:219], v[88:91], a[168:171], v[216:219]
    ds_read_b64_tr_b16 v[84:85], v17 offset:4096
    v_mfma_f32_16x16x32_bf16 v[216:219], v[92:95], a[184:187], v[216:219]
    ds_read_b64_tr_b16 v[86:87], v17 offset:4608
    s_add_u32 m0, s28, 98304
    s_add_u32 s30, s26, 0
    v_mfma_f32_16x16x32_bf16 v[220:223], v[88:91], a[172:175], v[220:223]
    buffer_load_dwordx4 v8, s[36:39], s30 offen offset:0 lds
    v_mfma_f32_16x16x32_bf16 v[220:223], v[92:95], a[188:191], v[220:223]
    s_waitcnt lgkmcnt(8)
    v_mfma_f32_16x16x32_bf16 v[96:99], v[64:67], a[192:195], v[96:99]
    ds_read_b64_tr_b16 v[88:89], v17 offset:8192
    v_mfma_f32_16x16x32_bf16 v[96:99], v[68:71], a[208:211], v[96:99]
    ds_read_b64_tr_b16 v[90:91], v17 offset:8704
    s_add_u32 s31, s18, 2048
    v_mfma_f32_16x16x32_bf16 v[100:103], v[64:67], a[196:199], v[100:103]
    buffer_load_dwordx4 a[80:83], v32, s[68:71], s31 offen sc1
    v_mfma_f32_16x16x32_bf16 v[100:103], v[68:71], a[212:215], v[100:103]
    v_mfma_f32_16x16x32_bf16 v[104:107], v[64:67], a[200:203], v[104:107]
    ds_read_b64_tr_b16 v[92:93], v17 offset:12288
    v_mfma_f32_16x16x32_bf16 v[104:107], v[68:71], a[216:219], v[104:107]
    ds_read_b64_tr_b16 v[94:95], v17 offset:12800
    v_mfma_f32_16x16x32_bf16 v[108:111], v[64:67], a[204:207], v[108:111]
    buffer_load_dwordx4 v9, s[36:39], s30 offen offset:1024 lds
    v_mfma_f32_16x16x32_bf16 v[108:111], v[68:71], a[220:223], v[108:111]
    s_waitcnt lgkmcnt(8)
    v_mfma_f32_16x16x32_bf16 v[160:163], v[72:75], a[192:195], v[160:163]
    ds_read_b64_tr_b16 v[64:65], v18 offset:0
    v_mfma_f32_16x16x32_bf16 v[160:163], v[76:79], a[208:211], v[160:163]
    ds_read_b64_tr_b16 v[66:67], v18 offset:512
    v_mfma_f32_16x16x32_bf16 v[164:167], v[72:75], a[196:199], v[164:167]
    buffer_load_dwordx4 a[84:87], v33, s[68:71], s31 offen sc1
    v_mfma_f32_16x16x32_bf16 v[164:167], v[76:79], a[212:215], v[164:167]
    v_mfma_f32_16x16x32_bf16 v[168:171], v[72:75], a[200:203], v[168:171]
    ds_read_b64_tr_b16 v[68:69], v18 offset:4096
    v_mfma_f32_16x16x32_bf16 v[168:171], v[76:79], a[216:219], v[168:171]
    ds_read_b64_tr_b16 v[70:71], v18 offset:4608
    v_mfma_f32_16x16x32_bf16 v[172:175], v[72:75], a[204:207], v[172:175]
    buffer_load_dwordx4 v[44:47], v38, s[48:51], s58 offen sc1
    v_mfma_f32_16x16x32_bf16 v[172:175], v[76:79], a[220:223], v[172:175]
    s_waitcnt lgkmcnt(8)
    v_mfma_f32_16x16x32_bf16 v[112:115], v[80:83], a[192:195], v[112:115]
    ds_read_b64_tr_b16 v[72:73], v18 offset:8192
    v_mfma_f32_16x16x32_bf16 v[112:115], v[84:87], a[208:211], v[112:115]
    ds_read_b64_tr_b16 v[74:75], v18 offset:8704
    s_add_u32 s31, s21, 2048
    v_mfma_f32_16x16x32_bf16 v[116:119], v[80:83], a[196:199], v[116:119]
    buffer_load_dwordx4 a[88:91], v32, s[68:71], s31 offen sc1
    v_mfma_f32_16x16x32_bf16 v[116:119], v[84:87], a[212:215], v[116:119]
    v_mfma_f32_16x16x32_bf16 v[120:123], v[80:83], a[200:203], v[120:123]
    ds_read_b64_tr_b16 v[76:77], v18 offset:12288
    v_mfma_f32_16x16x32_bf16 v[120:123], v[84:87], a[216:219], v[120:123]
    ds_read_b64_tr_b16 v[78:79], v18 offset:12800
    v_mfma_f32_16x16x32_bf16 v[124:127], v[80:83], a[204:207], v[124:127]
    buffer_load_dwordx4 v10, s[36:39], s30 offen offset:2048 lds
    v_mfma_f32_16x16x32_bf16 v[124:127], v[84:87], a[220:223], v[124:127]
    s_waitcnt lgkmcnt(8)
    v_mfma_f32_16x16x32_bf16 v[176:179], v[88:91], a[192:195], v[176:179]
    ds_read_b64_tr_b16 v[80:81], v19 offset:0
    v_mfma_f32_16x16x32_bf16 v[176:179], v[92:95], a[208:211], v[176:179]
    ds_read_b64_tr_b16 v[82:83], v19 offset:512
    v_mfma_f32_16x16x32_bf16 v[180:183], v[88:91], a[196:199], v[180:183]
    buffer_load_dwordx4 a[92:95], v33, s[68:71], s31 offen sc1
    v_mfma_f32_16x16x32_bf16 v[180:183], v[92:95], a[212:215], v[180:183]
    v_mfma_f32_16x16x32_bf16 v[184:187], v[88:91], a[200:203], v[184:187]
    ds_read_b64_tr_b16 v[84:85], v19 offset:4096
    v_mfma_f32_16x16x32_bf16 v[184:187], v[92:95], a[216:219], v[184:187]
    ds_read_b64_tr_b16 v[86:87], v19 offset:4608
    v_mfma_f32_16x16x32_bf16 v[188:191], v[88:91], a[204:207], v[188:191]
    buffer_load_dwordx4 v11, s[36:39], s30 offen offset:3072 lds
    v_mfma_f32_16x16x32_bf16 v[188:191], v[92:95], a[220:223], v[188:191]
    s_waitcnt lgkmcnt(8)
    v_mfma_f32_16x16x32_bf16 v[128:131], v[64:67], a[192:195], v[128:131]
    ds_read_b64_tr_b16 v[88:89], v19 offset:8192
    v_mfma_f32_16x16x32_bf16 v[128:131], v[68:71], a[208:211], v[128:131]
    ds_read_b64_tr_b16 v[90:91], v19 offset:8704
    v_mfma_f32_16x16x32_bf16 v[132:135], v[64:67], a[196:199], v[132:135]
    v_mfma_f32_16x16x32_bf16 v[132:135], v[68:71], a[212:215], v[132:135]
    v_mfma_f32_16x16x32_bf16 v[136:139], v[64:67], a[200:203], v[136:139]
    ds_read_b64_tr_b16 v[92:93], v19 offset:12288
    v_mfma_f32_16x16x32_bf16 v[136:139], v[68:71], a[216:219], v[136:139]
    ds_read_b64_tr_b16 v[94:95], v19 offset:12800
    s_add_u32 m0, s28, 114688
    s_add_u32 s30, s24, 0
    v_mfma_f32_16x16x32_bf16 v[140:143], v[64:67], a[204:207], v[140:143]
    buffer_load_dwordx4 v8, s[36:39], s30 offen offset:0 lds
    v_mfma_f32_16x16x32_bf16 v[140:143], v[68:71], a[220:223], v[140:143]
    s_waitcnt lgkmcnt(8)
    v_mfma_f32_16x16x32_bf16 v[192:195], v[72:75], a[192:195], v[192:195]
    ds_read_b64_tr_b16 v[64:65], v16 offset:16384
    v_mfma_f32_16x16x32_bf16 v[192:195], v[76:79], a[208:211], v[192:195]
    ds_read_b64_tr_b16 v[66:67], v16 offset:16896
    v_mfma_f32_16x16x32_bf16 v[196:199], v[72:75], a[196:199], v[196:199]
    v_mfma_f32_16x16x32_bf16 v[196:199], v[76:79], a[212:215], v[196:199]
    v_mfma_f32_16x16x32_bf16 v[200:203], v[72:75], a[200:203], v[200:203]
    ds_read_b64_tr_b16 v[68:69], v16 offset:20480
    v_mfma_f32_16x16x32_bf16 v[200:203], v[76:79], a[216:219], v[200:203]
    ds_read_b64_tr_b16 v[70:71], v16 offset:20992
    v_mfma_f32_16x16x32_bf16 v[204:207], v[72:75], a[204:207], v[204:207]
    buffer_load_dwordx4 v9, s[36:39], s30 offen offset:1024 lds
    v_mfma_f32_16x16x32_bf16 v[204:207], v[76:79], a[220:223], v[204:207]
    s_waitcnt lgkmcnt(8)
    v_mfma_f32_16x16x32_bf16 v[144:147], v[80:83], a[192:195], v[144:147]
    ds_read_b64_tr_b16 v[72:73], v16 offset:24576
    v_mfma_f32_16x16x32_bf16 v[144:147], v[84:87], a[208:211], v[144:147]
    ds_read_b64_tr_b16 v[74:75], v16 offset:25088
    v_mfma_f32_16x16x32_bf16 v[148:151], v[80:83], a[196:199], v[148:151]
    v_mfma_f32_16x16x32_bf16 v[148:151], v[84:87], a[212:215], v[148:151]
    v_mfma_f32_16x16x32_bf16 v[152:155], v[80:83], a[200:203], v[152:155]
    ds_read_b64_tr_b16 v[76:77], v16 offset:28672
    v_mfma_f32_16x16x32_bf16 v[152:155], v[84:87], a[216:219], v[152:155]
    ds_read_b64_tr_b16 v[78:79], v16 offset:29184
    v_mfma_f32_16x16x32_bf16 v[156:159], v[80:83], a[204:207], v[156:159]
    buffer_load_dwordx4 v10, s[36:39], s30 offen offset:2048 lds
    v_mfma_f32_16x16x32_bf16 v[156:159], v[84:87], a[220:223], v[156:159]
    s_waitcnt lgkmcnt(8)
    v_mfma_f32_16x16x32_bf16 v[208:211], v[88:91], a[192:195], v[208:211]
    ds_read_b64_tr_b16 v[80:81], v16 offset:32768
    v_mfma_f32_16x16x32_bf16 v[208:211], v[92:95], a[208:211], v[208:211]
    ds_read_b64_tr_b16 v[82:83], v16 offset:33280
    v_mfma_f32_16x16x32_bf16 v[212:215], v[88:91], a[196:199], v[212:215]
    v_mfma_f32_16x16x32_bf16 v[212:215], v[92:95], a[212:215], v[212:215]
    v_mfma_f32_16x16x32_bf16 v[216:219], v[88:91], a[200:203], v[216:219]
    ds_read_b64_tr_b16 v[84:85], v16 offset:36864
    v_mfma_f32_16x16x32_bf16 v[216:219], v[92:95], a[216:219], v[216:219]
    ds_read_b64_tr_b16 v[86:87], v16 offset:37376
    v_mfma_f32_16x16x32_bf16 v[220:223], v[88:91], a[204:207], v[220:223]
    buffer_load_dwordx4 v11, s[36:39], s30 offen offset:3072 lds
    v_mfma_f32_16x16x32_bf16 v[220:223], v[92:95], a[220:223], v[220:223]
    s_waitcnt vmcnt(8)
    s_mov_b32 s61, 0
parallel_fc12:
    v_xor_b32 v47, s3, v45
    v_cmp_ne_u32 vcc, 0, v47
    s_cbranch_vccz parallel_fx13
    s_add_u32 s61, s61, 1
    s_cmp_gt_u32 s61, 131072
    s_cbranch_scc1 parallel_fx13
    buffer_load_dwordx4 v[44:47], v38, s[48:51], s58 offen sc1
    s_waitcnt vmcnt(0)
    s_branch parallel_fc12
parallel_fx13:
    s_waitcnt lgkmcnt(8)
    v_mfma_f32_16x16x32_bf16 v[96:99], v[64:67], a[224:227], v[96:99]
    ds_read_b64_tr_b16 v[88:89], v16 offset:40960
    v_mfma_f32_16x16x32_bf16 v[96:99], v[68:71], a[240:243], v[96:99]
    ds_read_b64_tr_b16 v[90:91], v16 offset:41472
    s_add_u32 s31, s16, 4096
    v_mfma_f32_16x16x32_bf16 v[100:103], v[64:67], a[228:231], v[100:103]
    buffer_load_dwordx4 a[96:99], v32, s[68:71], s31 offen sc1
    v_mfma_f32_16x16x32_bf16 v[100:103], v[68:71], a[244:247], v[100:103]
    v_mfma_f32_16x16x32_bf16 v[104:107], v[64:67], a[232:235], v[104:107]
    ds_read_b64_tr_b16 v[92:93], v16 offset:45056
    v_mfma_f32_16x16x32_bf16 v[104:107], v[68:71], a[248:251], v[104:107]
    ds_read_b64_tr_b16 v[94:95], v16 offset:45568
    s_add_u32 m0, s28, 131072
    s_add_u32 s30, s27, 0
    v_mfma_f32_16x16x32_bf16 v[108:111], v[64:67], a[236:239], v[108:111]
    buffer_load_dwordx4 v8, s[36:39], s30 offen offset:0 lds
    v_mfma_f32_16x16x32_bf16 v[108:111], v[68:71], a[252:255], v[108:111]
    s_waitcnt lgkmcnt(8)
    v_mfma_f32_16x16x32_bf16 v[160:163], v[72:75], a[224:227], v[160:163]
    ds_read_b64_tr_b16 v[64:65], v17 offset:16384
    v_mfma_f32_16x16x32_bf16 v[160:163], v[76:79], a[240:243], v[160:163]
    ds_read_b64_tr_b16 v[66:67], v17 offset:16896
    v_mfma_f32_16x16x32_bf16 v[164:167], v[72:75], a[228:231], v[164:167]
    buffer_load_dwordx4 a[100:103], v33, s[68:71], s31 offen sc1
    v_mfma_f32_16x16x32_bf16 v[164:167], v[76:79], a[244:247], v[164:167]
    v_mfma_f32_16x16x32_bf16 v[168:171], v[72:75], a[232:235], v[168:171]
    ds_read_b64_tr_b16 v[68:69], v17 offset:20480
    v_mfma_f32_16x16x32_bf16 v[168:171], v[76:79], a[248:251], v[168:171]
    ds_read_b64_tr_b16 v[70:71], v17 offset:20992
    v_mfma_f32_16x16x32_bf16 v[172:175], v[72:75], a[236:239], v[172:175]
    buffer_load_dwordx4 v9, s[36:39], s30 offen offset:1024 lds
    v_mfma_f32_16x16x32_bf16 v[172:175], v[76:79], a[252:255], v[172:175]
    s_waitcnt lgkmcnt(8)
    v_mfma_f32_16x16x32_bf16 v[96:99], v[80:83], v[224:227], v[96:99]
    ds_read_b64_tr_b16 v[72:73], v17 offset:24576
    v_mfma_f32_16x16x32_bf16 v[96:99], v[84:87], v[240:243], v[96:99]
    ds_read_b64_tr_b16 v[74:75], v17 offset:25088
    s_add_u32 s31, s19, 4096
    v_mfma_f32_16x16x32_bf16 v[100:103], v[80:83], v[228:231], v[100:103]
    buffer_load_dwordx4 a[104:107], v32, s[68:71], s31 offen sc1
    v_mfma_f32_16x16x32_bf16 v[100:103], v[84:87], v[244:247], v[100:103]
    v_mfma_f32_16x16x32_bf16 v[104:107], v[80:83], v[232:235], v[104:107]
    ds_read_b64_tr_b16 v[76:77], v17 offset:28672
    v_mfma_f32_16x16x32_bf16 v[104:107], v[84:87], v[248:251], v[104:107]
    ds_read_b64_tr_b16 v[78:79], v17 offset:29184
    v_mfma_f32_16x16x32_bf16 v[108:111], v[80:83], v[236:239], v[108:111]
    buffer_load_dwordx4 v10, s[36:39], s30 offen offset:2048 lds
    v_mfma_f32_16x16x32_bf16 v[108:111], v[84:87], v[252:255], v[108:111]
    s_waitcnt lgkmcnt(8)
    v_mfma_f32_16x16x32_bf16 v[160:163], v[88:91], v[224:227], v[160:163]
    ds_read_b64_tr_b16 v[80:81], v17 offset:32768
    v_mfma_f32_16x16x32_bf16 v[160:163], v[92:95], v[240:243], v[160:163]
    ds_read_b64_tr_b16 v[82:83], v17 offset:33280
    v_mfma_f32_16x16x32_bf16 v[164:167], v[88:91], v[228:231], v[164:167]
    buffer_load_dwordx4 a[108:111], v33, s[68:71], s31 offen sc1
    v_mfma_f32_16x16x32_bf16 v[164:167], v[92:95], v[244:247], v[164:167]
    v_mfma_f32_16x16x32_bf16 v[168:171], v[88:91], v[232:235], v[168:171]
    ds_read_b64_tr_b16 v[84:85], v17 offset:36864
    v_mfma_f32_16x16x32_bf16 v[168:171], v[92:95], v[248:251], v[168:171]
    ds_read_b64_tr_b16 v[86:87], v17 offset:37376
    v_mfma_f32_16x16x32_bf16 v[172:175], v[88:91], v[236:239], v[172:175]
    buffer_load_dwordx4 v11, s[36:39], s30 offen offset:3072 lds
    v_mfma_f32_16x16x32_bf16 v[172:175], v[92:95], v[252:255], v[172:175]
    s_waitcnt lgkmcnt(8)
    v_mfma_f32_16x16x32_bf16 v[112:115], v[64:67], a[224:227], v[112:115]
    ds_read_b64_tr_b16 v[88:89], v17 offset:40960
    v_mul_f32 v96, v96, v160
    v_mfma_f32_16x16x32_bf16 v[112:115], v[68:71], a[240:243], v[112:115]
    ds_read_b64_tr_b16 v[90:91], v17 offset:41472
    s_add_u32 s31, s16, 6144
    v_mfma_f32_16x16x32_bf16 v[116:119], v[64:67], a[228:231], v[116:119]
    buffer_load_dwordx4 a[112:115], v32, s[68:71], s31 offen sc1
    v_mfma_f32_16x16x32_bf16 v[116:119], v[68:71], a[244:247], v[116:119]
    v_mul_f32 v97, v97, v161
    v_mul_f32 v98, v98, v162
    v_mfma_f32_16x16x32_bf16 v[120:123], v[64:67], a[232:235], v[120:123]
    ds_read_b64_tr_b16 v[92:93], v17 offset:45056
    v_mul_f32 v99, v99, v163
    v_mfma_f32_16x16x32_bf16 v[120:123], v[68:71], a[248:251], v[120:123]
    ds_read_b64_tr_b16 v[94:95], v17 offset:45568
    v_cvt_pk_bf16_f32 v160, v96, v97
    v_mfma_f32_16x16x32_bf16 v[124:127], v[64:67], a[236:239], v[124:127]
    v_cvt_pk_bf16_f32 v161, v98, v99
    v_mul_f32 v100, v100, v164
    v_mfma_f32_16x16x32_bf16 v[124:127], v[68:71], a[252:255], v[124:127]
    v_mul_f32 v101, v101, v165
    v_mul_f32 v102, v102, v166
    s_waitcnt lgkmcnt(8)
    v_mfma_f32_16x16x32_bf16 v[176:179], v[72:75], a[224:227], v[176:179]
    ds_read_b64_tr_b16 v[64:65], v18 offset:16384
    v_mul_f32 v103, v103, v167
    v_mfma_f32_16x16x32_bf16 v[176:179], v[76:79], a[240:243], v[176:179]
    ds_read_b64_tr_b16 v[66:67], v18 offset:16896
    v_cvt_pk_bf16_f32 v164, v100, v101
    v_mfma_f32_16x16x32_bf16 v[180:183], v[72:75], a[228:231], v[180:183]
    buffer_load_dwordx4 a[116:119], v33, s[68:71], s31 offen sc1
    v_mfma_f32_16x16x32_bf16 v[180:183], v[76:79], a[244:247], v[180:183]
    v_cvt_pk_bf16_f32 v165, v102, v103
    v_mul_f32 v104, v104, v168
    v_mfma_f32_16x16x32_bf16 v[184:187], v[72:75], a[232:235], v[184:187]
    ds_read_b64_tr_b16 v[68:69], v18 offset:20480
    v_mul_f32 v105, v105, v169
    v_mfma_f32_16x16x32_bf16 v[184:187], v[76:79], a[248:251], v[184:187]
    ds_read_b64_tr_b16 v[70:71], v18 offset:20992
    v_mul_f32 v106, v106, v170
    v_mfma_f32_16x16x32_bf16 v[188:191], v[72:75], a[236:239], v[188:191]
    v_mul_f32 v107, v107, v171
    v_cvt_pk_bf16_f32 v168, v104, v105
    v_mfma_f32_16x16x32_bf16 v[188:191], v[76:79], a[252:255], v[188:191]
    v_cvt_pk_bf16_f32 v169, v106, v107
    v_mul_f32 v108, v108, v172
    s_waitcnt lgkmcnt(8)
    v_mfma_f32_16x16x32_bf16 v[112:115], v[80:83], v[224:227], v[112:115]
    ds_read_b64_tr_b16 v[72:73], v18 offset:24576
    v_mul_f32 v109, v109, v173
    v_mfma_f32_16x16x32_bf16 v[112:115], v[84:87], v[240:243], v[112:115]
    ds_read_b64_tr_b16 v[74:75], v18 offset:25088
    s_add_u32 s31, s19, 6144
    v_mfma_f32_16x16x32_bf16 v[116:119], v[80:83], v[228:231], v[116:119]
    buffer_load_dwordx4 a[120:123], v32, s[68:71], s31 offen sc1
    v_mfma_f32_16x16x32_bf16 v[116:119], v[84:87], v[244:247], v[116:119]
    v_mul_f32 v110, v110, v174
    v_mul_f32 v111, v111, v175
    v_mfma_f32_16x16x32_bf16 v[120:123], v[80:83], v[232:235], v[120:123]
    ds_read_b64_tr_b16 v[76:77], v18 offset:28672
    v_cvt_pk_bf16_f32 v172, v108, v109
    v_mfma_f32_16x16x32_bf16 v[120:123], v[84:87], v[248:251], v[120:123]
    ds_read_b64_tr_b16 v[78:79], v18 offset:29184
    v_cvt_pk_bf16_f32 v173, v110, v111
    v_mfma_f32_16x16x32_bf16 v[124:127], v[80:83], v[236:239], v[124:127]
    v_mfma_f32_16x16x32_bf16 v[124:127], v[84:87], v[252:255], v[124:127]
    s_waitcnt lgkmcnt(8)
    v_mfma_f32_16x16x32_bf16 v[176:179], v[88:91], v[224:227], v[176:179]
    ds_read_b64_tr_b16 v[80:81], v18 offset:32768
    v_mfma_f32_16x16x32_bf16 v[176:179], v[92:95], v[240:243], v[176:179]
    ds_read_b64_tr_b16 v[82:83], v18 offset:33280
    v_mfma_f32_16x16x32_bf16 v[180:183], v[88:91], v[228:231], v[180:183]
    buffer_load_dwordx4 a[124:127], v33, s[68:71], s31 offen sc1
    v_mfma_f32_16x16x32_bf16 v[180:183], v[92:95], v[244:247], v[180:183]
    v_mfma_f32_16x16x32_bf16 v[184:187], v[88:91], v[232:235], v[184:187]
    ds_read_b64_tr_b16 v[84:85], v18 offset:36864
    v_mfma_f32_16x16x32_bf16 v[184:187], v[92:95], v[248:251], v[184:187]
    ds_read_b64_tr_b16 v[86:87], v18 offset:37376
    v_mfma_f32_16x16x32_bf16 v[188:191], v[88:91], v[236:239], v[188:191]
    v_mfma_f32_16x16x32_bf16 v[188:191], v[92:95], v[252:255], v[188:191]
    s_waitcnt lgkmcnt(8)
    v_mfma_f32_16x16x32_bf16 v[128:131], v[64:67], a[224:227], v[128:131]
    ds_read_b64_tr_b16 v[88:89], v18 offset:40960
    v_mul_f32 v112, v112, v176
    v_mfma_f32_16x16x32_bf16 v[128:131], v[68:71], a[240:243], v[128:131]
    ds_read_b64_tr_b16 v[90:91], v18 offset:41472
    s_add_u32 s31, s17, 4096
    v_mfma_f32_16x16x32_bf16 v[132:135], v[64:67], a[228:231], v[132:135]
    buffer_load_dwordx4 a[128:131], v32, s[68:71], s31 offen sc1
    v_mfma_f32_16x16x32_bf16 v[132:135], v[68:71], a[244:247], v[132:135]
    v_mul_f32 v113, v113, v177
    v_mul_f32 v114, v114, v178
    v_mfma_f32_16x16x32_bf16 v[136:139], v[64:67], a[232:235], v[136:139]
    ds_read_b64_tr_b16 v[92:93], v18 offset:45056
    v_mul_f32 v115, v115, v179
    v_mfma_f32_16x16x32_bf16 v[136:139], v[68:71], a[248:251], v[136:139]
    ds_read_b64_tr_b16 v[94:95], v18 offset:45568
    v_cvt_pk_bf16_f32 v162, v112, v113
    v_mfma_f32_16x16x32_bf16 v[140:143], v[64:67], a[236:239], v[140:143]
    v_cvt_pk_bf16_f32 v163, v114, v115
    s_mov_b32 s67, 8192
    buffer_store_dwordx4 v[160:163], v30, s[44:47], s67 offen offset:0 sc1
    v_mfma_f32_16x16x32_bf16 v[140:143], v[68:71], a[252:255], v[140:143]
    v_mul_f32 v116, v116, v180
    v_mul_f32 v117, v117, v181
    s_waitcnt lgkmcnt(8)
    v_mfma_f32_16x16x32_bf16 v[192:195], v[72:75], a[224:227], v[192:195]
    ds_read_b64_tr_b16 v[64:65], v19 offset:16384
    v_mul_f32 v118, v118, v182
    v_mfma_f32_16x16x32_bf16 v[192:195], v[76:79], a[240:243], v[192:195]
    ds_read_b64_tr_b16 v[66:67], v19 offset:16896
    v_mul_f32 v119, v119, v183
    v_mfma_f32_16x16x32_bf16 v[196:199], v[72:75], a[228:231], v[196:199]
    buffer_load_dwordx4 a[132:135], v33, s[68:71], s31 offen sc1
    v_mfma_f32_16x16x32_bf16 v[196:199], v[76:79], a[244:247], v[196:199]
    v_cvt_pk_bf16_f32 v166, v116, v117
    v_cvt_pk_bf16_f32 v167, v118, v119
    v_mfma_f32_16x16x32_bf16 v[200:203], v[72:75], a[232:235], v[200:203]
    ds_read_b64_tr_b16 v[68:69], v19 offset:20480
    s_mov_b32 s67, 8192
    buffer_store_dwordx4 v[164:167], v30, s[44:47], s67 offen offset:256 sc1
    v_mfma_f32_16x16x32_bf16 v[200:203], v[76:79], a[248:251], v[200:203]
    ds_read_b64_tr_b16 v[70:71], v19 offset:20992
    v_mul_f32 v120, v120, v184
    v_mfma_f32_16x16x32_bf16 v[204:207], v[72:75], a[236:239], v[204:207]
    v_mul_f32 v121, v121, v185
    v_mul_f32 v122, v122, v186
    v_mfma_f32_16x16x32_bf16 v[204:207], v[76:79], a[252:255], v[204:207]
    v_mul_f32 v123, v123, v187
    v_cvt_pk_bf16_f32 v170, v120, v121
    s_waitcnt lgkmcnt(8)
    v_mfma_f32_16x16x32_bf16 v[128:131], v[80:83], v[224:227], v[128:131]
    ds_read_b64_tr_b16 v[72:73], v19 offset:24576
    v_cvt_pk_bf16_f32 v171, v122, v123
    v_mfma_f32_16x16x32_bf16 v[128:131], v[84:87], v[240:243], v[128:131]
    ds_read_b64_tr_b16 v[74:75], v19 offset:25088
    s_add_u32 s31, s20, 4096
    v_mfma_f32_16x16x32_bf16 v[132:135], v[80:83], v[228:231], v[132:135]
    buffer_load_dwordx4 a[136:139], v32, s[68:71], s31 offen sc1
    v_mfma_f32_16x16x32_bf16 v[132:135], v[84:87], v[244:247], v[132:135]
    s_mov_b32 s67, 376832
    buffer_store_dwordx4 v[168:171], v30, s[44:47], s67 offen offset:0 sc1
    v_mul_f32 v124, v124, v188
    v_mfma_f32_16x16x32_bf16 v[136:139], v[80:83], v[232:235], v[136:139]
    ds_read_b64_tr_b16 v[76:77], v19 offset:28672
    v_mul_f32 v125, v125, v189
    v_mfma_f32_16x16x32_bf16 v[136:139], v[84:87], v[248:251], v[136:139]
    ds_read_b64_tr_b16 v[78:79], v19 offset:29184
    v_mul_f32 v126, v126, v190
    v_mfma_f32_16x16x32_bf16 v[140:143], v[80:83], v[236:239], v[140:143]
    v_mul_f32 v127, v127, v191
    v_cvt_pk_bf16_f32 v174, v124, v125
    v_mfma_f32_16x16x32_bf16 v[140:143], v[84:87], v[252:255], v[140:143]
    v_cvt_pk_bf16_f32 v175, v126, v127
    s_mov_b32 s67, 376832
    buffer_store_dwordx4 v[172:175], v30, s[44:47], s67 offen offset:256 sc1
    s_waitcnt lgkmcnt(8)
    v_mfma_f32_16x16x32_bf16 v[192:195], v[88:91], v[224:227], v[192:195]
    ds_read_b64_tr_b16 v[80:81], v19 offset:32768
    v_mfma_f32_16x16x32_bf16 v[192:195], v[92:95], v[240:243], v[192:195]
    ds_read_b64_tr_b16 v[82:83], v19 offset:33280
    v_mfma_f32_16x16x32_bf16 v[196:199], v[88:91], v[228:231], v[196:199]
    buffer_load_dwordx4 a[140:143], v33, s[68:71], s31 offen sc1
    v_mfma_f32_16x16x32_bf16 v[196:199], v[92:95], v[244:247], v[196:199]
    v_mfma_f32_16x16x32_bf16 v[200:203], v[88:91], v[232:235], v[200:203]
    ds_read_b64_tr_b16 v[84:85], v19 offset:36864
    v_mfma_f32_16x16x32_bf16 v[200:203], v[92:95], v[248:251], v[200:203]
    ds_read_b64_tr_b16 v[86:87], v19 offset:37376
    v_mfma_f32_16x16x32_bf16 v[204:207], v[88:91], v[236:239], v[204:207]
    v_mfma_f32_16x16x32_bf16 v[204:207], v[92:95], v[252:255], v[204:207]
    s_waitcnt lgkmcnt(8)
    v_mfma_f32_16x16x32_bf16 v[144:147], v[64:67], a[224:227], v[144:147]
    ds_read_b64_tr_b16 v[88:89], v19 offset:40960
    v_mul_f32 v128, v128, v192
    v_mfma_f32_16x16x32_bf16 v[144:147], v[68:71], a[240:243], v[144:147]
    ds_read_b64_tr_b16 v[90:91], v19 offset:41472
    s_add_u32 s31, s17, 6144
    v_mfma_f32_16x16x32_bf16 v[148:151], v[64:67], a[228:231], v[148:151]
    buffer_load_dwordx4 a[144:147], v32, s[68:71], s31 offen sc1
    v_mfma_f32_16x16x32_bf16 v[148:151], v[68:71], a[244:247], v[148:151]
    v_mul_f32 v129, v129, v193
    v_mul_f32 v130, v130, v194
    v_mfma_f32_16x16x32_bf16 v[152:155], v[64:67], a[232:235], v[152:155]
    ds_read_b64_tr_b16 v[92:93], v19 offset:45056
    v_mul_f32 v131, v131, v195
    v_mfma_f32_16x16x32_bf16 v[152:155], v[68:71], a[248:251], v[152:155]
    ds_read_b64_tr_b16 v[94:95], v19 offset:45568
    v_cvt_pk_bf16_f32 v192, v128, v129
    v_mfma_f32_16x16x32_bf16 v[156:159], v[64:67], a[236:239], v[156:159]
    v_cvt_pk_bf16_f32 v193, v130, v131
    v_mul_f32 v132, v132, v196
    v_mfma_f32_16x16x32_bf16 v[156:159], v[68:71], a[252:255], v[156:159]
    v_mul_f32 v133, v133, v197
    v_mul_f32 v134, v134, v198
    s_waitcnt vmcnt(25)
    s_barrier
    s_waitcnt lgkmcnt(8)
    v_mfma_f32_16x16x32_bf16 v[208:211], v[72:75], a[224:227], v[208:211]
    v_add_u32 v16, s43, v16
    ds_read_b64_tr_b16 v[64:65], v16 offset:49152
    v_mul_f32 v135, v135, v199
    v_mfma_f32_16x16x32_bf16 v[208:211], v[76:79], a[240:243], v[208:211]
    ds_read_b64_tr_b16 v[66:67], v16 offset:49664
    v_cvt_pk_bf16_f32 v196, v132, v133
    v_mfma_f32_16x16x32_bf16 v[212:215], v[72:75], a[228:231], v[212:215]
    buffer_load_dwordx4 a[148:151], v33, s[68:71], s31 offen sc1
    v_mfma_f32_16x16x32_bf16 v[212:215], v[76:79], a[244:247], v[212:215]
    v_cvt_pk_bf16_f32 v197, v134, v135
    v_mul_f32 v136, v136, v200
    v_mfma_f32_16x16x32_bf16 v[216:219], v[72:75], a[232:235], v[216:219]
    ds_read_b64_tr_b16 v[68:69], v16 offset:53248
    v_mul_f32 v137, v137, v201
    v_mfma_f32_16x16x32_bf16 v[216:219], v[76:79], a[248:251], v[216:219]
    ds_read_b64_tr_b16 v[70:71], v16 offset:53760
    v_mul_f32 v138, v138, v202
    v_mfma_f32_16x16x32_bf16 v[220:223], v[72:75], a[236:239], v[220:223]
    v_mul_f32 v139, v139, v203
    v_cvt_pk_bf16_f32 v200, v136, v137
    v_mfma_f32_16x16x32_bf16 v[220:223], v[76:79], a[252:255], v[220:223]
    v_cvt_pk_bf16_f32 v201, v138, v139
    v_mul_f32 v140, v140, v204
    s_waitcnt lgkmcnt(8)
    v_mfma_f32_16x16x32_bf16 v[144:147], v[80:83], v[224:227], v[144:147]
    v_add_u32 v17, s43, v17
    ds_read_b64_tr_b16 v[72:73], v17 offset:49152
    v_mul_f32 v141, v141, v205
    v_mfma_f32_16x16x32_bf16 v[144:147], v[84:87], v[240:243], v[144:147]
    ds_read_b64_tr_b16 v[74:75], v17 offset:49664
    s_add_u32 s31, s20, 6144
    v_mfma_f32_16x16x32_bf16 v[148:151], v[80:83], v[228:231], v[148:151]
    buffer_load_dwordx4 a[152:155], v32, s[68:71], s31 offen sc1
    v_mfma_f32_16x16x32_bf16 v[148:151], v[84:87], v[244:247], v[148:151]
    v_mul_f32 v142, v142, v206
    v_mul_f32 v143, v143, v207
    v_mfma_f32_16x16x32_bf16 v[152:155], v[80:83], v[232:235], v[152:155]
    ds_read_b64_tr_b16 v[76:77], v17 offset:53248
    v_cvt_pk_bf16_f32 v204, v140, v141
    v_mfma_f32_16x16x32_bf16 v[152:155], v[84:87], v[248:251], v[152:155]
    ds_read_b64_tr_b16 v[78:79], v17 offset:53760
    v_cvt_pk_bf16_f32 v205, v142, v143
    v_mfma_f32_16x16x32_bf16 v[156:159], v[80:83], v[236:239], v[156:159]
    v_mfma_f32_16x16x32_bf16 v[156:159], v[84:87], v[252:255], v[156:159]
    s_waitcnt lgkmcnt(8)
    v_mfma_f32_16x16x32_bf16 v[208:211], v[88:91], v[224:227], v[208:211]
    v_add_u32 v18, s43, v18
    ds_read_b64_tr_b16 v[80:81], v18 offset:49152
    v_mfma_f32_16x16x32_bf16 v[208:211], v[92:95], v[240:243], v[208:211]
    ds_read_b64_tr_b16 v[82:83], v18 offset:49664
    v_mfma_f32_16x16x32_bf16 v[212:215], v[88:91], v[228:231], v[212:215]
    buffer_load_dwordx4 a[156:159], v33, s[68:71], s31 offen sc1
    v_mfma_f32_16x16x32_bf16 v[212:215], v[92:95], v[244:247], v[212:215]
    v_mfma_f32_16x16x32_bf16 v[216:219], v[88:91], v[232:235], v[216:219]
    ds_read_b64_tr_b16 v[84:85], v18 offset:53248
    v_mfma_f32_16x16x32_bf16 v[216:219], v[92:95], v[248:251], v[216:219]
    ds_read_b64_tr_b16 v[86:87], v18 offset:53760
    v_mfma_f32_16x16x32_bf16 v[220:223], v[88:91], v[236:239], v[220:223]
    v_mfma_f32_16x16x32_bf16 v[220:223], v[92:95], v[252:255], v[220:223]
    s_waitcnt vmcnt(50) lgkmcnt(8)
    v_mfma_f32_16x16x32_bf16 v[96:99], v[64:67], a[0:3], 0
    v_add_u32 v19, s43, v19
    ds_read_b64_tr_b16 v[88:89], v19 offset:49152
    v_mul_f32 v144, v144, v208
    v_mfma_f32_16x16x32_bf16 v[96:99], v[68:71], a[16:19], v[96:99]
    ds_read_b64_tr_b16 v[90:91], v19 offset:49664
    s_add_u32 s31, s18, 4096
    v_mfma_f32_16x16x32_bf16 v[100:103], v[64:67], a[4:7], 0
    buffer_load_dwordx4 a[160:163], v32, s[68:71], s31 offen sc1
    v_mfma_f32_16x16x32_bf16 v[100:103], v[68:71], a[20:23], v[100:103]
    v_mul_f32 v145, v145, v209
    v_mul_f32 v146, v146, v210
    v_mfma_f32_16x16x32_bf16 v[104:107], v[64:67], a[8:11], 0
    ds_read_b64_tr_b16 v[92:93], v19 offset:53248
    v_mul_f32 v147, v147, v211
    v_mfma_f32_16x16x32_bf16 v[104:107], v[68:71], a[24:27], v[104:107]
    ds_read_b64_tr_b16 v[94:95], v19 offset:53760
    s_add_u32 m0, s28, 0
    s_add_u32 s30, s22, 73728
    v_mfma_f32_16x16x32_bf16 v[108:111], v[64:67], a[12:15], 0
    buffer_load_dwordx4 v8, s[36:39], s30 offen offset:0 lds
    v_mfma_f32_16x16x32_bf16 v[108:111], v[68:71], a[28:31], v[108:111]
    v_cvt_pk_bf16_f32 v194, v144, v145
    v_cvt_pk_bf16_f32 v195, v146, v147
    s_waitcnt lgkmcnt(8)
    v_mfma_f32_16x16x32_bf16 v[112:115], v[72:75], a[0:3], 0
    v_add_u32 v20, s43, v20
    ds_read_b64_tr_b16 v[64:65], v20 offset:0
    s_mov_b32 s67, 10240
    buffer_store_dwordx4 v[192:195], v30, s[44:47], s67 offen offset:0 sc1
    v_mfma_f32_16x16x32_bf16 v[112:115], v[76:79], a[16:19], v[112:115]
    ds_read_b64_tr_b16 v[66:67], v20 offset:512
    v_mul_f32 v148, v148, v212
    v_mfma_f32_16x16x32_bf16 v[116:119], v[72:75], a[4:7], 0
    buffer_load_dwordx4 a[164:167], v33, s[68:71], s31 offen sc1
    v_mfma_f32_16x16x32_bf16 v[116:119], v[76:79], a[20:23], v[116:119]
    v_mul_f32 v149, v149, v213
    v_mul_f32 v150, v150, v214
    v_mfma_f32_16x16x32_bf16 v[120:123], v[72:75], a[8:11], 0
    ds_read_b64_tr_b16 v[68:69], v20 offset:4096
    v_mul_f32 v151, v151, v215
    v_mfma_f32_16x16x32_bf16 v[120:123], v[76:79], a[24:27], v[120:123]
    ds_read_b64_tr_b16 v[70:71], v20 offset:4608
    v_cvt_pk_bf16_f32 v198, v148, v149
    v_mfma_f32_16x16x32_bf16 v[124:127], v[72:75], a[12:15], 0
    buffer_load_dwordx4 v9, s[36:39], s30 offen offset:1024 lds
    v_mfma_f32_16x16x32_bf16 v[124:127], v[76:79], a[28:31], v[124:127]
    v_cvt_pk_bf16_f32 v199, v150, v151
    s_mov_b32 s67, 10240
    buffer_store_dwordx4 v[196:199], v30, s[44:47], s67 offen offset:256 sc1
    s_waitcnt lgkmcnt(8)
    v_mfma_f32_16x16x32_bf16 v[160:163], v[80:83], a[0:3], 0
    v_add_u32 v21, s43, v21
    ds_read_b64_tr_b16 v[72:73], v21 offset:0
    v_mul_f32 v152, v152, v216
    v_mfma_f32_16x16x32_bf16 v[160:163], v[84:87], a[16:19], v[160:163]
    ds_read_b64_tr_b16 v[74:75], v21 offset:512
    s_add_u32 s31, s21, 4096
    v_mfma_f32_16x16x32_bf16 v[164:167], v[80:83], a[4:7], 0
    buffer_load_dwordx4 a[168:171], v32, s[68:71], s31 offen sc1
    v_mfma_f32_16x16x32_bf16 v[164:167], v[84:87], a[20:23], v[164:167]
    v_mul_f32 v153, v153, v217
    v_mul_f32 v154, v154, v218
    v_mfma_f32_16x16x32_bf16 v[168:171], v[80:83], a[8:11], 0
    ds_read_b64_tr_b16 v[76:77], v21 offset:4096
    v_mul_f32 v155, v155, v219
    v_mfma_f32_16x16x32_bf16 v[168:171], v[84:87], a[24:27], v[168:171]
    ds_read_b64_tr_b16 v[78:79], v21 offset:4608
    v_cvt_pk_bf16_f32 v202, v152, v153
    v_mfma_f32_16x16x32_bf16 v[172:175], v[80:83], a[12:15], 0
    buffer_load_dwordx4 v10, s[36:39], s30 offen offset:2048 lds
    v_mfma_f32_16x16x32_bf16 v[172:175], v[84:87], a[28:31], v[172:175]
    v_cvt_pk_bf16_f32 v203, v154, v155
    s_mov_b32 s67, 378880
    buffer_store_dwordx4 v[200:203], v30, s[44:47], s67 offen offset:0 sc1
    s_waitcnt lgkmcnt(8)
    v_mfma_f32_16x16x32_bf16 v[176:179], v[88:91], a[0:3], 0
    v_add_u32 v22, s43, v22
    ds_read_b64_tr_b16 v[80:81], v22 offset:0
    v_mul_f32 v156, v156, v220
    v_mfma_f32_16x16x32_bf16 v[176:179], v[92:95], a[16:19], v[176:179]
    ds_read_b64_tr_b16 v[82:83], v22 offset:512
    v_mul_f32 v157, v157, v221
    v_mfma_f32_16x16x32_bf16 v[180:183], v[88:91], a[4:7], 0
    buffer_load_dwordx4 a[172:175], v33, s[68:71], s31 offen sc1
    v_mfma_f32_16x16x32_bf16 v[180:183], v[92:95], a[20:23], v[180:183]
    v_mul_f32 v158, v158, v222
    v_mul_f32 v159, v159, v223
    v_mfma_f32_16x16x32_bf16 v[184:187], v[88:91], a[8:11], 0
    ds_read_b64_tr_b16 v[84:85], v22 offset:4096
    v_cvt_pk_bf16_f32 v206, v156, v157
    v_mfma_f32_16x16x32_bf16 v[184:187], v[92:95], a[24:27], v[184:187]
    ds_read_b64_tr_b16 v[86:87], v22 offset:4608
    v_cvt_pk_bf16_f32 v207, v158, v159
    v_mfma_f32_16x16x32_bf16 v[188:191], v[88:91], a[12:15], 0
    buffer_load_dwordx4 v11, s[36:39], s30 offen offset:3072 lds
    v_mfma_f32_16x16x32_bf16 v[188:191], v[92:95], a[28:31], v[188:191]
    s_mov_b32 s67, 378880
    buffer_store_dwordx4 v[204:207], v30, s[44:47], s67 offen offset:256 sc1
    s_waitcnt lgkmcnt(8)
    v_mfma_f32_16x16x32_bf16 v[128:131], v[64:67], a[0:3], 0
    v_add_u32 v23, s43, v23
    ds_read_b64_tr_b16 v[88:89], v23 offset:0
    v_mfma_f32_16x16x32_bf16 v[128:131], v[68:71], a[16:19], v[128:131]
    ds_read_b64_tr_b16 v[90:91], v23 offset:512
    s_add_u32 s31, s18, 6144
    v_mfma_f32_16x16x32_bf16 v[132:135], v[64:67], a[4:7], 0
    buffer_load_dwordx4 a[176:179], v32, s[68:71], s31 offen sc1
    v_mfma_f32_16x16x32_bf16 v[132:135], v[68:71], a[20:23], v[132:135]
    v_mfma_f32_16x16x32_bf16 v[136:139], v[64:67], a[8:11], 0
    ds_read_b64_tr_b16 v[92:93], v23 offset:4096
    v_mfma_f32_16x16x32_bf16 v[136:139], v[68:71], a[24:27], v[136:139]
    ds_read_b64_tr_b16 v[94:95], v23 offset:4608
    s_add_u32 m0, s28, 16384
    s_add_u32 s30, s25, 73728
    v_mfma_f32_16x16x32_bf16 v[140:143], v[64:67], a[12:15], 0
    buffer_load_dwordx4 v8, s[36:39], s30 offen offset:0 lds
    v_mfma_f32_16x16x32_bf16 v[140:143], v[68:71], a[28:31], v[140:143]
    s_waitcnt lgkmcnt(8)
    v_mfma_f32_16x16x32_bf16 v[144:147], v[72:75], a[0:3], 0
    ds_read_b64_tr_b16 v[64:65], v20 offset:16384
    s_lshl_b32 s12, s4, 14
    v_mfma_f32_16x16x32_bf16 v[144:147], v[76:79], a[16:19], v[144:147]
    ds_read_b64_tr_b16 v[66:67], v20 offset:16896
    s_add_u32 s14, s12, 81920
    v_mfma_f32_16x16x32_bf16 v[148:151], v[72:75], a[4:7], 0
    buffer_load_dwordx4 a[180:183], v33, s[68:71], s31 offen sc1
    v_mfma_f32_16x16x32_bf16 v[148:151], v[76:79], a[20:23], v[148:151]
    v_add_u32 v28, s14, v5
    s_xor_b32 s12, s12, 0x8000
    v_mfma_f32_16x16x32_bf16 v[152:155], v[72:75], a[8:11], 0
    ds_read_b64_tr_b16 v[68:69], v20 offset:20480
    s_add_u32 s14, s12, 81920
    v_mfma_f32_16x16x32_bf16 v[152:155], v[76:79], a[24:27], v[152:155]
    ds_read_b64_tr_b16 v[70:71], v20 offset:20992
    v_add_u32 v29, s14, v5
    v_mfma_f32_16x16x32_bf16 v[156:159], v[72:75], a[12:15], 0
    buffer_load_dwordx4 v9, s[36:39], s30 offen offset:1024 lds
    v_mfma_f32_16x16x32_bf16 v[156:159], v[76:79], a[28:31], v[156:159]
    s_add_u32 s76, s32, 0x1c00000
    s_addc_u32 s77, s33, 0
    s_mov_b32 s78, 2359296
    s_waitcnt lgkmcnt(8)
    v_mfma_f32_16x16x32_bf16 v[192:195], v[80:83], a[0:3], 0
    ds_read_b64_tr_b16 v[72:73], v21 offset:16384
    s_mov_b32 s79, 0x20000
    v_mfma_f32_16x16x32_bf16 v[192:195], v[84:87], a[16:19], v[192:195]
    ds_read_b64_tr_b16 v[74:75], v21 offset:16896
    s_add_u32 s31, s21, 6144
    v_mfma_f32_16x16x32_bf16 v[196:199], v[80:83], a[4:7], 0
    buffer_load_dwordx4 a[184:187], v32, s[68:71], s31 offen sc1
    v_mfma_f32_16x16x32_bf16 v[196:199], v[84:87], a[20:23], v[196:199]
    s_mov_b32 s80, s100
    s_mov_b32 s81, s101
    v_mfma_f32_16x16x32_bf16 v[200:203], v[80:83], a[8:11], 0
    ds_read_b64_tr_b16 v[76:77], v21 offset:20480
    s_mov_b32 s82, 4718592
    v_mfma_f32_16x16x32_bf16 v[200:203], v[84:87], a[24:27], v[200:203]
    ds_read_b64_tr_b16 v[78:79], v21 offset:20992
    s_mov_b32 s83, 0x20000
    v_mfma_f32_16x16x32_bf16 v[204:207], v[80:83], a[12:15], 0
    buffer_load_dwordx4 v10, s[36:39], s30 offen offset:2048 lds
    v_mfma_f32_16x16x32_bf16 v[204:207], v[84:87], a[28:31], v[204:207]
    v_bfe_u32 v6, v0, 2, 2
    v_lshlrev_b32 v6, 4, v6
    s_waitcnt lgkmcnt(8)
    v_mfma_f32_16x16x32_bf16 v[208:211], v[88:91], a[0:3], 0
    ds_read_b64_tr_b16 v[80:81], v22 offset:16384
    v_and_b32 v7, 3, v0
    v_mfma_f32_16x16x32_bf16 v[208:211], v[92:95], a[16:19], v[208:211]
    ds_read_b64_tr_b16 v[82:83], v22 offset:16896
    v_add_u32 v6, v6, v7
    v_mfma_f32_16x16x32_bf16 v[212:215], v[88:91], a[4:7], 0
    buffer_load_dwordx4 a[188:191], v33, s[68:71], s31 offen sc1
    v_mfma_f32_16x16x32_bf16 v[212:215], v[92:95], a[20:23], v[212:215]
    v_mul_u32_u24 v6, 1152, v6
    v_bfe_u32 v7, v0, 4, 2
    v_mfma_f32_16x16x32_bf16 v[216:219], v[88:91], a[8:11], 0
    ds_read_b64_tr_b16 v[84:85], v22 offset:20480
    v_lshl_add_u32 v4, v7, 3, v6
    v_mfma_f32_16x16x32_bf16 v[216:219], v[92:95], a[24:27], v[216:219]
    ds_read_b64_tr_b16 v[86:87], v22 offset:20992
    v_lshlrev_b32 v3, 1, v4
    v_mfma_f32_16x16x32_bf16 v[220:223], v[88:91], a[12:15], 0
    buffer_load_dwordx4 v11, s[36:39], s30 offen offset:3072 lds
    v_mfma_f32_16x16x32_bf16 v[220:223], v[92:95], a[28:31], v[220:223]
    s_lshl_b32 s12, s10, 1
    s_add_u32 s12, s12, s11
    s_waitcnt vmcnt(61) lgkmcnt(8)
    v_mfma_f32_16x16x32_bf16 v[96:99], v[64:67], a[32:35], v[96:99]
    ds_read_b64_tr_b16 v[88:89], v23 offset:16384
    s_xor_b32 s14, s12, 1
    v_mfma_f32_16x16x32_bf16 v[96:99], v[68:71], a[48:51], v[96:99]
    ds_read_b64_tr_b16 v[90:91], v23 offset:16896
    s_lshl_b32 s15, s13, 2
    v_mfma_f32_16x16x32_bf16 v[100:103], v[64:67], a[36:39], v[100:103]
    s_add_u32 s62, s15, s12
    s_add_u32 s63, s15, s14
    v_mfma_f32_16x16x32_bf16 v[100:103], v[68:71], a[52:55], v[100:103]
    s_lshl_b32 s62, s62, 6
    s_lshl_b32 s63, s63, 6
    v_mfma_f32_16x16x32_bf16 v[104:107], v[64:67], a[40:43], v[104:107]
    ds_read_b64_tr_b16 v[92:93], v23 offset:20480
    s_add_u32 s62, s62, 196608
    v_mfma_f32_16x16x32_bf16 v[104:107], v[68:71], a[56:59], v[104:107]
    ds_read_b64_tr_b16 v[94:95], v23 offset:20992
    s_add_u32 m0, s28, 32768
    s_add_u32 s30, s23, 73728
    v_mfma_f32_16x16x32_bf16 v[108:111], v[64:67], a[44:47], v[108:111]
    buffer_load_dwordx4 v8, s[36:39], s30 offen offset:0 lds
    v_mfma_f32_16x16x32_bf16 v[108:111], v[68:71], a[60:63], v[108:111]
    s_add_u32 s63, s63, 196608
    v_and_b32 v39, 15, v0
    s_waitcnt lgkmcnt(8)
    v_mfma_f32_16x16x32_bf16 v[112:115], v[72:75], a[32:35], v[112:115]
    ds_read_b64_tr_b16 v[64:65], v20 offset:32768
    v_lshlrev_b32 v39, 2, v39
    v_mfma_f32_16x16x32_bf16 v[112:115], v[76:79], a[48:51], v[112:115]
    ds_read_b64_tr_b16 v[66:67], v20 offset:33280
    s_lshl_b32 s15, s13, 4
    v_mfma_f32_16x16x32_bf16 v[116:119], v[72:75], a[36:39], v[116:119]
    s_add_u32 s12, s12, s15
    s_add_u32 s14, s14, s15
    v_mfma_f32_16x16x32_bf16 v[116:119], v[76:79], a[52:55], v[116:119]
    s_mul_i32 s12, s12, 4608
    s_mul_i32 s14, s14, 4608
    v_mfma_f32_16x16x32_bf16 v[120:123], v[72:75], a[40:43], v[120:123]
    ds_read_b64_tr_b16 v[68:69], v20 offset:36864
    s_mul_i32 s15, s9, 384
    v_mfma_f32_16x16x32_bf16 v[120:123], v[76:79], a[56:59], v[120:123]
    ds_read_b64_tr_b16 v[70:71], v20 offset:37376
    s_add_u32 s12, s12, s15
    v_mfma_f32_16x16x32_bf16 v[124:127], v[72:75], a[44:47], v[124:127]
    buffer_load_dwordx4 v9, s[36:39], s30 offen offset:1024 lds
    v_mfma_f32_16x16x32_bf16 v[124:127], v[76:79], a[60:63], v[124:127]
    s_add_u32 s14, s14, s15
    s_lshl_b32 s15, s6, 6
    s_waitcnt lgkmcnt(8)
    v_mfma_f32_16x16x32_bf16 v[160:163], v[80:83], a[32:35], v[160:163]
    ds_read_b64_tr_b16 v[72:73], v21 offset:32768
    s_add_u32 s87, s12, s15
    v_mfma_f32_16x16x32_bf16 v[160:163], v[84:87], a[48:51], v[160:163]
    ds_read_b64_tr_b16 v[74:75], v21 offset:33280
    s_add_u32 s88, s14, s15
    v_mfma_f32_16x16x32_bf16 v[164:167], v[80:83], a[36:39], v[164:167]
    s_and_b32 s15, s15, 64
    s_add_u32 s89, s12, s15
    v_mfma_f32_16x16x32_bf16 v[164:167], v[84:87], a[52:55], v[164:167]
    s_add_u32 s89, s89, 256
    s_lshl_b32 s84, s87, 1
    v_mfma_f32_16x16x32_bf16 v[168:171], v[80:83], a[40:43], v[168:171]
    ds_read_b64_tr_b16 v[76:77], v21 offset:36864
    s_lshl_b32 s85, s88, 1
    v_mfma_f32_16x16x32_bf16 v[168:171], v[84:87], a[56:59], v[168:171]
    ds_read_b64_tr_b16 v[78:79], v21 offset:37376
    s_lshl_b32 s86, s89, 1
    v_mfma_f32_16x16x32_bf16 v[172:175], v[80:83], a[44:47], v[172:175]
    buffer_load_dwordx4 v10, s[36:39], s30 offen offset:2048 lds
    v_mfma_f32_16x16x32_bf16 v[172:175], v[84:87], a[60:63], v[172:175]
    s_mul_i32 s52, s6, 49152
    s_add_u32 s53, s52, 12288
    s_waitcnt lgkmcnt(8)
    v_mfma_f32_16x16x32_bf16 v[176:179], v[88:91], a[32:35], v[176:179]
    ds_read_b64_tr_b16 v[80:81], v22 offset:32768
    s_add_u32 s54, s52, 24576
    v_mfma_f32_16x16x32_bf16 v[176:179], v[92:95], a[48:51], v[176:179]
    ds_read_b64_tr_b16 v[82:83], v22 offset:33280
    s_add_u32 s55, s52, 36864
    v_mfma_f32_16x16x32_bf16 v[180:183], v[88:91], a[36:39], v[180:183]
    s_mov_b32 s61, 0xffff0000
    s_lshl_b32 s12, s13, 3
    v_mfma_f32_16x16x32_bf16 v[180:183], v[92:95], a[52:55], v[180:183]
    s_lshl_b32 s14, s10, 2
    s_add_u32 s12, s12, s14
    s_waitcnt vmcnt(11)
    buffer_store_dword v36, v37, s[48:51], s56 offen offset:8 sc1
    buffer_store_dword v36, v37, s[48:51], s57 offen offset:16 sc1
    v_mfma_f32_16x16x32_bf16 v[184:187], v[88:91], a[40:43], v[184:187]
    ds_read_b64_tr_b16 v[84:85], v22 offset:36864
    s_lshl_b32 s12, s12, 7
    v_mfma_f32_16x16x32_bf16 v[184:187], v[92:95], a[56:59], v[184:187]
    ds_read_b64_tr_b16 v[86:87], v22 offset:37376
    s_add_u32 s12, s12, 16
    v_mfma_f32_16x16x32_bf16 v[188:191], v[88:91], a[44:47], v[188:191]
    buffer_load_dwordx4 v11, s[36:39], s30 offen offset:3072 lds
    v_mfma_f32_16x16x32_bf16 v[188:191], v[92:95], a[60:63], v[188:191]
    v_bfe_u32 v6, v0, 2, 2
    v_lshl_add_u32 v6, v6, 7, s12
    s_waitcnt lgkmcnt(8)
    v_mfma_f32_16x16x32_bf16 v[128:131], v[64:67], a[32:35], v[128:131]
    ds_read_b64_tr_b16 v[88:89], v23 offset:32768
    v_and_b32 v7, 3, v0
    v_mfma_f32_16x16x32_bf16 v[128:131], v[68:71], a[48:51], v[128:131]
    ds_read_b64_tr_b16 v[90:91], v23 offset:33280
    v_lshl_add_u32 v31, v7, 2, v6
    v_mfma_f32_16x16x32_bf16 v[132:135], v[64:67], a[36:39], v[132:135]
    s_and_b32 s12, s2, -7
    s_lshl_b32 s12, s12, 7
    v_mfma_f32_16x16x32_bf16 v[132:135], v[68:71], a[52:55], v[132:135]
    s_lshl_b32 s14, s4, 2
    s_add_u32 s12, s12, s14
    v_mfma_f32_16x16x32_bf16 v[136:139], v[64:67], a[40:43], v[136:139]
    ds_read_b64_tr_b16 v[92:93], v23 offset:36864
    s_add_u32 s12, s12, 16
    v_mfma_f32_16x16x32_bf16 v[136:139], v[68:71], a[56:59], v[136:139]
    ds_read_b64_tr_b16 v[94:95], v23 offset:37376
    v_writelane_b32 v31, s12, 16
    v_mfma_f32_16x16x32_bf16 v[140:143], v[64:67], a[44:47], v[140:143]
    s_add_u32 s12, s12, 256
    v_writelane_b32 v31, s12, 17
    v_mfma_f32_16x16x32_bf16 v[140:143], v[68:71], a[60:63], v[140:143]
    s_add_u32 s12, s12, 256
    v_writelane_b32 v31, s12, 18
    s_waitcnt vmcnt(42)
    s_barrier
    s_waitcnt lgkmcnt(8)
    v_mfma_f32_16x16x32_bf16 v[144:147], v[72:75], a[32:35], v[144:147]
    ds_read_b64_tr_b16 v[64:65], v20 offset:49152
    s_add_u32 s12, s12, 256
    v_mfma_f32_16x16x32_bf16 v[144:147], v[76:79], a[48:51], v[144:147]
    ds_read_b64_tr_b16 v[66:67], v20 offset:49664
    v_writelane_b32 v31, s12, 19
    v_mfma_f32_16x16x32_bf16 v[148:151], v[72:75], a[36:39], v[148:151]
    s_add_u32 s12, s12, 256
    s_and_b32 s12, s8, 1
    v_mfma_f32_16x16x32_bf16 v[148:151], v[76:79], a[52:55], v[148:151]
    s_lshl_b32 s14, s9, 1
    s_add_u32 s12, s12, s14
    v_mfma_f32_16x16x32_bf16 v[152:155], v[72:75], a[40:43], v[152:155]
    ds_read_b64_tr_b16 v[68:69], v20 offset:53248
    s_add_u32 s12, s12, 24
    v_mfma_f32_16x16x32_bf16 v[152:155], v[76:79], a[56:59], v[152:155]
    ds_read_b64_tr_b16 v[70:71], v20 offset:53760
    s_lshl_b32 s12, s12, 3
    v_mfma_f32_16x16x32_bf16 v[156:159], v[72:75], a[44:47], v[156:159]
    s_bfe_u32 s14, s8, 0x20001
    s_lshl_b32 s14, s14, 1
    v_mfma_f32_16x16x32_bf16 v[156:159], v[76:79], a[60:63], v[156:159]
    s_add_u32 s12, s12, s14
    s_lshr_b32 s14, s8, 3
    s_waitcnt lgkmcnt(8)
    v_mfma_f32_16x16x32_bf16 v[192:195], v[80:83], a[32:35], v[192:195]
    ds_read_b64_tr_b16 v[72:73], v21 offset:49152
    s_add_u32 s12, s12, s14
    v_mfma_f32_16x16x32_bf16 v[192:195], v[84:87], a[48:51], v[192:195]
    ds_read_b64_tr_b16 v[74:75], v21 offset:49664
    s_lshl_b32 s12, s12, 7
    v_mfma_f32_16x16x32_bf16 v[196:199], v[80:83], a[36:39], v[196:199]
    s_and_b32 s14, s4, 1
    s_lshl_b32 s14, s14, 1
    v_mfma_f32_16x16x32_bf16 v[196:199], v[84:87], a[52:55], v[196:199]
    s_add_u32 s14, s14, s10
    s_lshl_b32 s14, s14, 2
    v_mfma_f32_16x16x32_bf16 v[200:203], v[80:83], a[40:43], v[200:203]
    ds_read_b64_tr_b16 v[76:77], v21 offset:53248
    s_add_u32 s12, s12, s14
    v_mfma_f32_16x16x32_bf16 v[200:203], v[84:87], a[56:59], v[200:203]
    ds_read_b64_tr_b16 v[78:79], v21 offset:53760
    s_add_u32 s12, s12, 16
    v_mfma_f32_16x16x32_bf16 v[204:207], v[80:83], a[44:47], v[204:207]
    v_writelane_b32 v31, s12, 20
    v_mfma_f32_16x16x32_bf16 v[204:207], v[84:87], a[60:63], v[204:207]
    s_waitcnt lgkmcnt(8)
    v_mfma_f32_16x16x32_bf16 v[208:211], v[88:91], a[32:35], v[208:211]
    ds_read_b64_tr_b16 v[80:81], v22 offset:49152
    v_mfma_f32_16x16x32_bf16 v[208:211], v[92:95], a[48:51], v[208:211]
    ds_read_b64_tr_b16 v[82:83], v22 offset:49664
    v_mfma_f32_16x16x32_bf16 v[212:215], v[88:91], a[36:39], v[212:215]
    v_mfma_f32_16x16x32_bf16 v[212:215], v[92:95], a[52:55], v[212:215]
    v_mfma_f32_16x16x32_bf16 v[216:219], v[88:91], a[40:43], v[216:219]
    ds_read_b64_tr_b16 v[84:85], v22 offset:53248
    v_mfma_f32_16x16x32_bf16 v[216:219], v[92:95], a[56:59], v[216:219]
    ds_read_b64_tr_b16 v[86:87], v22 offset:53760
    s_add_u32 m0, s28, 49152
    s_add_u32 s30, s26, 73728
    v_mfma_f32_16x16x32_bf16 v[220:223], v[88:91], a[44:47], v[220:223]
    buffer_load_dwordx4 v8, s[36:39], s30 offen offset:0 lds
    v_mfma_f32_16x16x32_bf16 v[220:223], v[92:95], a[60:63], v[220:223]
    s_waitcnt vmcnt(56) lgkmcnt(8)
    v_mfma_f32_16x16x32_bf16 v[96:99], v[64:67], a[64:67], v[96:99]
    ds_read_b64_tr_b16 v[88:89], v23 offset:49152
    v_mfma_f32_16x16x32_bf16 v[96:99], v[68:71], a[80:83], v[96:99]
    ds_read_b64_tr_b16 v[90:91], v23 offset:49664
    v_mfma_f32_16x16x32_bf16 v[100:103], v[64:67], a[68:71], v[100:103]
    v_mfma_f32_16x16x32_bf16 v[100:103], v[68:71], a[84:87], v[100:103]
    v_mfma_f32_16x16x32_bf16 v[104:107], v[64:67], a[72:75], v[104:107]
    ds_read_b64_tr_b16 v[92:93], v23 offset:53248
    v_mfma_f32_16x16x32_bf16 v[104:107], v[68:71], a[88:91], v[104:107]
    ds_read_b64_tr_b16 v[94:95], v23 offset:53760
    v_mfma_f32_16x16x32_bf16 v[108:111], v[64:67], a[76:79], v[108:111]
    buffer_load_dwordx4 v9, s[36:39], s30 offen offset:1024 lds
    v_mfma_f32_16x16x32_bf16 v[108:111], v[68:71], a[92:95], v[108:111]
    s_waitcnt lgkmcnt(8)
    v_mfma_f32_16x16x32_bf16 v[112:115], v[72:75], a[64:67], v[112:115]
    v_add_u32 v24, s43, v24
    ds_read_b64_tr_b16 v[64:65], v24 offset:0
    v_mfma_f32_16x16x32_bf16 v[112:115], v[76:79], a[80:83], v[112:115]
    ds_read_b64_tr_b16 v[66:67], v24 offset:512
    v_mfma_f32_16x16x32_bf16 v[116:119], v[72:75], a[68:71], v[116:119]
    v_mfma_f32_16x16x32_bf16 v[116:119], v[76:79], a[84:87], v[116:119]
    v_mfma_f32_16x16x32_bf16 v[120:123], v[72:75], a[72:75], v[120:123]
    ds_read_b64_tr_b16 v[68:69], v24 offset:4096
    v_mfma_f32_16x16x32_bf16 v[120:123], v[76:79], a[88:91], v[120:123]
    ds_read_b64_tr_b16 v[70:71], v24 offset:4608
    v_mfma_f32_16x16x32_bf16 v[124:127], v[72:75], a[76:79], v[124:127]
    buffer_load_dwordx4 v10, s[36:39], s30 offen offset:2048 lds
    v_mfma_f32_16x16x32_bf16 v[124:127], v[76:79], a[92:95], v[124:127]
    s_waitcnt lgkmcnt(8)
    v_mfma_f32_16x16x32_bf16 v[160:163], v[80:83], a[64:67], v[160:163]
    v_add_u32 v25, s43, v25
    ds_read_b64_tr_b16 v[72:73], v25 offset:0
    v_mfma_f32_16x16x32_bf16 v[160:163], v[84:87], a[80:83], v[160:163]
    ds_read_b64_tr_b16 v[74:75], v25 offset:512
    v_mfma_f32_16x16x32_bf16 v[164:167], v[80:83], a[68:71], v[164:167]
    v_mfma_f32_16x16x32_bf16 v[164:167], v[84:87], a[84:87], v[164:167]
    v_mfma_f32_16x16x32_bf16 v[168:171], v[80:83], a[72:75], v[168:171]
    ds_read_b64_tr_b16 v[76:77], v25 offset:4096
    v_mfma_f32_16x16x32_bf16 v[168:171], v[84:87], a[88:91], v[168:171]
    ds_read_b64_tr_b16 v[78:79], v25 offset:4608
    v_mfma_f32_16x16x32_bf16 v[172:175], v[80:83], a[76:79], v[172:175]
    buffer_load_dwordx4 v11, s[36:39], s30 offen offset:3072 lds
    v_mfma_f32_16x16x32_bf16 v[172:175], v[84:87], a[92:95], v[172:175]
    s_waitcnt lgkmcnt(8)
    v_mfma_f32_16x16x32_bf16 v[176:179], v[88:91], a[64:67], v[176:179]
    v_add_u32 v26, s43, v26
    ds_read_b64_tr_b16 v[80:81], v26 offset:0
    v_mfma_f32_16x16x32_bf16 v[176:179], v[92:95], a[80:83], v[176:179]
    ds_read_b64_tr_b16 v[82:83], v26 offset:512
    v_mfma_f32_16x16x32_bf16 v[180:183], v[88:91], a[68:71], v[180:183]
    v_mfma_f32_16x16x32_bf16 v[180:183], v[92:95], a[84:87], v[180:183]
    v_mfma_f32_16x16x32_bf16 v[184:187], v[88:91], a[72:75], v[184:187]
    ds_read_b64_tr_b16 v[84:85], v26 offset:4096
    v_mfma_f32_16x16x32_bf16 v[184:187], v[92:95], a[88:91], v[184:187]
    ds_read_b64_tr_b16 v[86:87], v26 offset:4608
    s_add_u32 m0, s28, 65536
    s_add_u32 s30, s24, 73728
    v_mfma_f32_16x16x32_bf16 v[188:191], v[88:91], a[76:79], v[188:191]
    buffer_load_dwordx4 v8, s[36:39], s30 offen offset:0 lds
    v_mfma_f32_16x16x32_bf16 v[188:191], v[92:95], a[92:95], v[188:191]
    s_waitcnt lgkmcnt(8)
    v_mfma_f32_16x16x32_bf16 v[128:131], v[64:67], a[64:67], v[128:131]
    v_add_u32 v27, s43, v27
    ds_read_b64_tr_b16 v[88:89], v27 offset:0
    v_mfma_f32_16x16x32_bf16 v[128:131], v[68:71], a[80:83], v[128:131]
    ds_read_b64_tr_b16 v[90:91], v27 offset:512
    v_mfma_f32_16x16x32_bf16 v[132:135], v[64:67], a[68:71], v[132:135]
    v_mfma_f32_16x16x32_bf16 v[132:135], v[68:71], a[84:87], v[132:135]
    v_mfma_f32_16x16x32_bf16 v[136:139], v[64:67], a[72:75], v[136:139]
    ds_read_b64_tr_b16 v[92:93], v27 offset:4096
    v_mfma_f32_16x16x32_bf16 v[136:139], v[68:71], a[88:91], v[136:139]
    ds_read_b64_tr_b16 v[94:95], v27 offset:4608
    v_mfma_f32_16x16x32_bf16 v[140:143], v[64:67], a[76:79], v[140:143]
    buffer_load_dwordx4 v9, s[36:39], s30 offen offset:1024 lds
    v_mfma_f32_16x16x32_bf16 v[140:143], v[68:71], a[92:95], v[140:143]
    s_waitcnt vmcnt(12)
    s_barrier
    s_waitcnt lgkmcnt(8)
    v_mfma_f32_16x16x32_bf16 v[144:147], v[72:75], a[64:67], v[144:147]
    ds_read_b64_tr_b16 v[64:65], v16 offset:0
    v_mfma_f32_16x16x32_bf16 v[144:147], v[76:79], a[80:83], v[144:147]
    ds_read_b64_tr_b16 v[66:67], v16 offset:512
    v_mfma_f32_16x16x32_bf16 v[148:151], v[72:75], a[68:71], v[148:151]
    v_mfma_f32_16x16x32_bf16 v[148:151], v[76:79], a[84:87], v[148:151]
    v_mfma_f32_16x16x32_bf16 v[152:155], v[72:75], a[72:75], v[152:155]
    ds_read_b64_tr_b16 v[68:69], v16 offset:4096
    v_mfma_f32_16x16x32_bf16 v[152:155], v[76:79], a[88:91], v[152:155]
    ds_read_b64_tr_b16 v[70:71], v16 offset:4608
    v_mfma_f32_16x16x32_bf16 v[156:159], v[72:75], a[76:79], v[156:159]
    buffer_load_dwordx4 v10, s[36:39], s30 offen offset:2048 lds
    v_mfma_f32_16x16x32_bf16 v[156:159], v[76:79], a[92:95], v[156:159]
    s_waitcnt lgkmcnt(8)
    v_mfma_f32_16x16x32_bf16 v[192:195], v[80:83], a[64:67], v[192:195]
    ds_read_b64_tr_b16 v[72:73], v17 offset:0
    v_mfma_f32_16x16x32_bf16 v[192:195], v[84:87], a[80:83], v[192:195]
    ds_read_b64_tr_b16 v[74:75], v17 offset:512
    v_mfma_f32_16x16x32_bf16 v[196:199], v[80:83], a[68:71], v[196:199]
    v_mfma_f32_16x16x32_bf16 v[196:199], v[84:87], a[84:87], v[196:199]
    v_mfma_f32_16x16x32_bf16 v[200:203], v[80:83], a[72:75], v[200:203]
    ds_read_b64_tr_b16 v[76:77], v17 offset:4096
    v_mfma_f32_16x16x32_bf16 v[200:203], v[84:87], a[88:91], v[200:203]
    ds_read_b64_tr_b16 v[78:79], v17 offset:4608
    v_mfma_f32_16x16x32_bf16 v[204:207], v[80:83], a[76:79], v[204:207]
    buffer_load_dwordx4 v11, s[36:39], s30 offen offset:3072 lds
    v_mfma_f32_16x16x32_bf16 v[204:207], v[84:87], a[92:95], v[204:207]
    s_waitcnt lgkmcnt(8)
    v_mfma_f32_16x16x32_bf16 v[208:211], v[88:91], a[64:67], v[208:211]
    ds_read_b64_tr_b16 v[80:81], v18 offset:0
    v_mfma_f32_16x16x32_bf16 v[208:211], v[92:95], a[80:83], v[208:211]
    ds_read_b64_tr_b16 v[82:83], v18 offset:512
    v_mfma_f32_16x16x32_bf16 v[212:215], v[88:91], a[68:71], v[212:215]
    v_mfma_f32_16x16x32_bf16 v[212:215], v[92:95], a[84:87], v[212:215]
    v_mfma_f32_16x16x32_bf16 v[216:219], v[88:91], a[72:75], v[216:219]
    ds_read_b64_tr_b16 v[84:85], v18 offset:4096
    v_mfma_f32_16x16x32_bf16 v[216:219], v[92:95], a[88:91], v[216:219]
    ds_read_b64_tr_b16 v[86:87], v18 offset:4608
    s_add_u32 m0, s28, 81920
    s_add_u32 s30, s27, 73728
    v_mfma_f32_16x16x32_bf16 v[220:223], v[88:91], a[76:79], v[220:223]
    buffer_load_dwordx4 v8, s[36:39], s30 offen offset:0 lds
    v_mfma_f32_16x16x32_bf16 v[220:223], v[92:95], a[92:95], v[220:223]
    s_waitcnt vmcnt(47) lgkmcnt(8)
    v_mfma_f32_16x16x32_bf16 v[96:99], v[64:67], a[96:99], v[96:99]
    ds_read_b64_tr_b16 v[88:89], v19 offset:0
    v_mfma_f32_16x16x32_bf16 v[96:99], v[68:71], a[112:115], v[96:99]
    ds_read_b64_tr_b16 v[90:91], v19 offset:512
    v_mfma_f32_16x16x32_bf16 v[100:103], v[64:67], a[100:103], v[100:103]
    v_mfma_f32_16x16x32_bf16 v[100:103], v[68:71], a[116:119], v[100:103]
    v_mfma_f32_16x16x32_bf16 v[104:107], v[64:67], a[104:107], v[104:107]
    ds_read_b64_tr_b16 v[92:93], v19 offset:4096
    v_mfma_f32_16x16x32_bf16 v[104:107], v[68:71], a[120:123], v[104:107]
    ds_read_b64_tr_b16 v[94:95], v19 offset:4608
    v_mfma_f32_16x16x32_bf16 v[108:111], v[64:67], a[108:111], v[108:111]
    buffer_load_dwordx4 v9, s[36:39], s30 offen offset:1024 lds
    v_mfma_f32_16x16x32_bf16 v[108:111], v[68:71], a[124:127], v[108:111]
    s_waitcnt lgkmcnt(8)
    v_mfma_f32_16x16x32_bf16 v[112:115], v[72:75], a[96:99], v[112:115]
    ds_read_b64_tr_b16 v[64:65], v16 offset:16384
    v_mfma_f32_16x16x32_bf16 v[112:115], v[76:79], a[112:115], v[112:115]
    ds_read_b64_tr_b16 v[66:67], v16 offset:16896
    v_mfma_f32_16x16x32_bf16 v[116:119], v[72:75], a[100:103], v[116:119]
    v_mfma_f32_16x16x32_bf16 v[116:119], v[76:79], a[116:119], v[116:119]
    v_mfma_f32_16x16x32_bf16 v[120:123], v[72:75], a[104:107], v[120:123]
    ds_read_b64_tr_b16 v[68:69], v16 offset:20480
    v_mfma_f32_16x16x32_bf16 v[120:123], v[76:79], a[120:123], v[120:123]
    ds_read_b64_tr_b16 v[70:71], v16 offset:20992
    v_mfma_f32_16x16x32_bf16 v[124:127], v[72:75], a[108:111], v[124:127]
    buffer_load_dwordx4 v10, s[36:39], s30 offen offset:2048 lds
    v_mfma_f32_16x16x32_bf16 v[124:127], v[76:79], a[124:127], v[124:127]
    s_waitcnt lgkmcnt(8)
    v_mfma_f32_16x16x32_bf16 v[160:163], v[80:83], a[96:99], v[160:163]
    ds_read_b64_tr_b16 v[72:73], v17 offset:16384
    v_mfma_f32_16x16x32_bf16 v[160:163], v[84:87], a[112:115], v[160:163]
    ds_read_b64_tr_b16 v[74:75], v17 offset:16896
    v_mfma_f32_16x16x32_bf16 v[164:167], v[80:83], a[100:103], v[164:167]
    buffer_load_dwordx4 v[44:47], v38, s[48:51], s58 offen sc1
    v_mfma_f32_16x16x32_bf16 v[164:167], v[84:87], a[116:119], v[164:167]
    v_mfma_f32_16x16x32_bf16 v[168:171], v[80:83], a[104:107], v[168:171]
    ds_read_b64_tr_b16 v[76:77], v17 offset:20480
    v_mfma_f32_16x16x32_bf16 v[168:171], v[84:87], a[120:123], v[168:171]
    ds_read_b64_tr_b16 v[78:79], v17 offset:20992
    v_mfma_f32_16x16x32_bf16 v[172:175], v[80:83], a[108:111], v[172:175]
    buffer_load_dwordx4 v11, s[36:39], s30 offen offset:3072 lds
    v_mfma_f32_16x16x32_bf16 v[172:175], v[84:87], a[124:127], v[172:175]
    s_waitcnt lgkmcnt(8)
    v_mfma_f32_16x16x32_bf16 v[176:179], v[88:91], a[96:99], v[176:179]
    ds_read_b64_tr_b16 v[80:81], v18 offset:16384
    v_mfma_f32_16x16x32_bf16 v[176:179], v[92:95], a[112:115], v[176:179]
    ds_read_b64_tr_b16 v[82:83], v18 offset:16896
    v_mfma_f32_16x16x32_bf16 v[180:183], v[88:91], a[100:103], v[180:183]
    v_mfma_f32_16x16x32_bf16 v[180:183], v[92:95], a[116:119], v[180:183]
    v_mfma_f32_16x16x32_bf16 v[184:187], v[88:91], a[104:107], v[184:187]
    ds_read_b64_tr_b16 v[84:85], v18 offset:20480
    v_mfma_f32_16x16x32_bf16 v[184:187], v[92:95], a[120:123], v[184:187]
    ds_read_b64_tr_b16 v[86:87], v18 offset:20992
    s_add_u32 m0, s28, 147456
    s_add_u32 s30, s22, 147456
    v_mfma_f32_16x16x32_bf16 v[188:191], v[88:91], a[108:111], v[188:191]
    buffer_load_dwordx4 v8, s[36:39], s30 offen offset:0 lds
    v_mfma_f32_16x16x32_bf16 v[188:191], v[92:95], a[124:127], v[188:191]
    s_waitcnt lgkmcnt(8)
    v_mfma_f32_16x16x32_bf16 v[128:131], v[64:67], a[96:99], v[128:131]
    ds_read_b64_tr_b16 v[88:89], v19 offset:16384
    v_mfma_f32_16x16x32_bf16 v[128:131], v[68:71], a[112:115], v[128:131]
    ds_read_b64_tr_b16 v[90:91], v19 offset:16896
    v_mfma_f32_16x16x32_bf16 v[132:135], v[64:67], a[100:103], v[132:135]
    v_mfma_f32_16x16x32_bf16 v[132:135], v[68:71], a[116:119], v[132:135]
    v_mfma_f32_16x16x32_bf16 v[136:139], v[64:67], a[104:107], v[136:139]
    ds_read_b64_tr_b16 v[92:93], v19 offset:20480
    v_mfma_f32_16x16x32_bf16 v[136:139], v[68:71], a[120:123], v[136:139]
    ds_read_b64_tr_b16 v[94:95], v19 offset:20992
    v_mfma_f32_16x16x32_bf16 v[140:143], v[64:67], a[108:111], v[140:143]
    buffer_load_dwordx4 v9, s[36:39], s30 offen offset:1024 lds
    v_mfma_f32_16x16x32_bf16 v[140:143], v[68:71], a[124:127], v[140:143]
    s_waitcnt vmcnt(11)
    s_barrier
    s_waitcnt lgkmcnt(8)
    v_mfma_f32_16x16x32_bf16 v[144:147], v[72:75], a[96:99], v[144:147]
    ds_read_b64_tr_b16 v[64:65], v16 offset:32768
    v_mfma_f32_16x16x32_bf16 v[144:147], v[76:79], a[112:115], v[144:147]
    ds_read_b64_tr_b16 v[66:67], v16 offset:33280
    v_mfma_f32_16x16x32_bf16 v[148:151], v[72:75], a[100:103], v[148:151]
    v_mfma_f32_16x16x32_bf16 v[148:151], v[76:79], a[116:119], v[148:151]
    v_mfma_f32_16x16x32_bf16 v[152:155], v[72:75], a[104:107], v[152:155]
    ds_read_b64_tr_b16 v[68:69], v16 offset:36864
    v_mfma_f32_16x16x32_bf16 v[152:155], v[76:79], a[120:123], v[152:155]
    ds_read_b64_tr_b16 v[70:71], v16 offset:37376
    v_mfma_f32_16x16x32_bf16 v[156:159], v[72:75], a[108:111], v[156:159]
    buffer_load_dwordx4 v10, s[36:39], s30 offen offset:2048 lds
    v_mfma_f32_16x16x32_bf16 v[156:159], v[76:79], a[124:127], v[156:159]
    s_waitcnt lgkmcnt(8)
    v_mfma_f32_16x16x32_bf16 v[192:195], v[80:83], a[96:99], v[192:195]
    ds_read_b64_tr_b16 v[72:73], v17 offset:32768
    v_mfma_f32_16x16x32_bf16 v[192:195], v[84:87], a[112:115], v[192:195]
    ds_read_b64_tr_b16 v[74:75], v17 offset:33280
    v_mfma_f32_16x16x32_bf16 v[196:199], v[80:83], a[100:103], v[196:199]
    v_mfma_f32_16x16x32_bf16 v[196:199], v[84:87], a[116:119], v[196:199]
    v_mfma_f32_16x16x32_bf16 v[200:203], v[80:83], a[104:107], v[200:203]
    ds_read_b64_tr_b16 v[76:77], v17 offset:36864
    v_mfma_f32_16x16x32_bf16 v[200:203], v[84:87], a[120:123], v[200:203]
    ds_read_b64_tr_b16 v[78:79], v17 offset:37376
    v_mfma_f32_16x16x32_bf16 v[204:207], v[80:83], a[108:111], v[204:207]
    buffer_load_dwordx4 v11, s[36:39], s30 offen offset:3072 lds
    v_mfma_f32_16x16x32_bf16 v[204:207], v[84:87], a[124:127], v[204:207]
    s_waitcnt lgkmcnt(8)
    v_mfma_f32_16x16x32_bf16 v[208:211], v[88:91], a[96:99], v[208:211]
    ds_read_b64_tr_b16 v[80:81], v18 offset:32768
    v_mfma_f32_16x16x32_bf16 v[208:211], v[92:95], a[112:115], v[208:211]
    ds_read_b64_tr_b16 v[82:83], v18 offset:33280
    v_mfma_f32_16x16x32_bf16 v[212:215], v[88:91], a[100:103], v[212:215]
    v_mfma_f32_16x16x32_bf16 v[212:215], v[92:95], a[116:119], v[212:215]
    v_mfma_f32_16x16x32_bf16 v[216:219], v[88:91], a[104:107], v[216:219]
    ds_read_b64_tr_b16 v[84:85], v18 offset:36864
    v_mfma_f32_16x16x32_bf16 v[216:219], v[92:95], a[120:123], v[216:219]
    ds_read_b64_tr_b16 v[86:87], v18 offset:37376
    s_add_u32 m0, s28, 98304
    s_add_u32 s30, s25, 147456
    v_mfma_f32_16x16x32_bf16 v[220:223], v[88:91], a[108:111], v[220:223]
    buffer_load_dwordx4 v8, s[36:39], s30 offen offset:0 lds
    v_mfma_f32_16x16x32_bf16 v[220:223], v[92:95], a[124:127], v[220:223]
    s_waitcnt vmcnt(44) lgkmcnt(8)
    v_mfma_f32_16x16x32_bf16 v[96:99], v[64:67], a[128:131], v[96:99]
    ds_read_b64_tr_b16 v[88:89], v19 offset:32768
    v_mfma_f32_16x16x32_bf16 v[96:99], v[68:71], a[144:147], v[96:99]
    ds_read_b64_tr_b16 v[90:91], v19 offset:33280
    v_mfma_f32_16x16x32_bf16 v[100:103], v[64:67], a[132:135], v[100:103]
    buffer_load_dwordx4 v9, s[36:39], s30 offen offset:1024 lds
    v_mfma_f32_16x16x32_bf16 v[100:103], v[68:71], a[148:151], v[100:103]
    v_mfma_f32_16x16x32_bf16 v[104:107], v[64:67], a[136:139], v[104:107]
    ds_read_b64_tr_b16 v[92:93], v19 offset:36864
    v_mfma_f32_16x16x32_bf16 v[104:107], v[68:71], a[152:155], v[104:107]
    ds_read_b64_tr_b16 v[94:95], v19 offset:37376
    v_mfma_f32_16x16x32_bf16 v[108:111], v[64:67], a[140:143], v[108:111]
    buffer_load_dwordx4 v10, s[36:39], s30 offen offset:2048 lds
    v_mfma_f32_16x16x32_bf16 v[108:111], v[68:71], a[156:159], v[108:111]
    s_waitcnt vmcnt(8)
    s_mov_b32 s61, 0
parallel_fc14:
    v_xor_b32 v47, s3, v46
    v_cmp_ne_u32 vcc, 0, v47
    s_cbranch_vccz parallel_fx15
    s_add_u32 s61, s61, 1
    s_cmp_gt_u32 s61, 131072
    s_cbranch_scc1 parallel_fx15
    buffer_load_dwordx4 v[44:47], v38, s[48:51], s58 offen sc1
    s_waitcnt vmcnt(0)
    s_branch parallel_fc14
parallel_fx15:
    s_waitcnt lgkmcnt(8)
    v_mfma_f32_16x16x32_bf16 v[112:115], v[72:75], a[128:131], v[112:115]
    ds_read_b64_tr_b16 v[64:65], v16 offset:49152
    v_mfma_f32_16x16x32_bf16 v[112:115], v[76:79], a[144:147], v[112:115]
    ds_read_b64_tr_b16 v[66:67], v16 offset:49664
    s_add_u32 s31, s16, 8192
    v_mfma_f32_16x16x32_bf16 v[116:119], v[72:75], a[132:135], v[116:119]
    buffer_load_dwordx4 a[192:195], v32, s[68:71], s31 offen sc1
    v_mfma_f32_16x16x32_bf16 v[116:119], v[76:79], a[148:151], v[116:119]
    v_mfma_f32_16x16x32_bf16 v[120:123], v[72:75], a[136:139], v[120:123]
    ds_read_b64_tr_b16 v[68:69], v16 offset:53248
    v_mfma_f32_16x16x32_bf16 v[120:123], v[76:79], a[152:155], v[120:123]
    ds_read_b64_tr_b16 v[70:71], v16 offset:53760
    v_mfma_f32_16x16x32_bf16 v[124:127], v[72:75], a[140:143], v[124:127]
    buffer_load_dwordx4 v11, s[36:39], s30 offen offset:3072 lds
    v_mfma_f32_16x16x32_bf16 v[124:127], v[76:79], a[156:159], v[124:127]
    s_waitcnt lgkmcnt(8)
    v_mfma_f32_16x16x32_bf16 v[160:163], v[80:83], a[128:131], v[160:163]
    ds_read_b64_tr_b16 v[72:73], v17 offset:49152
    v_mfma_f32_16x16x32_bf16 v[160:163], v[84:87], a[144:147], v[160:163]
    ds_read_b64_tr_b16 v[74:75], v17 offset:49664
    v_mfma_f32_16x16x32_bf16 v[164:167], v[80:83], a[132:135], v[164:167]
    buffer_load_dwordx4 a[196:199], v33, s[68:71], s31 offen sc1
    v_mfma_f32_16x16x32_bf16 v[164:167], v[84:87], a[148:151], v[164:167]
    v_mfma_f32_16x16x32_bf16 v[168:171], v[80:83], a[136:139], v[168:171]
    ds_read_b64_tr_b16 v[76:77], v17 offset:53248
    v_mfma_f32_16x16x32_bf16 v[168:171], v[84:87], a[152:155], v[168:171]
    ds_read_b64_tr_b16 v[78:79], v17 offset:53760
    s_add_u32 m0, s28, 114688
    s_add_u32 s30, s23, 147456
    v_mfma_f32_16x16x32_bf16 v[172:175], v[80:83], a[140:143], v[172:175]
    buffer_load_dwordx4 v8, s[36:39], s30 offen offset:0 lds
    v_mfma_f32_16x16x32_bf16 v[172:175], v[84:87], a[156:159], v[172:175]
    s_waitcnt lgkmcnt(8)
    v_mfma_f32_16x16x32_bf16 v[176:179], v[88:91], a[128:131], v[176:179]
    ds_read_b64_tr_b16 v[80:81], v18 offset:49152
    v_mfma_f32_16x16x32_bf16 v[176:179], v[92:95], a[144:147], v[176:179]
    ds_read_b64_tr_b16 v[82:83], v18 offset:49664
    s_add_u32 s31, s19, 8192
    v_mfma_f32_16x16x32_bf16 v[180:183], v[88:91], a[132:135], v[180:183]
    buffer_load_dwordx4 a[200:203], v32, s[68:71], s31 offen sc1
    v_mfma_f32_16x16x32_bf16 v[180:183], v[92:95], a[148:151], v[180:183]
    v_mfma_f32_16x16x32_bf16 v[184:187], v[88:91], a[136:139], v[184:187]
    ds_read_b64_tr_b16 v[84:85], v18 offset:53248
    v_mfma_f32_16x16x32_bf16 v[184:187], v[92:95], a[152:155], v[184:187]
    ds_read_b64_tr_b16 v[86:87], v18 offset:53760
    v_mfma_f32_16x16x32_bf16 v[188:191], v[88:91], a[140:143], v[188:191]
    buffer_load_dwordx4 v9, s[36:39], s30 offen offset:1024 lds
    v_mfma_f32_16x16x32_bf16 v[188:191], v[92:95], a[156:159], v[188:191]
    s_waitcnt lgkmcnt(8)
    v_mfma_f32_16x16x32_bf16 v[128:131], v[64:67], a[128:131], v[128:131]
    ds_read_b64_tr_b16 v[88:89], v19 offset:49152
    v_mfma_f32_16x16x32_bf16 v[128:131], v[68:71], a[144:147], v[128:131]
    ds_read_b64_tr_b16 v[90:91], v19 offset:49664
    v_mfma_f32_16x16x32_bf16 v[132:135], v[64:67], a[132:135], v[132:135]
    buffer_load_dwordx4 a[204:207], v33, s[68:71], s31 offen sc1
    v_mfma_f32_16x16x32_bf16 v[132:135], v[68:71], a[148:151], v[132:135]
    v_mfma_f32_16x16x32_bf16 v[136:139], v[64:67], a[136:139], v[136:139]
    ds_read_b64_tr_b16 v[92:93], v19 offset:53248
    v_mfma_f32_16x16x32_bf16 v[136:139], v[68:71], a[152:155], v[136:139]
    ds_read_b64_tr_b16 v[94:95], v19 offset:53760
    v_mfma_f32_16x16x32_bf16 v[140:143], v[64:67], a[140:143], v[140:143]
    buffer_load_dwordx4 v10, s[36:39], s30 offen offset:2048 lds
    v_mfma_f32_16x16x32_bf16 v[140:143], v[68:71], a[156:159], v[140:143]
    s_waitcnt vmcnt(15)
    s_barrier
    s_waitcnt lgkmcnt(8)
    v_mfma_f32_16x16x32_bf16 v[144:147], v[72:75], a[128:131], v[144:147]
    ds_read_b64_tr_b16 v[64:65], v20 offset:0
    v_mfma_f32_16x16x32_bf16 v[144:147], v[76:79], a[144:147], v[144:147]
    ds_read_b64_tr_b16 v[66:67], v20 offset:512
    s_add_u32 s31, s16, 10240
    v_mfma_f32_16x16x32_bf16 v[148:151], v[72:75], a[132:135], v[148:151]
    buffer_load_dwordx4 a[208:211], v32, s[68:71], s31 offen sc1
    v_mfma_f32_16x16x32_bf16 v[148:151], v[76:79], a[148:151], v[148:151]
    v_mfma_f32_16x16x32_bf16 v[152:155], v[72:75], a[136:139], v[152:155]
    ds_read_b64_tr_b16 v[68:69], v20 offset:4096
    v_mfma_f32_16x16x32_bf16 v[152:155], v[76:79], a[152:155], v[152:155]
    ds_read_b64_tr_b16 v[70:71], v20 offset:4608
    v_mfma_f32_16x16x32_bf16 v[156:159], v[72:75], a[140:143], v[156:159]
    buffer_load_dwordx4 v11, s[36:39], s30 offen offset:3072 lds
    v_mfma_f32_16x16x32_bf16 v[156:159], v[76:79], a[156:159], v[156:159]
    s_waitcnt lgkmcnt(8)
    v_mfma_f32_16x16x32_bf16 v[192:195], v[80:83], a[128:131], v[192:195]
    ds_read_b64_tr_b16 v[72:73], v21 offset:0
    v_mfma_f32_16x16x32_bf16 v[192:195], v[84:87], a[144:147], v[192:195]
    ds_read_b64_tr_b16 v[74:75], v21 offset:512
    v_mfma_f32_16x16x32_bf16 v[196:199], v[80:83], a[132:135], v[196:199]
    buffer_load_dwordx4 a[212:215], v33, s[68:71], s31 offen sc1
    v_mfma_f32_16x16x32_bf16 v[196:199], v[84:87], a[148:151], v[196:199]
    v_mfma_f32_16x16x32_bf16 v[200:203], v[80:83], a[136:139], v[200:203]
    ds_read_b64_tr_b16 v[76:77], v21 offset:4096
    v_mfma_f32_16x16x32_bf16 v[200:203], v[84:87], a[152:155], v[200:203]
    ds_read_b64_tr_b16 v[78:79], v21 offset:4608
    s_add_u32 m0, s28, 131072
    s_add_u32 s30, s26, 147456
    v_mfma_f32_16x16x32_bf16 v[204:207], v[80:83], a[140:143], v[204:207]
    buffer_load_dwordx4 v8, s[36:39], s30 offen offset:0 lds
    v_mfma_f32_16x16x32_bf16 v[204:207], v[84:87], a[156:159], v[204:207]
    s_waitcnt lgkmcnt(8)
    v_mfma_f32_16x16x32_bf16 v[208:211], v[88:91], a[128:131], v[208:211]
    ds_read_b64_tr_b16 v[80:81], v22 offset:0
    v_mfma_f32_16x16x32_bf16 v[208:211], v[92:95], a[144:147], v[208:211]
    ds_read_b64_tr_b16 v[82:83], v22 offset:512
    s_add_u32 s31, s19, 10240
    v_mfma_f32_16x16x32_bf16 v[212:215], v[88:91], a[132:135], v[212:215]
    buffer_load_dwordx4 a[216:219], v32, s[68:71], s31 offen sc1
    v_mfma_f32_16x16x32_bf16 v[212:215], v[92:95], a[148:151], v[212:215]
    v_mfma_f32_16x16x32_bf16 v[216:219], v[88:91], a[136:139], v[216:219]
    ds_read_b64_tr_b16 v[84:85], v22 offset:4096
    v_mfma_f32_16x16x32_bf16 v[216:219], v[92:95], a[152:155], v[216:219]
    ds_read_b64_tr_b16 v[86:87], v22 offset:4608
    v_mfma_f32_16x16x32_bf16 v[220:223], v[88:91], a[140:143], v[220:223]
    buffer_load_dwordx4 v9, s[36:39], s30 offen offset:1024 lds
    v_mfma_f32_16x16x32_bf16 v[220:223], v[92:95], a[156:159], v[220:223]
    s_waitcnt vmcnt(41) lgkmcnt(8)
    v_mfma_f32_16x16x32_bf16 v[96:99], v[64:67], a[160:163], v[96:99]
    ds_read_b64_tr_b16 v[88:89], v23 offset:0
    v_mfma_f32_16x16x32_bf16 v[96:99], v[68:71], a[176:179], v[96:99]
    ds_read_b64_tr_b16 v[90:91], v23 offset:512
    v_mfma_f32_16x16x32_bf16 v[100:103], v[64:67], a[164:167], v[100:103]
    buffer_load_dwordx4 a[220:223], v33, s[68:71], s31 offen sc1
    v_mfma_f32_16x16x32_bf16 v[100:103], v[68:71], a[180:183], v[100:103]
    v_mfma_f32_16x16x32_bf16 v[104:107], v[64:67], a[168:171], v[104:107]
    ds_read_b64_tr_b16 v[92:93], v23 offset:4096
    v_mfma_f32_16x16x32_bf16 v[104:107], v[68:71], a[184:187], v[104:107]
    ds_read_b64_tr_b16 v[94:95], v23 offset:4608
    v_mfma_f32_16x16x32_bf16 v[108:111], v[64:67], a[172:175], v[108:111]
    buffer_load_dwordx4 v10, s[36:39], s30 offen offset:2048 lds
    v_mfma_f32_16x16x32_bf16 v[108:111], v[68:71], a[188:191], v[108:111]
    s_waitcnt lgkmcnt(8)
    v_mfma_f32_16x16x32_bf16 v[112:115], v[72:75], a[160:163], v[112:115]
    ds_read_b64_tr_b16 v[64:65], v20 offset:16384
    v_mfma_f32_16x16x32_bf16 v[112:115], v[76:79], a[176:179], v[112:115]
    ds_read_b64_tr_b16 v[66:67], v20 offset:16896
    s_add_u32 s31, s17, 8192
    v_mfma_f32_16x16x32_bf16 v[116:119], v[72:75], a[164:167], v[116:119]
    buffer_load_dwordx4 a[224:227], v32, s[68:71], s31 offen sc1
    v_mfma_f32_16x16x32_bf16 v[116:119], v[76:79], a[180:183], v[116:119]
    v_mfma_f32_16x16x32_bf16 v[120:123], v[72:75], a[168:171], v[120:123]
    ds_read_b64_tr_b16 v[68:69], v20 offset:20480
    v_mfma_f32_16x16x32_bf16 v[120:123], v[76:79], a[184:187], v[120:123]
    ds_read_b64_tr_b16 v[70:71], v20 offset:20992
    v_mfma_f32_16x16x32_bf16 v[124:127], v[72:75], a[172:175], v[124:127]
    buffer_load_dwordx4 v11, s[36:39], s30 offen offset:3072 lds
    v_mfma_f32_16x16x32_bf16 v[124:127], v[76:79], a[188:191], v[124:127]
    s_waitcnt lgkmcnt(8)
    v_mfma_f32_16x16x32_bf16 v[160:163], v[80:83], a[160:163], v[160:163]
    ds_read_b64_tr_b16 v[72:73], v21 offset:16384
    v_mfma_f32_16x16x32_bf16 v[160:163], v[84:87], a[176:179], v[160:163]
    ds_read_b64_tr_b16 v[74:75], v21 offset:16896
    v_mfma_f32_16x16x32_bf16 v[164:167], v[80:83], a[164:167], v[164:167]
    buffer_load_dwordx4 a[228:231], v33, s[68:71], s31 offen sc1
    v_mfma_f32_16x16x32_bf16 v[164:167], v[84:87], a[180:183], v[164:167]
    v_mfma_f32_16x16x32_bf16 v[168:171], v[80:83], a[168:171], v[168:171]
    ds_read_b64_tr_b16 v[76:77], v21 offset:20480
    v_mfma_f32_16x16x32_bf16 v[168:171], v[84:87], a[184:187], v[168:171]
    ds_read_b64_tr_b16 v[78:79], v21 offset:20992
    s_add_u32 m0, s28, 0
    s_add_u32 s30, s24, 147456
    v_mfma_f32_16x16x32_bf16 v[172:175], v[80:83], a[172:175], v[172:175]
    buffer_load_dwordx4 v8, s[36:39], s30 offen offset:0 lds
    v_mfma_f32_16x16x32_bf16 v[172:175], v[84:87], a[188:191], v[172:175]
    s_waitcnt lgkmcnt(8)
    v_mfma_f32_16x16x32_bf16 v[176:179], v[88:91], a[160:163], v[176:179]
    ds_read_b64_tr_b16 v[80:81], v22 offset:16384
    v_mfma_f32_16x16x32_bf16 v[176:179], v[92:95], a[176:179], v[176:179]
    ds_read_b64_tr_b16 v[82:83], v22 offset:16896
    s_add_u32 s31, s20, 8192
    v_mfma_f32_16x16x32_bf16 v[180:183], v[88:91], a[164:167], v[180:183]
    buffer_load_dwordx4 a[232:235], v32, s[68:71], s31 offen sc1
    v_mfma_f32_16x16x32_bf16 v[180:183], v[92:95], a[180:183], v[180:183]
    v_mfma_f32_16x16x32_bf16 v[184:187], v[88:91], a[168:171], v[184:187]
    ds_read_b64_tr_b16 v[84:85], v22 offset:20480
    v_mfma_f32_16x16x32_bf16 v[184:187], v[92:95], a[184:187], v[184:187]
    ds_read_b64_tr_b16 v[86:87], v22 offset:20992
    v_mfma_f32_16x16x32_bf16 v[188:191], v[88:91], a[172:175], v[188:191]
    buffer_load_dwordx4 v9, s[36:39], s30 offen offset:1024 lds
    v_mfma_f32_16x16x32_bf16 v[188:191], v[92:95], a[188:191], v[188:191]
    s_waitcnt lgkmcnt(8)
    v_mfma_f32_16x16x32_bf16 v[128:131], v[64:67], a[160:163], v[128:131]
    ds_read_b64_tr_b16 v[88:89], v23 offset:16384
    v_mfma_f32_16x16x32_bf16 v[128:131], v[68:71], a[176:179], v[128:131]
    ds_read_b64_tr_b16 v[90:91], v23 offset:16896
    v_mfma_f32_16x16x32_bf16 v[132:135], v[64:67], a[164:167], v[132:135]
    buffer_load_dwordx4 a[236:239], v33, s[68:71], s31 offen sc1
    v_mfma_f32_16x16x32_bf16 v[132:135], v[68:71], a[180:183], v[132:135]
    v_mfma_f32_16x16x32_bf16 v[136:139], v[64:67], a[168:171], v[136:139]
    ds_read_b64_tr_b16 v[92:93], v23 offset:20480
    v_mfma_f32_16x16x32_bf16 v[136:139], v[68:71], a[184:187], v[136:139]
    ds_read_b64_tr_b16 v[94:95], v23 offset:20992
    v_mfma_f32_16x16x32_bf16 v[140:143], v[64:67], a[172:175], v[140:143]
    buffer_load_dwordx4 v10, s[36:39], s30 offen offset:2048 lds
    v_mfma_f32_16x16x32_bf16 v[140:143], v[68:71], a[188:191], v[140:143]
    s_waitcnt vmcnt(22)
    s_barrier
    s_waitcnt lgkmcnt(8)
    v_mfma_f32_16x16x32_bf16 v[144:147], v[72:75], a[160:163], v[144:147]
    ds_read_b64_tr_b16 v[64:65], v24 offset:16384
    v_mfma_f32_16x16x32_bf16 v[144:147], v[76:79], a[176:179], v[144:147]
    ds_read_b64_tr_b16 v[66:67], v24 offset:16896
    s_add_u32 s31, s17, 10240
    v_mfma_f32_16x16x32_bf16 v[148:151], v[72:75], a[164:167], v[148:151]
    buffer_load_dwordx4 a[240:243], v32, s[68:71], s31 offen sc1
    v_mfma_f32_16x16x32_bf16 v[148:151], v[76:79], a[180:183], v[148:151]
    v_mfma_f32_16x16x32_bf16 v[152:155], v[72:75], a[168:171], v[152:155]
    ds_read_b64_tr_b16 v[68:69], v24 offset:20480
    v_mfma_f32_16x16x32_bf16 v[152:155], v[76:79], a[184:187], v[152:155]
    ds_read_b64_tr_b16 v[70:71], v24 offset:20992
    v_mfma_f32_16x16x32_bf16 v[156:159], v[72:75], a[172:175], v[156:159]
    buffer_load_dwordx4 v11, s[36:39], s30 offen offset:3072 lds
    v_mfma_f32_16x16x32_bf16 v[156:159], v[76:79], a[188:191], v[156:159]
    s_waitcnt lgkmcnt(8)
    v_mfma_f32_16x16x32_bf16 v[192:195], v[80:83], a[160:163], v[192:195]
    ds_read_b64_tr_b16 v[72:73], v25 offset:16384
    v_mfma_f32_16x16x32_bf16 v[192:195], v[84:87], a[176:179], v[192:195]
    ds_read_b64_tr_b16 v[74:75], v25 offset:16896
    v_mfma_f32_16x16x32_bf16 v[196:199], v[80:83], a[164:167], v[196:199]
    buffer_load_dwordx4 a[244:247], v33, s[68:71], s31 offen sc1
    v_mfma_f32_16x16x32_bf16 v[196:199], v[84:87], a[180:183], v[196:199]
    v_mfma_f32_16x16x32_bf16 v[200:203], v[80:83], a[168:171], v[200:203]
    ds_read_b64_tr_b16 v[76:77], v25 offset:20480
    v_mfma_f32_16x16x32_bf16 v[200:203], v[84:87], a[184:187], v[200:203]
    ds_read_b64_tr_b16 v[78:79], v25 offset:20992
    s_add_u32 m0, s28, 16384
    s_add_u32 s30, s27, 147456
    v_mfma_f32_16x16x32_bf16 v[204:207], v[80:83], a[172:175], v[204:207]
    buffer_load_dwordx4 v8, s[36:39], s30 offen offset:0 lds
    v_mfma_f32_16x16x32_bf16 v[204:207], v[84:87], a[188:191], v[204:207]
    s_waitcnt lgkmcnt(8)
    v_mfma_f32_16x16x32_bf16 v[208:211], v[88:91], a[160:163], v[208:211]
    ds_read_b64_tr_b16 v[80:81], v26 offset:16384
    v_mfma_f32_16x16x32_bf16 v[208:211], v[92:95], a[176:179], v[208:211]
    ds_read_b64_tr_b16 v[82:83], v26 offset:16896
    s_add_u32 s31, s20, 10240
    v_mfma_f32_16x16x32_bf16 v[212:215], v[88:91], a[164:167], v[212:215]
    buffer_load_dwordx4 a[248:251], v32, s[68:71], s31 offen sc1
    v_mfma_f32_16x16x32_bf16 v[212:215], v[92:95], a[180:183], v[212:215]
    v_mfma_f32_16x16x32_bf16 v[216:219], v[88:91], a[168:171], v[216:219]
    ds_read_b64_tr_b16 v[84:85], v26 offset:20480
    v_mfma_f32_16x16x32_bf16 v[216:219], v[92:95], a[184:187], v[216:219]
    ds_read_b64_tr_b16 v[86:87], v26 offset:20992
    v_mfma_f32_16x16x32_bf16 v[220:223], v[88:91], a[172:175], v[220:223]
    buffer_load_dwordx4 v9, s[36:39], s30 offen offset:1024 lds
    v_mfma_f32_16x16x32_bf16 v[220:223], v[92:95], a[188:191], v[220:223]
    s_waitcnt vmcnt(15) lgkmcnt(8)
    v_mfma_f32_16x16x32_bf16 v[96:99], v[64:67], a[192:195], v[96:99]
    ds_read_b64_tr_b16 v[88:89], v27 offset:16384
    v_mfma_f32_16x16x32_bf16 v[96:99], v[68:71], a[208:211], v[96:99]
    ds_read_b64_tr_b16 v[90:91], v27 offset:16896
    v_mfma_f32_16x16x32_bf16 v[100:103], v[64:67], a[196:199], v[100:103]
    buffer_load_dwordx4 a[252:255], v33, s[68:71], s31 offen sc1
    v_mfma_f32_16x16x32_bf16 v[100:103], v[68:71], a[212:215], v[100:103]
    v_mfma_f32_16x16x32_bf16 v[104:107], v[64:67], a[200:203], v[104:107]
    ds_read_b64_tr_b16 v[92:93], v27 offset:20480
    v_mfma_f32_16x16x32_bf16 v[104:107], v[68:71], a[216:219], v[104:107]
    ds_read_b64_tr_b16 v[94:95], v27 offset:20992
    v_mfma_f32_16x16x32_bf16 v[108:111], v[64:67], a[204:207], v[108:111]
    buffer_load_dwordx4 v10, s[36:39], s30 offen offset:2048 lds
    v_mfma_f32_16x16x32_bf16 v[108:111], v[68:71], a[220:223], v[108:111]
    s_waitcnt lgkmcnt(8)
    v_mfma_f32_16x16x32_bf16 v[112:115], v[72:75], a[192:195], v[112:115]
    ds_read_b64_tr_b16 v[64:65], v20 offset:32768
    v_mfma_f32_16x16x32_bf16 v[112:115], v[76:79], a[208:211], v[112:115]
    ds_read_b64_tr_b16 v[66:67], v20 offset:33280
    s_add_u32 s31, s18, 8192
    v_mfma_f32_16x16x32_bf16 v[116:119], v[72:75], a[196:199], v[116:119]
    buffer_load_dwordx4 v[224:227], v32, s[68:71], s31 offen sc1
    v_mfma_f32_16x16x32_bf16 v[116:119], v[76:79], a[212:215], v[116:119]
    v_mfma_f32_16x16x32_bf16 v[120:123], v[72:75], a[200:203], v[120:123]
    ds_read_b64_tr_b16 v[68:69], v20 offset:36864
    v_mfma_f32_16x16x32_bf16 v[120:123], v[76:79], a[216:219], v[120:123]
    ds_read_b64_tr_b16 v[70:71], v20 offset:37376
    v_mfma_f32_16x16x32_bf16 v[124:127], v[72:75], a[204:207], v[124:127]
    buffer_load_dwordx4 v11, s[36:39], s30 offen offset:3072 lds
    v_mfma_f32_16x16x32_bf16 v[124:127], v[76:79], a[220:223], v[124:127]
    s_waitcnt lgkmcnt(8)
    v_mfma_f32_16x16x32_bf16 v[160:163], v[80:83], a[192:195], v[160:163]
    ds_read_b64_tr_b16 v[72:73], v21 offset:32768
    v_mfma_f32_16x16x32_bf16 v[160:163], v[84:87], a[208:211], v[160:163]
    ds_read_b64_tr_b16 v[74:75], v21 offset:33280
    v_mfma_f32_16x16x32_bf16 v[164:167], v[80:83], a[196:199], v[164:167]
    buffer_load_dwordx4 v[228:231], v33, s[68:71], s31 offen sc1
    v_mfma_f32_16x16x32_bf16 v[164:167], v[84:87], a[212:215], v[164:167]
    v_mfma_f32_16x16x32_bf16 v[168:171], v[80:83], a[200:203], v[168:171]
    ds_read_b64_tr_b16 v[76:77], v21 offset:36864
    v_mfma_f32_16x16x32_bf16 v[168:171], v[84:87], a[216:219], v[168:171]
    ds_read_b64_tr_b16 v[78:79], v21 offset:37376
    s_add_u32 m0, s28, 32768
    s_add_u32 s30, s94, 256
    v_mfma_f32_16x16x32_bf16 v[172:175], v[80:83], a[204:207], v[172:175]
    buffer_load_dwordx4 v8, s[36:39], s30 offen offset:0 lds
    v_mfma_f32_16x16x32_bf16 v[172:175], v[84:87], a[220:223], v[172:175]
    s_waitcnt lgkmcnt(8)
    v_mfma_f32_16x16x32_bf16 v[176:179], v[88:91], a[192:195], v[176:179]
    ds_read_b64_tr_b16 v[80:81], v22 offset:32768
    v_mfma_f32_16x16x32_bf16 v[176:179], v[92:95], a[208:211], v[176:179]
    ds_read_b64_tr_b16 v[82:83], v22 offset:33280
    s_add_u32 s31, s21, 8192
    v_mfma_f32_16x16x32_bf16 v[180:183], v[88:91], a[196:199], v[180:183]
    buffer_load_dwordx4 v[232:235], v32, s[68:71], s31 offen sc1
    v_mfma_f32_16x16x32_bf16 v[180:183], v[92:95], a[212:215], v[180:183]
    v_mfma_f32_16x16x32_bf16 v[184:187], v[88:91], a[200:203], v[184:187]
    ds_read_b64_tr_b16 v[84:85], v22 offset:36864
    v_mfma_f32_16x16x32_bf16 v[184:187], v[92:95], a[216:219], v[184:187]
    ds_read_b64_tr_b16 v[86:87], v22 offset:37376
    v_mfma_f32_16x16x32_bf16 v[188:191], v[88:91], a[204:207], v[188:191]
    buffer_load_dwordx4 v9, s[36:39], s30 offen offset:1024 lds
    v_mfma_f32_16x16x32_bf16 v[188:191], v[92:95], a[220:223], v[188:191]
    s_waitcnt lgkmcnt(8)
    v_mfma_f32_16x16x32_bf16 v[128:131], v[64:67], a[192:195], v[128:131]
    ds_read_b64_tr_b16 v[88:89], v23 offset:32768
    v_mfma_f32_16x16x32_bf16 v[128:131], v[68:71], a[208:211], v[128:131]
    ds_read_b64_tr_b16 v[90:91], v23 offset:33280
    v_mfma_f32_16x16x32_bf16 v[132:135], v[64:67], a[196:199], v[132:135]
    buffer_load_dwordx4 v[236:239], v33, s[68:71], s31 offen sc1
    v_mfma_f32_16x16x32_bf16 v[132:135], v[68:71], a[212:215], v[132:135]
    v_mfma_f32_16x16x32_bf16 v[136:139], v[64:67], a[200:203], v[136:139]
    ds_read_b64_tr_b16 v[92:93], v23 offset:36864
    v_mfma_f32_16x16x32_bf16 v[136:139], v[68:71], a[216:219], v[136:139]
    ds_read_b64_tr_b16 v[94:95], v23 offset:37376
    v_mfma_f32_16x16x32_bf16 v[140:143], v[64:67], a[204:207], v[140:143]
    buffer_load_dwordx4 v10, s[36:39], s30 offen offset:2048 lds
    v_mfma_f32_16x16x32_bf16 v[140:143], v[68:71], a[220:223], v[140:143]
    s_waitcnt vmcnt(22)
    s_barrier
    s_waitcnt lgkmcnt(8)
    v_mfma_f32_16x16x32_bf16 v[144:147], v[72:75], a[192:195], v[144:147]
    ds_read_b64_tr_b16 v[64:65], v20 offset:49152
    v_mfma_f32_16x16x32_bf16 v[144:147], v[76:79], a[208:211], v[144:147]
    ds_read_b64_tr_b16 v[66:67], v20 offset:49664
    s_add_u32 s31, s18, 10240
    v_mfma_f32_16x16x32_bf16 v[148:151], v[72:75], a[196:199], v[148:151]
    buffer_load_dwordx4 v[240:243], v32, s[68:71], s31 offen sc1
    v_mfma_f32_16x16x32_bf16 v[148:151], v[76:79], a[212:215], v[148:151]
    v_mfma_f32_16x16x32_bf16 v[152:155], v[72:75], a[200:203], v[152:155]
    ds_read_b64_tr_b16 v[68:69], v20 offset:53248
    v_mfma_f32_16x16x32_bf16 v[152:155], v[76:79], a[216:219], v[152:155]
    ds_read_b64_tr_b16 v[70:71], v20 offset:53760
    v_mfma_f32_16x16x32_bf16 v[156:159], v[72:75], a[204:207], v[156:159]
    buffer_load_dwordx4 v11, s[36:39], s30 offen offset:3072 lds
    v_mfma_f32_16x16x32_bf16 v[156:159], v[76:79], a[220:223], v[156:159]
    s_waitcnt lgkmcnt(8)
    v_mfma_f32_16x16x32_bf16 v[192:195], v[80:83], a[192:195], v[192:195]
    ds_read_b64_tr_b16 v[72:73], v21 offset:49152
    v_mfma_f32_16x16x32_bf16 v[192:195], v[84:87], a[208:211], v[192:195]
    ds_read_b64_tr_b16 v[74:75], v21 offset:49664
    v_mfma_f32_16x16x32_bf16 v[196:199], v[80:83], a[196:199], v[196:199]
    buffer_load_dwordx4 v[244:247], v33, s[68:71], s31 offen sc1
    v_mfma_f32_16x16x32_bf16 v[196:199], v[84:87], a[212:215], v[196:199]
    v_mfma_f32_16x16x32_bf16 v[200:203], v[80:83], a[200:203], v[200:203]
    ds_read_b64_tr_b16 v[76:77], v21 offset:53248
    v_mfma_f32_16x16x32_bf16 v[200:203], v[84:87], a[216:219], v[200:203]
    ds_read_b64_tr_b16 v[78:79], v21 offset:53760
    s_add_u32 m0, s28, 49152
    s_add_u32 s30, s95, 256
    v_mfma_f32_16x16x32_bf16 v[204:207], v[80:83], a[204:207], v[204:207]
    buffer_load_dwordx4 v8, s[36:39], s30 offen offset:0 lds
    v_mfma_f32_16x16x32_bf16 v[204:207], v[84:87], a[220:223], v[204:207]
    s_waitcnt lgkmcnt(8)
    v_mfma_f32_16x16x32_bf16 v[208:211], v[88:91], a[192:195], v[208:211]
    ds_read_b64_tr_b16 v[80:81], v22 offset:49152
    v_mfma_f32_16x16x32_bf16 v[208:211], v[92:95], a[208:211], v[208:211]
    ds_read_b64_tr_b16 v[82:83], v22 offset:49664
    s_add_u32 s31, s21, 10240
    v_mfma_f32_16x16x32_bf16 v[212:215], v[88:91], a[196:199], v[212:215]
    buffer_load_dwordx4 v[248:251], v32, s[68:71], s31 offen sc1
    v_mfma_f32_16x16x32_bf16 v[212:215], v[92:95], a[212:215], v[212:215]
    v_mfma_f32_16x16x32_bf16 v[216:219], v[88:91], a[200:203], v[216:219]
    ds_read_b64_tr_b16 v[84:85], v22 offset:53248
    v_mfma_f32_16x16x32_bf16 v[216:219], v[92:95], a[216:219], v[216:219]
    ds_read_b64_tr_b16 v[86:87], v22 offset:53760
    v_mfma_f32_16x16x32_bf16 v[220:223], v[88:91], a[204:207], v[220:223]
    buffer_load_dwordx4 v9, s[36:39], s30 offen offset:1024 lds
    v_mfma_f32_16x16x32_bf16 v[220:223], v[92:95], a[220:223], v[220:223]
    s_waitcnt vmcnt(15) lgkmcnt(8)
    v_mfma_f32_16x16x32_bf16 v[96:99], v[64:67], a[224:227], v[96:99]
    ds_read_b64_tr_b16 v[88:89], v23 offset:49152
    v_mfma_f32_16x16x32_bf16 v[96:99], v[68:71], a[240:243], v[96:99]
    ds_read_b64_tr_b16 v[90:91], v23 offset:49664
    v_mfma_f32_16x16x32_bf16 v[100:103], v[64:67], a[228:231], v[100:103]
    buffer_load_dwordx4 v[252:255], v33, s[68:71], s31 offen sc1
    v_mfma_f32_16x16x32_bf16 v[100:103], v[68:71], a[244:247], v[100:103]
    v_mfma_f32_16x16x32_bf16 v[104:107], v[64:67], a[232:235], v[104:107]
    ds_read_b64_tr_b16 v[92:93], v23 offset:53248
    v_mfma_f32_16x16x32_bf16 v[104:107], v[68:71], a[248:251], v[104:107]
    ds_read_b64_tr_b16 v[94:95], v23 offset:53760
    v_mfma_f32_16x16x32_bf16 v[108:111], v[64:67], a[236:239], v[108:111]
    buffer_load_dwordx4 v10, s[36:39], s30 offen offset:2048 lds
    v_mfma_f32_16x16x32_bf16 v[108:111], v[68:71], a[252:255], v[108:111]
    s_waitcnt lgkmcnt(8)
    v_mfma_f32_16x16x32_bf16 v[112:115], v[72:75], a[224:227], v[112:115]
    ds_read_b64_tr_b16 v[64:65], v24 offset:0
    v_mfma_f32_16x16x32_bf16 v[112:115], v[76:79], a[240:243], v[112:115]
    ds_read_b64_tr_b16 v[66:67], v24 offset:512
    v_mfma_f32_16x16x32_bf16 v[116:119], v[72:75], a[228:231], v[116:119]
    buffer_load_dwordx4 v11, s[36:39], s30 offen offset:3072 lds
    v_mfma_f32_16x16x32_bf16 v[116:119], v[76:79], a[244:247], v[116:119]
    v_mfma_f32_16x16x32_bf16 v[120:123], v[72:75], a[232:235], v[120:123]
    ds_read_b64_tr_b16 v[68:69], v24 offset:4096
    v_mfma_f32_16x16x32_bf16 v[120:123], v[76:79], a[248:251], v[120:123]
    ds_read_b64_tr_b16 v[70:71], v24 offset:4608
    s_add_u32 m0, s28, 65536
    s_add_u32 s30, s96, 256
    v_mfma_f32_16x16x32_bf16 v[124:127], v[72:75], a[236:239], v[124:127]
    buffer_load_dwordx4 v8, s[36:39], s30 offen offset:0 lds
    v_mfma_f32_16x16x32_bf16 v[124:127], v[76:79], a[252:255], v[124:127]
    s_waitcnt lgkmcnt(8)
    v_mfma_f32_16x16x32_bf16 v[160:163], v[80:83], a[224:227], v[160:163]
    ds_read_b64_tr_b16 v[72:73], v25 offset:0
    v_mfma_f32_16x16x32_bf16 v[160:163], v[84:87], a[240:243], v[160:163]
    ds_read_b64_tr_b16 v[74:75], v25 offset:512
    v_mfma_f32_16x16x32_bf16 v[164:167], v[80:83], a[228:231], v[164:167]
    buffer_load_dwordx4 v9, s[36:39], s30 offen offset:1024 lds
    v_mfma_f32_16x16x32_bf16 v[164:167], v[84:87], a[244:247], v[164:167]
    v_mfma_f32_16x16x32_bf16 v[168:171], v[80:83], a[232:235], v[168:171]
    ds_read_b64_tr_b16 v[76:77], v25 offset:4096
    v_mfma_f32_16x16x32_bf16 v[168:171], v[84:87], a[248:251], v[168:171]
    ds_read_b64_tr_b16 v[78:79], v25 offset:4608
    v_mfma_f32_16x16x32_bf16 v[172:175], v[80:83], a[236:239], v[172:175]
    buffer_load_dwordx4 v10, s[36:39], s30 offen offset:2048 lds
    v_mfma_f32_16x16x32_bf16 v[172:175], v[84:87], a[252:255], v[172:175]
    s_waitcnt lgkmcnt(8)
    v_mfma_f32_16x16x32_bf16 v[176:179], v[88:91], a[224:227], v[176:179]
    ds_read_b64_tr_b16 v[80:81], v26 offset:0
    v_mfma_f32_16x16x32_bf16 v[176:179], v[92:95], a[240:243], v[176:179]
    ds_read_b64_tr_b16 v[82:83], v26 offset:512
    v_mfma_f32_16x16x32_bf16 v[180:183], v[88:91], a[228:231], v[180:183]
    buffer_load_dwordx4 v11, s[36:39], s30 offen offset:3072 lds
    v_mfma_f32_16x16x32_bf16 v[180:183], v[92:95], a[244:247], v[180:183]
    v_mfma_f32_16x16x32_bf16 v[184:187], v[88:91], a[232:235], v[184:187]
    ds_read_b64_tr_b16 v[84:85], v26 offset:4096
    v_mfma_f32_16x16x32_bf16 v[184:187], v[92:95], a[248:251], v[184:187]
    ds_read_b64_tr_b16 v[86:87], v26 offset:4608
    s_add_u32 m0, s28, 147456
    s_add_u32 s30, s94, 73984
    v_mfma_f32_16x16x32_bf16 v[188:191], v[88:91], a[236:239], v[188:191]
    buffer_load_dwordx4 v8, s[36:39], s30 offen offset:0 lds
    v_mfma_f32_16x16x32_bf16 v[188:191], v[92:95], a[252:255], v[188:191]
    s_waitcnt lgkmcnt(8)
    v_mfma_f32_16x16x32_bf16 v[128:131], v[64:67], a[224:227], v[128:131]
    ds_read_b64_tr_b16 v[88:89], v27 offset:0
    v_mfma_f32_16x16x32_bf16 v[128:131], v[68:71], a[240:243], v[128:131]
    ds_read_b64_tr_b16 v[90:91], v27 offset:512
    v_mfma_f32_16x16x32_bf16 v[132:135], v[64:67], a[228:231], v[132:135]
    buffer_load_dwordx4 v9, s[36:39], s30 offen offset:1024 lds
    v_mfma_f32_16x16x32_bf16 v[132:135], v[68:71], a[244:247], v[132:135]
    v_mfma_f32_16x16x32_bf16 v[136:139], v[64:67], a[232:235], v[136:139]
    ds_read_b64_tr_b16 v[92:93], v27 offset:4096
    v_mfma_f32_16x16x32_bf16 v[136:139], v[68:71], a[248:251], v[136:139]
    ds_read_b64_tr_b16 v[94:95], v27 offset:4608
    v_mfma_f32_16x16x32_bf16 v[140:143], v[64:67], a[236:239], v[140:143]
    buffer_load_dwordx4 v10, s[36:39], s30 offen offset:2048 lds
    v_mfma_f32_16x16x32_bf16 v[140:143], v[68:71], a[252:255], v[140:143]
    s_waitcnt vmcnt(22)
    s_barrier
    s_waitcnt lgkmcnt(8)
    v_mfma_f32_16x16x32_bf16 v[144:147], v[72:75], a[224:227], v[144:147]
    ds_read_b64_tr_b16 v[64:65], v16 offset:0
    v_mfma_f32_16x16x32_bf16 v[144:147], v[76:79], a[240:243], v[144:147]
    ds_read_b64_tr_b16 v[66:67], v16 offset:512
    v_mfma_f32_16x16x32_bf16 v[148:151], v[72:75], a[228:231], v[148:151]
    buffer_load_dwordx4 v11, s[36:39], s30 offen offset:3072 lds
    v_mfma_f32_16x16x32_bf16 v[148:151], v[76:79], a[244:247], v[148:151]
    v_mfma_f32_16x16x32_bf16 v[152:155], v[72:75], a[232:235], v[152:155]
    ds_read_b64_tr_b16 v[68:69], v16 offset:4096
    v_mfma_f32_16x16x32_bf16 v[152:155], v[76:79], a[248:251], v[152:155]
    ds_read_b64_tr_b16 v[70:71], v16 offset:4608
    v_mfma_f32_16x16x32_bf16 v[156:159], v[72:75], a[236:239], v[156:159]
    v_mfma_f32_16x16x32_bf16 v[156:159], v[76:79], a[252:255], v[156:159]
    s_waitcnt lgkmcnt(8)
    v_mfma_f32_16x16x32_bf16 v[192:195], v[80:83], a[224:227], v[192:195]
    ds_read_b64_tr_b16 v[72:73], v17 offset:0
    v_mfma_f32_16x16x32_bf16 v[192:195], v[84:87], a[240:243], v[192:195]
    ds_read_b64_tr_b16 v[74:75], v17 offset:512
    v_mfma_f32_16x16x32_bf16 v[196:199], v[80:83], a[228:231], v[196:199]
    v_mfma_f32_16x16x32_bf16 v[196:199], v[84:87], a[244:247], v[196:199]
    v_mfma_f32_16x16x32_bf16 v[200:203], v[80:83], a[232:235], v[200:203]
    ds_read_b64_tr_b16 v[76:77], v17 offset:4096
    v_mfma_f32_16x16x32_bf16 v[200:203], v[84:87], a[248:251], v[200:203]
    ds_read_b64_tr_b16 v[78:79], v17 offset:4608
    v_mfma_f32_16x16x32_bf16 v[204:207], v[80:83], a[236:239], v[204:207]
    v_mfma_f32_16x16x32_bf16 v[204:207], v[84:87], a[252:255], v[204:207]
    s_waitcnt lgkmcnt(8)
    v_mfma_f32_16x16x32_bf16 v[208:211], v[88:91], a[224:227], v[208:211]
    ds_read_b64_tr_b16 v[80:81], v18 offset:0
    v_mfma_f32_16x16x32_bf16 v[208:211], v[92:95], a[240:243], v[208:211]
    ds_read_b64_tr_b16 v[82:83], v18 offset:512
    v_mfma_f32_16x16x32_bf16 v[212:215], v[88:91], a[228:231], v[212:215]
    v_mfma_f32_16x16x32_bf16 v[212:215], v[92:95], a[244:247], v[212:215]
    v_mfma_f32_16x16x32_bf16 v[216:219], v[88:91], a[232:235], v[216:219]
    ds_read_b64_tr_b16 v[84:85], v18 offset:4096
    v_mfma_f32_16x16x32_bf16 v[216:219], v[92:95], a[248:251], v[216:219]
    ds_read_b64_tr_b16 v[86:87], v18 offset:4608
    v_mfma_f32_16x16x32_bf16 v[220:223], v[88:91], a[236:239], v[220:223]
    v_mfma_f32_16x16x32_bf16 v[220:223], v[92:95], a[252:255], v[220:223]
    s_waitcnt vmcnt(10) lgkmcnt(8)
    v_mfma_f32_16x16x32_bf16 v[96:99], v[64:67], v[224:227], v[96:99]
    ds_read_b64_tr_b16 v[88:89], v19 offset:0
    v_mfma_f32_16x16x32_bf16 v[96:99], v[68:71], v[240:243], v[96:99]
    ds_read_b64_tr_b16 v[90:91], v19 offset:512
    v_mfma_f32_16x16x32_bf16 v[100:103], v[64:67], v[228:231], v[100:103]
    v_mfma_f32_16x16x32_bf16 v[100:103], v[68:71], v[244:247], v[100:103]
    v_mfma_f32_16x16x32_bf16 v[104:107], v[64:67], v[232:235], v[104:107]
    ds_read_b64_tr_b16 v[92:93], v19 offset:4096
    v_mfma_f32_16x16x32_bf16 v[104:107], v[68:71], v[248:251], v[104:107]
    ds_read_b64_tr_b16 v[94:95], v19 offset:4608
    v_mfma_f32_16x16x32_bf16 v[108:111], v[64:67], v[236:239], v[108:111]
    v_mfma_f32_16x16x32_bf16 v[108:111], v[68:71], v[252:255], v[108:111]
    s_waitcnt lgkmcnt(8)
    v_mfma_f32_16x16x32_bf16 v[112:115], v[72:75], v[224:227], v[112:115]
    ds_read_b64_tr_b16 v[64:65], v16 offset:16384
    v_mfma_f32_16x16x32_bf16 v[112:115], v[76:79], v[240:243], v[112:115]
    ds_read_b64_tr_b16 v[66:67], v16 offset:16896
    v_mfma_f32_16x16x32_bf16 v[116:119], v[72:75], v[228:231], v[116:119]
    v_mfma_f32_16x16x32_bf16 v[116:119], v[76:79], v[244:247], v[116:119]
    v_mfma_f32_16x16x32_bf16 v[120:123], v[72:75], v[232:235], v[120:123]
    ds_read_b64_tr_b16 v[68:69], v16 offset:20480
    v_mfma_f32_16x16x32_bf16 v[120:123], v[76:79], v[248:251], v[120:123]
    ds_read_b64_tr_b16 v[70:71], v16 offset:20992
    v_mfma_f32_16x16x32_bf16 v[124:127], v[72:75], v[236:239], v[124:127]
    v_mfma_f32_16x16x32_bf16 v[124:127], v[76:79], v[252:255], v[124:127]
    s_waitcnt lgkmcnt(8)
    v_mfma_f32_16x16x32_bf16 v[160:163], v[80:83], v[224:227], v[160:163]
    ds_read_b64_tr_b16 v[72:73], v17 offset:16384
    v_mfma_f32_16x16x32_bf16 v[160:163], v[84:87], v[240:243], v[160:163]
    ds_read_b64_tr_b16 v[74:75], v17 offset:16896
    v_mfma_f32_16x16x32_bf16 v[164:167], v[80:83], v[228:231], v[164:167]
    ds_write_b128 v28, v[104:107] offset:0
    ds_write_b128 v28, v[108:111] offset:1024
    v_mfma_f32_16x16x32_bf16 v[164:167], v[84:87], v[244:247], v[164:167]
    ds_write_b128 v28, v[120:123] offset:2048
    ds_write_b128 v28, v[124:127] offset:3072
    v_mfma_f32_16x16x32_bf16 v[168:171], v[80:83], v[232:235], v[168:171]
    ds_read_b64_tr_b16 v[76:77], v17 offset:20480
    v_mfma_f32_16x16x32_bf16 v[168:171], v[84:87], v[248:251], v[168:171]
    ds_read_b64_tr_b16 v[78:79], v17 offset:20992
    v_mfma_f32_16x16x32_bf16 v[172:175], v[80:83], v[236:239], v[172:175]
    v_mfma_f32_16x16x32_bf16 v[172:175], v[84:87], v[252:255], v[172:175]
    s_waitcnt lgkmcnt(12)
    v_mfma_f32_16x16x32_bf16 v[176:179], v[88:91], v[224:227], v[176:179]
    ds_read_b64_tr_b16 v[80:81], v18 offset:16384
    v_mfma_f32_16x16x32_bf16 v[176:179], v[92:95], v[240:243], v[176:179]
    ds_read_b64_tr_b16 v[82:83], v18 offset:16896
    v_mfma_f32_16x16x32_bf16 v[180:183], v[88:91], v[228:231], v[180:183]
    v_mfma_f32_16x16x32_bf16 v[180:183], v[92:95], v[244:247], v[180:183]
    v_mfma_f32_16x16x32_bf16 v[184:187], v[88:91], v[232:235], v[184:187]
    ds_read_b64_tr_b16 v[84:85], v18 offset:20480
    v_mfma_f32_16x16x32_bf16 v[184:187], v[92:95], v[248:251], v[184:187]
    ds_read_b64_tr_b16 v[86:87], v18 offset:20992
    v_mfma_f32_16x16x32_bf16 v[188:191], v[88:91], v[236:239], v[188:191]
    v_mfma_f32_16x16x32_bf16 v[188:191], v[92:95], v[252:255], v[188:191]
    s_waitcnt lgkmcnt(12)
    v_mfma_f32_16x16x32_bf16 v[128:131], v[64:67], v[224:227], v[128:131]
    ds_read_b64_tr_b16 v[88:89], v19 offset:16384
    v_mfma_f32_16x16x32_bf16 v[128:131], v[68:71], v[240:243], v[128:131]
    ds_read_b64_tr_b16 v[90:91], v19 offset:16896
    v_mfma_f32_16x16x32_bf16 v[132:135], v[64:67], v[228:231], v[132:135]
    ds_write_b128 v28, v[168:171] offset:4096
    ds_write_b128 v28, v[172:175] offset:5120
    v_mfma_f32_16x16x32_bf16 v[132:135], v[68:71], v[244:247], v[132:135]
    ds_write_b128 v28, v[184:187] offset:6144
    ds_write_b128 v28, v[188:191] offset:7168
    v_mfma_f32_16x16x32_bf16 v[136:139], v[64:67], v[232:235], v[136:139]
    ds_read_b64_tr_b16 v[92:93], v19 offset:20480
    v_mfma_f32_16x16x32_bf16 v[136:139], v[68:71], v[248:251], v[136:139]
    ds_read_b64_tr_b16 v[94:95], v19 offset:20992
    v_mfma_f32_16x16x32_bf16 v[140:143], v[64:67], v[236:239], v[140:143]
    v_mfma_f32_16x16x32_bf16 v[140:143], v[68:71], v[252:255], v[140:143]
    s_waitcnt vmcnt(8)
    s_barrier
    s_waitcnt lgkmcnt(12)
    v_mfma_f32_16x16x32_bf16 v[144:147], v[72:75], v[224:227], v[144:147]
    ds_read_b64_tr_b16 v[64:65], v16 offset:32768
    v_mfma_f32_16x16x32_bf16 v[144:147], v[76:79], v[240:243], v[144:147]
    ds_read_b64_tr_b16 v[66:67], v16 offset:33280
    v_mfma_f32_16x16x32_bf16 v[148:151], v[72:75], v[228:231], v[148:151]
    v_mfma_f32_16x16x32_bf16 v[148:151], v[76:79], v[244:247], v[148:151]
    v_mfma_f32_16x16x32_bf16 v[152:155], v[72:75], v[232:235], v[152:155]
    ds_read_b64_tr_b16 v[68:69], v16 offset:36864
    v_mfma_f32_16x16x32_bf16 v[152:155], v[76:79], v[248:251], v[152:155]
    ds_read_b64_tr_b16 v[70:71], v16 offset:37376
    v_mfma_f32_16x16x32_bf16 v[156:159], v[72:75], v[236:239], v[156:159]
    v_mfma_f32_16x16x32_bf16 v[156:159], v[76:79], v[252:255], v[156:159]
    s_waitcnt lgkmcnt(12)
    v_mfma_f32_16x16x32_bf16 v[192:195], v[80:83], v[224:227], v[192:195]
    ds_read_b64_tr_b16 v[72:73], v17 offset:32768
    v_mfma_f32_16x16x32_bf16 v[192:195], v[84:87], v[240:243], v[192:195]
    ds_read_b64_tr_b16 v[74:75], v17 offset:33280
    v_mfma_f32_16x16x32_bf16 v[196:199], v[80:83], v[228:231], v[196:199]
    ds_write_b128 v28, v[136:139] offset:8192
    ds_write_b128 v28, v[140:143] offset:9216
    v_mfma_f32_16x16x32_bf16 v[196:199], v[84:87], v[244:247], v[196:199]
    ds_write_b128 v28, v[152:155] offset:10240
    ds_write_b128 v28, v[156:159] offset:11264
    v_mfma_f32_16x16x32_bf16 v[200:203], v[80:83], v[232:235], v[200:203]
    ds_read_b64_tr_b16 v[76:77], v17 offset:36864
    v_mfma_f32_16x16x32_bf16 v[200:203], v[84:87], v[248:251], v[200:203]
    ds_read_b64_tr_b16 v[78:79], v17 offset:37376
    v_mfma_f32_16x16x32_bf16 v[204:207], v[80:83], v[236:239], v[204:207]
    v_mfma_f32_16x16x32_bf16 v[204:207], v[84:87], v[252:255], v[204:207]
    s_waitcnt lgkmcnt(12)
    v_mfma_f32_16x16x32_bf16 v[208:211], v[88:91], v[224:227], v[208:211]
    ds_read_b64_tr_b16 v[80:81], v18 offset:32768
    v_mfma_f32_16x16x32_bf16 v[208:211], v[92:95], v[240:243], v[208:211]
    ds_read_b64_tr_b16 v[82:83], v18 offset:33280
    v_mfma_f32_16x16x32_bf16 v[212:215], v[88:91], v[228:231], v[212:215]
    v_mfma_f32_16x16x32_bf16 v[212:215], v[92:95], v[244:247], v[212:215]
    v_mfma_f32_16x16x32_bf16 v[216:219], v[88:91], v[232:235], v[216:219]
    ds_read_b64_tr_b16 v[84:85], v18 offset:36864
    v_mfma_f32_16x16x32_bf16 v[216:219], v[92:95], v[248:251], v[216:219]
    ds_read_b64_tr_b16 v[86:87], v18 offset:37376
    s_add_u32 m0, s28, 0
    s_add_u32 s30, s95, 73984
    v_mfma_f32_16x16x32_bf16 v[220:223], v[88:91], v[236:239], v[220:223]
    buffer_load_dwordx4 v8, s[36:39], s30 offen offset:0 lds
    v_mfma_f32_16x16x32_bf16 v[220:223], v[92:95], v[252:255], v[220:223]
    s_waitcnt lgkmcnt(12)
    v_mfma_f32_16x16x32_bf16 v[104:107], v[64:67], a[0:3], 0
    ds_read_b64_tr_b16 v[88:89], v19 offset:32768
    v_mfma_f32_16x16x32_bf16 v[104:107], v[68:71], a[16:19], v[104:107]
    ds_read_b64_tr_b16 v[90:91], v19 offset:33280
    v_mfma_f32_16x16x32_bf16 v[108:111], v[64:67], a[4:7], 0
    buffer_load_dwordx4 v9, s[36:39], s30 offen offset:1024 lds
    v_mfma_f32_16x16x32_bf16 v[108:111], v[68:71], a[20:23], v[108:111]
    ds_write_b128 v28, v[200:203] offset:12288
    ds_write_b128 v28, v[204:207] offset:13312
    v_mfma_f32_16x16x32_bf16 v[120:123], v[64:67], a[8:11], 0
    ds_read_b64_tr_b16 v[92:93], v19 offset:36864
    ds_write_b128 v28, v[216:219] offset:14336
    v_mfma_f32_16x16x32_bf16 v[120:123], v[68:71], a[24:27], v[120:123]
    ds_read_b64_tr_b16 v[94:95], v19 offset:37376
    ds_write_b128 v28, v[220:223] offset:15360
    v_mfma_f32_16x16x32_bf16 v[124:127], v[64:67], a[12:15], 0
    buffer_load_dwordx4 v10, s[36:39], s30 offen offset:2048 lds
    v_mfma_f32_16x16x32_bf16 v[124:127], v[68:71], a[28:31], v[124:127]
    s_waitcnt lgkmcnt(12)
    v_mfma_f32_16x16x32_bf16 v[168:171], v[72:75], a[0:3], 0
    ds_read_b64_tr_b16 v[64:65], v16 offset:49152
    v_mfma_f32_16x16x32_bf16 v[168:171], v[76:79], a[16:19], v[168:171]
    ds_read_b64_tr_b16 v[66:67], v16 offset:49664
    v_mfma_f32_16x16x32_bf16 v[172:175], v[72:75], a[4:7], 0
    buffer_load_dwordx4 v11, s[36:39], s30 offen offset:3072 lds
    v_mfma_f32_16x16x32_bf16 v[172:175], v[76:79], a[20:23], v[172:175]
    v_mfma_f32_16x16x32_bf16 v[184:187], v[72:75], a[8:11], 0
    ds_read_b64_tr_b16 v[68:69], v16 offset:53248
    v_mfma_f32_16x16x32_bf16 v[184:187], v[76:79], a[24:27], v[184:187]
    ds_read_b64_tr_b16 v[70:71], v16 offset:53760
    s_add_u32 m0, s28, 16384
    s_add_u32 s30, s96, 73984
    v_mfma_f32_16x16x32_bf16 v[188:191], v[72:75], a[12:15], 0
    buffer_load_dwordx4 v8, s[36:39], s30 offen offset:0 lds
    v_mfma_f32_16x16x32_bf16 v[188:191], v[76:79], a[28:31], v[188:191]
    s_waitcnt lgkmcnt(12)
    v_mfma_f32_16x16x32_bf16 v[136:139], v[80:83], a[0:3], 0
    ds_read_b64_tr_b16 v[72:73], v17 offset:49152
    v_mfma_f32_16x16x32_bf16 v[136:139], v[84:87], a[16:19], v[136:139]
    ds_read_b64_tr_b16 v[74:75], v17 offset:49664
    v_mfma_f32_16x16x32_bf16 v[140:143], v[80:83], a[4:7], 0
    buffer_load_dwordx4 v9, s[36:39], s30 offen offset:1024 lds
    v_mfma_f32_16x16x32_bf16 v[140:143], v[84:87], a[20:23], v[140:143]
    s_waitcnt lgkmcnt(6)
    s_barrier
    v_mfma_f32_16x16x32_bf16 v[152:155], v[80:83], a[8:11], 0
    ds_read_b64_tr_b16 v[76:77], v17 offset:53248
    ds_read_b128 v[48:51], v29 offset:4096
    v_mfma_f32_16x16x32_bf16 v[152:155], v[84:87], a[24:27], v[152:155]
    ds_read_b64_tr_b16 v[78:79], v17 offset:53760
    ds_read_b128 v[52:55], v29 offset:6144
    v_mfma_f32_16x16x32_bf16 v[156:159], v[80:83], a[12:15], 0
    buffer_load_dwordx4 v10, s[36:39], s30 offen offset:2048 lds
    v_mfma_f32_16x16x32_bf16 v[156:159], v[84:87], a[28:31], v[156:159]
    ds_read_b128 v[56:59], v29 offset:5120
    s_waitcnt lgkmcnt(11)
    v_mfma_f32_16x16x32_bf16 v[200:203], v[88:91], a[0:3], 0
    ds_read_b64_tr_b16 v[80:81], v18 offset:49152
    v_mfma_f32_16x16x32_bf16 v[200:203], v[92:95], a[16:19], v[200:203]
    ds_read_b64_tr_b16 v[82:83], v18 offset:49664
    v_mfma_f32_16x16x32_bf16 v[204:207], v[88:91], a[4:7], 0
    buffer_load_dwordx4 v11, s[36:39], s30 offen offset:3072 lds
    v_mfma_f32_16x16x32_bf16 v[204:207], v[92:95], a[20:23], v[204:207]
    s_waitcnt lgkmcnt(5)
    v_mfma_f32_16x16x32_bf16 v[216:219], v[88:91], a[8:11], 0
    ds_read_b64_tr_b16 v[84:85], v18 offset:53248
    v_add_f32 v160, v160, v48
    v_mfma_f32_16x16x32_bf16 v[216:219], v[92:95], a[24:27], v[216:219]
    ds_read_b64_tr_b16 v[86:87], v18 offset:53760
    v_add_f32 v161, v161, v49
    v_mfma_f32_16x16x32_bf16 v[220:223], v[88:91], a[12:15], 0
    v_add_f32 v162, v162, v50
    v_add_f32 v163, v163, v51
    v_mfma_f32_16x16x32_bf16 v[220:223], v[92:95], a[28:31], v[220:223]
    ds_read_b128 v[48:51], v29 offset:7168
    s_waitcnt lgkmcnt(6)
    s_waitcnt lgkmcnt(12)
    v_mfma_f32_16x16x32_bf16 v[104:107], v[64:67], a[32:35], v[104:107]
    ds_read_b64_tr_b16 v[88:89], v19 offset:49152
    v_add_f32 v176, v176, v52
    v_mfma_f32_16x16x32_bf16 v[104:107], v[68:71], a[48:51], v[104:107]
    ds_read_b64_tr_b16 v[90:91], v19 offset:49664
    v_add_f32 v177, v177, v53
    v_mfma_f32_16x16x32_bf16 v[108:111], v[64:67], a[36:39], v[108:111]
    v_add_f32 v178, v178, v54
    v_add_f32 v179, v179, v55
    v_mfma_f32_16x16x32_bf16 v[108:111], v[68:71], a[52:55], v[108:111]
    ds_read_b128 v[52:55], v29 offset:8192
    v_cvt_pk_bf16_f32 v160, v160, v161
    v_mfma_f32_16x16x32_bf16 v[120:123], v[64:67], a[40:43], v[120:123]
    ds_read_b64_tr_b16 v[92:93], v19 offset:53248
    v_cvt_pk_bf16_f32 v161, v162, v163
    v_mfma_f32_16x16x32_bf16 v[120:123], v[68:71], a[56:59], v[120:123]
    ds_read_b64_tr_b16 v[94:95], v19 offset:53760
    v_cvt_pk_bf16_f32 v162, v176, v177
    v_mfma_f32_16x16x32_bf16 v[124:127], v[64:67], a[44:47], v[124:127]
    v_cvt_pk_bf16_f32 v163, v178, v179
    buffer_store_dwordx4 v[160:163], v5, s[72:75], s64 offen offset:0 sc1
    v_mfma_f32_16x16x32_bf16 v[124:127], v[68:71], a[60:63], v[124:127]
    s_waitcnt lgkmcnt(10)
    v_add_f32 v164, v164, v56
    s_waitcnt vmcnt(9)
    s_barrier
    s_waitcnt lgkmcnt(12)
    v_mfma_f32_16x16x32_bf16 v[168:171], v[72:75], a[32:35], v[168:171]
    ds_read_b64_tr_b16 v[64:65], v20 offset:0
    v_add_f32 v165, v165, v57
    v_mfma_f32_16x16x32_bf16 v[168:171], v[76:79], a[48:51], v[168:171]
    ds_read_b64_tr_b16 v[66:67], v20 offset:512
    s_add_u32 m0, s28, 32768
    s_add_u32 s30, s94, 147712
    v_mfma_f32_16x16x32_bf16 v[172:175], v[72:75], a[36:39], v[172:175]
    buffer_load_dwordx4 v8, s[36:39], s30 offen offset:0 lds
    v_mfma_f32_16x16x32_bf16 v[172:175], v[76:79], a[52:55], v[172:175]
    v_add_f32 v166, v166, v58
    v_add_f32 v167, v167, v59
    v_mfma_f32_16x16x32_bf16 v[184:187], v[72:75], a[40:43], v[184:187]
    ds_read_b64_tr_b16 v[68:69], v20 offset:4096
    ds_read_b128 v[56:59], v29 offset:10240
    v_mfma_f32_16x16x32_bf16 v[184:187], v[76:79], a[56:59], v[184:187]
    ds_read_b64_tr_b16 v[70:71], v20 offset:4608
    s_waitcnt lgkmcnt(10)
    v_mfma_f32_16x16x32_bf16 v[188:191], v[72:75], a[44:47], v[188:191]
    buffer_load_dwordx4 v9, s[36:39], s30 offen offset:1024 lds
    v_mfma_f32_16x16x32_bf16 v[188:191], v[76:79], a[60:63], v[188:191]
    v_add_f32 v180, v180, v48
    v_add_f32 v181, v181, v49
    s_waitcnt lgkmcnt(11)
    v_mfma_f32_16x16x32_bf16 v[136:139], v[80:83], a[32:35], v[136:139]
    ds_read_b64_tr_b16 v[72:73], v21 offset:0
    v_add_f32 v182, v182, v50
    v_mfma_f32_16x16x32_bf16 v[136:139], v[84:87], a[48:51], v[136:139]
    ds_read_b64_tr_b16 v[74:75], v21 offset:512
    v_add_f32 v183, v183, v51
    v_mfma_f32_16x16x32_bf16 v[140:143], v[80:83], a[36:39], v[140:143]
    buffer_load_dwordx4 v10, s[36:39], s30 offen offset:2048 lds
    v_mfma_f32_16x16x32_bf16 v[140:143], v[84:87], a[52:55], v[140:143]
    ds_read_b128 v[48:51], v29 offset:9216
    v_cvt_pk_bf16_f32 v164, v164, v165
    v_mfma_f32_16x16x32_bf16 v[152:155], v[80:83], a[40:43], v[152:155]
    ds_read_b64_tr_b16 v[76:77], v21 offset:4096
    v_cvt_pk_bf16_f32 v165, v166, v167
    v_mfma_f32_16x16x32_bf16 v[152:155], v[84:87], a[56:59], v[152:155]
    ds_read_b64_tr_b16 v[78:79], v21 offset:4608
    v_cvt_pk_bf16_f32 v166, v180, v181
    v_mfma_f32_16x16x32_bf16 v[156:159], v[80:83], a[44:47], v[156:159]
    buffer_load_dwordx4 v11, s[36:39], s30 offen offset:3072 lds
    v_mfma_f32_16x16x32_bf16 v[156:159], v[84:87], a[60:63], v[156:159]
    v_cvt_pk_bf16_f32 v167, v182, v183
    buffer_store_dwordx4 v[164:167], v5, s[72:75], s64 offen offset:1024 sc1
    s_waitcnt lgkmcnt(10)
    v_mfma_f32_16x16x32_bf16 v[200:203], v[88:91], a[32:35], v[200:203]
    ds_read_b64_tr_b16 v[80:81], v22 offset:0
    s_waitcnt lgkmcnt(13)
    v_mfma_f32_16x16x32_bf16 v[200:203], v[92:95], a[48:51], v[200:203]
    ds_read_b64_tr_b16 v[82:83], v22 offset:512
    v_add_f32 v128, v128, v52
    v_mfma_f32_16x16x32_bf16 v[204:207], v[88:91], a[36:39], v[204:207]
    v_add_f32 v129, v129, v53
    v_add_f32 v130, v130, v54
    v_mfma_f32_16x16x32_bf16 v[204:207], v[92:95], a[52:55], v[204:207]
    v_add_f32 v131, v131, v55
    ds_read_b128 v[52:55], v29 offset:11264
    v_mfma_f32_16x16x32_bf16 v[216:219], v[88:91], a[40:43], v[216:219]
    ds_read_b64_tr_b16 v[84:85], v22 offset:4096
    s_waitcnt lgkmcnt(10)
    v_mfma_f32_16x16x32_bf16 v[216:219], v[92:95], a[56:59], v[216:219]
    ds_read_b64_tr_b16 v[86:87], v22 offset:4608
    s_add_u32 m0, s28, 49152
    s_add_u32 s30, s95, 147712
    v_mfma_f32_16x16x32_bf16 v[220:223], v[88:91], a[44:47], v[220:223]
    buffer_load_dwordx4 v8, s[36:39], s30 offen offset:0 lds
    v_mfma_f32_16x16x32_bf16 v[220:223], v[92:95], a[60:63], v[220:223]
    v_add_f32 v144, v144, v56
    v_add_f32 v145, v145, v57
    s_waitcnt lgkmcnt(10)
    v_mfma_f32_16x16x32_bf16 v[104:107], v[64:67], a[64:67], v[104:107]
    ds_read_b64_tr_b16 v[88:89], v23 offset:0
    v_add_f32 v146, v146, v58
    v_mfma_f32_16x16x32_bf16 v[104:107], v[68:71], a[80:83], v[104:107]
    ds_read_b64_tr_b16 v[90:91], v23 offset:512
    v_add_f32 v147, v147, v59
    v_mfma_f32_16x16x32_bf16 v[108:111], v[64:67], a[68:71], v[108:111]
    buffer_load_dwordx4 v9, s[36:39], s30 offen offset:1024 lds
    v_mfma_f32_16x16x32_bf16 v[108:111], v[68:71], a[84:87], v[108:111]
    ds_read_b128 v[56:59], v29 offset:12288
    v_cvt_pk_bf16_f32 v128, v128, v129
    v_mfma_f32_16x16x32_bf16 v[120:123], v[64:67], a[72:75], v[120:123]
    ds_read_b64_tr_b16 v[92:93], v23 offset:4096
    v_cvt_pk_bf16_f32 v129, v130, v131
    v_mfma_f32_16x16x32_bf16 v[120:123], v[68:71], a[88:91], v[120:123]
    ds_read_b64_tr_b16 v[94:95], v23 offset:4608
    v_cvt_pk_bf16_f32 v130, v144, v145
    v_mfma_f32_16x16x32_bf16 v[124:127], v[64:67], a[76:79], v[124:127]
    buffer_load_dwordx4 v10, s[36:39], s30 offen offset:2048 lds
    v_mfma_f32_16x16x32_bf16 v[124:127], v[68:71], a[92:95], v[124:127]
    v_cvt_pk_bf16_f32 v131, v146, v147
    buffer_store_dwordx4 v[128:131], v5, s[72:75], s65 offen offset:1024 sc1
    s_waitcnt lgkmcnt(10)
    v_mfma_f32_16x16x32_bf16 v[168:171], v[72:75], a[64:67], v[168:171]
    ds_read_b64_tr_b16 v[64:65], v24 offset:16384
    s_waitcnt lgkmcnt(13)
    v_mfma_f32_16x16x32_bf16 v[168:171], v[76:79], a[80:83], v[168:171]
    ds_read_b64_tr_b16 v[66:67], v24 offset:16896
    v_add_f32 v132, v132, v48
    v_mfma_f32_16x16x32_bf16 v[172:175], v[72:75], a[68:71], v[172:175]
    buffer_load_dwordx4 v11, s[36:39], s30 offen offset:3072 lds
    v_mfma_f32_16x16x32_bf16 v[172:175], v[76:79], a[84:87], v[172:175]
    v_add_f32 v133, v133, v49
    v_add_f32 v134, v134, v50
    v_mfma_f32_16x16x32_bf16 v[184:187], v[72:75], a[72:75], v[184:187]
    ds_read_b64_tr_b16 v[68:69], v24 offset:20480
    v_add_f32 v135, v135, v51
    v_mfma_f32_16x16x32_bf16 v[184:187], v[76:79], a[88:91], v[184:187]
    ds_read_b64_tr_b16 v[70:71], v24 offset:20992
    ds_read_b128 v[48:51], v29 offset:14336
    v_mfma_f32_16x16x32_bf16 v[188:191], v[72:75], a[76:79], v[188:191]
    buffer_load_dword v44, v31, s[48:51], 0 offen sc1
    v_mfma_f32_16x16x32_bf16 v[188:191], v[76:79], a[92:95], v[188:191]
    s_waitcnt lgkmcnt(12)
    v_add_f32 v148, v148, v52
    s_waitcnt lgkmcnt(10)
    v_mfma_f32_16x16x32_bf16 v[136:139], v[80:83], a[64:67], v[136:139]
    ds_read_b64_tr_b16 v[72:73], v25 offset:16384
    v_add_f32 v149, v149, v53
    v_mfma_f32_16x16x32_bf16 v[136:139], v[84:87], a[80:83], v[136:139]
    ds_read_b64_tr_b16 v[74:75], v25 offset:16896
    v_add_f32 v150, v150, v54
    v_mfma_f32_16x16x32_bf16 v[140:143], v[80:83], a[68:71], v[140:143]
    v_add_f32 v151, v151, v55
    ds_read_b128 v[52:55], v29 offset:13312
    v_mfma_f32_16x16x32_bf16 v[140:143], v[84:87], a[84:87], v[140:143]
    v_cvt_pk_bf16_f32 v132, v132, v133
    v_cvt_pk_bf16_f32 v133, v134, v135
    v_mfma_f32_16x16x32_bf16 v[152:155], v[80:83], a[72:75], v[152:155]
    ds_read_b64_tr_b16 v[76:77], v25 offset:20480
    v_cvt_pk_bf16_f32 v134, v148, v149
    v_mfma_f32_16x16x32_bf16 v[152:155], v[84:87], a[88:91], v[152:155]
    ds_read_b64_tr_b16 v[78:79], v25 offset:20992
    v_cvt_pk_bf16_f32 v135, v150, v151
    v_mfma_f32_16x16x32_bf16 v[156:159], v[80:83], a[76:79], v[156:159]
    buffer_store_dwordx4 v[132:135], v5, s[72:75], s65 offen offset:0 sc1
    s_waitcnt lgkmcnt(12)
    v_mfma_f32_16x16x32_bf16 v[156:159], v[84:87], a[92:95], v[156:159]
    v_add_f32 v192, v192, v56
    v_add_f32 v193, v193, v57
    s_waitcnt lgkmcnt(10)
    v_mfma_f32_16x16x32_bf16 v[200:203], v[88:91], a[64:67], v[200:203]
    ds_read_b64_tr_b16 v[80:81], v26 offset:16384
    v_add_f32 v194, v194, v58
    v_mfma_f32_16x16x32_bf16 v[200:203], v[92:95], a[80:83], v[200:203]
    ds_read_b64_tr_b16 v[82:83], v26 offset:16896
    v_add_f32 v195, v195, v59
    v_mfma_f32_16x16x32_bf16 v[204:207], v[88:91], a[68:71], v[204:207]
    ds_read_b128 v[56:59], v29 offset:15360
    s_waitcnt lgkmcnt(8)
    v_mfma_f32_16x16x32_bf16 v[204:207], v[92:95], a[84:87], v[204:207]
    v_add_f32 v208, v208, v48
    v_add_f32 v209, v209, v49
    v_mfma_f32_16x16x32_bf16 v[216:219], v[88:91], a[72:75], v[216:219]
    ds_read_b64_tr_b16 v[84:85], v26 offset:20480
    v_add_f32 v210, v210, v50
    v_mfma_f32_16x16x32_bf16 v[216:219], v[92:95], a[88:91], v[216:219]
    ds_read_b64_tr_b16 v[86:87], v26 offset:20992
    v_add_f32 v211, v211, v51
    v_mfma_f32_16x16x32_bf16 v[220:223], v[88:91], a[76:79], v[220:223]
    ds_read_b128 v[48:51], v29 offset:0
    v_cvt_pk_bf16_f32 v192, v192, v193
    v_mfma_f32_16x16x32_bf16 v[220:223], v[92:95], a[92:95], v[220:223]
    v_cvt_pk_bf16_f32 v193, v194, v195
    v_cvt_pk_bf16_f32 v194, v208, v209
    s_waitcnt lgkmcnt(12)
    v_mfma_f32_16x16x32_bf16 v[104:107], v[64:67], a[96:99], v[104:107]
    ds_read_b64_tr_b16 v[88:89], v27 offset:16384
    v_cvt_pk_bf16_f32 v195, v210, v211
    v_mfma_f32_16x16x32_bf16 v[104:107], v[68:71], a[112:115], v[104:107]
    ds_read_b64_tr_b16 v[90:91], v27 offset:16896
    buffer_store_dwordx4 v[192:195], v5, s[72:75], s66 offen offset:1024 sc1
    v_mfma_f32_16x16x32_bf16 v[108:111], v[64:67], a[100:103], v[108:111]
    s_waitcnt lgkmcnt(10)
    v_add_f32 v196, v196, v52
    v_mfma_f32_16x16x32_bf16 v[108:111], v[68:71], a[116:119], v[108:111]
    v_add_f32 v197, v197, v53
    v_add_f32 v198, v198, v54
    v_mfma_f32_16x16x32_bf16 v[120:123], v[64:67], a[104:107], v[120:123]
    ds_read_b64_tr_b16 v[92:93], v27 offset:20480
    v_add_f32 v199, v199, v55
    v_mfma_f32_16x16x32_bf16 v[120:123], v[68:71], a[120:123], v[120:123]
    ds_read_b64_tr_b16 v[94:95], v27 offset:20992
    ds_read_b128 v[52:55], v29 offset:2048
    v_mfma_f32_16x16x32_bf16 v[124:127], v[64:67], a[108:111], v[124:127]
    s_waitcnt lgkmcnt(8)
    v_add_f32 v212, v212, v56
    v_mfma_f32_16x16x32_bf16 v[124:127], v[68:71], a[124:127], v[124:127]
    v_add_f32 v213, v213, v57
    v_add_f32 v214, v214, v58
    s_waitcnt vmcnt(14)
    s_barrier
    s_waitcnt lgkmcnt(11)
    v_mfma_f32_16x16x32_bf16 v[168:171], v[72:75], a[96:99], v[168:171]
    ds_read_b64_tr_b16 v[64:65], v16 offset:0
    v_add_f32 v215, v215, v59
    v_mfma_f32_16x16x32_bf16 v[168:171], v[76:79], a[112:115], v[168:171]
    ds_read_b64_tr_b16 v[66:67], v16 offset:512
    ds_read_b128 v[56:59], v29 offset:1024
    v_mfma_f32_16x16x32_bf16 v[172:175], v[72:75], a[100:103], v[172:175]
    v_cvt_pk_bf16_f32 v196, v196, v197
    v_cvt_pk_bf16_f32 v197, v198, v199
    v_mfma_f32_16x16x32_bf16 v[172:175], v[76:79], a[116:119], v[172:175]
    v_cvt_pk_bf16_f32 v198, v212, v213
    v_cvt_pk_bf16_f32 v199, v214, v215
    v_mfma_f32_16x16x32_bf16 v[184:187], v[72:75], a[104:107], v[184:187]
    ds_read_b64_tr_b16 v[68:69], v16 offset:4096
    buffer_store_dwordx4 v[196:199], v5, s[72:75], s66 offen offset:0 sc1
    v_mfma_f32_16x16x32_bf16 v[184:187], v[76:79], a[120:123], v[184:187]
    ds_read_b64_tr_b16 v[70:71], v16 offset:4608
    s_waitcnt lgkmcnt(10)
    v_mfma_f32_16x16x32_bf16 v[188:191], v[72:75], a[108:111], v[188:191]
    v_add_f32 v96, v96, v48
    v_add_f32 v97, v97, v49
    v_mfma_f32_16x16x32_bf16 v[188:191], v[76:79], a[124:127], v[188:191]
    v_add_f32 v98, v98, v50
    v_add_f32 v99, v99, v51
    s_waitcnt lgkmcnt(11)
    v_mfma_f32_16x16x32_bf16 v[136:139], v[80:83], a[96:99], v[136:139]
    ds_read_b64_tr_b16 v[72:73], v17 offset:0
    ds_read_b128 v[48:51], v29 offset:3072
    v_mfma_f32_16x16x32_bf16 v[136:139], v[84:87], a[112:115], v[136:139]
    ds_read_b64_tr_b16 v[74:75], v17 offset:512
    s_waitcnt lgkmcnt(8)
    v_mfma_f32_16x16x32_bf16 v[140:143], v[80:83], a[100:103], v[140:143]
    v_add_f32 v112, v112, v52
    v_add_f32 v113, v113, v53
    v_mfma_f32_16x16x32_bf16 v[140:143], v[84:87], a[116:119], v[140:143]
    v_add_f32 v114, v114, v54
    v_add_f32 v115, v115, v55
    v_mfma_f32_16x16x32_bf16 v[152:155], v[80:83], a[104:107], v[152:155]
    ds_read_b64_tr_b16 v[76:77], v17 offset:4096
    s_waitcnt lgkmcnt(6)
    v_mfma_f32_16x16x32_bf16 v[152:155], v[84:87], a[120:123], v[152:155]
    ds_read_b64_tr_b16 v[78:79], v17 offset:4608
    v_add_f32 v100, v100, v56
    v_mfma_f32_16x16x32_bf16 v[156:159], v[80:83], a[108:111], v[156:159]
    v_add_f32 v101, v101, v57
    v_add_f32 v102, v102, v58
    v_mfma_f32_16x16x32_bf16 v[156:159], v[84:87], a[124:127], v[156:159]
    v_add_f32 v103, v103, v59
    s_waitcnt lgkmcnt(3)
    s_waitcnt lgkmcnt(11)
    v_mfma_f32_16x16x32_bf16 v[200:203], v[88:91], a[96:99], v[200:203]
    ds_read_b64_tr_b16 v[80:81], v18 offset:0
    v_add_f32 v116, v116, v48
    v_mfma_f32_16x16x32_bf16 v[200:203], v[92:95], a[112:115], v[200:203]
    ds_read_b64_tr_b16 v[82:83], v18 offset:512
    v_add_f32 v117, v117, v49
    v_mfma_f32_16x16x32_bf16 v[204:207], v[88:91], a[100:103], v[204:207]
    v_add_f32 v118, v118, v50
    v_add_f32 v119, v119, v51
    v_mfma_f32_16x16x32_bf16 v[204:207], v[92:95], a[116:119], v[204:207]
    v_mfma_f32_16x16x32_bf16 v[216:219], v[88:91], a[104:107], v[216:219]
    ds_read_b64_tr_b16 v[84:85], v18 offset:4096
    v_mfma_f32_16x16x32_bf16 v[216:219], v[92:95], a[120:123], v[216:219]
    ds_read_b64_tr_b16 v[86:87], v18 offset:4608
    s_add_u32 m0, s28, 65536
    s_add_u32 s30, s96, 147712
    v_mfma_f32_16x16x32_bf16 v[220:223], v[88:91], a[108:111], v[220:223]
    buffer_load_dwordx4 v8, s[36:39], s30 offen offset:0 lds
    v_mfma_f32_16x16x32_bf16 v[220:223], v[92:95], a[124:127], v[220:223]
    s_waitcnt lgkmcnt(9)
    v_mfma_f32_16x16x32_bf16 v[104:107], v[64:67], a[128:131], v[104:107]
    ds_read_b64_tr_b16 v[88:89], v19 offset:0
    v_mfma_f32_16x16x32_bf16 v[104:107], v[68:71], a[144:147], v[104:107]
    ds_read_b64_tr_b16 v[90:91], v19 offset:512
    v_mfma_f32_16x16x32_bf16 v[108:111], v[64:67], a[132:135], v[108:111]
    buffer_load_dwordx4 v9, s[36:39], s30 offen offset:1024 lds
    v_mfma_f32_16x16x32_bf16 v[108:111], v[68:71], a[148:151], v[108:111]
    v_mfma_f32_16x16x32_bf16 v[120:123], v[64:67], a[136:139], v[120:123]
    ds_read_b64_tr_b16 v[92:93], v19 offset:4096
    v_mfma_f32_16x16x32_bf16 v[120:123], v[68:71], a[152:155], v[120:123]
    ds_read_b64_tr_b16 v[94:95], v19 offset:4608
    v_mfma_f32_16x16x32_bf16 v[124:127], v[64:67], a[140:143], v[124:127]
    buffer_load_dwordx4 v10, s[36:39], s30 offen offset:2048 lds
    v_mfma_f32_16x16x32_bf16 v[124:127], v[68:71], a[156:159], v[124:127]
    s_waitcnt lgkmcnt(8)
    v_mfma_f32_16x16x32_bf16 v[168:171], v[72:75], a[128:131], v[168:171]
    ds_read_b64_tr_b16 v[64:65], v16 offset:16384
    v_mfma_f32_16x16x32_bf16 v[168:171], v[76:79], a[144:147], v[168:171]
    ds_read_b64_tr_b16 v[66:67], v16 offset:16896
    v_mfma_f32_16x16x32_bf16 v[172:175], v[72:75], a[132:135], v[172:175]
    buffer_load_dwordx4 v11, s[36:39], s30 offen offset:3072 lds
    v_mfma_f32_16x16x32_bf16 v[172:175], v[76:79], a[148:151], v[172:175]
    s_waitcnt vmcnt(7)
    s_mov_b32 s60, 0
parallel_fc16:
    v_xor_b32 v47, s3, v44
    v_cmp_ne_u32 vcc, 0, v47
    s_cbranch_vccz parallel_fx17
    s_add_u32 s60, s60, 1
    s_cmp_gt_u32 s60, 131072
    s_cbranch_scc1 parallel_fx17
    buffer_load_dword v44, v31, s[48:51], 0 offen sc1
    s_waitcnt vmcnt(0)
    s_branch parallel_fc16
parallel_fx17:
    v_mfma_f32_16x16x32_bf16 v[184:187], v[72:75], a[136:139], v[184:187]
    ds_read_b64_tr_b16 v[68:69], v16 offset:20480
    v_mfma_f32_16x16x32_bf16 v[184:187], v[76:79], a[152:155], v[184:187]
    ds_read_b64_tr_b16 v[70:71], v16 offset:20992
    v_mfma_f32_16x16x32_bf16 v[188:191], v[72:75], a[140:143], v[188:191]
    buffer_load_dwordx2 v[40:41], v4, s[76:79], s87 offen offset:0 sc1
    v_mfma_f32_16x16x32_bf16 v[188:191], v[76:79], a[156:159], v[188:191]
    s_waitcnt lgkmcnt(8)
    v_mfma_f32_16x16x32_bf16 v[136:139], v[80:83], a[128:131], v[136:139]
    ds_read_b64_tr_b16 v[72:73], v17 offset:16384
    v_mfma_f32_16x16x32_bf16 v[136:139], v[84:87], a[144:147], v[136:139]
    ds_read_b64_tr_b16 v[74:75], v17 offset:16896
    v_mfma_f32_16x16x32_bf16 v[140:143], v[80:83], a[132:135], v[140:143]
    v_mfma_f32_16x16x32_bf16 v[140:143], v[84:87], a[148:151], v[140:143]
    v_mfma_f32_16x16x32_bf16 v[152:155], v[80:83], a[136:139], v[152:155]
    ds_read_b64_tr_b16 v[76:77], v17 offset:20480
    v_mfma_f32_16x16x32_bf16 v[152:155], v[84:87], a[152:155], v[152:155]
    ds_read_b64_tr_b16 v[78:79], v17 offset:20992
    v_mfma_f32_16x16x32_bf16 v[156:159], v[80:83], a[140:143], v[156:159]
    v_mfma_f32_16x16x32_bf16 v[156:159], v[84:87], a[156:159], v[156:159]
    s_waitcnt lgkmcnt(8)
    v_mfma_f32_16x16x32_bf16 v[200:203], v[88:91], a[128:131], v[200:203]
    ds_read_b64_tr_b16 v[80:81], v18 offset:16384
    v_mfma_f32_16x16x32_bf16 v[200:203], v[92:95], a[144:147], v[200:203]
    ds_read_b64_tr_b16 v[82:83], v18 offset:16896
    v_mfma_f32_16x16x32_bf16 v[204:207], v[88:91], a[132:135], v[204:207]
    buffer_load_dwordx2 v[42:43], v4, s[76:79], s87 offen offset:32 sc1
    v_mfma_f32_16x16x32_bf16 v[204:207], v[92:95], a[148:151], v[204:207]
    v_mfma_f32_16x16x32_bf16 v[216:219], v[88:91], a[136:139], v[216:219]
    ds_read_b64_tr_b16 v[84:85], v18 offset:20480
    v_mfma_f32_16x16x32_bf16 v[216:219], v[92:95], a[152:155], v[216:219]
    ds_read_b64_tr_b16 v[86:87], v18 offset:20992
    v_mfma_f32_16x16x32_bf16 v[220:223], v[88:91], a[140:143], v[220:223]
    v_mfma_f32_16x16x32_bf16 v[220:223], v[92:95], a[156:159], v[220:223]
    s_waitcnt lgkmcnt(8)
    v_mfma_f32_16x16x32_bf16 v[104:107], v[64:67], a[160:163], v[104:107]
    ds_read_b64_tr_b16 v[88:89], v19 offset:16384
    v_mfma_f32_16x16x32_bf16 v[104:107], v[68:71], a[176:179], v[104:107]
    ds_read_b64_tr_b16 v[90:91], v19 offset:16896
    v_mfma_f32_16x16x32_bf16 v[108:111], v[64:67], a[164:167], v[108:111]
    v_mfma_f32_16x16x32_bf16 v[108:111], v[68:71], a[180:183], v[108:111]
    v_mfma_f32_16x16x32_bf16 v[120:123], v[64:67], a[168:171], v[120:123]
    ds_read_b64_tr_b16 v[92:93], v19 offset:20480
    v_mfma_f32_16x16x32_bf16 v[120:123], v[68:71], a[184:187], v[120:123]
    ds_read_b64_tr_b16 v[94:95], v19 offset:20992
    v_mfma_f32_16x16x32_bf16 v[124:127], v[64:67], a[172:175], v[124:127]
    buffer_load_dwordx2 v[60:61], v4, s[76:79], s88 offen offset:0 sc1
    v_mfma_f32_16x16x32_bf16 v[124:127], v[68:71], a[188:191], v[124:127]
    s_waitcnt vmcnt(11)
    s_barrier
    s_waitcnt lgkmcnt(8)
    v_mfma_f32_16x16x32_bf16 v[168:171], v[72:75], a[160:163], v[168:171]
    ds_read_b64_tr_b16 v[64:65], v16 offset:32768
    v_mfma_f32_16x16x32_bf16 v[168:171], v[76:79], a[176:179], v[168:171]
    ds_read_b64_tr_b16 v[66:67], v16 offset:33280
    v_mfma_f32_16x16x32_bf16 v[172:175], v[72:75], a[164:167], v[172:175]
    v_mfma_f32_16x16x32_bf16 v[172:175], v[76:79], a[180:183], v[172:175]
    v_mfma_f32_16x16x32_bf16 v[184:187], v[72:75], a[168:171], v[184:187]
    ds_read_b64_tr_b16 v[68:69], v16 offset:36864
    v_mfma_f32_16x16x32_bf16 v[184:187], v[76:79], a[184:187], v[184:187]
    ds_read_b64_tr_b16 v[70:71], v16 offset:37376
    v_mfma_f32_16x16x32_bf16 v[188:191], v[72:75], a[172:175], v[188:191]
    v_mfma_f32_16x16x32_bf16 v[188:191], v[76:79], a[188:191], v[188:191]
    s_waitcnt lgkmcnt(8)
    v_mfma_f32_16x16x32_bf16 v[136:139], v[80:83], a[160:163], v[136:139]
    ds_read_b64_tr_b16 v[72:73], v17 offset:32768
    v_mfma_f32_16x16x32_bf16 v[136:139], v[84:87], a[176:179], v[136:139]
    ds_read_b64_tr_b16 v[74:75], v17 offset:33280
    v_mfma_f32_16x16x32_bf16 v[140:143], v[80:83], a[164:167], v[140:143]
    buffer_load_dwordx2 v[62:63], v4, s[76:79], s88 offen offset:32 sc1
    v_mfma_f32_16x16x32_bf16 v[140:143], v[84:87], a[180:183], v[140:143]
    v_mfma_f32_16x16x32_bf16 v[152:155], v[80:83], a[168:171], v[152:155]
    ds_read_b64_tr_b16 v[76:77], v17 offset:36864
    v_mfma_f32_16x16x32_bf16 v[152:155], v[84:87], a[184:187], v[152:155]
    ds_read_b64_tr_b16 v[78:79], v17 offset:37376
    v_mfma_f32_16x16x32_bf16 v[156:159], v[80:83], a[172:175], v[156:159]
    v_mfma_f32_16x16x32_bf16 v[156:159], v[84:87], a[188:191], v[156:159]
    s_waitcnt lgkmcnt(8)
    v_mfma_f32_16x16x32_bf16 v[200:203], v[88:91], a[160:163], v[200:203]
    ds_read_b64_tr_b16 v[80:81], v18 offset:32768
    v_mfma_f32_16x16x32_bf16 v[200:203], v[92:95], a[176:179], v[200:203]
    ds_read_b64_tr_b16 v[82:83], v18 offset:33280
    v_mfma_f32_16x16x32_bf16 v[204:207], v[88:91], a[164:167], v[204:207]
    v_mfma_f32_16x16x32_bf16 v[204:207], v[92:95], a[180:183], v[204:207]
    v_mfma_f32_16x16x32_bf16 v[216:219], v[88:91], a[168:171], v[216:219]
    ds_read_b64_tr_b16 v[84:85], v18 offset:36864
    v_mfma_f32_16x16x32_bf16 v[216:219], v[92:95], a[184:187], v[216:219]
    ds_read_b64_tr_b16 v[86:87], v18 offset:37376
    v_mfma_f32_16x16x32_bf16 v[220:223], v[88:91], a[172:175], v[220:223]
    buffer_load_dwordx2 v[12:13], v4, s[76:79], s89 offen offset:0 sc1
    v_mfma_f32_16x16x32_bf16 v[220:223], v[92:95], a[188:191], v[220:223]
    s_waitcnt lgkmcnt(8)
    v_mfma_f32_16x16x32_bf16 v[104:107], v[64:67], a[192:195], v[104:107]
    ds_read_b64_tr_b16 v[88:89], v19 offset:32768
    v_mfma_f32_16x16x32_bf16 v[104:107], v[68:71], a[208:211], v[104:107]
    ds_read_b64_tr_b16 v[90:91], v19 offset:33280
    v_mfma_f32_16x16x32_bf16 v[108:111], v[64:67], a[196:199], v[108:111]
    v_mfma_f32_16x16x32_bf16 v[108:111], v[68:71], a[212:215], v[108:111]
    v_mfma_f32_16x16x32_bf16 v[120:123], v[64:67], a[200:203], v[120:123]
    ds_read_b64_tr_b16 v[92:93], v19 offset:36864
    v_mfma_f32_16x16x32_bf16 v[120:123], v[68:71], a[216:219], v[120:123]
    ds_read_b64_tr_b16 v[94:95], v19 offset:37376
    v_mfma_f32_16x16x32_bf16 v[124:127], v[64:67], a[204:207], v[124:127]
    v_mfma_f32_16x16x32_bf16 v[124:127], v[68:71], a[220:223], v[124:127]
    s_waitcnt lgkmcnt(8)
    v_mfma_f32_16x16x32_bf16 v[168:171], v[72:75], a[192:195], v[168:171]
    ds_read_b64_tr_b16 v[64:65], v16 offset:49152
    v_mfma_f32_16x16x32_bf16 v[168:171], v[76:79], a[208:211], v[168:171]
    ds_read_b64_tr_b16 v[66:67], v16 offset:49664
    v_mfma_f32_16x16x32_bf16 v[172:175], v[72:75], a[196:199], v[172:175]
    buffer_load_dwordx2 v[14:15], v4, s[76:79], s89 offen offset:32 sc1
    v_mfma_f32_16x16x32_bf16 v[172:175], v[76:79], a[212:215], v[172:175]
    v_mfma_f32_16x16x32_bf16 v[184:187], v[72:75], a[200:203], v[184:187]
    ds_read_b64_tr_b16 v[68:69], v16 offset:53248
    v_mfma_f32_16x16x32_bf16 v[184:187], v[76:79], a[216:219], v[184:187]
    ds_read_b64_tr_b16 v[70:71], v16 offset:53760
    v_mfma_f32_16x16x32_bf16 v[188:191], v[72:75], a[204:207], v[188:191]
    v_mfma_f32_16x16x32_bf16 v[188:191], v[76:79], a[220:223], v[188:191]
    s_waitcnt lgkmcnt(8)
    v_mfma_f32_16x16x32_bf16 v[136:139], v[80:83], a[192:195], v[136:139]
    ds_read_b64_tr_b16 v[72:73], v17 offset:49152
    v_mfma_f32_16x16x32_bf16 v[136:139], v[84:87], a[208:211], v[136:139]
    ds_read_b64_tr_b16 v[74:75], v17 offset:49664
    v_mfma_f32_16x16x32_bf16 v[140:143], v[80:83], a[196:199], v[140:143]
    v_mfma_f32_16x16x32_bf16 v[140:143], v[84:87], a[212:215], v[140:143]
    v_mfma_f32_16x16x32_bf16 v[152:155], v[80:83], a[200:203], v[152:155]
    ds_read_b64_tr_b16 v[76:77], v17 offset:53248
    v_mfma_f32_16x16x32_bf16 v[152:155], v[84:87], a[216:219], v[152:155]
    ds_read_b64_tr_b16 v[78:79], v17 offset:53760
    v_mfma_f32_16x16x32_bf16 v[156:159], v[80:83], a[204:207], v[156:159]
    v_mfma_f32_16x16x32_bf16 v[156:159], v[84:87], a[220:223], v[156:159]
    s_waitcnt lgkmcnt(8)
    v_mfma_f32_16x16x32_bf16 v[200:203], v[88:91], a[192:195], v[200:203]
    ds_read_b64_tr_b16 v[80:81], v18 offset:49152
    v_mfma_f32_16x16x32_bf16 v[200:203], v[92:95], a[208:211], v[200:203]
    ds_read_b64_tr_b16 v[82:83], v18 offset:49664
    v_mfma_f32_16x16x32_bf16 v[204:207], v[88:91], a[196:199], v[204:207]
    buffer_load_dwordx4 v[176:179], v5, s[72:75], s52 offen offset:0 sc1
    v_mfma_f32_16x16x32_bf16 v[204:207], v[92:95], a[212:215], v[204:207]
    v_mfma_f32_16x16x32_bf16 v[216:219], v[88:91], a[200:203], v[216:219]
    ds_read_b64_tr_b16 v[84:85], v18 offset:53248
    v_mfma_f32_16x16x32_bf16 v[216:219], v[92:95], a[216:219], v[216:219]
    ds_read_b64_tr_b16 v[86:87], v18 offset:53760
    v_mfma_f32_16x16x32_bf16 v[220:223], v[88:91], a[204:207], v[220:223]
    buffer_load_dwordx4 v[144:147], v5, s[72:75], s53 offen offset:0 sc1
    v_mfma_f32_16x16x32_bf16 v[220:223], v[92:95], a[220:223], v[220:223]
    s_waitcnt lgkmcnt(8)
    v_mfma_f32_16x16x32_bf16 v[104:107], v[64:67], a[224:227], v[104:107]
    ds_read_b64_tr_b16 v[88:89], v19 offset:49152
    v_mfma_f32_16x16x32_bf16 v[104:107], v[68:71], a[240:243], v[104:107]
    ds_read_b64_tr_b16 v[90:91], v19 offset:49664
    v_mfma_f32_16x16x32_bf16 v[108:111], v[64:67], a[228:231], v[108:111]
    buffer_load_dwordx4 v[208:211], v5, s[72:75], s54 offen offset:0 sc1
    v_mfma_f32_16x16x32_bf16 v[108:111], v[68:71], a[244:247], v[108:111]
    v_mfma_f32_16x16x32_bf16 v[120:123], v[64:67], a[232:235], v[120:123]
    ds_read_b64_tr_b16 v[92:93], v19 offset:53248
    v_mfma_f32_16x16x32_bf16 v[120:123], v[68:71], a[248:251], v[120:123]
    ds_read_b64_tr_b16 v[94:95], v19 offset:53760
    v_mfma_f32_16x16x32_bf16 v[124:127], v[64:67], a[236:239], v[124:127]
    buffer_load_dwordx4 v[160:163], v5, s[72:75], s55 offen offset:0 sc1
    v_mfma_f32_16x16x32_bf16 v[124:127], v[68:71], a[252:255], v[124:127]
    s_waitcnt vmcnt(10)
    s_barrier
    s_waitcnt lgkmcnt(8)
    v_mfma_f32_16x16x32_bf16 v[168:171], v[72:75], a[224:227], v[168:171]
    ds_read_b64_tr_b16 v[64:65], v22 offset:0
    v_mfma_f32_16x16x32_bf16 v[168:171], v[76:79], a[240:243], v[168:171]
    ds_read_b64_tr_b16 v[66:67], v22 offset:512
    v_mfma_f32_16x16x32_bf16 v[172:175], v[72:75], a[228:231], v[172:175]
    buffer_load_dwordx4 v[180:183], v5, s[72:75], s52 offen offset:1024 sc1
    v_mfma_f32_16x16x32_bf16 v[172:175], v[76:79], a[244:247], v[172:175]
    v_mfma_f32_16x16x32_bf16 v[184:187], v[72:75], a[232:235], v[184:187]
    ds_read_b64_tr_b16 v[68:69], v22 offset:4096
    v_mfma_f32_16x16x32_bf16 v[184:187], v[76:79], a[248:251], v[184:187]
    ds_read_b64_tr_b16 v[70:71], v22 offset:4608
    v_mfma_f32_16x16x32_bf16 v[188:191], v[72:75], a[236:239], v[188:191]
    buffer_load_dwordx4 v[148:151], v5, s[72:75], s53 offen offset:1024 sc1
    v_mfma_f32_16x16x32_bf16 v[188:191], v[76:79], a[252:255], v[188:191]
    s_waitcnt lgkmcnt(8)
    v_mfma_f32_16x16x32_bf16 v[136:139], v[80:83], a[224:227], v[136:139]
    ds_read_b64_tr_b16 v[72:73], v23 offset:0
    v_mfma_f32_16x16x32_bf16 v[136:139], v[84:87], a[240:243], v[136:139]
    ds_read_b64_tr_b16 v[74:75], v23 offset:512
    v_mfma_f32_16x16x32_bf16 v[140:143], v[80:83], a[228:231], v[140:143]
    buffer_load_dwordx4 v[212:215], v5, s[72:75], s54 offen offset:1024 sc1
    v_mfma_f32_16x16x32_bf16 v[140:143], v[84:87], a[244:247], v[140:143]
    v_mfma_f32_16x16x32_bf16 v[152:155], v[80:83], a[232:235], v[152:155]
    ds_read_b64_tr_b16 v[76:77], v23 offset:4096
    v_mfma_f32_16x16x32_bf16 v[152:155], v[84:87], a[248:251], v[152:155]
    ds_read_b64_tr_b16 v[78:79], v23 offset:4608
    v_mfma_f32_16x16x32_bf16 v[156:159], v[80:83], a[236:239], v[156:159]
    buffer_load_dwordx4 v[164:167], v5, s[72:75], s55 offen offset:1024 sc1
    v_mfma_f32_16x16x32_bf16 v[156:159], v[84:87], a[252:255], v[156:159]
    s_waitcnt lgkmcnt(8)
    v_mfma_f32_16x16x32_bf16 v[200:203], v[88:91], a[224:227], v[200:203]
    ds_read_b64_tr_b16 v[80:81], v20 offset:0
    v_mfma_f32_16x16x32_bf16 v[200:203], v[92:95], a[240:243], v[200:203]
    ds_read_b64_tr_b16 v[82:83], v20 offset:512
    v_mfma_f32_16x16x32_bf16 v[204:207], v[88:91], a[228:231], v[204:207]
    v_mfma_f32_16x16x32_bf16 v[204:207], v[92:95], a[244:247], v[204:207]
    v_mfma_f32_16x16x32_bf16 v[216:219], v[88:91], a[232:235], v[216:219]
    ds_read_b64_tr_b16 v[84:85], v20 offset:4096
    v_mfma_f32_16x16x32_bf16 v[216:219], v[92:95], a[248:251], v[216:219]
    ds_read_b64_tr_b16 v[86:87], v20 offset:4608
    v_mfma_f32_16x16x32_bf16 v[220:223], v[88:91], a[236:239], v[220:223]
    v_mfma_f32_16x16x32_bf16 v[220:223], v[92:95], a[252:255], v[220:223]
    s_waitcnt lgkmcnt(8)
    v_mfma_f32_16x16x32_bf16 v[136:139], v[64:67], v[224:227], v[136:139]
    ds_read_b64_tr_b16 v[88:89], v21 offset:0
    v_mfma_f32_16x16x32_bf16 v[136:139], v[68:71], v[240:243], v[136:139]
    ds_read_b64_tr_b16 v[90:91], v21 offset:512
    v_mfma_f32_16x16x32_bf16 v[140:143], v[64:67], v[228:231], v[140:143]
    v_mfma_f32_16x16x32_bf16 v[140:143], v[68:71], v[244:247], v[140:143]
    v_mfma_f32_16x16x32_bf16 v[152:155], v[64:67], v[232:235], v[152:155]
    ds_read_b64_tr_b16 v[92:93], v21 offset:4096
    v_mfma_f32_16x16x32_bf16 v[152:155], v[68:71], v[248:251], v[152:155]
    ds_read_b64_tr_b16 v[94:95], v21 offset:4608
    v_mfma_f32_16x16x32_bf16 v[156:159], v[64:67], v[236:239], v[156:159]
    v_mfma_f32_16x16x32_bf16 v[156:159], v[68:71], v[252:255], v[156:159]
    s_waitcnt lgkmcnt(8)
    v_mfma_f32_16x16x32_bf16 v[200:203], v[72:75], v[224:227], v[200:203]
    v_mfma_f32_16x16x32_bf16 v[200:203], v[76:79], v[240:243], v[200:203]
    v_mfma_f32_16x16x32_bf16 v[204:207], v[72:75], v[228:231], v[204:207]
    v_mfma_f32_16x16x32_bf16 v[204:207], v[76:79], v[244:247], v[204:207]
    v_mfma_f32_16x16x32_bf16 v[216:219], v[72:75], v[232:235], v[216:219]
    v_mfma_f32_16x16x32_bf16 v[216:219], v[76:79], v[248:251], v[216:219]
    v_mfma_f32_16x16x32_bf16 v[220:223], v[72:75], v[236:239], v[220:223]
    v_mfma_f32_16x16x32_bf16 v[220:223], v[76:79], v[252:255], v[220:223]
    s_waitcnt lgkmcnt(4)
    v_mfma_f32_16x16x32_bf16 v[104:107], v[80:83], v[224:227], v[104:107]
    v_mfma_f32_16x16x32_bf16 v[104:107], v[84:87], v[240:243], v[104:107]
    ds_write_b128 v28, v[152:155] offset:4096
    ds_write_b128 v28, v[156:159] offset:5120
    v_mfma_f32_16x16x32_bf16 v[108:111], v[80:83], v[228:231], v[108:111]
    ds_write_b128 v28, v[216:219] offset:6144
    s_nop 0
    ds_write_b128 v28, v[220:223] offset:7168
    v_mfma_f32_16x16x32_bf16 v[108:111], v[84:87], v[244:247], v[108:111]
    v_mfma_f32_16x16x32_bf16 v[120:123], v[80:83], v[232:235], v[120:123]
    v_mfma_f32_16x16x32_bf16 v[120:123], v[84:87], v[248:251], v[120:123]
    v_mfma_f32_16x16x32_bf16 v[124:127], v[80:83], v[236:239], v[124:127]
    v_mfma_f32_16x16x32_bf16 v[124:127], v[84:87], v[252:255], v[124:127]
    s_waitcnt lgkmcnt(4)
    v_mfma_f32_16x16x32_bf16 v[168:171], v[88:91], v[224:227], v[168:171]
    v_mfma_f32_16x16x32_bf16 v[168:171], v[92:95], v[240:243], v[168:171]
    v_mfma_f32_16x16x32_bf16 v[172:175], v[88:91], v[228:231], v[172:175]
    v_mfma_f32_16x16x32_bf16 v[172:175], v[92:95], v[244:247], v[172:175]
    v_mfma_f32_16x16x32_bf16 v[184:187], v[88:91], v[232:235], v[184:187]
    v_mfma_f32_16x16x32_bf16 v[184:187], v[92:95], v[248:251], v[184:187]
    v_mfma_f32_16x16x32_bf16 v[188:191], v[88:91], v[236:239], v[188:191]
    v_mfma_f32_16x16x32_bf16 v[188:191], v[92:95], v[252:255], v[188:191]
    ds_write_b128 v28, v[120:123] offset:0
    ds_write_b128 v28, v[124:127] offset:1024
    s_nop 3
    ds_write_b128 v28, v[184:187] offset:2048
    s_nop 0
    ds_write_b128 v28, v[188:191] offset:3072
    s_mov_b32 s61, 0xffff0000
    s_waitcnt lgkmcnt(0)
    s_barrier
    ds_read_b128 v[64:67], v29 offset:4096
    ds_read_b128 v[68:71], v29 offset:6144
    ds_read_b128 v[72:75], v29 offset:1024
    ds_read_b128 v[76:79], v29 offset:3072
    ds_read_b128 v[80:83], v29 offset:5120
    ds_read_b128 v[84:87], v29 offset:7168
    ds_read_b128 v[88:91], v29 offset:0
    ds_read_b128 v[92:95], v29 offset:2048
    s_waitcnt lgkmcnt(7)
    v_pk_add_f32 v[136:137], v[136:137], v[64:65]
    v_pk_add_f32 v[138:139], v[138:139], v[66:67]
    s_waitcnt lgkmcnt(6)
    v_pk_add_f32 v[200:201], v[200:201], v[68:69]
    v_pk_add_f32 v[202:203], v[202:203], v[70:71]
    v_cvt_pk_bf16_f32 v136, v136, v137
    v_cvt_pk_bf16_f32 v137, v138, v139
    v_cvt_pk_bf16_f32 v138, v200, v201
    v_cvt_pk_bf16_f32 v139, v202, v203
    buffer_store_dwordx4 v[136:139], v5, s[72:75], s64 offen offset:2048 sc1
    s_waitcnt lgkmcnt(5)
    v_pk_add_f32 v[108:109], v[108:109], v[72:73]
    v_pk_add_f32 v[110:111], v[110:111], v[74:75]
    s_waitcnt lgkmcnt(4)
    v_pk_add_f32 v[172:173], v[172:173], v[76:77]
    v_pk_add_f32 v[174:175], v[174:175], v[78:79]
    v_cvt_pk_bf16_f32 v108, v108, v109
    v_cvt_pk_bf16_f32 v109, v110, v111
    v_cvt_pk_bf16_f32 v110, v172, v173
    v_cvt_pk_bf16_f32 v111, v174, v175
    buffer_store_dwordx4 v[108:111], v5, s[72:75], s65 offen offset:2048 sc1
    s_waitcnt lgkmcnt(3)
    v_pk_add_f32 v[140:141], v[140:141], v[80:81]
    v_pk_add_f32 v[142:143], v[142:143], v[82:83]
    s_waitcnt lgkmcnt(2)
    v_pk_add_f32 v[204:205], v[204:205], v[84:85]
    v_pk_add_f32 v[206:207], v[206:207], v[86:87]
    v_cvt_pk_bf16_f32 v140, v140, v141
    v_cvt_pk_bf16_f32 v141, v142, v143
    v_cvt_pk_bf16_f32 v142, v204, v205
    v_cvt_pk_bf16_f32 v143, v206, v207
    buffer_store_dwordx4 v[140:143], v5, s[72:75], s66 offen offset:2048 sc1
    s_waitcnt lgkmcnt(1)
    v_pk_add_f32 v[104:105], v[104:105], v[88:89]
    v_pk_add_f32 v[106:107], v[106:107], v[90:91]
    s_waitcnt lgkmcnt(0)
    v_pk_add_f32 v[168:169], v[168:169], v[92:93]
    v_pk_add_f32 v[170:171], v[170:171], v[94:95]
    s_waitcnt vmcnt(7)
    s_mov_b32 s60, 0
parallel_ck18:
    v_max3_u32 v6, v176, v177, v178
    v_max3_u32 v7, v179, v144, v145
    v_max3_u32 v6, v6, v146, v147
    v_max3_u32 v7, v7, v208, v209
    v_max3_u32 v6, v6, v210, v211
    v_max3_u32 v7, v7, v160, v161
    v_max3_u32 v6, v6, v162, v163
    v_max_u32 v6, v6, v7
    v_cmp_eq_u32 vcc, -1, v6
    s_cbranch_vccz parallel_ckx19
    s_add_u32 s60, s60, 1
    s_cmp_gt_u32 s60, 131072
    s_cbranch_scc1 parallel_ckx19
    buffer_load_dwordx4 v[176:179], v5, s[72:75], s52 offen offset:0 sc1
    buffer_load_dwordx4 v[144:147], v5, s[72:75], s53 offen offset:0 sc1
    buffer_load_dwordx4 v[208:211], v5, s[72:75], s54 offen offset:0 sc1
    buffer_load_dwordx4 v[160:163], v5, s[72:75], s55 offen offset:0 sc1
    s_waitcnt vmcnt(0)
    s_branch parallel_ck18
parallel_ckx19:
    v_lshlrev_b32 v16, 16, v176
    v_and_b32 v17, s61, v176
    v_lshlrev_b32 v18, 16, v144
    v_and_b32 v19, s61, v144
    v_lshlrev_b32 v20, 16, v208
    v_and_b32 v21, s61, v208
    v_lshlrev_b32 v22, 16, v160
    v_and_b32 v23, s61, v160
    v_lshlrev_b32 v24, 16, v40
    v_and_b32 v25, s61, v40
    v_pk_add_f32 v[16:17], v[16:17], v[18:19]
    v_pk_add_f32 v[96:97], v[96:97], v[20:21]
    v_pk_add_f32 v[22:23], v[22:23], v[24:25]
    v_pk_add_f32 v[96:97], v[96:97], v[16:17]
    v_pk_add_f32 v[96:97], v[96:97], v[22:23]
    v_lshlrev_b32 v16, 16, v177
    v_and_b32 v17, s61, v177
    v_lshlrev_b32 v18, 16, v145
    v_and_b32 v19, s61, v145
    v_lshlrev_b32 v20, 16, v209
    v_and_b32 v21, s61, v209
    v_lshlrev_b32 v22, 16, v161
    v_and_b32 v23, s61, v161
    v_lshlrev_b32 v24, 16, v41
    v_and_b32 v25, s61, v41
    v_pk_add_f32 v[16:17], v[16:17], v[18:19]
    v_pk_add_f32 v[98:99], v[98:99], v[20:21]
    v_pk_add_f32 v[22:23], v[22:23], v[24:25]
    v_pk_add_f32 v[98:99], v[98:99], v[16:17]
    v_pk_add_f32 v[98:99], v[98:99], v[22:23]
    v_lshlrev_b32 v16, 16, v178
    v_and_b32 v17, s61, v178
    v_lshlrev_b32 v18, 16, v146
    v_and_b32 v19, s61, v146
    v_lshlrev_b32 v20, 16, v210
    v_and_b32 v21, s61, v210
    v_lshlrev_b32 v22, 16, v162
    v_and_b32 v23, s61, v162
    v_lshlrev_b32 v24, 16, v42
    v_and_b32 v25, s61, v42
    v_pk_add_f32 v[16:17], v[16:17], v[18:19]
    v_pk_add_f32 v[112:113], v[112:113], v[20:21]
    v_pk_add_f32 v[22:23], v[22:23], v[24:25]
    v_pk_add_f32 v[112:113], v[112:113], v[16:17]
    v_pk_add_f32 v[112:113], v[112:113], v[22:23]
    v_lshlrev_b32 v16, 16, v179
    v_and_b32 v17, s61, v179
    v_lshlrev_b32 v18, 16, v147
    v_and_b32 v19, s61, v147
    v_lshlrev_b32 v20, 16, v211
    v_and_b32 v21, s61, v211
    v_lshlrev_b32 v22, 16, v163
    v_and_b32 v23, s61, v163
    v_lshlrev_b32 v24, 16, v43
    v_and_b32 v25, s61, v43
    v_pk_add_f32 v[16:17], v[16:17], v[18:19]
    v_pk_add_f32 v[114:115], v[114:115], v[20:21]
    v_pk_add_f32 v[22:23], v[22:23], v[24:25]
    v_pk_add_f32 v[114:115], v[114:115], v[16:17]
    v_pk_add_f32 v[114:115], v[114:115], v[22:23]
    s_waitcnt vmcnt(3)
    s_mov_b32 s60, 0
parallel_ck20:
    v_max3_u32 v6, v180, v181, v182
    v_max3_u32 v7, v183, v148, v149
    v_max3_u32 v6, v6, v150, v151
    v_max3_u32 v7, v7, v212, v213
    v_max3_u32 v6, v6, v214, v215
    v_max3_u32 v7, v7, v164, v165
    v_max3_u32 v6, v6, v166, v167
    v_max_u32 v6, v6, v7
    v_cmp_eq_u32 vcc, -1, v6
    s_cbranch_vccz parallel_ckx21
    s_add_u32 s60, s60, 1
    s_cmp_gt_u32 s60, 131072
    s_cbranch_scc1 parallel_ckx21
    buffer_load_dwordx4 v[180:183], v5, s[72:75], s52 offen offset:1024 sc1
    buffer_load_dwordx4 v[148:151], v5, s[72:75], s53 offen offset:1024 sc1
    buffer_load_dwordx4 v[212:215], v5, s[72:75], s54 offen offset:1024 sc1
    buffer_load_dwordx4 v[164:167], v5, s[72:75], s55 offen offset:1024 sc1
    s_waitcnt vmcnt(0)
    s_branch parallel_ck20
parallel_ckx21:
    v_lshlrev_b32 v16, 16, v180
    v_and_b32 v17, s61, v180
    v_lshlrev_b32 v18, 16, v148
    v_and_b32 v19, s61, v148
    v_lshlrev_b32 v20, 16, v212
    v_and_b32 v21, s61, v212
    v_lshlrev_b32 v22, 16, v164
    v_and_b32 v23, s61, v164
    v_lshlrev_b32 v24, 16, v60
    v_and_b32 v25, s61, v60
    v_pk_add_f32 v[16:17], v[16:17], v[18:19]
    v_pk_add_f32 v[100:101], v[100:101], v[20:21]
    v_pk_add_f32 v[22:23], v[22:23], v[24:25]
    v_pk_add_f32 v[100:101], v[100:101], v[16:17]
    v_pk_add_f32 v[100:101], v[100:101], v[22:23]
    v_lshlrev_b32 v16, 16, v181
    v_and_b32 v17, s61, v181
    v_lshlrev_b32 v18, 16, v149
    v_and_b32 v19, s61, v149
    v_lshlrev_b32 v20, 16, v213
    v_and_b32 v21, s61, v213
    v_lshlrev_b32 v22, 16, v165
    v_and_b32 v23, s61, v165
    v_lshlrev_b32 v24, 16, v61
    v_and_b32 v25, s61, v61
    v_pk_add_f32 v[16:17], v[16:17], v[18:19]
    v_pk_add_f32 v[102:103], v[102:103], v[20:21]
    v_pk_add_f32 v[22:23], v[22:23], v[24:25]
    v_pk_add_f32 v[102:103], v[102:103], v[16:17]
    v_pk_add_f32 v[102:103], v[102:103], v[22:23]
    v_lshlrev_b32 v16, 16, v182
    v_and_b32 v17, s61, v182
    v_lshlrev_b32 v18, 16, v150
    v_and_b32 v19, s61, v150
    v_lshlrev_b32 v20, 16, v214
    v_and_b32 v21, s61, v214
    v_lshlrev_b32 v22, 16, v166
    v_and_b32 v23, s61, v166
    v_lshlrev_b32 v24, 16, v62
    v_and_b32 v25, s61, v62
    v_pk_add_f32 v[16:17], v[16:17], v[18:19]
    v_pk_add_f32 v[116:117], v[116:117], v[20:21]
    v_pk_add_f32 v[22:23], v[22:23], v[24:25]
    v_pk_add_f32 v[116:117], v[116:117], v[16:17]
    v_pk_add_f32 v[116:117], v[116:117], v[22:23]
    v_lshlrev_b32 v16, 16, v183
    v_and_b32 v17, s61, v183
    v_lshlrev_b32 v18, 16, v151
    v_and_b32 v19, s61, v151
    v_lshlrev_b32 v20, 16, v215
    v_and_b32 v21, s61, v215
    v_lshlrev_b32 v22, 16, v167
    v_and_b32 v23, s61, v167
    v_lshlrev_b32 v24, 16, v63
    v_and_b32 v25, s61, v63
    v_pk_add_f32 v[16:17], v[16:17], v[18:19]
    v_pk_add_f32 v[118:119], v[118:119], v[20:21]
    v_pk_add_f32 v[22:23], v[22:23], v[24:25]
    v_pk_add_f32 v[118:119], v[118:119], v[16:17]
    v_pk_add_f32 v[118:119], v[118:119], v[22:23]
    buffer_load_dwordx4 v[64:67], v5, s[72:75], s52 offen offset:2048 sc1
    buffer_load_dwordx4 v[68:71], v5, s[72:75], s53 offen offset:2048 sc1
    buffer_load_dwordx4 v[72:75], v5, s[72:75], s54 offen offset:2048 sc1
    buffer_load_dwordx4 v[76:79], v5, s[72:75], s55 offen offset:2048 sc1
    buffer_store_dwordx4 v[96:99], v3, s[80:83], s84 offen offset:0 sc1
    buffer_store_dwordx4 v[112:115], v3, s[80:83], s84 offen offset:64 sc1
    buffer_store_dwordx4 v[100:103], v3, s[80:83], s85 offen offset:0 sc1
    buffer_store_dwordx4 v[116:119], v3, s[80:83], s85 offen offset:64 sc1
    s_waitcnt vmcnt(4)
    s_mov_b32 s60, 0
parallel_ck22:
    v_max3_u32 v6, v64, v65, v66
    v_max3_u32 v7, v67, v68, v69
    v_max3_u32 v6, v6, v70, v71
    v_max3_u32 v7, v7, v72, v73
    v_max3_u32 v6, v6, v74, v75
    v_max3_u32 v7, v7, v76, v77
    v_max3_u32 v6, v6, v78, v79
    v_max_u32 v6, v6, v7
    v_cmp_eq_u32 vcc, -1, v6
    s_cbranch_vccz parallel_ckx23
    s_add_u32 s60, s60, 1
    s_cmp_gt_u32 s60, 131072
    s_cbranch_scc1 parallel_ckx23
    buffer_load_dwordx4 v[64:67], v5, s[72:75], s52 offen offset:2048 sc1
    buffer_load_dwordx4 v[68:71], v5, s[72:75], s53 offen offset:2048 sc1
    buffer_load_dwordx4 v[72:75], v5, s[72:75], s54 offen offset:2048 sc1
    buffer_load_dwordx4 v[76:79], v5, s[72:75], s55 offen offset:2048 sc1
    s_waitcnt vmcnt(0)
    s_branch parallel_ck22
parallel_ckx23:
    v_lshlrev_b32 v16, 16, v64
    v_and_b32 v17, s61, v64
    v_lshlrev_b32 v18, 16, v68
    v_and_b32 v19, s61, v68
    v_lshlrev_b32 v20, 16, v72
    v_and_b32 v21, s61, v72
    v_lshlrev_b32 v22, 16, v76
    v_and_b32 v23, s61, v76
    v_lshlrev_b32 v24, 16, v12
    v_and_b32 v25, s61, v12
    v_pk_add_f32 v[16:17], v[16:17], v[18:19]
    v_pk_add_f32 v[104:105], v[104:105], v[20:21]
    v_pk_add_f32 v[22:23], v[22:23], v[24:25]
    v_pk_add_f32 v[104:105], v[104:105], v[16:17]
    v_pk_add_f32 v[104:105], v[104:105], v[22:23]
    v_lshlrev_b32 v16, 16, v65
    v_and_b32 v17, s61, v65
    v_lshlrev_b32 v18, 16, v69
    v_and_b32 v19, s61, v69
    v_lshlrev_b32 v20, 16, v73
    v_and_b32 v21, s61, v73
    v_lshlrev_b32 v22, 16, v77
    v_and_b32 v23, s61, v77
    v_lshlrev_b32 v24, 16, v13
    v_and_b32 v25, s61, v13
    v_pk_add_f32 v[16:17], v[16:17], v[18:19]
    v_pk_add_f32 v[106:107], v[106:107], v[20:21]
    v_pk_add_f32 v[22:23], v[22:23], v[24:25]
    v_pk_add_f32 v[106:107], v[106:107], v[16:17]
    v_pk_add_f32 v[106:107], v[106:107], v[22:23]
    buffer_store_dwordx4 v[104:107], v3, s[80:83], s86 offen offset:0 sc1
    v_lshlrev_b32 v16, 16, v66
    v_and_b32 v17, s61, v66
    v_lshlrev_b32 v18, 16, v70
    v_and_b32 v19, s61, v70
    v_lshlrev_b32 v20, 16, v74
    v_and_b32 v21, s61, v74
    v_lshlrev_b32 v22, 16, v78
    v_and_b32 v23, s61, v78
    v_lshlrev_b32 v24, 16, v14
    v_and_b32 v25, s61, v14
    v_pk_add_f32 v[16:17], v[16:17], v[18:19]
    v_pk_add_f32 v[168:169], v[168:169], v[20:21]
    v_pk_add_f32 v[22:23], v[22:23], v[24:25]
    v_pk_add_f32 v[168:169], v[168:169], v[16:17]
    v_pk_add_f32 v[168:169], v[168:169], v[22:23]
    v_lshlrev_b32 v16, 16, v67
    v_and_b32 v17, s61, v67
    v_lshlrev_b32 v18, 16, v71
    v_and_b32 v19, s61, v71
    v_lshlrev_b32 v20, 16, v75
    v_and_b32 v21, s61, v75
    v_lshlrev_b32 v22, 16, v79
    v_and_b32 v23, s61, v79
    v_lshlrev_b32 v24, 16, v15
    v_and_b32 v25, s61, v15
    v_pk_add_f32 v[16:17], v[16:17], v[18:19]
    v_pk_add_f32 v[170:171], v[170:171], v[20:21]
    v_pk_add_f32 v[22:23], v[22:23], v[24:25]
    v_pk_add_f32 v[170:171], v[170:171], v[16:17]
    v_pk_add_f32 v[170:171], v[170:171], v[22:23]
    buffer_store_dwordx4 v[168:171], v3, s[80:83], s86 offen offset:64 sc1
    s_branch parallel_done24
parallel_done24:
    s_endpgm
parallel_ssm2:
    s_load_dwordx4 s[20:23], s[0:1], 40
    s_load_dwordx2 s[72:73], s[0:1], 32
    s_load_dwordx2 s[74:75], s[0:1], 56
    s_load_dwordx4 s[68:71], s[0:1], 16
    s_load_dwordx2 s[96:97], s[0:1], 8
    s_bfe_u32 s8, s7, 0x10002
    s_lshl_b32 s9, s6, 1
    s_add_u32 s8, s8, s9
    s_and_b32 s9, s7, 3
    s_lshl_b32 s10, s5, 2
    s_add_u32 s9, s9, s10
    s_lshl_b32 s10, s9, 2
    s_add_u32 s10, s10, s4
    v_lshrrev_b32 v107, 3, v2
    v_and_b32 v108, 7, v2
    v_lshrrev_b32 v109, 1, v107
    s_lshr_b32 s11, s4, 1
    s_lshl_b32 s12, s11, 2
    v_or_b32 v109, s12, v109
    v_xor_b32 v108, v108, v109
    s_and_b32 s12, s4, 1
    s_mul_i32 s13, s12, 40
    v_add_u32 v107, s13, v107
    v_mul_u32_u24 v107, 1152, v107
    v_lshl_add_u32 v96, v108, 4, v107
    v_add_u32 v97, 8192, v96
    v_add_u32 v98, 16384, v96
    v_add_u32 v99, 24576, v96
    v_add_u32 v100, 36864, v96
    v_min_u32 v102, 17, v2
    s_mul_i32 s13, s4, 18
    v_add_u32 v102, s13, v102
    s_mul_i32 s14, s8, 144
    v_lshl_add_u32 v103, v102, 1, s14
    s_waitcnt lgkmcnt(0)
    s_cmp_ge_u32 s4, 2
    s_cselect_b32 s26, s72, s70
    s_cselect_b32 s27, s73, s71
    s_mul_i32 s14, s8, 82944
    s_add_u32 s36, s26, s14
    s_addc_u32 s37, s27, 0
    s_mov_b32 s38, 0x14400
    s_mov_b32 s39, 0x20000
    s_mul_i32 s28, s11, 10240
    s_mul_i32 s13, s12, 5120
    s_add_u32 s28, s28, s13
    s_mov_b32 s80, s96
    s_mov_b32 s81, s97
    s_mov_b32 s82, 0x480
    s_mov_b32 s83, 0x20000
    s_mov_b32 s84, s68
    s_mov_b32 s85, s69
    s_mov_b32 s86, 0x480
    s_mov_b32 s87, 0x20000
    s_mov_b32 s88, s74
    s_mov_b32 s89, s75
    s_mov_b32 s90, 0x480
    s_mov_b32 s91, 0x20000
    buffer_load_ushort v104, v103, s[80:83], 0 offen
    buffer_load_ushort v105, v103, s[84:87], 0 offen
    buffer_load_ushort v106, v103, s[88:91], 0 offen
    s_and_b32 s13, s7, 3
    s_lshl_b32 s13, s13, 1
    s_bfe_u32 s64, s7, 0x10002
    s_mul_i32 s64, s64, 3
    s_add_u32 s13, s13, s64
    s_add_u32 s13, s13, 2
    s_cmp_ge_u32 s13, 9
    s_cselect_b32 s64, 9, 0
    s_sub_u32 s13, s13, s64
    s_cmp_ge_u32 s13, 9
    s_cselect_b32 s64, 9, 0
    s_sub_u32 s13, s13, s64
    s_nop 4
    s_cmp_ge_u32 s13, 3
    s_cselect_b32 s64, 3, 0
    s_sub_u32 s13, s13, s64
    s_cmp_ge_u32 s13, 3
    s_cselect_b32 s64, 3, 0
    s_sub_u32 s13, s13, s64
    s_mul_i32 s76, s13, 128
    s_add_u32 s79, s76, 384
    s_add_u32 s82, s76, 768
    s_mul_i32 s85, s13, 8192
    s_add_u32 s88, s85, 24576
    s_add_u32 s91, s85, 49152
    s_add_u32 s13, s13, 1
    s_cmp_eq_u32 s13, 3
    s_cselect_b32 s13, 0, s13
    s_mul_i32 s77, s13, 128
    s_add_u32 s80, s77, 384
    s_add_u32 s83, s77, 768
    s_mul_i32 s86, s13, 8192
    s_add_u32 s89, s86, 24576
    s_add_u32 s92, s86, 49152
    s_add_u32 s13, s13, 1
    s_cmp_eq_u32 s13, 3
    s_cselect_b32 s13, 0, s13
    s_mul_i32 s78, s13, 128
    s_add_u32 s81, s78, 384
    s_add_u32 s84, s78, 768
    s_mul_i32 s87, s13, 8192
    s_add_u32 s90, s87, 24576
    s_add_u32 s93, s87, 49152
    s_add_u32 m0, s28, 0
    s_nop 0
    buffer_load_dwordx4 v96, s[36:39], s76 offen offset:0 lds
    buffer_load_dwordx4 v97, s[36:39], s76 offen offset:1024 lds
    buffer_load_dwordx4 v98, s[36:39], s76 offen offset:2048 lds
    buffer_load_dwordx4 v99, s[36:39], s76 offen offset:3072 lds
    s_add_u32 m0, s28, 4096
    s_nop 0
    buffer_load_dwordx4 v100, s[36:39], s76 offen offset:0 lds
    s_add_u32 m0, s28, 20480
    s_nop 0
    buffer_load_dwordx4 v96, s[36:39], s77 offen offset:0 lds
    buffer_load_dwordx4 v97, s[36:39], s77 offen offset:1024 lds
    buffer_load_dwordx4 v98, s[36:39], s77 offen offset:2048 lds
    buffer_load_dwordx4 v99, s[36:39], s77 offen offset:3072 lds
    s_add_u32 m0, s28, 24576
    s_nop 0
    buffer_load_dwordx4 v100, s[36:39], s77 offen offset:0 lds
    s_mov_b32 s48, s32
    s_mov_b32 s49, s33
    s_mov_b32 s50, 0x240000
    s_mov_b32 s51, 0x20000
    s_mov_b32 s45, 0xffff0000
    v_lshlrev_b32 v13, 7, v6
    v_lshl_add_u32 v13, v7, 4, v13
    v_add_u32 v13, 147456, v13
    v_add_u32 v14, 6144, v13
    v_cndmask_b32 v13, v14, v13, vcc
    s_waitcnt vmcnt(14)
    v_lshlrev_b32 v40, 16, v16
    v_and_b32 v41, s45, v16
    v_lshlrev_b32 v42, 16, v17
    v_and_b32 v43, s45, v17
    v_lshlrev_b32 v44, 16, v18
    v_and_b32 v45, s45, v18
    v_lshlrev_b32 v46, 16, v19
    v_and_b32 v47, s45, v19
    v_lshlrev_b32 v48, 16, v20
    v_and_b32 v49, s45, v20
    v_lshlrev_b32 v50, 16, v21
    v_and_b32 v51, s45, v21
    v_lshlrev_b32 v52, 16, v22
    v_and_b32 v53, s45, v22
    v_lshlrev_b32 v54, 16, v23
    v_and_b32 v55, s45, v23
    v_lshlrev_b32 v56, 16, v24
    v_and_b32 v57, s45, v24
    v_lshlrev_b32 v58, 16, v25
    v_and_b32 v59, s45, v25
    v_lshlrev_b32 v60, 16, v26
    v_and_b32 v61, s45, v26
    v_lshlrev_b32 v62, 16, v27
    v_and_b32 v63, s45, v27
    v_pk_add_f32 v[92:93], v[40:41], v[42:43]
    v_pk_add_f32 v[94:95], v[44:45], v[46:47]
    v_pk_add_f32 v[92:93], v[92:93], v[48:49]
    v_pk_add_f32 v[94:95], v[94:95], v[50:51]
    v_pk_add_f32 v[92:93], v[92:93], v[52:53]
    v_pk_add_f32 v[94:95], v[94:95], v[54:55]
    v_pk_add_f32 v[92:93], v[92:93], v[56:57]
    v_pk_add_f32 v[94:95], v[94:95], v[58:59]
    v_pk_add_f32 v[92:93], v[92:93], v[60:61]
    v_pk_add_f32 v[94:95], v[94:95], v[62:63]
    v_pk_add_f32 v[92:93], v[92:93], v[94:95]
    v_add_f32 v92, v92, v93
    s_nop 1
    v_add_f32_dpp v92, v92, v92 row_ror:8 row_mask:0xf bank_mask:0xf
    s_nop 1
    v_add_f32_dpp v92, v92, v92 row_ror:4 row_mask:0xf bank_mask:0xf
    s_nop 1
    v_add_f32_dpp v92, v92, v92 row_ror:2 row_mask:0xf bank_mask:0xf
    s_nop 1
    v_add_f32_dpp v92, v92, v92 row_ror:1 row_mask:0xf bank_mask:0xf
    v_mov_b32 v93, v92
    s_nop 1
    v_permlane16_swap_b32 v92, v93
    v_add_f32 v92, v92, v93
    v_mul_f32 v92, 0x3ae38e39, v92
    v_cvt_pk_bf16_f32 v93, v92, v92
    v_lshlrev_b32 v90, 16, v93
    v_sub_f32 v88, v92, v90
    v_pk_add_f32 v[64:65], v[40:41], v[90:91] op_sel_hi:[1,0] neg_lo:[0,1] neg_hi:[0,1]
    v_pk_add_f32 v[66:67], v[42:43], v[90:91] op_sel_hi:[1,0] neg_lo:[0,1] neg_hi:[0,1]
    v_pk_add_f32 v[68:69], v[44:45], v[90:91] op_sel_hi:[1,0] neg_lo:[0,1] neg_hi:[0,1]
    v_pk_add_f32 v[70:71], v[46:47], v[90:91] op_sel_hi:[1,0] neg_lo:[0,1] neg_hi:[0,1]
    v_pk_add_f32 v[72:73], v[48:49], v[90:91] op_sel_hi:[1,0] neg_lo:[0,1] neg_hi:[0,1]
    v_pk_add_f32 v[74:75], v[50:51], v[90:91] op_sel_hi:[1,0] neg_lo:[0,1] neg_hi:[0,1]
    v_pk_add_f32 v[76:77], v[52:53], v[90:91] op_sel_hi:[1,0] neg_lo:[0,1] neg_hi:[0,1]
    v_pk_add_f32 v[78:79], v[54:55], v[90:91] op_sel_hi:[1,0] neg_lo:[0,1] neg_hi:[0,1]
    v_pk_add_f32 v[80:81], v[56:57], v[90:91] op_sel_hi:[1,0] neg_lo:[0,1] neg_hi:[0,1]
    v_pk_add_f32 v[82:83], v[58:59], v[90:91] op_sel_hi:[1,0] neg_lo:[0,1] neg_hi:[0,1]
    v_pk_add_f32 v[84:85], v[60:61], v[90:91] op_sel_hi:[1,0] neg_lo:[0,1] neg_hi:[0,1]
    v_pk_add_f32 v[86:87], v[62:63], v[90:91] op_sel_hi:[1,0] neg_lo:[0,1] neg_hi:[0,1]
    v_pk_mul_f32 v[92:93], v[64:65], v[64:65]
    v_pk_mul_f32 v[94:95], v[66:67], v[66:67]
    v_pk_fma_f32 v[92:93], v[68:69], v[68:69], v[92:93]
    v_pk_fma_f32 v[94:95], v[70:71], v[70:71], v[94:95]
    v_pk_fma_f32 v[92:93], v[72:73], v[72:73], v[92:93]
    v_pk_fma_f32 v[94:95], v[74:75], v[74:75], v[94:95]
    v_pk_fma_f32 v[92:93], v[76:77], v[76:77], v[92:93]
    v_pk_fma_f32 v[94:95], v[78:79], v[78:79], v[94:95]
    v_pk_fma_f32 v[92:93], v[80:81], v[80:81], v[92:93]
    v_pk_fma_f32 v[94:95], v[82:83], v[82:83], v[94:95]
    v_pk_fma_f32 v[92:93], v[84:85], v[84:85], v[92:93]
    v_pk_fma_f32 v[94:95], v[86:87], v[86:87], v[94:95]
    v_pk_add_f32 v[92:93], v[92:93], v[94:95]
    v_add_f32 v92, v92, v93
    v_mul_f32 v92, v92, v12
    v_cvt_pk_bf16_f32 v16, v64, v65
    v_cvt_pk_bf16_f32 v17, v66, v67
    v_cvt_pk_bf16_f32 v18, v68, v69
    v_cvt_pk_bf16_f32 v19, v70, v71
    v_cvt_pk_bf16_f32 v20, v72, v73
    v_cvt_pk_bf16_f32 v21, v74, v75
    v_cvt_pk_bf16_f32 v22, v76, v77
    v_cvt_pk_bf16_f32 v23, v78, v79
    v_cvt_pk_bf16_f32 v24, v80, v81
    v_cvt_pk_bf16_f32 v25, v82, v83
    v_cvt_pk_bf16_f32 v26, v84, v85
    v_cvt_pk_bf16_f32 v27, v86, v87
    v_add_f32_dpp v92, v92, v92 row_ror:8 row_mask:0xf bank_mask:0xf
    s_nop 1
    v_add_f32_dpp v92, v92, v92 row_ror:4 row_mask:0xf bank_mask:0xf
    s_nop 1
    v_add_f32_dpp v92, v92, v92 row_ror:2 row_mask:0xf bank_mask:0xf
    s_nop 1
    v_add_f32_dpp v92, v92, v92 row_ror:1 row_mask:0xf bank_mask:0xf
    v_mov_b32 v93, v92
    s_nop 1
    v_permlane16_swap_b32 v92, v93
    v_add_f32 v92, v92, v93
    v_mul_f32 v92, 0x3ae38e39, v92
    v_fma_f32 v92, -v88, v88, v92
    v_max_f32 v92, 0, v92
    v_cvt_pk_bf16_f32 v92, v92, v92
    v_lshlrev_b32 v92, 16, v92
    v_add_f32 v92, 0x3727c5ac, v92
    v_cvt_pk_bf16_f32 v92, v92, v92
    v_lshlrev_b32 v92, 16, v92
    v_sqrt_f32 v92, v92
    v_lshlrev_b32 v64, 16, v16
    v_and_b32 v65, s45, v16
    v_lshlrev_b32 v66, 16, v17
    v_and_b32 v67, s45, v17
    v_lshlrev_b32 v68, 16, v18
    v_and_b32 v69, s45, v18
    v_lshlrev_b32 v70, 16, v19
    v_and_b32 v71, s45, v19
    v_lshlrev_b32 v72, 16, v20
    v_and_b32 v73, s45, v20
    v_lshlrev_b32 v74, 16, v21
    v_and_b32 v75, s45, v21
    v_lshlrev_b32 v76, 16, v22
    v_and_b32 v77, s45, v22
    v_lshlrev_b32 v78, 16, v23
    v_and_b32 v79, s45, v23
    v_lshlrev_b32 v80, 16, v24
    v_and_b32 v81, s45, v24
    v_lshlrev_b32 v82, 16, v25
    v_and_b32 v83, s45, v25
    v_lshlrev_b32 v84, 16, v26
    v_and_b32 v85, s45, v26
    v_lshlrev_b32 v86, 16, v27
    v_and_b32 v87, s45, v27
    v_cvt_pk_bf16_f32 v92, v92, v92
    v_lshlrev_b32 v92, 16, v92
    v_rcp_f32 v92, v92
    s_nop 0
    v_pk_mul_f32 v[64:65], v[64:65], v[92:93] op_sel_hi:[1,0]
    v_pk_mul_f32 v[66:67], v[66:67], v[92:93] op_sel_hi:[1,0]
    v_pk_mul_f32 v[68:69], v[68:69], v[92:93] op_sel_hi:[1,0]
    v_pk_mul_f32 v[70:71], v[70:71], v[92:93] op_sel_hi:[1,0]
    v_cvt_pk_bf16_f32 v16, v64, v65
    v_cvt_pk_bf16_f32 v17, v66, v67
    v_cvt_pk_bf16_f32 v18, v68, v69
    v_cvt_pk_bf16_f32 v19, v70, v71
    ds_write_b128 v13, v[16:19] offset:0
    v_pk_mul_f32 v[72:73], v[72:73], v[92:93] op_sel_hi:[1,0]
    v_pk_mul_f32 v[74:75], v[74:75], v[92:93] op_sel_hi:[1,0]
    v_pk_mul_f32 v[76:77], v[76:77], v[92:93] op_sel_hi:[1,0]
    v_pk_mul_f32 v[78:79], v[78:79], v[92:93] op_sel_hi:[1,0]
    v_cvt_pk_bf16_f32 v20, v72, v73
    v_cvt_pk_bf16_f32 v21, v74, v75
    v_cvt_pk_bf16_f32 v22, v76, v77
    v_cvt_pk_bf16_f32 v23, v78, v79
    ds_write_b128 v13, v[20:23] offset:3072
    v_pk_mul_f32 v[80:81], v[80:81], v[92:93] op_sel_hi:[1,0]
    v_pk_mul_f32 v[82:83], v[82:83], v[92:93] op_sel_hi:[1,0]
    v_pk_mul_f32 v[84:85], v[84:85], v[92:93] op_sel_hi:[1,0]
    v_pk_mul_f32 v[86:87], v[86:87], v[92:93] op_sel_hi:[1,0]
    v_cvt_pk_bf16_f32 v24, v80, v81
    v_cvt_pk_bf16_f32 v25, v82, v83
    v_cvt_pk_bf16_f32 v26, v84, v85
    v_cvt_pk_bf16_f32 v27, v86, v87
    ds_write_b128 v13, v[24:27] offset:6144
    v_lshrrev_b32 v14, 5, v2
    v_lshlrev_b32 v14, 12, v14
    v_bfe_u32 v15, v0, 3, 2
    v_lshl_add_u32 v14, v15, 8, v14
    v_and_b32 v15, 7, v0
    v_lshl_add_u32 v14, v15, 4, v14
    s_mul_i32 s44, s4, 3072
    s_add_u32 s44, s44, 147456
    v_add_u32 v15, s44, v5
    s_mul_i32 s43, s40, 73728
    s_lshl_b32 s44, s41, 10
    s_add_u32 s43, s43, s44
    s_lshl_b32 s44, s42, 4
    s_add_u32 s43, s43, s44
    s_mul_i32 s44, s4, 24576
    s_add_u32 s43, s43, s44
    s_cmp_eq_u32 s4, 3
    s_cselect_b32 s43, 0x7f000000, s43
    s_add_u32 s44, s43, 8192
    s_add_u32 s46, s43, 16384
    v_mov_b32 v88, 0
    v_mov_b32 v91, 158720
    ds_write_b32 v91, v88
    buffer_load_dword v89, v88, s[56:59], 0 offen sc1
    s_waitcnt lgkmcnt(0)
    s_barrier
    ds_read_b128 v[64:67], v15 offset:0
    ds_read_b128 v[68:71], v15 offset:1024
    ds_read_b128 v[72:75], v15 offset:2048
    s_add_u32 s52, s32, 0x1c00000
    s_addc_u32 s53, s33, 0
    s_mov_b32 s54, 0x240000
    s_mov_b32 s55, 0x20000
    v_mul_u32_u24 v10, 1152, v9
    v_lshl_add_u32 v10, v6, 4, v10
    v_cndmask_b32 v10, v11, v10, vcc
    s_waitcnt lgkmcnt(2)
    buffer_store_dwordx4 v[64:67], v14, s[48:51], s43 offen sc1
    s_waitcnt lgkmcnt(1)
    buffer_store_dwordx4 v[68:71], v14, s[48:51], s44 offen sc1
    s_waitcnt lgkmcnt(0)
    buffer_store_dwordx4 v[72:75], v14, s[48:51], s46 offen sc1
    v_lshlrev_b32 v78, 16, v16
    v_and_b32 v79, s45, v16
    v_lshlrev_b32 v80, 16, v28
    v_and_b32 v81, s45, v28
    v_pk_mul_f32 v[78:79], v[78:79], v[80:81]
    v_cvt_pk_bf16_f32 v80, v78, v79
    v_lshlrev_b32 v78, 16, v80
    v_and_b32 v79, s45, v80
    v_pk_add_f32 v[78:79], v[40:41], v[78:79]
    v_cvt_pk_bf16_f32 v40, v78, v79
    v_lshlrev_b32 v82, 16, v17
    v_and_b32 v83, s45, v17
    v_lshlrev_b32 v84, 16, v29
    v_and_b32 v85, s45, v29
    v_pk_mul_f32 v[82:83], v[82:83], v[84:85]
    v_cvt_pk_bf16_f32 v84, v82, v83
    v_lshlrev_b32 v82, 16, v84
    v_and_b32 v83, s45, v84
    v_pk_add_f32 v[82:83], v[42:43], v[82:83]
    v_cvt_pk_bf16_f32 v41, v82, v83
    v_lshlrev_b32 v78, 16, v18
    v_and_b32 v79, s45, v18
    v_lshlrev_b32 v80, 16, v30
    v_and_b32 v81, s45, v30
    v_pk_mul_f32 v[78:79], v[78:79], v[80:81]
    v_cvt_pk_bf16_f32 v80, v78, v79
    v_lshlrev_b32 v78, 16, v80
    v_and_b32 v79, s45, v80
    v_pk_add_f32 v[78:79], v[44:45], v[78:79]
    v_cvt_pk_bf16_f32 v42, v78, v79
    v_lshlrev_b32 v82, 16, v19
    v_and_b32 v83, s45, v19
    v_lshlrev_b32 v84, 16, v31
    v_and_b32 v85, s45, v31
    v_pk_mul_f32 v[82:83], v[82:83], v[84:85]
    v_cvt_pk_bf16_f32 v84, v82, v83
    v_lshlrev_b32 v82, 16, v84
    v_and_b32 v83, s45, v84
    v_pk_add_f32 v[82:83], v[46:47], v[82:83]
    v_cvt_pk_bf16_f32 v43, v82, v83
    v_lshlrev_b32 v78, 16, v20
    v_and_b32 v79, s45, v20
    v_lshlrev_b32 v80, 16, v32
    v_and_b32 v81, s45, v32
    v_pk_mul_f32 v[78:79], v[78:79], v[80:81]
    v_cvt_pk_bf16_f32 v80, v78, v79
    v_lshlrev_b32 v78, 16, v80
    v_and_b32 v79, s45, v80
    v_pk_add_f32 v[78:79], v[48:49], v[78:79]
    v_cvt_pk_bf16_f32 v44, v78, v79
    v_lshlrev_b32 v82, 16, v21
    v_and_b32 v83, s45, v21
    v_lshlrev_b32 v84, 16, v33
    v_and_b32 v85, s45, v33
    v_pk_mul_f32 v[82:83], v[82:83], v[84:85]
    v_cvt_pk_bf16_f32 v84, v82, v83
    v_lshlrev_b32 v82, 16, v84
    v_and_b32 v83, s45, v84
    v_pk_add_f32 v[82:83], v[50:51], v[82:83]
    v_cvt_pk_bf16_f32 v45, v82, v83
    v_lshlrev_b32 v78, 16, v22
    v_and_b32 v79, s45, v22
    v_lshlrev_b32 v80, 16, v34
    v_and_b32 v81, s45, v34
    v_pk_mul_f32 v[78:79], v[78:79], v[80:81]
    v_cvt_pk_bf16_f32 v80, v78, v79
    v_lshlrev_b32 v78, 16, v80
    v_and_b32 v79, s45, v80
    v_pk_add_f32 v[78:79], v[52:53], v[78:79]
    v_cvt_pk_bf16_f32 v46, v78, v79
    v_lshlrev_b32 v82, 16, v23
    v_and_b32 v83, s45, v23
    v_lshlrev_b32 v84, 16, v35
    v_and_b32 v85, s45, v35
    v_pk_mul_f32 v[82:83], v[82:83], v[84:85]
    v_cvt_pk_bf16_f32 v84, v82, v83
    v_lshlrev_b32 v82, 16, v84
    v_and_b32 v83, s45, v84
    v_pk_add_f32 v[82:83], v[54:55], v[82:83]
    v_cvt_pk_bf16_f32 v47, v82, v83
    v_lshlrev_b32 v78, 16, v24
    v_and_b32 v79, s45, v24
    v_lshlrev_b32 v80, 16, v36
    v_and_b32 v81, s45, v36
    v_pk_mul_f32 v[78:79], v[78:79], v[80:81]
    v_cvt_pk_bf16_f32 v80, v78, v79
    v_lshlrev_b32 v78, 16, v80
    v_and_b32 v79, s45, v80
    v_pk_add_f32 v[78:79], v[56:57], v[78:79]
    v_cvt_pk_bf16_f32 v48, v78, v79
    v_lshlrev_b32 v82, 16, v25
    v_and_b32 v83, s45, v25
    v_lshlrev_b32 v84, 16, v37
    v_and_b32 v85, s45, v37
    v_pk_mul_f32 v[82:83], v[82:83], v[84:85]
    v_cvt_pk_bf16_f32 v84, v82, v83
    v_lshlrev_b32 v82, 16, v84
    v_and_b32 v83, s45, v84
    v_pk_add_f32 v[82:83], v[58:59], v[82:83]
    v_cvt_pk_bf16_f32 v49, v82, v83
    v_lshlrev_b32 v78, 16, v26
    v_and_b32 v79, s45, v26
    v_lshlrev_b32 v80, 16, v38
    v_and_b32 v81, s45, v38
    v_pk_mul_f32 v[78:79], v[78:79], v[80:81]
    v_cvt_pk_bf16_f32 v80, v78, v79
    v_lshlrev_b32 v78, 16, v80
    v_and_b32 v79, s45, v80
    v_pk_add_f32 v[78:79], v[60:61], v[78:79]
    v_cvt_pk_bf16_f32 v50, v78, v79
    v_lshlrev_b32 v82, 16, v27
    v_and_b32 v83, s45, v27
    v_lshlrev_b32 v84, 16, v39
    v_and_b32 v85, s45, v39
    v_pk_mul_f32 v[82:83], v[82:83], v[84:85]
    v_cvt_pk_bf16_f32 v84, v82, v83
    v_lshlrev_b32 v82, 16, v84
    v_and_b32 v83, s45, v84
    v_pk_add_f32 v[82:83], v[62:63], v[82:83]
    v_cvt_pk_bf16_f32 v51, v82, v83
    buffer_store_dwordx4 v[40:43], v10, s[52:55], 0 offen offset:0 sc1
    buffer_store_dwordx4 v[44:47], v10, s[52:55], 0 offen offset:384 sc1
    buffer_store_dwordx4 v[48:51], v10, s[52:55], 0 offen offset:768 sc1
    s_add_u32 s48, s32, 0x2280000
    s_addc_u32 s49, s33, 0
    s_mov_b32 s50, 0x100000
    s_mov_b32 s51, 0x20000
    s_waitcnt vmcnt(3)
    s_mov_b32 s44, 0
parallel_nl25:
    v_readfirstlane_b32 s3, v89
    s_nop 0
    s_cmp_lg_u32 s3, 0
    s_cbranch_scc1 parallel_no26
    s_add_u32 s44, s44, 1
    s_cmp_gt_u32 s44, 131072
    s_cbranch_scc1 parallel_no26
    v_mov_b32 v88, 0
    buffer_load_dword v89, v88, s[56:59], 0 offen sc1
    s_waitcnt vmcnt(0)
    s_branch parallel_nl25
parallel_no26:
    v_mov_b32 v91, s3
    v_mov_b32 v88, 158720
    v_mov_b32 v90, 1
    s_mov_b64 exec, 1
    ds_add_rtn_u32 v90, v88, v90
    s_mov_b64 exec, -1
    s_lshl_b32 s43, s2, 7
    s_add_u32 s43, s43, 131072
    v_lshlrev_b32 v88, 2, v6
    s_waitcnt lgkmcnt(0)
    v_readfirstlane_b32 s29, v90
    s_nop 0
    s_cmp_lg_u32 s29, 3
    s_cbranch_scc1 parallel_pf27
    buffer_store_dword v91, v88, s[48:51], s43 offen sc1
parallel_pf27:
    s_add_u32 m0, s28, 40960
    s_nop 0
    buffer_load_dwordx4 v96, s[36:39], s78 offen offset:0 lds
    buffer_load_dwordx4 v97, s[36:39], s78 offen offset:1024 lds
    buffer_load_dwordx4 v98, s[36:39], s78 offen offset:2048 lds
    buffer_load_dwordx4 v99, s[36:39], s78 offen offset:3072 lds
    s_add_u32 m0, s28, 45056
    s_nop 0
    buffer_load_dwordx4 v100, s[36:39], s78 offen offset:0 lds
    s_add_u32 m0, s28, 61440
    s_nop 0
    buffer_load_dwordx4 v96, s[36:39], s79 offen offset:0 lds
    buffer_load_dwordx4 v97, s[36:39], s79 offen offset:1024 lds
    buffer_load_dwordx4 v98, s[36:39], s79 offen offset:2048 lds
    buffer_load_dwordx4 v99, s[36:39], s79 offen offset:3072 lds
    s_add_u32 m0, s28, 65536
    s_nop 0
    buffer_load_dwordx4 v100, s[36:39], s79 offen offset:0 lds
    v_lshlrev_b32 v104, 16, v104
    v_lshlrev_b32 v105, 16, v105
    v_lshlrev_b32 v106, 16, v106
    v_mul_f32 v106, 0x3fb8aa3b, v106
    v_exp_f32 v106, v106
    s_nop 0
    v_cvt_pk_bf16_f32 v106, v106, v106
    v_lshlrev_b32 v106, 16, v106
    v_mul_f32 v16, v106, v104
    v_mul_f32 v17, v106, v105
    v_mul_f32 v16, 0x3fb8aa3b, v16
    v_exp_f32 v16, v16
    v_mul_f32 v17, 0.15915494, v17
    v_rndne_f32 v18, v17
    v_sub_f32 v17, v17, v18
    v_cos_f32 v18, v17
    v_sin_f32 v19, v17
    v_mul_f32 v32, v16, v18
    v_mul_f32 v33, v16, v19
    v_add_f32 v16, -1.0, v32
    v_mul_f32 v17, v104, v104
    v_fmac_f32 v17, v105, v105
    v_rcp_f32 v17, v17
    v_mul_f32 v18, v16, v104
    v_fmac_f32 v18, v33, v105
    v_mul_f32 v19, v33, v104
    v_fma_f32 v19, -v16, v105, v19
    v_mul_f32 v34, v18, v17
    v_mul_f32 v35, v19, v17
    v_sub_f32 v33, 0, v33
    v_mul_f32 v30, v33, v33
    v_mul_f32 v17, v32, v33
    v_fma_f32 v16, v32, v32, -v30
    v_add_f32 v17, v17, v17
    v_mul_f32 v30, v17, v17
    v_mul_f32 v17, v16, v17
    v_fma_f32 v16, v16, v16, -v30
    v_add_f32 v17, v17, v17
    v_mul_f32 v30, v17, v17
    v_mul_f32 v17, v16, v17
    v_fma_f32 v16, v16, v16, -v30
    v_add_f32 v17, v17, v17
    v_mul_f32 v30, v17, v17
    v_mul_f32 v17, v16, v17
    v_fma_f32 v16, v16, v16, -v30
    v_add_f32 v17, v17, v17
    v_mul_f32 v30, v17, v17
    v_mul_f32 v19, v16, v17
    v_fma_f32 v18, v16, v16, -v30
    v_add_f32 v19, v19, v19
    v_mul_f32 v20, v16, v18
    v_mul_f32 v21, v16, v19
    v_fma_f32 v20, -v17, v19, v20
    v_fmac_f32 v21, v17, v18
    v_mul_f32 v30, v19, v19
    v_mul_f32 v23, v18, v19
    v_fma_f32 v22, v18, v18, -v30
    v_add_f32 v23, v23, v23
    v_mul_f32 v30, v23, v23
    v_mul_f32 v25, v22, v23
    v_fma_f32 v24, v22, v22, -v30
    v_add_f32 v25, v25, v25
    v_mul_f32 v30, v25, v25
    v_mul_f32 v25, v24, v25
    v_fma_f32 v24, v24, v24, -v30
    v_add_f32 v25, v25, v25
    v_mul_f32 v30, v25, v25
    v_mul_f32 v25, v24, v25
    v_fma_f32 v24, v24, v24, -v30
    v_add_f32 v25, v25, v25
    v_mul_f32 v30, v25, v25
    v_mul_f32 v27, v24, v25
    v_fma_f32 v26, v24, v24, -v30
    v_add_f32 v27, v27, v27
    v_mul_f32 v28, v24, v26
    v_mul_f32 v29, v24, v27
    v_fma_f32 v28, -v25, v27, v28
    v_fmac_f32 v29, v25, v26
    v_lshlrev_b32 v36, 6, v102
    v_add_u32 v36, 122880, v36
    v_lshlrev_b32 v37, 7, v102
    v_add_u32 v37, 127488, v37
    v_mul_f32 v64, 1.0, v32
    v_mul_f32 v65, -1.0, v33
    v_mul_f32 v66, 2.0, v34
    v_mul_f32 v67, -2.0, v35
    v_mul_f32 v68, 1.0, v16
    v_mul_f32 v69, 1.0, v17
    v_mul_f32 v70, 1.0, v22
    v_mul_f32 v71, 1.0, v23
    ds_write_b128 v36, v[64:67] offset:0
    ds_write_b128 v36, v[68:71] offset:16
    v_mov_b32 v72, 1.0
    v_mov_b32 v73, 0
    v_mov_b32 v74, 1.0
    v_mov_b32 v75, 0
    ds_write_b128 v37, v[72:75] offset:0
    v_mul_f32 v76, 1.0, v16
    v_mul_f32 v77, 1.0, v17
    v_mul_f32 v78, 1.0, v24
    v_mul_f32 v79, 1.0, v25
    ds_write_b128 v37, v[76:79] offset:16
    v_mul_f32 v80, 1.0, v18
    v_mul_f32 v81, 1.0, v19
    v_mul_f32 v82, 1.0, v26
    v_mul_f32 v83, 1.0, v27
    ds_write_b128 v37, v[80:83] offset:32
    v_mul_f32 v84, 1.0, v20
    v_mul_f32 v85, 1.0, v21
    v_mul_f32 v86, 1.0, v28
    v_mul_f32 v87, 1.0, v29
    ds_write_b128 v37, v[84:87] offset:48
    s_waitcnt lgkmcnt(0)
    v_mul_f32 v64, 1.0, v32
    v_mul_f32 v65, 1.0, v33
    v_mul_f32 v66, -2.0, v34
    v_mul_f32 v67, -2.0, v35
    v_mul_f32 v68, 1.0, v16
    v_mul_f32 v69, -1.0, v17
    v_mul_f32 v70, 1.0, v22
    v_mul_f32 v71, -1.0, v23
    ds_write_b128 v36, v[64:67] offset:32
    ds_write_b128 v36, v[68:71] offset:48
    v_mov_b32 v72, 1.0
    v_mov_b32 v73, 0
    v_mov_b32 v74, 1.0
    v_mov_b32 v75, 0
    ds_write_b128 v37, v[72:75] offset:64
    v_mul_f32 v76, 1.0, v16
    v_mul_f32 v77, -1.0, v17
    v_mul_f32 v78, 1.0, v24
    v_mul_f32 v79, -1.0, v25
    ds_write_b128 v37, v[76:79] offset:80
    v_mul_f32 v80, 1.0, v18
    v_mul_f32 v81, -1.0, v19
    v_mul_f32 v82, 1.0, v26
    v_mul_f32 v83, -1.0, v27
    ds_write_b128 v37, v[80:83] offset:96
    v_mul_f32 v84, 1.0, v20
    v_mul_f32 v85, -1.0, v21
    v_mul_f32 v86, 1.0, v28
    v_mul_f32 v87, -1.0, v29
    ds_write_b128 v37, v[84:87] offset:112
    s_waitcnt lgkmcnt(0)
    s_mul_i32 s14, s10, 73728
    s_add_u32 s60, s32, s14
    s_addc_u32 s61, s33, 0
    s_mov_b32 s62, 0x12000
    s_mov_b32 s63, 0x20000
    s_lshl_b32 s43, s10, 10
    s_add_u32 s43, s43, 131072
    v_and_b32 v15, 7, v0
    v_lshlrev_b32 v15, 7, v15
    s_mov_b32 s44, 0
parallel_poll29:
    buffer_load_dwordx4 v[92:95], v15, s[48:51], s43 offen sc1
    s_add_u32 s44, s44, 1
    s_cmp_gt_u32 s44, 131072
    s_waitcnt vmcnt(0)
    s_cbranch_scc1 parallel_lw28
    v_xor_b32 v92, s3, v92
    v_xor_b32 v93, s3, v93
    v_xor_b32 v94, s3, v94
    v_or3_b32 v92, v92, v93, v94
    v_cmp_ne_u32 vcc, 0, v92
    s_cbranch_vccnz parallel_poll29
parallel_lw28:
    s_add_u32 s31, s85, 0
    buffer_load_dwordx4 a[0:3], v5, s[60:63], s31 offen offset:0 sc1
    buffer_load_dwordx4 a[4:7], v5, s[60:63], s31 offen offset:1024 sc1
    buffer_load_dwordx4 a[8:11], v5, s[60:63], s31 offen offset:2048 sc1
    buffer_load_dwordx4 a[12:15], v5, s[60:63], s31 offen offset:3072 sc1
    s_add_u32 s31, s85, 4096
    buffer_load_dwordx4 a[16:19], v5, s[60:63], s31 offen offset:0 sc1
    buffer_load_dwordx4 a[20:23], v5, s[60:63], s31 offen offset:1024 sc1
    buffer_load_dwordx4 a[24:27], v5, s[60:63], s31 offen offset:2048 sc1
    buffer_load_dwordx4 a[28:31], v5, s[60:63], s31 offen offset:3072 sc1
    s_add_u32 s31, s86, 0
    buffer_load_dwordx4 a[32:35], v5, s[60:63], s31 offen offset:0 sc1
    buffer_load_dwordx4 a[36:39], v5, s[60:63], s31 offen offset:1024 sc1
    buffer_load_dwordx4 a[40:43], v5, s[60:63], s31 offen offset:2048 sc1
    buffer_load_dwordx4 a[44:47], v5, s[60:63], s31 offen offset:3072 sc1
    s_barrier
    s_add_u32 s56, s32, 0x2280000
    s_addc_u32 s57, s33, 0
    s_mov_b32 s58, 0x100000
    s_mov_b32 s59, 0x20000
    v_mov_b32 v8, v96
    v_mov_b32 v9, v97
    v_mov_b32 v10, v98
    v_mov_b32 v11, v99
    v_mov_b32 v12, v100
    v_and_b32 v6, 7, v2
    v_bfe_u32 v7, v2, 3, 1
    v_lshrrev_b32 v13, 1, v6
    v_lshl_add_u32 v13, v7, 2, v13
    v_xor_b32 v13, v13, v4
    v_lshlrev_b32 v18, 6, v6
    v_lshl_add_u32 v18, v7, 5, v18
    v_add_u32 v18, 122880, v18
    v_lshlrev_b32 v19, 7, v6
    v_lshl_add_u32 v19, v7, 6, v19
    v_lshl_add_u32 v19, v4, 4, v19
    v_add_u32 v19, 127488, v19
    v_mul_u32_u24 v7, 10240, v7
    v_lshl_add_u32 v7, v6, 7, v7
    v_lshl_add_u32 v14, v13, 4, v7
    v_xor_b32 v13, 4, v13
    v_lshl_add_u32 v15, v13, 4, v7
    v_add_u32 v16, 61440, v14
    v_add_u32 v17, 61440, v15
    s_add_u32 s44, s32, 0x300000
    s_addc_u32 s45, s33, 0
    s_mov_b32 s46, 0x1680000
    s_mov_b32 s47, 0x20000
    ds_read_b128 v[40:43], v14 offset:0
    ds_read_b128 v[44:47], v14 offset:1024
    ds_read_b128 v[48:51], v14 offset:2048
    ds_read_b128 v[52:55], v14 offset:3072
    ds_read_b128 v[56:59], v14 offset:4096
    ds_read_b128 v[60:63], v14 offset:5120
    ds_read_b128 v[64:67], v14 offset:6144
    ds_read_b128 v[68:71], v14 offset:7168
    ds_read_b128 v[72:75], v14 offset:8192
    s_waitcnt vmcnt(8) lgkmcnt(8)
    v_mfma_f32_16x16x32_bf16 v[112:115], a[0:3], v[40:43], 0
    ds_read_b128 v[76:79], v15 offset:0
    v_mfma_f32_16x16x32_bf16 v[116:119], a[4:7], v[40:43], 0
    v_mfma_f32_16x16x32_bf16 v[120:123], a[8:11], v[40:43], 0
    s_add_u32 m0, s28, 81920
    s_nop 0
    buffer_load_dwordx4 v8, s[36:39], s80 offen offset:0 lds
    v_mfma_f32_16x16x32_bf16 v[124:127], a[12:15], v[40:43], 0
    s_waitcnt lgkmcnt(8)
    v_mfma_f32_16x16x32_bf16 v[128:131], a[0:3], v[44:47], 0
    ds_read_b128 v[80:83], v15 offset:1024
    v_mfma_f32_16x16x32_bf16 v[132:135], a[4:7], v[44:47], 0
    v_mfma_f32_16x16x32_bf16 v[136:139], a[8:11], v[44:47], 0
    s_add_u32 s31, s86, 4096
    buffer_load_dwordx4 a[48:51], v5, s[60:63], s31 offen offset:0 sc1
    v_mfma_f32_16x16x32_bf16 v[140:143], a[12:15], v[44:47], 0
    s_waitcnt lgkmcnt(8)
    v_mfma_f32_16x16x32_bf16 v[144:147], a[0:3], v[48:51], 0
    ds_read_b128 v[84:87], v15 offset:2048
    v_mfma_f32_16x16x32_bf16 v[148:151], a[4:7], v[48:51], 0
    v_mfma_f32_16x16x32_bf16 v[152:155], a[8:11], v[48:51], 0
    buffer_load_dwordx4 v9, s[36:39], s80 offen offset:1024 lds
    v_mfma_f32_16x16x32_bf16 v[156:159], a[12:15], v[48:51], 0
    s_waitcnt lgkmcnt(8)
    v_mfma_f32_16x16x32_bf16 v[160:163], a[0:3], v[52:55], 0
    ds_read_b128 v[40:43], v15 offset:3072
    v_mfma_f32_16x16x32_bf16 v[164:167], a[4:7], v[52:55], 0
    v_mfma_f32_16x16x32_bf16 v[168:171], a[8:11], v[52:55], 0
    buffer_load_dwordx4 a[52:55], v5, s[60:63], s31 offen offset:1024 sc1
    v_mfma_f32_16x16x32_bf16 v[172:175], a[12:15], v[52:55], 0
    s_waitcnt lgkmcnt(8)
    v_mfma_f32_16x16x32_bf16 v[176:179], a[0:3], v[56:59], 0
    ds_read_b128 v[44:47], v15 offset:4096
    v_mfma_f32_16x16x32_bf16 v[180:183], a[4:7], v[56:59], 0
    v_mfma_f32_16x16x32_bf16 v[184:187], a[8:11], v[56:59], 0
    buffer_load_dwordx4 v10, s[36:39], s80 offen offset:2048 lds
    v_mfma_f32_16x16x32_bf16 v[188:191], a[12:15], v[56:59], 0
    s_waitcnt lgkmcnt(8)
    v_mfma_f32_16x16x32_bf16 v[192:195], a[0:3], v[60:63], 0
    ds_read_b128 v[48:51], v15 offset:5120
    v_mfma_f32_16x16x32_bf16 v[196:199], a[4:7], v[60:63], 0
    v_mfma_f32_16x16x32_bf16 v[200:203], a[8:11], v[60:63], 0
    buffer_load_dwordx4 a[56:59], v5, s[60:63], s31 offen offset:2048 sc1
    v_mfma_f32_16x16x32_bf16 v[204:207], a[12:15], v[60:63], 0
    s_waitcnt lgkmcnt(8)
    v_mfma_f32_16x16x32_bf16 v[208:211], a[0:3], v[64:67], 0
    ds_read_b128 v[52:55], v15 offset:6144
    v_mfma_f32_16x16x32_bf16 v[212:215], a[4:7], v[64:67], 0
    v_mfma_f32_16x16x32_bf16 v[216:219], a[8:11], v[64:67], 0
    buffer_load_dwordx4 v11, s[36:39], s80 offen offset:3072 lds
    v_mfma_f32_16x16x32_bf16 v[220:223], a[12:15], v[64:67], 0
    s_waitcnt lgkmcnt(8)
    v_mfma_f32_16x16x32_bf16 v[224:227], a[0:3], v[68:71], 0
    ds_read_b128 v[56:59], v15 offset:7168
    v_mfma_f32_16x16x32_bf16 v[228:231], a[4:7], v[68:71], 0
    v_mfma_f32_16x16x32_bf16 v[232:235], a[8:11], v[68:71], 0
    buffer_load_dwordx4 a[60:63], v5, s[60:63], s31 offen offset:3072 sc1
    v_mfma_f32_16x16x32_bf16 v[236:239], a[12:15], v[68:71], 0
    s_waitcnt lgkmcnt(8)
    v_mfma_f32_16x16x32_bf16 v[240:243], a[0:3], v[72:75], 0
    ds_read_b128 v[60:63], v15 offset:8192
    v_mfma_f32_16x16x32_bf16 v[244:247], a[4:7], v[72:75], 0
    v_mfma_f32_16x16x32_bf16 v[248:251], a[8:11], v[72:75], 0
    s_add_u32 m0, s28, 86016
    s_nop 0
    buffer_load_dwordx4 v12, s[36:39], s80 offen offset:0 lds
    v_mfma_f32_16x16x32_bf16 v[252:255], a[12:15], v[72:75], 0
    s_waitcnt vmcnt(13) lgkmcnt(8)
    v_mfma_f32_16x16x32_bf16 v[112:115], a[16:19], v[76:79], v[112:115]
    ds_read_b128 v[64:67], v14 offset:20480
    v_mfma_f32_16x16x32_bf16 v[116:119], a[20:23], v[76:79], v[116:119]
    v_mfma_f32_16x16x32_bf16 v[120:123], a[24:27], v[76:79], v[120:123]
    s_add_u32 s31, s87, 0
    buffer_load_dwordx4 a[64:67], v5, s[60:63], s31 offen offset:0 sc1
    v_mfma_f32_16x16x32_bf16 v[124:127], a[28:31], v[76:79], v[124:127]
    s_waitcnt lgkmcnt(8)
    v_mfma_f32_16x16x32_bf16 v[128:131], a[16:19], v[80:83], v[128:131]
    ds_read_b128 v[68:71], v14 offset:21504
    v_mfma_f32_16x16x32_bf16 v[132:135], a[20:23], v[80:83], v[132:135]
    v_mfma_f32_16x16x32_bf16 v[136:139], a[24:27], v[80:83], v[136:139]
    s_add_u32 m0, s28, 102400
    s_nop 0
    buffer_load_dwordx4 v8, s[36:39], s81 offen offset:0 lds
    v_mfma_f32_16x16x32_bf16 v[140:143], a[28:31], v[80:83], v[140:143]
    s_waitcnt lgkmcnt(8)
    v_mfma_f32_16x16x32_bf16 v[144:147], a[16:19], v[84:87], v[144:147]
    ds_read_b128 v[72:75], v14 offset:22528
    v_mfma_f32_16x16x32_bf16 v[148:151], a[20:23], v[84:87], v[148:151]
    v_mfma_f32_16x16x32_bf16 v[152:155], a[24:27], v[84:87], v[152:155]
    buffer_load_dwordx4 a[68:71], v5, s[60:63], s31 offen offset:1024 sc1
    v_mfma_f32_16x16x32_bf16 v[156:159], a[28:31], v[84:87], v[156:159]
    s_waitcnt lgkmcnt(8)
    v_mfma_f32_16x16x32_bf16 v[160:163], a[16:19], v[40:43], v[160:163]
    ds_read_b128 v[76:79], v14 offset:23552
    v_mfma_f32_16x16x32_bf16 v[164:167], a[20:23], v[40:43], v[164:167]
    v_mfma_f32_16x16x32_bf16 v[168:171], a[24:27], v[40:43], v[168:171]
    buffer_load_dwordx4 v9, s[36:39], s81 offen offset:1024 lds
    v_mfma_f32_16x16x32_bf16 v[172:175], a[28:31], v[40:43], v[172:175]
    s_waitcnt lgkmcnt(8)
    v_mfma_f32_16x16x32_bf16 v[176:179], a[16:19], v[44:47], v[176:179]
    ds_read_b128 v[80:83], v14 offset:24576
    v_mfma_f32_16x16x32_bf16 v[180:183], a[20:23], v[44:47], v[180:183]
    v_mfma_f32_16x16x32_bf16 v[184:187], a[24:27], v[44:47], v[184:187]
    buffer_load_dwordx4 a[72:75], v5, s[60:63], s31 offen offset:2048 sc1
    v_mfma_f32_16x16x32_bf16 v[188:191], a[28:31], v[44:47], v[188:191]
    s_waitcnt lgkmcnt(8)
    v_mfma_f32_16x16x32_bf16 v[192:195], a[16:19], v[48:51], v[192:195]
    ds_read_b128 v[84:87], v14 offset:25600
    v_mfma_f32_16x16x32_bf16 v[196:199], a[20:23], v[48:51], v[196:199]
    v_mfma_f32_16x16x32_bf16 v[200:203], a[24:27], v[48:51], v[200:203]
    buffer_load_dwordx4 v10, s[36:39], s81 offen offset:2048 lds
    v_mfma_f32_16x16x32_bf16 v[204:207], a[28:31], v[48:51], v[204:207]
    s_waitcnt lgkmcnt(8)
    v_mfma_f32_16x16x32_bf16 v[208:211], a[16:19], v[52:55], v[208:211]
    ds_read_b128 v[40:43], v14 offset:26624
    v_mfma_f32_16x16x32_bf16 v[212:215], a[20:23], v[52:55], v[212:215]
    v_mfma_f32_16x16x32_bf16 v[216:219], a[24:27], v[52:55], v[216:219]
    buffer_load_dwordx4 a[76:79], v5, s[60:63], s31 offen offset:3072 sc1
    v_mfma_f32_16x16x32_bf16 v[220:223], a[28:31], v[52:55], v[220:223]
    s_waitcnt lgkmcnt(8)
    v_mfma_f32_16x16x32_bf16 v[224:227], a[16:19], v[56:59], v[224:227]
    ds_read_b128 v[44:47], v14 offset:27648
    v_mfma_f32_16x16x32_bf16 v[228:231], a[20:23], v[56:59], v[228:231]
    v_mfma_f32_16x16x32_bf16 v[232:235], a[24:27], v[56:59], v[232:235]
    buffer_load_dwordx4 v11, s[36:39], s81 offen offset:3072 lds
    v_mfma_f32_16x16x32_bf16 v[236:239], a[28:31], v[56:59], v[236:239]
    s_waitcnt lgkmcnt(8)
    v_mfma_f32_16x16x32_bf16 v[240:243], a[16:19], v[60:63], v[240:243]
    ds_read_b128 v[48:51], v14 offset:28672
    v_mfma_f32_16x16x32_bf16 v[244:247], a[20:23], v[60:63], v[244:247]
    v_mfma_f32_16x16x32_bf16 v[248:251], a[24:27], v[60:63], v[248:251]
    s_add_u32 s31, s87, 4096
    buffer_load_dwordx4 a[80:83], v5, s[60:63], s31 offen offset:0 sc1
    v_mfma_f32_16x16x32_bf16 v[252:255], a[28:31], v[60:63], v[252:255]
    s_waitcnt vmcnt(18) lgkmcnt(8)
    v_mfma_f32_16x16x32_bf16 v[112:115], a[32:35], v[64:67], v[112:115]
    ds_read_b128 v[52:55], v15 offset:20480
    v_mfma_f32_16x16x32_bf16 v[116:119], a[36:39], v[64:67], v[116:119]
    v_mfma_f32_16x16x32_bf16 v[120:123], a[40:43], v[64:67], v[120:123]
    s_add_u32 m0, s28, 106496
    s_nop 0
    buffer_load_dwordx4 v12, s[36:39], s81 offen offset:0 lds
    v_mfma_f32_16x16x32_bf16 v[124:127], a[44:47], v[64:67], v[124:127]
    s_waitcnt lgkmcnt(8)
    v_mfma_f32_16x16x32_bf16 v[128:131], a[32:35], v[68:71], v[128:131]
    ds_read_b128 v[56:59], v15 offset:21504
    v_mfma_f32_16x16x32_bf16 v[132:135], a[36:39], v[68:71], v[132:135]
    v_mfma_f32_16x16x32_bf16 v[136:139], a[40:43], v[68:71], v[136:139]
    buffer_load_dwordx4 a[84:87], v5, s[60:63], s31 offen offset:1024 sc1
    v_mfma_f32_16x16x32_bf16 v[140:143], a[44:47], v[68:71], v[140:143]
    s_waitcnt lgkmcnt(8)
    v_mfma_f32_16x16x32_bf16 v[144:147], a[32:35], v[72:75], v[144:147]
    ds_read_b128 v[60:63], v15 offset:22528
    v_mfma_f32_16x16x32_bf16 v[148:151], a[36:39], v[72:75], v[148:151]
    v_mfma_f32_16x16x32_bf16 v[152:155], a[40:43], v[72:75], v[152:155]
    buffer_load_dwordx4 a[88:91], v5, s[60:63], s31 offen offset:2048 sc1
    v_mfma_f32_16x16x32_bf16 v[156:159], a[44:47], v[72:75], v[156:159]
    s_waitcnt lgkmcnt(8)
    v_mfma_f32_16x16x32_bf16 v[160:163], a[32:35], v[76:79], v[160:163]
    ds_read_b128 v[64:67], v15 offset:23552
    v_mfma_f32_16x16x32_bf16 v[164:167], a[36:39], v[76:79], v[164:167]
    v_mfma_f32_16x16x32_bf16 v[168:171], a[40:43], v[76:79], v[168:171]
    buffer_load_dwordx4 a[92:95], v5, s[60:63], s31 offen offset:3072 sc1
    v_mfma_f32_16x16x32_bf16 v[172:175], a[44:47], v[76:79], v[172:175]
    s_waitcnt lgkmcnt(8)
    v_mfma_f32_16x16x32_bf16 v[176:179], a[32:35], v[80:83], v[176:179]
    ds_read_b128 v[68:71], v15 offset:24576
    v_mfma_f32_16x16x32_bf16 v[180:183], a[36:39], v[80:83], v[180:183]
    v_mfma_f32_16x16x32_bf16 v[184:187], a[40:43], v[80:83], v[184:187]
    s_add_u32 s31, s88, 0
    buffer_load_dwordx4 a[96:99], v5, s[60:63], s31 offen offset:0 sc1
    v_mfma_f32_16x16x32_bf16 v[188:191], a[44:47], v[80:83], v[188:191]
    s_waitcnt lgkmcnt(8)
    v_mfma_f32_16x16x32_bf16 v[192:195], a[32:35], v[84:87], v[192:195]
    ds_read_b128 v[72:75], v15 offset:25600
    v_mfma_f32_16x16x32_bf16 v[196:199], a[36:39], v[84:87], v[196:199]
    v_mfma_f32_16x16x32_bf16 v[200:203], a[40:43], v[84:87], v[200:203]
    buffer_load_dwordx4 a[100:103], v5, s[60:63], s31 offen offset:1024 sc1
    v_mfma_f32_16x16x32_bf16 v[204:207], a[44:47], v[84:87], v[204:207]
    s_waitcnt lgkmcnt(8)
    v_mfma_f32_16x16x32_bf16 v[208:211], a[32:35], v[40:43], v[208:211]
    ds_read_b128 v[76:79], v15 offset:26624
    v_mfma_f32_16x16x32_bf16 v[212:215], a[36:39], v[40:43], v[212:215]
    v_mfma_f32_16x16x32_bf16 v[216:219], a[40:43], v[40:43], v[216:219]
    buffer_load_dwordx4 a[104:107], v5, s[60:63], s31 offen offset:2048 sc1
    v_mfma_f32_16x16x32_bf16 v[220:223], a[44:47], v[40:43], v[220:223]
    s_waitcnt lgkmcnt(8)
    v_mfma_f32_16x16x32_bf16 v[224:227], a[32:35], v[44:47], v[224:227]
    ds_read_b128 v[80:83], v15 offset:27648
    v_mfma_f32_16x16x32_bf16 v[228:231], a[36:39], v[44:47], v[228:231]
    v_mfma_f32_16x16x32_bf16 v[232:235], a[40:43], v[44:47], v[232:235]
    buffer_load_dwordx4 a[108:111], v5, s[60:63], s31 offen offset:3072 sc1
    v_mfma_f32_16x16x32_bf16 v[236:239], a[44:47], v[44:47], v[236:239]
    s_waitcnt lgkmcnt(8)
    v_mfma_f32_16x16x32_bf16 v[240:243], a[32:35], v[48:51], v[240:243]
    ds_read_b128 v[84:87], v15 offset:28672
    v_mfma_f32_16x16x32_bf16 v[244:247], a[36:39], v[48:51], v[244:247]
    v_mfma_f32_16x16x32_bf16 v[248:251], a[40:43], v[48:51], v[248:251]
    s_add_u32 s31, s88, 4096
    buffer_load_dwordx4 a[112:115], v5, s[60:63], s31 offen offset:0 sc1
    v_mfma_f32_16x16x32_bf16 v[252:255], a[44:47], v[48:51], v[252:255]
    s_waitcnt vmcnt(39)
    s_barrier
    s_waitcnt vmcnt(19) lgkmcnt(8)
    v_mfma_f32_16x16x32_bf16 v[112:115], a[48:51], v[52:55], v[112:115]
    ds_read_b128 v[40:43], v14 offset:40960
    v_mfma_f32_16x16x32_bf16 v[116:119], a[52:55], v[52:55], v[116:119]
    v_mfma_f32_16x16x32_bf16 v[120:123], a[56:59], v[52:55], v[120:123]
    buffer_load_dwordx4 a[116:119], v5, s[60:63], s31 offen offset:1024 sc1
    v_mfma_f32_16x16x32_bf16 v[124:127], a[60:63], v[52:55], v[124:127]
    s_waitcnt lgkmcnt(8)
    v_mfma_f32_16x16x32_bf16 v[128:131], a[48:51], v[56:59], v[128:131]
    ds_read_b128 v[44:47], v14 offset:41984
    v_mfma_f32_16x16x32_bf16 v[132:135], a[52:55], v[56:59], v[132:135]
    v_mfma_f32_16x16x32_bf16 v[136:139], a[56:59], v[56:59], v[136:139]
    buffer_load_dwordx4 a[120:123], v5, s[60:63], s31 offen offset:2048 sc1
    v_mfma_f32_16x16x32_bf16 v[140:143], a[60:63], v[56:59], v[140:143]
    s_waitcnt lgkmcnt(8)
    v_mfma_f32_16x16x32_bf16 v[144:147], a[48:51], v[60:63], v[144:147]
    ds_read_b128 v[48:51], v14 offset:43008
    v_mfma_f32_16x16x32_bf16 v[148:151], a[52:55], v[60:63], v[148:151]
    v_mfma_f32_16x16x32_bf16 v[152:155], a[56:59], v[60:63], v[152:155]
    buffer_load_dwordx4 a[124:127], v5, s[60:63], s31 offen offset:3072 sc1
    v_mfma_f32_16x16x32_bf16 v[156:159], a[60:63], v[60:63], v[156:159]
    s_waitcnt lgkmcnt(8)
    v_mfma_f32_16x16x32_bf16 v[160:163], a[48:51], v[64:67], v[160:163]
    ds_read_b128 v[52:55], v14 offset:44032
    v_mfma_f32_16x16x32_bf16 v[164:167], a[52:55], v[64:67], v[164:167]
    v_mfma_f32_16x16x32_bf16 v[168:171], a[56:59], v[64:67], v[168:171]
    s_add_u32 s31, s89, 0
    buffer_load_dwordx4 a[128:131], v5, s[60:63], s31 offen offset:0 sc1
    v_mfma_f32_16x16x32_bf16 v[172:175], a[60:63], v[64:67], v[172:175]
    s_waitcnt lgkmcnt(8)
    v_mfma_f32_16x16x32_bf16 v[176:179], a[48:51], v[68:71], v[176:179]
    ds_read_b128 v[56:59], v14 offset:45056
    v_mfma_f32_16x16x32_bf16 v[180:183], a[52:55], v[68:71], v[180:183]
    v_mfma_f32_16x16x32_bf16 v[184:187], a[56:59], v[68:71], v[184:187]
    buffer_load_dwordx4 a[132:135], v5, s[60:63], s31 offen offset:1024 sc1
    v_mfma_f32_16x16x32_bf16 v[188:191], a[60:63], v[68:71], v[188:191]
    s_waitcnt lgkmcnt(8)
    v_mfma_f32_16x16x32_bf16 v[192:195], a[48:51], v[72:75], v[192:195]
    ds_read_b128 v[60:63], v14 offset:46080
    v_mfma_f32_16x16x32_bf16 v[196:199], a[52:55], v[72:75], v[196:199]
    v_mfma_f32_16x16x32_bf16 v[200:203], a[56:59], v[72:75], v[200:203]
    buffer_load_dwordx4 a[136:139], v5, s[60:63], s31 offen offset:2048 sc1
    v_mfma_f32_16x16x32_bf16 v[204:207], a[60:63], v[72:75], v[204:207]
    s_waitcnt lgkmcnt(8)
    v_mfma_f32_16x16x32_bf16 v[208:211], a[48:51], v[76:79], v[208:211]
    ds_read_b128 v[64:67], v14 offset:47104
    v_mfma_f32_16x16x32_bf16 v[212:215], a[52:55], v[76:79], v[212:215]
    v_mfma_f32_16x16x32_bf16 v[216:219], a[56:59], v[76:79], v[216:219]
    buffer_load_dwordx4 a[140:143], v5, s[60:63], s31 offen offset:3072 sc1
    v_mfma_f32_16x16x32_bf16 v[220:223], a[60:63], v[76:79], v[220:223]
    s_waitcnt lgkmcnt(8)
    v_mfma_f32_16x16x32_bf16 v[224:227], a[48:51], v[80:83], v[224:227]
    ds_read_b128 v[68:71], v14 offset:48128
    v_mfma_f32_16x16x32_bf16 v[228:231], a[52:55], v[80:83], v[228:231]
    v_mfma_f32_16x16x32_bf16 v[232:235], a[56:59], v[80:83], v[232:235]
    s_add_u32 s31, s89, 4096
    buffer_load_dwordx4 a[144:147], v5, s[60:63], s31 offen offset:0 sc1
    v_mfma_f32_16x16x32_bf16 v[236:239], a[60:63], v[80:83], v[236:239]
    s_waitcnt lgkmcnt(8)
    v_mfma_f32_16x16x32_bf16 v[240:243], a[48:51], v[84:87], v[240:243]
    ds_read_b128 v[72:75], v14 offset:49152
    v_mfma_f32_16x16x32_bf16 v[244:247], a[52:55], v[84:87], v[244:247]
    v_mfma_f32_16x16x32_bf16 v[248:251], a[56:59], v[84:87], v[248:251]
    buffer_load_dwordx4 a[148:151], v5, s[60:63], s31 offen offset:1024 sc1
    v_mfma_f32_16x16x32_bf16 v[252:255], a[60:63], v[84:87], v[252:255]
    s_waitcnt vmcnt(20) lgkmcnt(8)
    v_mfma_f32_16x16x32_bf16 v[112:115], a[64:67], v[40:43], v[112:115]
    ds_read_b128 v[76:79], v15 offset:40960
    v_mfma_f32_16x16x32_bf16 v[116:119], a[68:71], v[40:43], v[116:119]
    v_mfma_f32_16x16x32_bf16 v[120:123], a[72:75], v[40:43], v[120:123]
    buffer_load_dwordx4 a[152:155], v5, s[60:63], s31 offen offset:2048 sc1
    v_mfma_f32_16x16x32_bf16 v[124:127], a[76:79], v[40:43], v[124:127]
    s_waitcnt lgkmcnt(8)
    v_mfma_f32_16x16x32_bf16 v[128:131], a[64:67], v[44:47], v[128:131]
    ds_read_b128 v[80:83], v15 offset:41984
    v_mfma_f32_16x16x32_bf16 v[132:135], a[68:71], v[44:47], v[132:135]
    v_mfma_f32_16x16x32_bf16 v[136:139], a[72:75], v[44:47], v[136:139]
    buffer_load_dwordx4 a[156:159], v5, s[60:63], s31 offen offset:3072 sc1
    v_mfma_f32_16x16x32_bf16 v[140:143], a[76:79], v[44:47], v[140:143]
    s_waitcnt lgkmcnt(8)
    v_mfma_f32_16x16x32_bf16 v[144:147], a[64:67], v[48:51], v[144:147]
    ds_read_b128 v[84:87], v15 offset:43008
    v_mfma_f32_16x16x32_bf16 v[148:151], a[68:71], v[48:51], v[148:151]
    v_mfma_f32_16x16x32_bf16 v[152:155], a[72:75], v[48:51], v[152:155]
    s_add_u32 s31, s90, 0
    buffer_load_dwordx4 a[160:163], v5, s[60:63], s31 offen offset:0 sc1
    v_mfma_f32_16x16x32_bf16 v[156:159], a[76:79], v[48:51], v[156:159]
    s_waitcnt lgkmcnt(8)
    v_mfma_f32_16x16x32_bf16 v[160:163], a[64:67], v[52:55], v[160:163]
    ds_read_b128 v[40:43], v15 offset:44032
    v_mfma_f32_16x16x32_bf16 v[164:167], a[68:71], v[52:55], v[164:167]
    v_mfma_f32_16x16x32_bf16 v[168:171], a[72:75], v[52:55], v[168:171]
    s_add_u32 m0, s28, 0
    s_nop 0
    buffer_load_dwordx4 v8, s[36:39], s82 offen offset:0 lds
    v_mfma_f32_16x16x32_bf16 v[172:175], a[76:79], v[52:55], v[172:175]
    s_waitcnt lgkmcnt(8)
    v_mfma_f32_16x16x32_bf16 v[176:179], a[64:67], v[56:59], v[176:179]
    ds_read_b128 v[44:47], v15 offset:45056
    v_mfma_f32_16x16x32_bf16 v[180:183], a[68:71], v[56:59], v[180:183]
    v_mfma_f32_16x16x32_bf16 v[184:187], a[72:75], v[56:59], v[184:187]
    buffer_load_dwordx4 a[164:167], v5, s[60:63], s31 offen offset:1024 sc1
    v_mfma_f32_16x16x32_bf16 v[188:191], a[76:79], v[56:59], v[188:191]
    s_waitcnt lgkmcnt(8)
    v_mfma_f32_16x16x32_bf16 v[192:195], a[64:67], v[60:63], v[192:195]
    ds_read_b128 v[48:51], v15 offset:46080
    v_mfma_f32_16x16x32_bf16 v[196:199], a[68:71], v[60:63], v[196:199]
    v_mfma_f32_16x16x32_bf16 v[200:203], a[72:75], v[60:63], v[200:203]
    buffer_load_dwordx4 a[168:171], v5, s[60:63], s31 offen offset:2048 sc1
    v_mfma_f32_16x16x32_bf16 v[204:207], a[76:79], v[60:63], v[204:207]
    s_waitcnt lgkmcnt(8)
    v_mfma_f32_16x16x32_bf16 v[208:211], a[64:67], v[64:67], v[208:211]
    ds_read_b128 v[52:55], v15 offset:47104
    v_mfma_f32_16x16x32_bf16 v[212:215], a[68:71], v[64:67], v[212:215]
    v_mfma_f32_16x16x32_bf16 v[216:219], a[72:75], v[64:67], v[216:219]
    buffer_load_dwordx4 v9, s[36:39], s82 offen offset:1024 lds
    v_mfma_f32_16x16x32_bf16 v[220:223], a[76:79], v[64:67], v[220:223]
    s_waitcnt lgkmcnt(8)
    v_mfma_f32_16x16x32_bf16 v[224:227], a[64:67], v[68:71], v[224:227]
    ds_read_b128 v[56:59], v15 offset:48128
    v_mfma_f32_16x16x32_bf16 v[228:231], a[68:71], v[68:71], v[228:231]
    v_mfma_f32_16x16x32_bf16 v[232:235], a[72:75], v[68:71], v[232:235]
    buffer_load_dwordx4 a[172:175], v5, s[60:63], s31 offen offset:3072 sc1
    v_mfma_f32_16x16x32_bf16 v[236:239], a[76:79], v[68:71], v[236:239]
    s_waitcnt lgkmcnt(8)
    v_mfma_f32_16x16x32_bf16 v[240:243], a[64:67], v[72:75], v[240:243]
    ds_read_b128 v[60:63], v15 offset:49152
    v_mfma_f32_16x16x32_bf16 v[244:247], a[68:71], v[72:75], v[244:247]
    v_mfma_f32_16x16x32_bf16 v[248:251], a[72:75], v[72:75], v[248:251]
    v_mfma_f32_16x16x32_bf16 v[252:255], a[76:79], v[72:75], v[252:255]
    s_waitcnt vmcnt(22) lgkmcnt(8)
    v_mfma_f32_16x16x32_bf16 v[112:115], a[80:83], v[76:79], v[112:115]
    ds_read_b128 v[64:67], v16 offset:0
    v_mfma_f32_16x16x32_bf16 v[116:119], a[84:87], v[76:79], v[116:119]
    v_mfma_f32_16x16x32_bf16 v[120:123], a[88:91], v[76:79], v[120:123]
    buffer_load_dwordx4 v10, s[36:39], s82 offen offset:2048 lds
    v_mfma_f32_16x16x32_bf16 v[124:127], a[92:95], v[76:79], v[124:127]
    s_waitcnt lgkmcnt(8)
    v_mfma_f32_16x16x32_bf16 v[128:131], a[80:83], v[80:83], v[128:131]
    ds_read_b128 v[68:71], v16 offset:1024
    v_mfma_f32_16x16x32_bf16 v[132:135], a[84:87], v[80:83], v[132:135]
    v_mfma_f32_16x16x32_bf16 v[136:139], a[88:91], v[80:83], v[136:139]
    s_add_u32 s31, s90, 4096
    buffer_load_dwordx4 a[176:179], v5, s[60:63], s31 offen offset:0 sc1
    v_mfma_f32_16x16x32_bf16 v[140:143], a[92:95], v[80:83], v[140:143]
    s_waitcnt lgkmcnt(8)
    v_mfma_f32_16x16x32_bf16 v[144:147], a[80:83], v[84:87], v[144:147]
    ds_read_b128 v[72:75], v16 offset:2048
    v_mfma_f32_16x16x32_bf16 v[148:151], a[84:87], v[84:87], v[148:151]
    v_mfma_f32_16x16x32_bf16 v[152:155], a[88:91], v[84:87], v[152:155]
    buffer_load_dwordx4 a[180:183], v5, s[60:63], s31 offen offset:1024 sc1
    v_mfma_f32_16x16x32_bf16 v[156:159], a[92:95], v[84:87], v[156:159]
    s_waitcnt lgkmcnt(8)
    v_mfma_f32_16x16x32_bf16 v[160:163], a[80:83], v[40:43], v[160:163]
    ds_read_b128 v[76:79], v16 offset:3072
    v_mfma_f32_16x16x32_bf16 v[164:167], a[84:87], v[40:43], v[164:167]
    v_mfma_f32_16x16x32_bf16 v[168:171], a[88:91], v[40:43], v[168:171]
    buffer_load_dwordx4 v11, s[36:39], s82 offen offset:3072 lds
    v_mfma_f32_16x16x32_bf16 v[172:175], a[92:95], v[40:43], v[172:175]
    s_waitcnt lgkmcnt(8)
    v_mfma_f32_16x16x32_bf16 v[176:179], a[80:83], v[44:47], v[176:179]
    ds_read_b128 v[80:83], v16 offset:4096
    v_mfma_f32_16x16x32_bf16 v[180:183], a[84:87], v[44:47], v[180:183]
    v_mfma_f32_16x16x32_bf16 v[184:187], a[88:91], v[44:47], v[184:187]
    buffer_load_dwordx4 a[184:187], v5, s[60:63], s31 offen offset:2048 sc1
    v_mfma_f32_16x16x32_bf16 v[188:191], a[92:95], v[44:47], v[188:191]
    s_waitcnt lgkmcnt(8)
    v_mfma_f32_16x16x32_bf16 v[192:195], a[80:83], v[48:51], v[192:195]
    ds_read_b128 v[84:87], v16 offset:5120
    v_mfma_f32_16x16x32_bf16 v[196:199], a[84:87], v[48:51], v[196:199]
    v_mfma_f32_16x16x32_bf16 v[200:203], a[88:91], v[48:51], v[200:203]
    buffer_load_dwordx4 a[188:191], v5, s[60:63], s31 offen offset:3072 sc1
    v_mfma_f32_16x16x32_bf16 v[204:207], a[92:95], v[48:51], v[204:207]
    s_waitcnt lgkmcnt(8)
    v_mfma_f32_16x16x32_bf16 v[208:211], a[80:83], v[52:55], v[208:211]
    ds_read_b128 v[40:43], v16 offset:6144
    v_mfma_f32_16x16x32_bf16 v[212:215], a[84:87], v[52:55], v[212:215]
    v_mfma_f32_16x16x32_bf16 v[216:219], a[88:91], v[52:55], v[216:219]
    s_add_u32 m0, s28, 4096
    s_nop 0
    buffer_load_dwordx4 v12, s[36:39], s82 offen offset:0 lds
    v_mfma_f32_16x16x32_bf16 v[220:223], a[92:95], v[52:55], v[220:223]
    s_waitcnt lgkmcnt(8)
    v_mfma_f32_16x16x32_bf16 v[224:227], a[80:83], v[56:59], v[224:227]
    ds_read_b128 v[44:47], v16 offset:7168
    v_mfma_f32_16x16x32_bf16 v[228:231], a[84:87], v[56:59], v[228:231]
    v_mfma_f32_16x16x32_bf16 v[232:235], a[88:91], v[56:59], v[232:235]
    v_mfma_f32_16x16x32_bf16 v[236:239], a[92:95], v[56:59], v[236:239]
    s_waitcnt lgkmcnt(8)
    v_mfma_f32_16x16x32_bf16 v[240:243], a[80:83], v[60:63], v[240:243]
    ds_read_b128 v[48:51], v16 offset:8192
    v_mfma_f32_16x16x32_bf16 v[244:247], a[84:87], v[60:63], v[244:247]
    v_mfma_f32_16x16x32_bf16 v[248:251], a[88:91], v[60:63], v[248:251]
    v_mfma_f32_16x16x32_bf16 v[252:255], a[92:95], v[60:63], v[252:255]
    s_waitcnt vmcnt(25) lgkmcnt(8)
    v_mfma_f32_16x16x32_bf16 v[112:115], a[96:99], v[64:67], v[112:115]
    ds_read_b128 v[52:55], v17 offset:0
    v_mfma_f32_16x16x32_bf16 v[116:119], a[100:103], v[64:67], v[116:119]
    v_mfma_f32_16x16x32_bf16 v[120:123], a[104:107], v[64:67], v[120:123]
    s_add_u32 m0, s28, 20480
    s_nop 0
    buffer_load_dwordx4 v8, s[36:39], s83 offen offset:0 lds
    v_mfma_f32_16x16x32_bf16 v[124:127], a[108:111], v[64:67], v[124:127]
    s_waitcnt lgkmcnt(8)
    v_mfma_f32_16x16x32_bf16 v[128:131], a[96:99], v[68:71], v[128:131]
    ds_read_b128 v[56:59], v17 offset:1024
    v_mfma_f32_16x16x32_bf16 v[132:135], a[100:103], v[68:71], v[132:135]
    v_mfma_f32_16x16x32_bf16 v[136:139], a[104:107], v[68:71], v[136:139]
    s_add_u32 s31, s91, 0
    buffer_load_dwordx4 a[192:195], v5, s[60:63], s31 offen offset:0 sc1
    v_mfma_f32_16x16x32_bf16 v[140:143], a[108:111], v[68:71], v[140:143]
    s_waitcnt lgkmcnt(8)
    v_mfma_f32_16x16x32_bf16 v[144:147], a[96:99], v[72:75], v[144:147]
    ds_read_b128 v[60:63], v17 offset:2048
    v_mfma_f32_16x16x32_bf16 v[148:151], a[100:103], v[72:75], v[148:151]
    v_mfma_f32_16x16x32_bf16 v[152:155], a[104:107], v[72:75], v[152:155]
    buffer_load_dwordx4 a[196:199], v5, s[60:63], s31 offen offset:1024 sc1
    v_mfma_f32_16x16x32_bf16 v[156:159], a[108:111], v[72:75], v[156:159]
    s_waitcnt lgkmcnt(8)
    v_mfma_f32_16x16x32_bf16 v[160:163], a[96:99], v[76:79], v[160:163]
    ds_read_b128 v[64:67], v17 offset:3072
    v_mfma_f32_16x16x32_bf16 v[164:167], a[100:103], v[76:79], v[164:167]
    v_mfma_f32_16x16x32_bf16 v[168:171], a[104:107], v[76:79], v[168:171]
    buffer_load_dwordx4 v9, s[36:39], s83 offen offset:1024 lds
    v_mfma_f32_16x16x32_bf16 v[172:175], a[108:111], v[76:79], v[172:175]
    s_waitcnt lgkmcnt(8)
    v_mfma_f32_16x16x32_bf16 v[176:179], a[96:99], v[80:83], v[176:179]
    ds_read_b128 v[68:71], v17 offset:4096
    v_mfma_f32_16x16x32_bf16 v[180:183], a[100:103], v[80:83], v[180:183]
    v_mfma_f32_16x16x32_bf16 v[184:187], a[104:107], v[80:83], v[184:187]
    buffer_load_dwordx4 a[200:203], v5, s[60:63], s31 offen offset:2048 sc1
    v_mfma_f32_16x16x32_bf16 v[188:191], a[108:111], v[80:83], v[188:191]
    s_waitcnt lgkmcnt(8)
    v_mfma_f32_16x16x32_bf16 v[192:195], a[96:99], v[84:87], v[192:195]
    ds_read_b128 v[72:75], v17 offset:5120
    v_mfma_f32_16x16x32_bf16 v[196:199], a[100:103], v[84:87], v[196:199]
    v_mfma_f32_16x16x32_bf16 v[200:203], a[104:107], v[84:87], v[200:203]
    buffer_load_dwordx4 a[204:207], v5, s[60:63], s31 offen offset:3072 sc1
    v_mfma_f32_16x16x32_bf16 v[204:207], a[108:111], v[84:87], v[204:207]
    s_waitcnt lgkmcnt(8)
    v_mfma_f32_16x16x32_bf16 v[208:211], a[96:99], v[40:43], v[208:211]
    ds_read_b128 v[76:79], v17 offset:6144
    v_mfma_f32_16x16x32_bf16 v[212:215], a[100:103], v[40:43], v[212:215]
    v_mfma_f32_16x16x32_bf16 v[216:219], a[104:107], v[40:43], v[216:219]
    buffer_load_dwordx4 v10, s[36:39], s83 offen offset:2048 lds
    v_mfma_f32_16x16x32_bf16 v[220:223], a[108:111], v[40:43], v[220:223]
    s_waitcnt lgkmcnt(8)
    v_mfma_f32_16x16x32_bf16 v[224:227], a[96:99], v[44:47], v[224:227]
    ds_read_b128 v[80:83], v17 offset:7168
    v_mfma_f32_16x16x32_bf16 v[228:231], a[100:103], v[44:47], v[228:231]
    v_mfma_f32_16x16x32_bf16 v[232:235], a[104:107], v[44:47], v[232:235]
    v_mfma_f32_16x16x32_bf16 v[236:239], a[108:111], v[44:47], v[236:239]
    s_waitcnt lgkmcnt(8)
    v_mfma_f32_16x16x32_bf16 v[240:243], a[96:99], v[48:51], v[240:243]
    ds_read_b128 v[84:87], v17 offset:8192
    v_mfma_f32_16x16x32_bf16 v[244:247], a[100:103], v[48:51], v[244:247]
    v_mfma_f32_16x16x32_bf16 v[248:251], a[104:107], v[48:51], v[248:251]
    v_mfma_f32_16x16x32_bf16 v[252:255], a[108:111], v[48:51], v[252:255]
    s_waitcnt vmcnt(39)
    s_barrier
    s_waitcnt vmcnt(28) lgkmcnt(8)
    v_mfma_f32_16x16x32_bf16 v[112:115], a[112:115], v[52:55], v[112:115]
    ds_read_b128 v[40:43], v16 offset:20480
    v_mfma_f32_16x16x32_bf16 v[116:119], a[116:119], v[52:55], v[116:119]
    v_mfma_f32_16x16x32_bf16 v[120:123], a[120:123], v[52:55], v[120:123]
    buffer_load_dwordx4 v11, s[36:39], s83 offen offset:3072 lds
    v_mfma_f32_16x16x32_bf16 v[124:127], a[124:127], v[52:55], v[124:127]
    s_waitcnt lgkmcnt(8)
    v_mfma_f32_16x16x32_bf16 v[128:131], a[112:115], v[56:59], v[128:131]
    ds_read_b128 v[44:47], v16 offset:21504
    v_mfma_f32_16x16x32_bf16 v[132:135], a[116:119], v[56:59], v[132:135]
    v_mfma_f32_16x16x32_bf16 v[136:139], a[120:123], v[56:59], v[136:139]
    s_add_u32 s31, s91, 4096
    buffer_load_dwordx4 a[208:211], v5, s[60:63], s31 offen offset:0 sc1
    v_mfma_f32_16x16x32_bf16 v[140:143], a[124:127], v[56:59], v[140:143]
    s_waitcnt lgkmcnt(8)
    v_mfma_f32_16x16x32_bf16 v[144:147], a[112:115], v[60:63], v[144:147]
    ds_read_b128 v[48:51], v16 offset:22528
    v_mfma_f32_16x16x32_bf16 v[148:151], a[116:119], v[60:63], v[148:151]
    v_mfma_f32_16x16x32_bf16 v[152:155], a[120:123], v[60:63], v[152:155]
    buffer_load_dwordx4 a[212:215], v5, s[60:63], s31 offen offset:1024 sc1
    v_mfma_f32_16x16x32_bf16 v[156:159], a[124:127], v[60:63], v[156:159]
    s_waitcnt lgkmcnt(8)
    v_mfma_f32_16x16x32_bf16 v[160:163], a[112:115], v[64:67], v[160:163]
    ds_read_b128 v[52:55], v16 offset:23552
    v_mfma_f32_16x16x32_bf16 v[164:167], a[116:119], v[64:67], v[164:167]
    v_mfma_f32_16x16x32_bf16 v[168:171], a[120:123], v[64:67], v[168:171]
    s_add_u32 m0, s28, 24576
    s_nop 0
    buffer_load_dwordx4 v12, s[36:39], s83 offen offset:0 lds
    v_mfma_f32_16x16x32_bf16 v[172:175], a[124:127], v[64:67], v[172:175]
    s_waitcnt lgkmcnt(8)
    v_mfma_f32_16x16x32_bf16 v[176:179], a[112:115], v[68:71], v[176:179]
    ds_read_b128 v[56:59], v16 offset:24576
    v_mfma_f32_16x16x32_bf16 v[180:183], a[116:119], v[68:71], v[180:183]
    v_mfma_f32_16x16x32_bf16 v[184:187], a[120:123], v[68:71], v[184:187]
    buffer_load_dwordx4 a[216:219], v5, s[60:63], s31 offen offset:2048 sc1
    v_mfma_f32_16x16x32_bf16 v[188:191], a[124:127], v[68:71], v[188:191]
    s_waitcnt lgkmcnt(8)
    v_mfma_f32_16x16x32_bf16 v[192:195], a[112:115], v[72:75], v[192:195]
    ds_read_b128 v[60:63], v16 offset:25600
    v_mfma_f32_16x16x32_bf16 v[196:199], a[116:119], v[72:75], v[196:199]
    v_mfma_f32_16x16x32_bf16 v[200:203], a[120:123], v[72:75], v[200:203]
    buffer_load_dwordx4 a[220:223], v5, s[60:63], s31 offen offset:3072 sc1
    v_mfma_f32_16x16x32_bf16 v[204:207], a[124:127], v[72:75], v[204:207]
    s_waitcnt lgkmcnt(8)
    v_mfma_f32_16x16x32_bf16 v[208:211], a[112:115], v[76:79], v[208:211]
    ds_read_b128 v[64:67], v16 offset:26624
    v_mfma_f32_16x16x32_bf16 v[212:215], a[116:119], v[76:79], v[212:215]
    v_mfma_f32_16x16x32_bf16 v[216:219], a[120:123], v[76:79], v[216:219]
    v_mfma_f32_16x16x32_bf16 v[220:223], a[124:127], v[76:79], v[220:223]
    s_waitcnt lgkmcnt(8)
    v_mfma_f32_16x16x32_bf16 v[224:227], a[112:115], v[80:83], v[224:227]
    ds_read_b128 v[68:71], v16 offset:27648
    v_mfma_f32_16x16x32_bf16 v[228:231], a[116:119], v[80:83], v[228:231]
    v_mfma_f32_16x16x32_bf16 v[232:235], a[120:123], v[80:83], v[232:235]
    v_mfma_f32_16x16x32_bf16 v[236:239], a[124:127], v[80:83], v[236:239]
    s_waitcnt lgkmcnt(8)
    v_mfma_f32_16x16x32_bf16 v[240:243], a[112:115], v[84:87], v[240:243]
    ds_read_b128 v[72:75], v16 offset:28672
    v_mfma_f32_16x16x32_bf16 v[244:247], a[116:119], v[84:87], v[244:247]
    v_mfma_f32_16x16x32_bf16 v[248:251], a[120:123], v[84:87], v[248:251]
    v_mfma_f32_16x16x32_bf16 v[252:255], a[124:127], v[84:87], v[252:255]
    s_waitcnt vmcnt(30) lgkmcnt(8)
    v_mfma_f32_16x16x32_bf16 v[112:115], a[128:131], v[40:43], v[112:115]
    ds_read_b128 v[76:79], v17 offset:20480
    v_mfma_f32_16x16x32_bf16 v[116:119], a[132:135], v[40:43], v[116:119]
    v_mfma_f32_16x16x32_bf16 v[120:123], a[136:139], v[40:43], v[120:123]
    s_add_u32 s31, s92, 0
    buffer_load_dwordx4 a[224:227], v5, s[60:63], s31 offen offset:0 sc1
    v_mfma_f32_16x16x32_bf16 v[124:127], a[140:143], v[40:43], v[124:127]
    s_waitcnt lgkmcnt(8)
    v_mfma_f32_16x16x32_bf16 v[128:131], a[128:131], v[44:47], v[128:131]
    ds_read_b128 v[80:83], v17 offset:21504
    v_mfma_f32_16x16x32_bf16 v[132:135], a[132:135], v[44:47], v[132:135]
    v_mfma_f32_16x16x32_bf16 v[136:139], a[136:139], v[44:47], v[136:139]
    buffer_load_dwordx4 a[228:231], v5, s[60:63], s31 offen offset:1024 sc1
    v_mfma_f32_16x16x32_bf16 v[140:143], a[140:143], v[44:47], v[140:143]
    s_waitcnt lgkmcnt(8)
    v_mfma_f32_16x16x32_bf16 v[144:147], a[128:131], v[48:51], v[144:147]
    ds_read_b128 v[84:87], v17 offset:22528
    v_mfma_f32_16x16x32_bf16 v[148:151], a[132:135], v[48:51], v[148:151]
    v_mfma_f32_16x16x32_bf16 v[152:155], a[136:139], v[48:51], v[152:155]
    buffer_load_dwordx4 a[232:235], v5, s[60:63], s31 offen offset:2048 sc1
    v_mfma_f32_16x16x32_bf16 v[156:159], a[140:143], v[48:51], v[156:159]
    s_waitcnt lgkmcnt(8)
    v_mfma_f32_16x16x32_bf16 v[160:163], a[128:131], v[52:55], v[160:163]
    ds_read_b128 v[40:43], v17 offset:23552
    v_mfma_f32_16x16x32_bf16 v[164:167], a[132:135], v[52:55], v[164:167]
    v_mfma_f32_16x16x32_bf16 v[168:171], a[136:139], v[52:55], v[168:171]
    s_add_u32 m0, s28, 40960
    s_nop 0
    buffer_load_dwordx4 v8, s[36:39], s84 offen offset:0 lds
    v_mfma_f32_16x16x32_bf16 v[172:175], a[140:143], v[52:55], v[172:175]
    s_waitcnt lgkmcnt(8)
    v_mfma_f32_16x16x32_bf16 v[176:179], a[128:131], v[56:59], v[176:179]
    ds_read_b128 v[44:47], v17 offset:24576
    v_mfma_f32_16x16x32_bf16 v[180:183], a[132:135], v[56:59], v[180:183]
    v_mfma_f32_16x16x32_bf16 v[184:187], a[136:139], v[56:59], v[184:187]
    buffer_load_dwordx4 a[236:239], v5, s[60:63], s31 offen offset:3072 sc1
    v_mfma_f32_16x16x32_bf16 v[188:191], a[140:143], v[56:59], v[188:191]
    s_waitcnt lgkmcnt(8)
    v_mfma_f32_16x16x32_bf16 v[192:195], a[128:131], v[60:63], v[192:195]
    ds_read_b128 v[48:51], v17 offset:25600
    v_mfma_f32_16x16x32_bf16 v[196:199], a[132:135], v[60:63], v[196:199]
    v_mfma_f32_16x16x32_bf16 v[200:203], a[136:139], v[60:63], v[200:203]
    v_mfma_f32_16x16x32_bf16 v[204:207], a[140:143], v[60:63], v[204:207]
    s_waitcnt lgkmcnt(8)
    v_mfma_f32_16x16x32_bf16 v[208:211], a[128:131], v[64:67], v[208:211]
    ds_read_b128 v[52:55], v17 offset:26624
    v_mfma_f32_16x16x32_bf16 v[212:215], a[132:135], v[64:67], v[212:215]
    v_mfma_f32_16x16x32_bf16 v[216:219], a[136:139], v[64:67], v[216:219]
    buffer_load_dwordx4 v9, s[36:39], s84 offen offset:1024 lds
    v_mfma_f32_16x16x32_bf16 v[220:223], a[140:143], v[64:67], v[220:223]
    s_waitcnt lgkmcnt(8)
    v_mfma_f32_16x16x32_bf16 v[224:227], a[128:131], v[68:71], v[224:227]
    ds_read_b128 v[56:59], v17 offset:27648
    v_mfma_f32_16x16x32_bf16 v[228:231], a[132:135], v[68:71], v[228:231]
    v_mfma_f32_16x16x32_bf16 v[232:235], a[136:139], v[68:71], v[232:235]
    v_mfma_f32_16x16x32_bf16 v[236:239], a[140:143], v[68:71], v[236:239]
    s_waitcnt lgkmcnt(8)
    v_mfma_f32_16x16x32_bf16 v[240:243], a[128:131], v[72:75], v[240:243]
    ds_read_b128 v[60:63], v17 offset:28672
    v_mfma_f32_16x16x32_bf16 v[244:247], a[132:135], v[72:75], v[244:247]
    v_mfma_f32_16x16x32_bf16 v[248:251], a[136:139], v[72:75], v[248:251]
    v_mfma_f32_16x16x32_bf16 v[252:255], a[140:143], v[72:75], v[252:255]
    s_waitcnt vmcnt(32) lgkmcnt(8)
    v_mfma_f32_16x16x32_bf16 v[112:115], a[144:147], v[76:79], v[112:115]
    ds_read_b128 v[64:67], v16 offset:40960
    v_mfma_f32_16x16x32_bf16 v[116:119], a[148:151], v[76:79], v[116:119]
    v_mfma_f32_16x16x32_bf16 v[120:123], a[152:155], v[76:79], v[120:123]
    buffer_load_dwordx4 v10, s[36:39], s84 offen offset:2048 lds
    v_mfma_f32_16x16x32_bf16 v[124:127], a[156:159], v[76:79], v[124:127]
    s_waitcnt lgkmcnt(8)
    v_mfma_f32_16x16x32_bf16 v[128:131], a[144:147], v[80:83], v[128:131]
    ds_read_b128 v[68:71], v16 offset:41984
    v_mfma_f32_16x16x32_bf16 v[132:135], a[148:151], v[80:83], v[132:135]
    v_mfma_f32_16x16x32_bf16 v[136:139], a[152:155], v[80:83], v[136:139]
    s_add_u32 s31, s92, 4096
    buffer_load_dwordx4 a[240:243], v5, s[60:63], s31 offen offset:0 sc1
    v_mfma_f32_16x16x32_bf16 v[140:143], a[156:159], v[80:83], v[140:143]
    s_waitcnt lgkmcnt(8)
    v_mfma_f32_16x16x32_bf16 v[144:147], a[144:147], v[84:87], v[144:147]
    ds_read_b128 v[72:75], v16 offset:43008
    v_mfma_f32_16x16x32_bf16 v[148:151], a[148:151], v[84:87], v[148:151]
    v_mfma_f32_16x16x32_bf16 v[152:155], a[152:155], v[84:87], v[152:155]
    buffer_load_dwordx4 a[244:247], v5, s[60:63], s31 offen offset:1024 sc1
    v_mfma_f32_16x16x32_bf16 v[156:159], a[156:159], v[84:87], v[156:159]
    s_waitcnt lgkmcnt(8)
    v_mfma_f32_16x16x32_bf16 v[160:163], a[144:147], v[40:43], v[160:163]
    ds_read_b128 v[76:79], v16 offset:44032
    v_mfma_f32_16x16x32_bf16 v[164:167], a[148:151], v[40:43], v[164:167]
    v_mfma_f32_16x16x32_bf16 v[168:171], a[152:155], v[40:43], v[168:171]
    buffer_load_dwordx4 v11, s[36:39], s84 offen offset:3072 lds
    v_mfma_f32_16x16x32_bf16 v[172:175], a[156:159], v[40:43], v[172:175]
    s_waitcnt lgkmcnt(8)
    v_mfma_f32_16x16x32_bf16 v[176:179], a[144:147], v[44:47], v[176:179]
    ds_read_b128 v[80:83], v16 offset:45056
    v_mfma_f32_16x16x32_bf16 v[180:183], a[148:151], v[44:47], v[180:183]
    v_mfma_f32_16x16x32_bf16 v[184:187], a[152:155], v[44:47], v[184:187]
    buffer_load_dwordx4 a[248:251], v5, s[60:63], s31 offen offset:2048 sc1
    v_mfma_f32_16x16x32_bf16 v[188:191], a[156:159], v[44:47], v[188:191]
    s_waitcnt lgkmcnt(8)
    v_mfma_f32_16x16x32_bf16 v[192:195], a[144:147], v[48:51], v[192:195]
    ds_read_b128 v[84:87], v16 offset:46080
    v_mfma_f32_16x16x32_bf16 v[196:199], a[148:151], v[48:51], v[196:199]
    v_mfma_f32_16x16x32_bf16 v[200:203], a[152:155], v[48:51], v[200:203]
    buffer_load_dwordx4 a[252:255], v5, s[60:63], s31 offen offset:3072 sc1
    v_mfma_f32_16x16x32_bf16 v[204:207], a[156:159], v[48:51], v[204:207]
    s_waitcnt lgkmcnt(8)
    v_mfma_f32_16x16x32_bf16 v[208:211], a[144:147], v[52:55], v[208:211]
    ds_read_b128 v[40:43], v16 offset:47104
    v_mfma_f32_16x16x32_bf16 v[212:215], a[148:151], v[52:55], v[212:215]
    v_mfma_f32_16x16x32_bf16 v[216:219], a[152:155], v[52:55], v[216:219]
    s_add_u32 m0, s28, 45056
    s_nop 0
    buffer_load_dwordx4 v12, s[36:39], s84 offen offset:0 lds
    v_mfma_f32_16x16x32_bf16 v[220:223], a[156:159], v[52:55], v[220:223]
    s_waitcnt lgkmcnt(8)
    v_mfma_f32_16x16x32_bf16 v[224:227], a[144:147], v[56:59], v[224:227]
    ds_read_b128 v[44:47], v16 offset:48128
    v_mfma_f32_16x16x32_bf16 v[228:231], a[148:151], v[56:59], v[228:231]
    v_mfma_f32_16x16x32_bf16 v[232:235], a[152:155], v[56:59], v[232:235]
    v_mfma_f32_16x16x32_bf16 v[236:239], a[156:159], v[56:59], v[236:239]
    s_waitcnt lgkmcnt(8)
    v_mfma_f32_16x16x32_bf16 v[240:243], a[144:147], v[60:63], v[240:243]
    ds_read_b128 v[48:51], v16 offset:49152
    v_mfma_f32_16x16x32_bf16 v[244:247], a[148:151], v[60:63], v[244:247]
    v_mfma_f32_16x16x32_bf16 v[248:251], a[152:155], v[60:63], v[248:251]
    v_mfma_f32_16x16x32_bf16 v[252:255], a[156:159], v[60:63], v[252:255]
    s_waitcnt vmcnt(33) lgkmcnt(8)
    v_mfma_f32_16x16x32_bf16 v[112:115], a[160:163], v[64:67], v[112:115]
    ds_read_b128 v[52:55], v17 offset:40960
    v_mfma_f32_16x16x32_bf16 v[116:119], a[164:167], v[64:67], v[116:119]
    v_mfma_f32_16x16x32_bf16 v[120:123], a[168:171], v[64:67], v[120:123]
    s_add_u32 s31, s93, 0
    buffer_load_dwordx4 a[0:3], v5, s[60:63], s31 offen offset:0 sc1
    v_mfma_f32_16x16x32_bf16 v[124:127], a[172:175], v[64:67], v[124:127]
    s_waitcnt lgkmcnt(8)
    v_mfma_f32_16x16x32_bf16 v[128:131], a[160:163], v[68:71], v[128:131]
    ds_read_b128 v[56:59], v17 offset:41984
    v_mfma_f32_16x16x32_bf16 v[132:135], a[164:167], v[68:71], v[132:135]
    v_mfma_f32_16x16x32_bf16 v[136:139], a[168:171], v[68:71], v[136:139]
    buffer_load_dwordx4 a[4:7], v5, s[60:63], s31 offen offset:1024 sc1
    v_mfma_f32_16x16x32_bf16 v[140:143], a[172:175], v[68:71], v[140:143]
    s_waitcnt lgkmcnt(8)
    v_mfma_f32_16x16x32_bf16 v[144:147], a[160:163], v[72:75], v[144:147]
    ds_read_b128 v[60:63], v17 offset:43008
    v_mfma_f32_16x16x32_bf16 v[148:151], a[164:167], v[72:75], v[148:151]
    v_mfma_f32_16x16x32_bf16 v[152:155], a[168:171], v[72:75], v[152:155]
    buffer_load_dwordx4 a[8:11], v5, s[60:63], s31 offen offset:2048 sc1
    v_mfma_f32_16x16x32_bf16 v[156:159], a[172:175], v[72:75], v[156:159]
    s_waitcnt lgkmcnt(8)
    v_mfma_f32_16x16x32_bf16 v[160:163], a[160:163], v[76:79], v[160:163]
    ds_read_b128 v[64:67], v17 offset:44032
    v_mfma_f32_16x16x32_bf16 v[164:167], a[164:167], v[76:79], v[164:167]
    v_mfma_f32_16x16x32_bf16 v[168:171], a[168:171], v[76:79], v[168:171]
    buffer_load_dwordx4 a[12:15], v5, s[60:63], s31 offen offset:3072 sc1
    v_mfma_f32_16x16x32_bf16 v[172:175], a[172:175], v[76:79], v[172:175]
    s_waitcnt lgkmcnt(8)
    v_mfma_f32_16x16x32_bf16 v[176:179], a[160:163], v[80:83], v[176:179]
    ds_read_b128 v[68:71], v17 offset:45056
    v_mfma_f32_16x16x32_bf16 v[180:183], a[164:167], v[80:83], v[180:183]
    v_mfma_f32_16x16x32_bf16 v[184:187], a[168:171], v[80:83], v[184:187]
    v_mfma_f32_16x16x32_bf16 v[188:191], a[172:175], v[80:83], v[188:191]
    s_waitcnt lgkmcnt(8)
    v_mfma_f32_16x16x32_bf16 v[192:195], a[160:163], v[84:87], v[192:195]
    ds_read_b128 v[72:75], v17 offset:46080
    v_mfma_f32_16x16x32_bf16 v[196:199], a[164:167], v[84:87], v[196:199]
    v_mfma_f32_16x16x32_bf16 v[200:203], a[168:171], v[84:87], v[200:203]
    v_mfma_f32_16x16x32_bf16 v[204:207], a[172:175], v[84:87], v[204:207]
    s_waitcnt lgkmcnt(8)
    v_mfma_f32_16x16x32_bf16 v[208:211], a[160:163], v[40:43], v[208:211]
    ds_read_b128 v[76:79], v17 offset:47104
    v_mfma_f32_16x16x32_bf16 v[212:215], a[164:167], v[40:43], v[212:215]
    v_mfma_f32_16x16x32_bf16 v[216:219], a[168:171], v[40:43], v[216:219]
    v_mfma_f32_16x16x32_bf16 v[220:223], a[172:175], v[40:43], v[220:223]
    s_waitcnt lgkmcnt(8)
    v_mfma_f32_16x16x32_bf16 v[224:227], a[160:163], v[44:47], v[224:227]
    ds_read_b128 v[80:83], v17 offset:48128
    v_mfma_f32_16x16x32_bf16 v[228:231], a[164:167], v[44:47], v[228:231]
    v_mfma_f32_16x16x32_bf16 v[232:235], a[168:171], v[44:47], v[232:235]
    v_mfma_f32_16x16x32_bf16 v[236:239], a[172:175], v[44:47], v[236:239]
    s_waitcnt lgkmcnt(8)
    v_mfma_f32_16x16x32_bf16 v[240:243], a[160:163], v[48:51], v[240:243]
    ds_read_b128 v[84:87], v17 offset:49152
    v_mfma_f32_16x16x32_bf16 v[244:247], a[164:167], v[48:51], v[244:247]
    v_mfma_f32_16x16x32_bf16 v[248:251], a[168:171], v[48:51], v[248:251]
    v_mfma_f32_16x16x32_bf16 v[252:255], a[172:175], v[48:51], v[252:255]
    s_waitcnt vmcnt(19)
    s_barrier
    s_waitcnt vmcnt(31) lgkmcnt(8)
    v_mfma_f32_16x16x32_bf16 v[112:115], a[176:179], v[52:55], v[112:115]
    ds_read_b128 v[40:43], v14 offset:0
    v_mfma_f32_16x16x32_bf16 v[116:119], a[180:183], v[52:55], v[116:119]
    v_mfma_f32_16x16x32_bf16 v[120:123], a[184:187], v[52:55], v[120:123]
    s_add_u32 s31, s93, 4096
    buffer_load_dwordx4 a[16:19], v5, s[60:63], s31 offen offset:0 sc1
    v_mfma_f32_16x16x32_bf16 v[124:127], a[188:191], v[52:55], v[124:127]
    s_waitcnt lgkmcnt(8)
    v_mfma_f32_16x16x32_bf16 v[128:131], a[176:179], v[56:59], v[128:131]
    ds_read_b128 v[44:47], v14 offset:1024
    v_mfma_f32_16x16x32_bf16 v[132:135], a[180:183], v[56:59], v[132:135]
    v_mfma_f32_16x16x32_bf16 v[136:139], a[184:187], v[56:59], v[136:139]
    buffer_load_dwordx4 a[20:23], v5, s[60:63], s31 offen offset:1024 sc1
    v_mfma_f32_16x16x32_bf16 v[140:143], a[188:191], v[56:59], v[140:143]
    s_waitcnt lgkmcnt(8)
    v_mfma_f32_16x16x32_bf16 v[144:147], a[176:179], v[60:63], v[144:147]
    ds_read_b128 v[48:51], v14 offset:2048
    v_mfma_f32_16x16x32_bf16 v[148:151], a[180:183], v[60:63], v[148:151]
    v_mfma_f32_16x16x32_bf16 v[152:155], a[184:187], v[60:63], v[152:155]
    buffer_load_dwordx4 a[24:27], v5, s[60:63], s31 offen offset:2048 sc1
    v_mfma_f32_16x16x32_bf16 v[156:159], a[188:191], v[60:63], v[156:159]
    s_waitcnt lgkmcnt(8)
    v_mfma_f32_16x16x32_bf16 v[160:163], a[176:179], v[64:67], v[160:163]
    ds_read_b128 v[52:55], v14 offset:3072
    v_mfma_f32_16x16x32_bf16 v[164:167], a[180:183], v[64:67], v[164:167]
    v_mfma_f32_16x16x32_bf16 v[168:171], a[184:187], v[64:67], v[168:171]
    buffer_load_dwordx4 a[28:31], v5, s[60:63], s31 offen offset:3072 sc1
    v_mfma_f32_16x16x32_bf16 v[172:175], a[188:191], v[64:67], v[172:175]
    s_waitcnt lgkmcnt(8)
    v_mfma_f32_16x16x32_bf16 v[176:179], a[176:179], v[68:71], v[176:179]
    ds_read_b128 v[56:59], v14 offset:4096
    v_mfma_f32_16x16x32_bf16 v[180:183], a[180:183], v[68:71], v[180:183]
    v_mfma_f32_16x16x32_bf16 v[184:187], a[184:187], v[68:71], v[184:187]
    v_mfma_f32_16x16x32_bf16 v[188:191], a[188:191], v[68:71], v[188:191]
    s_waitcnt lgkmcnt(8)
    v_mfma_f32_16x16x32_bf16 v[192:195], a[176:179], v[72:75], v[192:195]
    ds_read_b128 v[60:63], v14 offset:5120
    v_mfma_f32_16x16x32_bf16 v[196:199], a[180:183], v[72:75], v[196:199]
    v_mfma_f32_16x16x32_bf16 v[200:203], a[184:187], v[72:75], v[200:203]
    v_mfma_f32_16x16x32_bf16 v[204:207], a[188:191], v[72:75], v[204:207]
    s_waitcnt lgkmcnt(8)
    v_mfma_f32_16x16x32_bf16 v[208:211], a[176:179], v[76:79], v[208:211]
    ds_read_b128 v[64:67], v14 offset:6144
    v_mfma_f32_16x16x32_bf16 v[212:215], a[180:183], v[76:79], v[212:215]
    v_mfma_f32_16x16x32_bf16 v[216:219], a[184:187], v[76:79], v[216:219]
    v_mfma_f32_16x16x32_bf16 v[220:223], a[188:191], v[76:79], v[220:223]
    s_waitcnt lgkmcnt(8)
    v_mfma_f32_16x16x32_bf16 v[224:227], a[176:179], v[80:83], v[224:227]
    ds_read_b128 v[68:71], v14 offset:7168
    v_mfma_f32_16x16x32_bf16 v[228:231], a[180:183], v[80:83], v[228:231]
    v_mfma_f32_16x16x32_bf16 v[232:235], a[184:187], v[80:83], v[232:235]
    v_mfma_f32_16x16x32_bf16 v[236:239], a[188:191], v[80:83], v[236:239]
    s_waitcnt lgkmcnt(8)
    v_mfma_f32_16x16x32_bf16 v[240:243], a[176:179], v[84:87], v[240:243]
    ds_read_b128 v[72:75], v14 offset:8192
    v_mfma_f32_16x16x32_bf16 v[244:247], a[180:183], v[84:87], v[244:247]
    v_mfma_f32_16x16x32_bf16 v[248:251], a[184:187], v[84:87], v[248:251]
    v_mfma_f32_16x16x32_bf16 v[252:255], a[188:191], v[84:87], v[252:255]
    s_waitcnt vmcnt(28) lgkmcnt(8)
    v_mfma_f32_16x16x32_bf16 v[112:115], a[192:195], v[40:43], v[112:115]
    ds_read_b128 v[76:79], v15 offset:0
    v_mfma_f32_16x16x32_bf16 v[116:119], a[196:199], v[40:43], v[116:119]
    v_mfma_f32_16x16x32_bf16 v[120:123], a[200:203], v[40:43], v[120:123]
    v_mfma_f32_16x16x32_bf16 v[124:127], a[204:207], v[40:43], v[124:127]
    s_waitcnt lgkmcnt(8)
    v_mfma_f32_16x16x32_bf16 v[128:131], a[192:195], v[44:47], v[128:131]
    ds_read_b128 v[80:83], v15 offset:1024
    v_mfma_f32_16x16x32_bf16 v[132:135], a[196:199], v[44:47], v[132:135]
    v_mfma_f32_16x16x32_bf16 v[136:139], a[200:203], v[44:47], v[136:139]
    v_mfma_f32_16x16x32_bf16 v[140:143], a[204:207], v[44:47], v[140:143]
    s_waitcnt lgkmcnt(8)
    v_mfma_f32_16x16x32_bf16 v[144:147], a[192:195], v[48:51], v[144:147]
    ds_read_b128 v[84:87], v15 offset:2048
    v_mfma_f32_16x16x32_bf16 v[148:151], a[196:199], v[48:51], v[148:151]
    v_mfma_f32_16x16x32_bf16 v[152:155], a[200:203], v[48:51], v[152:155]
    v_mfma_f32_16x16x32_bf16 v[156:159], a[204:207], v[48:51], v[156:159]
    s_waitcnt lgkmcnt(8)
    v_mfma_f32_16x16x32_bf16 v[160:163], a[192:195], v[52:55], v[160:163]
    ds_read_b128 v[40:43], v15 offset:3072
    v_mfma_f32_16x16x32_bf16 v[164:167], a[196:199], v[52:55], v[164:167]
    v_mfma_f32_16x16x32_bf16 v[168:171], a[200:203], v[52:55], v[168:171]
    v_mfma_f32_16x16x32_bf16 v[172:175], a[204:207], v[52:55], v[172:175]
    s_waitcnt lgkmcnt(8)
    v_mfma_f32_16x16x32_bf16 v[176:179], a[192:195], v[56:59], v[176:179]
    ds_read_b128 v[44:47], v15 offset:4096
    v_mfma_f32_16x16x32_bf16 v[180:183], a[196:199], v[56:59], v[180:183]
    v_mfma_f32_16x16x32_bf16 v[184:187], a[200:203], v[56:59], v[184:187]
    v_mfma_f32_16x16x32_bf16 v[188:191], a[204:207], v[56:59], v[188:191]
    s_waitcnt lgkmcnt(8)
    v_mfma_f32_16x16x32_bf16 v[192:195], a[192:195], v[60:63], v[192:195]
    ds_read_b128 v[48:51], v15 offset:5120
    v_mfma_f32_16x16x32_bf16 v[196:199], a[196:199], v[60:63], v[196:199]
    v_mfma_f32_16x16x32_bf16 v[200:203], a[200:203], v[60:63], v[200:203]
    v_mfma_f32_16x16x32_bf16 v[204:207], a[204:207], v[60:63], v[204:207]
    s_waitcnt lgkmcnt(8)
    v_mfma_f32_16x16x32_bf16 v[208:211], a[192:195], v[64:67], v[208:211]
    ds_read_b128 v[52:55], v15 offset:6144
    v_mfma_f32_16x16x32_bf16 v[212:215], a[196:199], v[64:67], v[212:215]
    v_mfma_f32_16x16x32_bf16 v[216:219], a[200:203], v[64:67], v[216:219]
    v_mfma_f32_16x16x32_bf16 v[220:223], a[204:207], v[64:67], v[220:223]
    s_waitcnt lgkmcnt(8)
    v_mfma_f32_16x16x32_bf16 v[224:227], a[192:195], v[68:71], v[224:227]
    ds_read_b128 v[56:59], v15 offset:7168
    v_mfma_f32_16x16x32_bf16 v[228:231], a[196:199], v[68:71], v[228:231]
    v_mfma_f32_16x16x32_bf16 v[232:235], a[200:203], v[68:71], v[232:235]
    v_mfma_f32_16x16x32_bf16 v[236:239], a[204:207], v[68:71], v[236:239]
    s_waitcnt lgkmcnt(8)
    v_mfma_f32_16x16x32_bf16 v[240:243], a[192:195], v[72:75], v[240:243]
    ds_read_b128 v[60:63], v15 offset:8192
    v_mfma_f32_16x16x32_bf16 v[244:247], a[196:199], v[72:75], v[244:247]
    v_mfma_f32_16x16x32_bf16 v[248:251], a[200:203], v[72:75], v[248:251]
    v_mfma_f32_16x16x32_bf16 v[252:255], a[204:207], v[72:75], v[252:255]
    s_waitcnt vmcnt(21) lgkmcnt(8)
    v_mfma_f32_16x16x32_bf16 v[112:115], a[208:211], v[76:79], v[112:115]
    ds_read_b128 v[64:67], v14 offset:20480
    v_mfma_f32_16x16x32_bf16 v[116:119], a[212:215], v[76:79], v[116:119]
    v_mfma_f32_16x16x32_bf16 v[120:123], a[216:219], v[76:79], v[120:123]
    v_mfma_f32_16x16x32_bf16 v[124:127], a[220:223], v[76:79], v[124:127]
    s_waitcnt lgkmcnt(8)
    v_mfma_f32_16x16x32_bf16 v[128:131], a[208:211], v[80:83], v[128:131]
    ds_read_b128 v[68:71], v14 offset:21504
    v_mfma_f32_16x16x32_bf16 v[132:135], a[212:215], v[80:83], v[132:135]
    v_mfma_f32_16x16x32_bf16 v[136:139], a[216:219], v[80:83], v[136:139]
    v_mfma_f32_16x16x32_bf16 v[140:143], a[220:223], v[80:83], v[140:143]
    s_waitcnt lgkmcnt(8)
    v_mfma_f32_16x16x32_bf16 v[144:147], a[208:211], v[84:87], v[144:147]
    ds_read_b128 v[72:75], v14 offset:22528
    v_mfma_f32_16x16x32_bf16 v[148:151], a[212:215], v[84:87], v[148:151]
    v_mfma_f32_16x16x32_bf16 v[152:155], a[216:219], v[84:87], v[152:155]
    v_mfma_f32_16x16x32_bf16 v[156:159], a[220:223], v[84:87], v[156:159]
    s_waitcnt lgkmcnt(8)
    v_mfma_f32_16x16x32_bf16 v[160:163], a[208:211], v[40:43], v[160:163]
    ds_read_b128 v[76:79], v14 offset:23552
    v_mfma_f32_16x16x32_bf16 v[164:167], a[212:215], v[40:43], v[164:167]
    v_mfma_f32_16x16x32_bf16 v[168:171], a[216:219], v[40:43], v[168:171]
    v_mfma_f32_16x16x32_bf16 v[172:175], a[220:223], v[40:43], v[172:175]
    s_waitcnt lgkmcnt(8)
    v_mfma_f32_16x16x32_bf16 v[176:179], a[208:211], v[44:47], v[176:179]
    ds_read_b128 v[80:83], v14 offset:24576
    v_mfma_f32_16x16x32_bf16 v[180:183], a[212:215], v[44:47], v[180:183]
    v_mfma_f32_16x16x32_bf16 v[184:187], a[216:219], v[44:47], v[184:187]
    v_mfma_f32_16x16x32_bf16 v[188:191], a[220:223], v[44:47], v[188:191]
    s_waitcnt lgkmcnt(8)
    v_mfma_f32_16x16x32_bf16 v[192:195], a[208:211], v[48:51], v[192:195]
    ds_read_b128 v[84:87], v14 offset:25600
    v_mfma_f32_16x16x32_bf16 v[196:199], a[212:215], v[48:51], v[196:199]
    v_mfma_f32_16x16x32_bf16 v[200:203], a[216:219], v[48:51], v[200:203]
    v_mfma_f32_16x16x32_bf16 v[204:207], a[220:223], v[48:51], v[204:207]
    s_waitcnt lgkmcnt(8)
    v_mfma_f32_16x16x32_bf16 v[208:211], a[208:211], v[52:55], v[208:211]
    ds_read_b128 v[40:43], v14 offset:26624
    v_mfma_f32_16x16x32_bf16 v[212:215], a[212:215], v[52:55], v[212:215]
    v_mfma_f32_16x16x32_bf16 v[216:219], a[216:219], v[52:55], v[216:219]
    v_mfma_f32_16x16x32_bf16 v[220:223], a[220:223], v[52:55], v[220:223]
    s_waitcnt lgkmcnt(8)
    v_mfma_f32_16x16x32_bf16 v[224:227], a[208:211], v[56:59], v[224:227]
    ds_read_b128 v[44:47], v14 offset:27648
    v_mfma_f32_16x16x32_bf16 v[228:231], a[212:215], v[56:59], v[228:231]
    v_mfma_f32_16x16x32_bf16 v[232:235], a[216:219], v[56:59], v[232:235]
    v_mfma_f32_16x16x32_bf16 v[236:239], a[220:223], v[56:59], v[236:239]
    s_waitcnt lgkmcnt(8)
    v_mfma_f32_16x16x32_bf16 v[240:243], a[208:211], v[60:63], v[240:243]
    ds_read_b128 v[48:51], v14 offset:28672
    v_mfma_f32_16x16x32_bf16 v[244:247], a[212:215], v[60:63], v[244:247]
    v_mfma_f32_16x16x32_bf16 v[248:251], a[216:219], v[60:63], v[248:251]
    v_mfma_f32_16x16x32_bf16 v[252:255], a[220:223], v[60:63], v[252:255]
    s_waitcnt vmcnt(16) lgkmcnt(8)
    v_mfma_f32_16x16x32_bf16 v[112:115], a[224:227], v[64:67], v[112:115]
    ds_read_b128 v[52:55], v15 offset:20480
    v_mfma_f32_16x16x32_bf16 v[116:119], a[228:231], v[64:67], v[116:119]
    v_mfma_f32_16x16x32_bf16 v[120:123], a[232:235], v[64:67], v[120:123]
    v_mfma_f32_16x16x32_bf16 v[124:127], a[236:239], v[64:67], v[124:127]
    s_waitcnt lgkmcnt(8)
    v_mfma_f32_16x16x32_bf16 v[128:131], a[224:227], v[68:71], v[128:131]
    ds_read_b128 v[56:59], v15 offset:21504
    v_mfma_f32_16x16x32_bf16 v[132:135], a[228:231], v[68:71], v[132:135]
    v_mfma_f32_16x16x32_bf16 v[136:139], a[232:235], v[68:71], v[136:139]
    v_mfma_f32_16x16x32_bf16 v[140:143], a[236:239], v[68:71], v[140:143]
    s_waitcnt lgkmcnt(8)
    v_mfma_f32_16x16x32_bf16 v[144:147], a[224:227], v[72:75], v[144:147]
    ds_read_b128 v[60:63], v15 offset:22528
    v_mfma_f32_16x16x32_bf16 v[148:151], a[228:231], v[72:75], v[148:151]
    v_mfma_f32_16x16x32_bf16 v[152:155], a[232:235], v[72:75], v[152:155]
    v_mfma_f32_16x16x32_bf16 v[156:159], a[236:239], v[72:75], v[156:159]
    s_waitcnt lgkmcnt(8)
    v_mfma_f32_16x16x32_bf16 v[160:163], a[224:227], v[76:79], v[160:163]
    ds_read_b128 v[64:67], v15 offset:23552
    v_mfma_f32_16x16x32_bf16 v[164:167], a[228:231], v[76:79], v[164:167]
    v_mfma_f32_16x16x32_bf16 v[168:171], a[232:235], v[76:79], v[168:171]
    v_mfma_f32_16x16x32_bf16 v[172:175], a[236:239], v[76:79], v[172:175]
    s_waitcnt lgkmcnt(8)
    v_mfma_f32_16x16x32_bf16 v[176:179], a[224:227], v[80:83], v[176:179]
    ds_read_b128 v[68:71], v15 offset:24576
    v_mfma_f32_16x16x32_bf16 v[180:183], a[228:231], v[80:83], v[180:183]
    v_mfma_f32_16x16x32_bf16 v[184:187], a[232:235], v[80:83], v[184:187]
    v_mfma_f32_16x16x32_bf16 v[188:191], a[236:239], v[80:83], v[188:191]
    s_waitcnt lgkmcnt(8)
    v_mfma_f32_16x16x32_bf16 v[192:195], a[224:227], v[84:87], v[192:195]
    ds_read_b128 v[72:75], v15 offset:25600
    v_mfma_f32_16x16x32_bf16 v[196:199], a[228:231], v[84:87], v[196:199]
    v_mfma_f32_16x16x32_bf16 v[200:203], a[232:235], v[84:87], v[200:203]
    v_mfma_f32_16x16x32_bf16 v[204:207], a[236:239], v[84:87], v[204:207]
    s_waitcnt lgkmcnt(8)
    v_mfma_f32_16x16x32_bf16 v[208:211], a[224:227], v[40:43], v[208:211]
    ds_read_b128 v[76:79], v15 offset:26624
    v_mfma_f32_16x16x32_bf16 v[212:215], a[228:231], v[40:43], v[212:215]
    v_mfma_f32_16x16x32_bf16 v[216:219], a[232:235], v[40:43], v[216:219]
    v_mfma_f32_16x16x32_bf16 v[220:223], a[236:239], v[40:43], v[220:223]
    s_waitcnt lgkmcnt(8)
    v_mfma_f32_16x16x32_bf16 v[224:227], a[224:227], v[44:47], v[224:227]
    ds_read_b128 v[80:83], v15 offset:27648
    v_mfma_f32_16x16x32_bf16 v[228:231], a[228:231], v[44:47], v[228:231]
    v_mfma_f32_16x16x32_bf16 v[232:235], a[232:235], v[44:47], v[232:235]
    v_mfma_f32_16x16x32_bf16 v[236:239], a[236:239], v[44:47], v[236:239]
    s_waitcnt lgkmcnt(8)
    v_mfma_f32_16x16x32_bf16 v[240:243], a[224:227], v[48:51], v[240:243]
    ds_read_b128 v[84:87], v15 offset:28672
    v_mfma_f32_16x16x32_bf16 v[244:247], a[228:231], v[48:51], v[244:247]
    v_mfma_f32_16x16x32_bf16 v[248:251], a[232:235], v[48:51], v[248:251]
    v_mfma_f32_16x16x32_bf16 v[252:255], a[236:239], v[48:51], v[252:255]
    s_waitcnt vmcnt(8)
    s_barrier
    s_waitcnt vmcnt(9) lgkmcnt(8)
    v_mfma_f32_16x16x32_bf16 v[112:115], a[240:243], v[52:55], v[112:115]
    ds_read_b128 v[40:43], v14 offset:40960
    v_mfma_f32_16x16x32_bf16 v[116:119], a[244:247], v[52:55], v[116:119]
    v_mfma_f32_16x16x32_bf16 v[120:123], a[248:251], v[52:55], v[120:123]
    v_mfma_f32_16x16x32_bf16 v[124:127], a[252:255], v[52:55], v[124:127]
    s_waitcnt lgkmcnt(8)
    v_mfma_f32_16x16x32_bf16 v[128:131], a[240:243], v[56:59], v[128:131]
    ds_read_b128 v[44:47], v14 offset:41984
    v_mfma_f32_16x16x32_bf16 v[132:135], a[244:247], v[56:59], v[132:135]
    v_mfma_f32_16x16x32_bf16 v[136:139], a[248:251], v[56:59], v[136:139]
    v_mfma_f32_16x16x32_bf16 v[140:143], a[252:255], v[56:59], v[140:143]
    s_waitcnt lgkmcnt(8)
    v_mfma_f32_16x16x32_bf16 v[144:147], a[240:243], v[60:63], v[144:147]
    ds_read_b128 v[48:51], v14 offset:43008
    v_mfma_f32_16x16x32_bf16 v[148:151], a[244:247], v[60:63], v[148:151]
    v_mfma_f32_16x16x32_bf16 v[152:155], a[248:251], v[60:63], v[152:155]
    v_mfma_f32_16x16x32_bf16 v[156:159], a[252:255], v[60:63], v[156:159]
    s_waitcnt lgkmcnt(8)
    v_mfma_f32_16x16x32_bf16 v[160:163], a[240:243], v[64:67], v[160:163]
    ds_read_b128 v[52:55], v14 offset:44032
    v_mfma_f32_16x16x32_bf16 v[164:167], a[244:247], v[64:67], v[164:167]
    v_mfma_f32_16x16x32_bf16 v[168:171], a[248:251], v[64:67], v[168:171]
    v_mfma_f32_16x16x32_bf16 v[172:175], a[252:255], v[64:67], v[172:175]
    s_waitcnt lgkmcnt(8)
    v_mfma_f32_16x16x32_bf16 v[176:179], a[240:243], v[68:71], v[176:179]
    ds_read_b128 v[56:59], v14 offset:45056
    v_mfma_f32_16x16x32_bf16 v[180:183], a[244:247], v[68:71], v[180:183]
    v_mfma_f32_16x16x32_bf16 v[184:187], a[248:251], v[68:71], v[184:187]
    v_mfma_f32_16x16x32_bf16 v[188:191], a[252:255], v[68:71], v[188:191]
    s_waitcnt lgkmcnt(8)
    v_mfma_f32_16x16x32_bf16 v[192:195], a[240:243], v[72:75], v[192:195]
    ds_read_b128 v[60:63], v14 offset:46080
    v_mfma_f32_16x16x32_bf16 v[196:199], a[244:247], v[72:75], v[196:199]
    v_mfma_f32_16x16x32_bf16 v[200:203], a[248:251], v[72:75], v[200:203]
    v_mfma_f32_16x16x32_bf16 v[204:207], a[252:255], v[72:75], v[204:207]
    s_waitcnt lgkmcnt(8)
    v_mfma_f32_16x16x32_bf16 v[208:211], a[240:243], v[76:79], v[208:211]
    ds_read_b128 v[64:67], v14 offset:47104
    v_mfma_f32_16x16x32_bf16 v[212:215], a[244:247], v[76:79], v[212:215]
    v_mfma_f32_16x16x32_bf16 v[216:219], a[248:251], v[76:79], v[216:219]
    v_mfma_f32_16x16x32_bf16 v[220:223], a[252:255], v[76:79], v[220:223]
    s_waitcnt lgkmcnt(8)
    v_mfma_f32_16x16x32_bf16 v[224:227], a[240:243], v[80:83], v[224:227]
    ds_read_b128 v[68:71], v14 offset:48128
    v_mfma_f32_16x16x32_bf16 v[228:231], a[244:247], v[80:83], v[228:231]
    v_mfma_f32_16x16x32_bf16 v[232:235], a[248:251], v[80:83], v[232:235]
    v_mfma_f32_16x16x32_bf16 v[236:239], a[252:255], v[80:83], v[236:239]
    s_waitcnt lgkmcnt(8)
    v_mfma_f32_16x16x32_bf16 v[240:243], a[240:243], v[84:87], v[240:243]
    ds_read_b128 v[72:75], v14 offset:49152
    v_mfma_f32_16x16x32_bf16 v[244:247], a[244:247], v[84:87], v[244:247]
    v_mfma_f32_16x16x32_bf16 v[248:251], a[248:251], v[84:87], v[248:251]
    v_mfma_f32_16x16x32_bf16 v[252:255], a[252:255], v[84:87], v[252:255]
    s_waitcnt vmcnt(4) lgkmcnt(8)
    v_mfma_f32_16x16x32_bf16 v[112:115], a[0:3], v[40:43], v[112:115]
    ds_read_b128 v[76:79], v15 offset:40960
    v_mfma_f32_16x16x32_bf16 v[116:119], a[4:7], v[40:43], v[116:119]
    v_mfma_f32_16x16x32_bf16 v[120:123], a[8:11], v[40:43], v[120:123]
    v_mfma_f32_16x16x32_bf16 v[124:127], a[12:15], v[40:43], v[124:127]
    s_waitcnt lgkmcnt(8)
    v_mfma_f32_16x16x32_bf16 v[128:131], a[0:3], v[44:47], v[128:131]
    ds_read_b128 v[80:83], v15 offset:41984
    v_mfma_f32_16x16x32_bf16 v[132:135], a[4:7], v[44:47], v[132:135]
    v_mfma_f32_16x16x32_bf16 v[136:139], a[8:11], v[44:47], v[136:139]
    v_mfma_f32_16x16x32_bf16 v[140:143], a[12:15], v[44:47], v[140:143]
    s_waitcnt lgkmcnt(8)
    v_mfma_f32_16x16x32_bf16 v[144:147], a[0:3], v[48:51], v[144:147]
    ds_read_b128 v[84:87], v15 offset:43008
    v_mfma_f32_16x16x32_bf16 v[148:151], a[4:7], v[48:51], v[148:151]
    v_mfma_f32_16x16x32_bf16 v[152:155], a[8:11], v[48:51], v[152:155]
    v_mfma_f32_16x16x32_bf16 v[156:159], a[12:15], v[48:51], v[156:159]
    s_waitcnt lgkmcnt(8)
    v_mfma_f32_16x16x32_bf16 v[160:163], a[0:3], v[52:55], v[160:163]
    ds_read_b128 v[40:43], v15 offset:44032
    v_mfma_f32_16x16x32_bf16 v[164:167], a[4:7], v[52:55], v[164:167]
    v_mfma_f32_16x16x32_bf16 v[168:171], a[8:11], v[52:55], v[168:171]
    v_mfma_f32_16x16x32_bf16 v[172:175], a[12:15], v[52:55], v[172:175]
    s_waitcnt lgkmcnt(8)
    v_mfma_f32_16x16x32_bf16 v[176:179], a[0:3], v[56:59], v[176:179]
    ds_read_b128 v[44:47], v15 offset:45056
    v_mfma_f32_16x16x32_bf16 v[180:183], a[4:7], v[56:59], v[180:183]
    v_mfma_f32_16x16x32_bf16 v[184:187], a[8:11], v[56:59], v[184:187]
    v_mfma_f32_16x16x32_bf16 v[188:191], a[12:15], v[56:59], v[188:191]
    s_waitcnt lgkmcnt(8)
    v_mfma_f32_16x16x32_bf16 v[192:195], a[0:3], v[60:63], v[192:195]
    ds_read_b128 v[48:51], v15 offset:46080
    v_mfma_f32_16x16x32_bf16 v[196:199], a[4:7], v[60:63], v[196:199]
    v_mfma_f32_16x16x32_bf16 v[200:203], a[8:11], v[60:63], v[200:203]
    v_mfma_f32_16x16x32_bf16 v[204:207], a[12:15], v[60:63], v[204:207]
    s_waitcnt lgkmcnt(8)
    v_mfma_f32_16x16x32_bf16 v[208:211], a[0:3], v[64:67], v[208:211]
    ds_read_b128 v[52:55], v15 offset:47104
    v_mfma_f32_16x16x32_bf16 v[212:215], a[4:7], v[64:67], v[212:215]
    v_mfma_f32_16x16x32_bf16 v[216:219], a[8:11], v[64:67], v[216:219]
    v_mfma_f32_16x16x32_bf16 v[220:223], a[12:15], v[64:67], v[220:223]
    s_waitcnt lgkmcnt(8)
    v_mfma_f32_16x16x32_bf16 v[224:227], a[0:3], v[68:71], v[224:227]
    ds_read_b128 v[56:59], v15 offset:48128
    v_mfma_f32_16x16x32_bf16 v[228:231], a[4:7], v[68:71], v[228:231]
    v_mfma_f32_16x16x32_bf16 v[232:235], a[8:11], v[68:71], v[232:235]
    v_mfma_f32_16x16x32_bf16 v[236:239], a[12:15], v[68:71], v[236:239]
    s_waitcnt lgkmcnt(8)
    v_mfma_f32_16x16x32_bf16 v[240:243], a[0:3], v[72:75], v[240:243]
    ds_read_b128 v[60:63], v15 offset:49152
    v_mfma_f32_16x16x32_bf16 v[244:247], a[4:7], v[72:75], v[244:247]
    v_mfma_f32_16x16x32_bf16 v[248:251], a[8:11], v[72:75], v[248:251]
    v_mfma_f32_16x16x32_bf16 v[252:255], a[12:15], v[72:75], v[252:255]
    s_waitcnt vmcnt(0) lgkmcnt(8)
    v_mfma_f32_16x16x32_bf16 v[112:115], a[16:19], v[76:79], v[112:115]
    v_mfma_f32_16x16x32_bf16 v[116:119], a[20:23], v[76:79], v[116:119]
    v_mfma_f32_16x16x32_bf16 v[120:123], a[24:27], v[76:79], v[120:123]
    v_mfma_f32_16x16x32_bf16 v[124:127], a[28:31], v[76:79], v[124:127]
    s_waitcnt lgkmcnt(7)
    v_mfma_f32_16x16x32_bf16 v[128:131], a[16:19], v[80:83], v[128:131]
    v_mfma_f32_16x16x32_bf16 v[132:135], a[20:23], v[80:83], v[132:135]
    v_mfma_f32_16x16x32_bf16 v[136:139], a[24:27], v[80:83], v[136:139]
    v_mfma_f32_16x16x32_bf16 v[140:143], a[28:31], v[80:83], v[140:143]
    s_waitcnt lgkmcnt(6)
    v_mfma_f32_16x16x32_bf16 v[144:147], a[16:19], v[84:87], v[144:147]
    v_mfma_f32_16x16x32_bf16 v[148:151], a[20:23], v[84:87], v[148:151]
    v_mfma_f32_16x16x32_bf16 v[152:155], a[24:27], v[84:87], v[152:155]
    v_mfma_f32_16x16x32_bf16 v[156:159], a[28:31], v[84:87], v[156:159]
    s_waitcnt lgkmcnt(5)
    v_mfma_f32_16x16x32_bf16 v[160:163], a[16:19], v[40:43], v[160:163]
    v_mfma_f32_16x16x32_bf16 v[164:167], a[20:23], v[40:43], v[164:167]
    v_mfma_f32_16x16x32_bf16 v[168:171], a[24:27], v[40:43], v[168:171]
    v_mfma_f32_16x16x32_bf16 v[172:175], a[28:31], v[40:43], v[172:175]
    s_waitcnt lgkmcnt(4)
    v_mfma_f32_16x16x32_bf16 v[176:179], a[16:19], v[44:47], v[176:179]
    v_mfma_f32_16x16x32_bf16 v[180:183], a[20:23], v[44:47], v[180:183]
    v_mfma_f32_16x16x32_bf16 v[184:187], a[24:27], v[44:47], v[184:187]
    v_mfma_f32_16x16x32_bf16 v[188:191], a[28:31], v[44:47], v[188:191]
    s_waitcnt lgkmcnt(3)
    v_mfma_f32_16x16x32_bf16 v[192:195], a[16:19], v[48:51], v[192:195]
    v_mfma_f32_16x16x32_bf16 v[196:199], a[20:23], v[48:51], v[196:199]
    v_mfma_f32_16x16x32_bf16 v[200:203], a[24:27], v[48:51], v[200:203]
    v_mfma_f32_16x16x32_bf16 v[204:207], a[28:31], v[48:51], v[204:207]
    s_waitcnt lgkmcnt(2)
    v_mfma_f32_16x16x32_bf16 v[208:211], a[16:19], v[52:55], v[208:211]
    v_mfma_f32_16x16x32_bf16 v[212:215], a[20:23], v[52:55], v[212:215]
    v_mfma_f32_16x16x32_bf16 v[216:219], a[24:27], v[52:55], v[216:219]
    v_mfma_f32_16x16x32_bf16 v[220:223], a[28:31], v[52:55], v[220:223]
    s_waitcnt lgkmcnt(1)
    v_mfma_f32_16x16x32_bf16 v[224:227], a[16:19], v[56:59], v[224:227]
    v_mfma_f32_16x16x32_bf16 v[228:231], a[20:23], v[56:59], v[228:231]
    v_mfma_f32_16x16x32_bf16 v[232:235], a[24:27], v[56:59], v[232:235]
    v_mfma_f32_16x16x32_bf16 v[236:239], a[28:31], v[56:59], v[236:239]
    s_waitcnt lgkmcnt(0)
    v_mfma_f32_16x16x32_bf16 v[240:243], a[16:19], v[60:63], v[240:243]
    v_mfma_f32_16x16x32_bf16 v[244:247], a[20:23], v[60:63], v[244:247]
    v_mfma_f32_16x16x32_bf16 v[248:251], a[24:27], v[60:63], v[248:251]
    v_mfma_f32_16x16x32_bf16 v[252:255], a[28:31], v[60:63], v[252:255]
    v_cmp_eq_u32 s[86:87], 1, v4
    v_cmp_eq_u32 s[88:89], 2, v4
    v_cmp_eq_u32 s[90:91], 3, v4
    s_lshl_b32 s14, s8, 15
    s_add_u32 s48, s32, 0x2200000
    s_addc_u32 s49, s33, 0
    s_add_u32 s48, s48, s14
    s_addc_u32 s49, s49, 0
    s_mov_b32 s50, 0x8000
    s_mov_b32 s51, 0x20000
    s_lshl_b32 s15, s10, 10
    v_lshlrev_b32 v8, 13, v4
    v_lshlrev_b32 v7, 4, v3
    v_sub_u32 v8, v7, v8
    s_sub_u32 s14, s15, 8192
    v_add_u32 v8, s14, v8
    s_mul_i32 s13, s4, 4096
    s_add_u32 s13, s13, 147456
    v_lshlrev_b32 v10, 2, v2
    v_add_u32 v10, s13, v10
    v_lshlrev_b32 v11, 2, v3
    v_add_u32 v11, s13, v11
    ds_read_b128 v[20:23], v18 offset:0
    ds_read_b128 v[24:27], v18 offset:16
    ds_read_b128 v[28:31], v18 offset:512
    ds_read_b128 v[32:35], v18 offset:528
    ds_read_b128 v[36:39], v18 offset:1024
    ds_read_b128 v[40:43], v18 offset:1040
    ds_read_b128 v[44:47], v18 offset:1536
    ds_read_b128 v[48:51], v18 offset:1552
    ds_read_b128 v[52:55], v18 offset:2048
    ds_read_b128 v[56:59], v18 offset:2064
    ds_read_b128 v[60:63], v18 offset:2560
    ds_read_b128 v[64:67], v18 offset:2576
    ds_read_b128 v[68:71], v18 offset:3072
    ds_read_b128 v[72:75], v18 offset:3088
    ds_read_b128 v[76:79], v18 offset:3584
    ds_read_b128 v[80:83], v18 offset:3600
    ds_read_b128 v[84:87], v18 offset:4096
    ds_read_b128 v[88:91], v18 offset:4112
    s_waitcnt lgkmcnt(0)
    v_fma_f32 v93, v20, v112, v113
    v_fma_f32 v95, v28, v128, v129
    v_fma_f32 v97, v36, v144, v145
    v_fma_f32 v99, v44, v160, v161
    v_fma_f32 v101, v52, v176, v177
    v_fma_f32 v103, v60, v192, v193
    v_fma_f32 v105, v68, v208, v209
    v_fma_f32 v107, v76, v224, v225
    v_fma_f32 v109, v84, v240, v241
    v_fmac_f32_dpp v93, v112, -v21 row_ror:8 row_mask:0xf bank_mask:0xf
    v_fmac_f32_dpp v95, v128, -v29 row_ror:8 row_mask:0xf bank_mask:0xf
    v_fmac_f32_dpp v97, v144, -v37 row_ror:8 row_mask:0xf bank_mask:0xf
    v_fmac_f32_dpp v99, v160, -v45 row_ror:8 row_mask:0xf bank_mask:0xf
    v_fmac_f32_dpp v101, v176, -v53 row_ror:8 row_mask:0xf bank_mask:0xf
    v_fmac_f32_dpp v103, v192, -v61 row_ror:8 row_mask:0xf bank_mask:0xf
    v_fmac_f32_dpp v105, v208, -v69 row_ror:8 row_mask:0xf bank_mask:0xf
    v_fmac_f32_dpp v107, v224, -v77 row_ror:8 row_mask:0xf bank_mask:0xf
    v_fmac_f32_dpp v109, v240, -v85 row_ror:8 row_mask:0xf bank_mask:0xf
    v_fma_f32 v92, v20, v93, v114
    v_fma_f32 v94, v28, v95, v130
    v_fma_f32 v96, v36, v97, v146
    v_fma_f32 v98, v44, v99, v162
    v_fma_f32 v100, v52, v101, v178
    v_fma_f32 v102, v60, v103, v194
    v_fma_f32 v104, v68, v105, v210
    v_fma_f32 v106, v76, v107, v226
    v_fma_f32 v108, v84, v109, v242
    v_fmac_f32_dpp v92, v93, -v21 row_ror:8 row_mask:0xf bank_mask:0xf
    v_fmac_f32_dpp v94, v95, -v29 row_ror:8 row_mask:0xf bank_mask:0xf
    v_fmac_f32_dpp v96, v97, -v37 row_ror:8 row_mask:0xf bank_mask:0xf
    v_fmac_f32_dpp v98, v99, -v45 row_ror:8 row_mask:0xf bank_mask:0xf
    v_fmac_f32_dpp v100, v101, -v53 row_ror:8 row_mask:0xf bank_mask:0xf
    v_fmac_f32_dpp v102, v103, -v61 row_ror:8 row_mask:0xf bank_mask:0xf
    v_fmac_f32_dpp v104, v105, -v69 row_ror:8 row_mask:0xf bank_mask:0xf
    v_fmac_f32_dpp v106, v107, -v77 row_ror:8 row_mask:0xf bank_mask:0xf
    v_fmac_f32_dpp v108, v109, -v85 row_ror:8 row_mask:0xf bank_mask:0xf
    v_fma_f32 v93, v20, v92, v115
    v_fma_f32 v95, v28, v94, v131
    v_fma_f32 v97, v36, v96, v147
    v_fma_f32 v99, v44, v98, v163
    v_fma_f32 v101, v52, v100, v179
    v_fma_f32 v103, v60, v102, v195
    v_fma_f32 v105, v68, v104, v211
    v_fma_f32 v107, v76, v106, v227
    v_fma_f32 v109, v84, v108, v243
    v_fmac_f32_dpp v93, v92, -v21 row_ror:8 row_mask:0xf bank_mask:0xf
    v_fmac_f32_dpp v95, v94, -v29 row_ror:8 row_mask:0xf bank_mask:0xf
    v_fmac_f32_dpp v97, v96, -v37 row_ror:8 row_mask:0xf bank_mask:0xf
    v_fmac_f32_dpp v99, v98, -v45 row_ror:8 row_mask:0xf bank_mask:0xf
    v_fmac_f32_dpp v101, v100, -v53 row_ror:8 row_mask:0xf bank_mask:0xf
    v_fmac_f32_dpp v103, v102, -v61 row_ror:8 row_mask:0xf bank_mask:0xf
    v_fmac_f32_dpp v105, v104, -v69 row_ror:8 row_mask:0xf bank_mask:0xf
    v_fmac_f32_dpp v107, v106, -v77 row_ror:8 row_mask:0xf bank_mask:0xf
    v_fmac_f32_dpp v109, v108, -v85 row_ror:8 row_mask:0xf bank_mask:0xf
    v_fma_f32 v92, v20, v93, v116
    v_fma_f32 v94, v28, v95, v132
    v_fma_f32 v96, v36, v97, v148
    v_fma_f32 v98, v44, v99, v164
    v_fma_f32 v100, v52, v101, v180
    v_fma_f32 v102, v60, v103, v196
    v_fma_f32 v104, v68, v105, v212
    v_fma_f32 v106, v76, v107, v228
    v_fma_f32 v108, v84, v109, v244
    v_fmac_f32_dpp v92, v93, -v21 row_ror:8 row_mask:0xf bank_mask:0xf
    v_fmac_f32_dpp v94, v95, -v29 row_ror:8 row_mask:0xf bank_mask:0xf
    v_fmac_f32_dpp v96, v97, -v37 row_ror:8 row_mask:0xf bank_mask:0xf
    v_fmac_f32_dpp v98, v99, -v45 row_ror:8 row_mask:0xf bank_mask:0xf
    v_fmac_f32_dpp v100, v101, -v53 row_ror:8 row_mask:0xf bank_mask:0xf
    v_fmac_f32_dpp v102, v103, -v61 row_ror:8 row_mask:0xf bank_mask:0xf
    v_fmac_f32_dpp v104, v105, -v69 row_ror:8 row_mask:0xf bank_mask:0xf
    v_fmac_f32_dpp v106, v107, -v77 row_ror:8 row_mask:0xf bank_mask:0xf
    v_fmac_f32_dpp v108, v109, -v85 row_ror:8 row_mask:0xf bank_mask:0xf
    v_fma_f32 v93, v20, v92, v117
    v_fma_f32 v95, v28, v94, v133
    v_fma_f32 v97, v36, v96, v149
    v_fma_f32 v99, v44, v98, v165
    v_fma_f32 v101, v52, v100, v181
    v_fma_f32 v103, v60, v102, v197
    v_fma_f32 v105, v68, v104, v213
    v_fma_f32 v107, v76, v106, v229
    v_fma_f32 v109, v84, v108, v245
    v_fmac_f32_dpp v93, v92, -v21 row_ror:8 row_mask:0xf bank_mask:0xf
    v_fmac_f32_dpp v95, v94, -v29 row_ror:8 row_mask:0xf bank_mask:0xf
    v_fmac_f32_dpp v97, v96, -v37 row_ror:8 row_mask:0xf bank_mask:0xf
    v_fmac_f32_dpp v99, v98, -v45 row_ror:8 row_mask:0xf bank_mask:0xf
    v_fmac_f32_dpp v101, v100, -v53 row_ror:8 row_mask:0xf bank_mask:0xf
    v_fmac_f32_dpp v103, v102, -v61 row_ror:8 row_mask:0xf bank_mask:0xf
    v_fmac_f32_dpp v105, v104, -v69 row_ror:8 row_mask:0xf bank_mask:0xf
    v_fmac_f32_dpp v107, v106, -v77 row_ror:8 row_mask:0xf bank_mask:0xf
    v_fmac_f32_dpp v109, v108, -v85 row_ror:8 row_mask:0xf bank_mask:0xf
    v_fma_f32 v92, v20, v93, v118
    v_fma_f32 v94, v28, v95, v134
    v_fma_f32 v96, v36, v97, v150
    v_fma_f32 v98, v44, v99, v166
    v_fma_f32 v100, v52, v101, v182
    v_fma_f32 v102, v60, v103, v198
    v_fma_f32 v104, v68, v105, v214
    v_fma_f32 v106, v76, v107, v230
    v_fma_f32 v108, v84, v109, v246
    v_fmac_f32_dpp v92, v93, -v21 row_ror:8 row_mask:0xf bank_mask:0xf
    v_fmac_f32_dpp v94, v95, -v29 row_ror:8 row_mask:0xf bank_mask:0xf
    v_fmac_f32_dpp v96, v97, -v37 row_ror:8 row_mask:0xf bank_mask:0xf
    v_fmac_f32_dpp v98, v99, -v45 row_ror:8 row_mask:0xf bank_mask:0xf
    v_fmac_f32_dpp v100, v101, -v53 row_ror:8 row_mask:0xf bank_mask:0xf
    v_fmac_f32_dpp v102, v103, -v61 row_ror:8 row_mask:0xf bank_mask:0xf
    v_fmac_f32_dpp v104, v105, -v69 row_ror:8 row_mask:0xf bank_mask:0xf
    v_fmac_f32_dpp v106, v107, -v77 row_ror:8 row_mask:0xf bank_mask:0xf
    v_fmac_f32_dpp v108, v109, -v85 row_ror:8 row_mask:0xf bank_mask:0xf
    v_fma_f32 v93, v20, v92, v119
    v_fma_f32 v95, v28, v94, v135
    v_fma_f32 v97, v36, v96, v151
    v_fma_f32 v99, v44, v98, v167
    v_fma_f32 v101, v52, v100, v183
    v_fma_f32 v103, v60, v102, v199
    v_fma_f32 v105, v68, v104, v215
    v_fma_f32 v107, v76, v106, v231
    v_fma_f32 v109, v84, v108, v247
    v_fmac_f32_dpp v93, v92, -v21 row_ror:8 row_mask:0xf bank_mask:0xf
    v_fmac_f32_dpp v95, v94, -v29 row_ror:8 row_mask:0xf bank_mask:0xf
    v_fmac_f32_dpp v97, v96, -v37 row_ror:8 row_mask:0xf bank_mask:0xf
    v_fmac_f32_dpp v99, v98, -v45 row_ror:8 row_mask:0xf bank_mask:0xf
    v_fmac_f32_dpp v101, v100, -v53 row_ror:8 row_mask:0xf bank_mask:0xf
    v_fmac_f32_dpp v103, v102, -v61 row_ror:8 row_mask:0xf bank_mask:0xf
    v_fmac_f32_dpp v105, v104, -v69 row_ror:8 row_mask:0xf bank_mask:0xf
    v_fmac_f32_dpp v107, v106, -v77 row_ror:8 row_mask:0xf bank_mask:0xf
    v_fmac_f32_dpp v109, v108, -v85 row_ror:8 row_mask:0xf bank_mask:0xf
    v_fma_f32 v92, v20, v93, v120
    v_fma_f32 v94, v28, v95, v136
    v_fma_f32 v96, v36, v97, v152
    v_fma_f32 v98, v44, v99, v168
    v_fma_f32 v100, v52, v101, v184
    v_fma_f32 v102, v60, v103, v200
    v_fma_f32 v104, v68, v105, v216
    v_fma_f32 v106, v76, v107, v232
    v_fma_f32 v108, v84, v109, v248
    v_fmac_f32_dpp v92, v93, -v21 row_ror:8 row_mask:0xf bank_mask:0xf
    v_fmac_f32_dpp v94, v95, -v29 row_ror:8 row_mask:0xf bank_mask:0xf
    v_fmac_f32_dpp v96, v97, -v37 row_ror:8 row_mask:0xf bank_mask:0xf
    v_fmac_f32_dpp v98, v99, -v45 row_ror:8 row_mask:0xf bank_mask:0xf
    v_fmac_f32_dpp v100, v101, -v53 row_ror:8 row_mask:0xf bank_mask:0xf
    v_fmac_f32_dpp v102, v103, -v61 row_ror:8 row_mask:0xf bank_mask:0xf
    v_fmac_f32_dpp v104, v105, -v69 row_ror:8 row_mask:0xf bank_mask:0xf
    v_fmac_f32_dpp v106, v107, -v77 row_ror:8 row_mask:0xf bank_mask:0xf
    v_fmac_f32_dpp v108, v109, -v85 row_ror:8 row_mask:0xf bank_mask:0xf
    v_fma_f32 v93, v20, v92, v121
    v_fma_f32 v95, v28, v94, v137
    v_fma_f32 v97, v36, v96, v153
    v_fma_f32 v99, v44, v98, v169
    v_fma_f32 v101, v52, v100, v185
    v_fma_f32 v103, v60, v102, v201
    v_fma_f32 v105, v68, v104, v217
    v_fma_f32 v107, v76, v106, v233
    v_fma_f32 v109, v84, v108, v249
    v_fmac_f32_dpp v93, v92, -v21 row_ror:8 row_mask:0xf bank_mask:0xf
    v_fmac_f32_dpp v95, v94, -v29 row_ror:8 row_mask:0xf bank_mask:0xf
    v_fmac_f32_dpp v97, v96, -v37 row_ror:8 row_mask:0xf bank_mask:0xf
    v_fmac_f32_dpp v99, v98, -v45 row_ror:8 row_mask:0xf bank_mask:0xf
    v_fmac_f32_dpp v101, v100, -v53 row_ror:8 row_mask:0xf bank_mask:0xf
    v_fmac_f32_dpp v103, v102, -v61 row_ror:8 row_mask:0xf bank_mask:0xf
    v_fmac_f32_dpp v105, v104, -v69 row_ror:8 row_mask:0xf bank_mask:0xf
    v_fmac_f32_dpp v107, v106, -v77 row_ror:8 row_mask:0xf bank_mask:0xf
    v_fmac_f32_dpp v109, v108, -v85 row_ror:8 row_mask:0xf bank_mask:0xf
    v_fma_f32 v92, v20, v93, v122
    v_fma_f32 v94, v28, v95, v138
    v_fma_f32 v96, v36, v97, v154
    v_fma_f32 v98, v44, v99, v170
    v_fma_f32 v100, v52, v101, v186
    v_fma_f32 v102, v60, v103, v202
    v_fma_f32 v104, v68, v105, v218
    v_fma_f32 v106, v76, v107, v234
    v_fma_f32 v108, v84, v109, v250
    v_fmac_f32_dpp v92, v93, -v21 row_ror:8 row_mask:0xf bank_mask:0xf
    v_fmac_f32_dpp v94, v95, -v29 row_ror:8 row_mask:0xf bank_mask:0xf
    v_fmac_f32_dpp v96, v97, -v37 row_ror:8 row_mask:0xf bank_mask:0xf
    v_fmac_f32_dpp v98, v99, -v45 row_ror:8 row_mask:0xf bank_mask:0xf
    v_fmac_f32_dpp v100, v101, -v53 row_ror:8 row_mask:0xf bank_mask:0xf
    v_fmac_f32_dpp v102, v103, -v61 row_ror:8 row_mask:0xf bank_mask:0xf
    v_fmac_f32_dpp v104, v105, -v69 row_ror:8 row_mask:0xf bank_mask:0xf
    v_fmac_f32_dpp v106, v107, -v77 row_ror:8 row_mask:0xf bank_mask:0xf
    v_fmac_f32_dpp v108, v109, -v85 row_ror:8 row_mask:0xf bank_mask:0xf
    v_fma_f32 v93, v20, v92, v123
    v_fma_f32 v95, v28, v94, v139
    v_fma_f32 v97, v36, v96, v155
    v_fma_f32 v99, v44, v98, v171
    v_fma_f32 v101, v52, v100, v187
    v_fma_f32 v103, v60, v102, v203
    v_fma_f32 v105, v68, v104, v219
    v_fma_f32 v107, v76, v106, v235
    v_fma_f32 v109, v84, v108, v251
    v_fmac_f32_dpp v93, v92, -v21 row_ror:8 row_mask:0xf bank_mask:0xf
    v_fmac_f32_dpp v95, v94, -v29 row_ror:8 row_mask:0xf bank_mask:0xf
    v_fmac_f32_dpp v97, v96, -v37 row_ror:8 row_mask:0xf bank_mask:0xf
    v_fmac_f32_dpp v99, v98, -v45 row_ror:8 row_mask:0xf bank_mask:0xf
    v_fmac_f32_dpp v101, v100, -v53 row_ror:8 row_mask:0xf bank_mask:0xf
    v_fmac_f32_dpp v103, v102, -v61 row_ror:8 row_mask:0xf bank_mask:0xf
    v_fmac_f32_dpp v105, v104, -v69 row_ror:8 row_mask:0xf bank_mask:0xf
    v_fmac_f32_dpp v107, v106, -v77 row_ror:8 row_mask:0xf bank_mask:0xf
    v_fmac_f32_dpp v109, v108, -v85 row_ror:8 row_mask:0xf bank_mask:0xf
    v_fma_f32 v92, v20, v93, v124
    v_fma_f32 v94, v28, v95, v140
    v_fma_f32 v96, v36, v97, v156
    v_fma_f32 v98, v44, v99, v172
    v_fma_f32 v100, v52, v101, v188
    v_fma_f32 v102, v60, v103, v204
    v_fma_f32 v104, v68, v105, v220
    v_fma_f32 v106, v76, v107, v236
    v_fma_f32 v108, v84, v109, v252
    v_fmac_f32_dpp v92, v93, -v21 row_ror:8 row_mask:0xf bank_mask:0xf
    v_fmac_f32_dpp v94, v95, -v29 row_ror:8 row_mask:0xf bank_mask:0xf
    v_fmac_f32_dpp v96, v97, -v37 row_ror:8 row_mask:0xf bank_mask:0xf
    v_fmac_f32_dpp v98, v99, -v45 row_ror:8 row_mask:0xf bank_mask:0xf
    v_fmac_f32_dpp v100, v101, -v53 row_ror:8 row_mask:0xf bank_mask:0xf
    v_fmac_f32_dpp v102, v103, -v61 row_ror:8 row_mask:0xf bank_mask:0xf
    v_fmac_f32_dpp v104, v105, -v69 row_ror:8 row_mask:0xf bank_mask:0xf
    v_fmac_f32_dpp v106, v107, -v77 row_ror:8 row_mask:0xf bank_mask:0xf
    v_fmac_f32_dpp v108, v109, -v85 row_ror:8 row_mask:0xf bank_mask:0xf
    v_fma_f32 v93, v20, v92, v125
    v_fma_f32 v95, v28, v94, v141
    v_fma_f32 v97, v36, v96, v157
    v_fma_f32 v99, v44, v98, v173
    v_fma_f32 v101, v52, v100, v189
    v_fma_f32 v103, v60, v102, v205
    v_fma_f32 v105, v68, v104, v221
    v_fma_f32 v107, v76, v106, v237
    v_fma_f32 v109, v84, v108, v253
    v_fmac_f32_dpp v93, v92, -v21 row_ror:8 row_mask:0xf bank_mask:0xf
    v_fmac_f32_dpp v95, v94, -v29 row_ror:8 row_mask:0xf bank_mask:0xf
    v_fmac_f32_dpp v97, v96, -v37 row_ror:8 row_mask:0xf bank_mask:0xf
    v_fmac_f32_dpp v99, v98, -v45 row_ror:8 row_mask:0xf bank_mask:0xf
    v_fmac_f32_dpp v101, v100, -v53 row_ror:8 row_mask:0xf bank_mask:0xf
    v_fmac_f32_dpp v103, v102, -v61 row_ror:8 row_mask:0xf bank_mask:0xf
    v_fmac_f32_dpp v105, v104, -v69 row_ror:8 row_mask:0xf bank_mask:0xf
    v_fmac_f32_dpp v107, v106, -v77 row_ror:8 row_mask:0xf bank_mask:0xf
    v_fmac_f32_dpp v109, v108, -v85 row_ror:8 row_mask:0xf bank_mask:0xf
    v_fma_f32 v92, v20, v93, v126
    v_fma_f32 v94, v28, v95, v142
    v_fma_f32 v96, v36, v97, v158
    v_fma_f32 v98, v44, v99, v174
    v_fma_f32 v100, v52, v101, v190
    v_fma_f32 v102, v60, v103, v206
    v_fma_f32 v104, v68, v105, v222
    v_fma_f32 v106, v76, v107, v238
    v_fma_f32 v108, v84, v109, v254
    v_fmac_f32_dpp v92, v93, -v21 row_ror:8 row_mask:0xf bank_mask:0xf
    v_fmac_f32_dpp v94, v95, -v29 row_ror:8 row_mask:0xf bank_mask:0xf
    v_fmac_f32_dpp v96, v97, -v37 row_ror:8 row_mask:0xf bank_mask:0xf
    v_fmac_f32_dpp v98, v99, -v45 row_ror:8 row_mask:0xf bank_mask:0xf
    v_fmac_f32_dpp v100, v101, -v53 row_ror:8 row_mask:0xf bank_mask:0xf
    v_fmac_f32_dpp v102, v103, -v61 row_ror:8 row_mask:0xf bank_mask:0xf
    v_fmac_f32_dpp v104, v105, -v69 row_ror:8 row_mask:0xf bank_mask:0xf
    v_fmac_f32_dpp v106, v107, -v77 row_ror:8 row_mask:0xf bank_mask:0xf
    v_fmac_f32_dpp v108, v109, -v85 row_ror:8 row_mask:0xf bank_mask:0xf
    v_fma_f32 v93, v20, v92, v127
    v_fma_f32 v95, v28, v94, v143
    v_fma_f32 v97, v36, v96, v159
    v_fma_f32 v99, v44, v98, v175
    v_fma_f32 v101, v52, v100, v191
    v_fma_f32 v103, v60, v102, v207
    v_fma_f32 v105, v68, v104, v223
    v_fma_f32 v107, v76, v106, v239
    v_fma_f32 v109, v84, v108, v255
    v_fmac_f32_dpp v93, v92, -v21 row_ror:8 row_mask:0xf bank_mask:0xf
    v_fmac_f32_dpp v95, v94, -v29 row_ror:8 row_mask:0xf bank_mask:0xf
    v_fmac_f32_dpp v97, v96, -v37 row_ror:8 row_mask:0xf bank_mask:0xf
    v_fmac_f32_dpp v99, v98, -v45 row_ror:8 row_mask:0xf bank_mask:0xf
    v_fmac_f32_dpp v101, v100, -v53 row_ror:8 row_mask:0xf bank_mask:0xf
    v_fmac_f32_dpp v103, v102, -v61 row_ror:8 row_mask:0xf bank_mask:0xf
    v_fmac_f32_dpp v105, v104, -v69 row_ror:8 row_mask:0xf bank_mask:0xf
    v_fmac_f32_dpp v107, v106, -v77 row_ror:8 row_mask:0xf bank_mask:0xf
    v_fmac_f32_dpp v109, v108, -v85 row_ror:8 row_mask:0xf bank_mask:0xf
    ds_write_b32 v10, v93 offset:0
    ds_write_b32 v10, v95 offset:256
    ds_write_b32 v10, v97 offset:512
    ds_write_b32 v10, v99 offset:768
    ds_write_b32 v10, v101 offset:1024
    ds_write_b32 v10, v103 offset:1280
    ds_write_b32 v10, v105 offset:1536
    ds_write_b32 v10, v107 offset:1792
    ds_write_b32 v10, v109 offset:2048
    ds_read2_b32 v[26:27], v11 offset0:0 offset1:16
    ds_read2_b32 v[92:93], v11 offset0:32 offset1:48
    ds_read2_b32 v[34:35], v11 offset0:64 offset1:80
    ds_read2_b32 v[94:95], v11 offset0:96 offset1:112
    ds_read2_b32 v[42:43], v11 offset0:128 offset1:144
    ds_read2_b32 v[96:97], v11 offset0:160 offset1:176
    ds_read2_b32 v[50:51], v11 offset0:192 offset1:208
    ds_read2_b32 v[98:99], v11 offset0:224 offset1:240
    v_add_u32 v11, 1024, v11
    ds_read2_b32 v[58:59], v11 offset0:0 offset1:16
    ds_read2_b32 v[100:101], v11 offset0:32 offset1:48
    ds_read2_b32 v[66:67], v11 offset0:64 offset1:80
    ds_read2_b32 v[102:103], v11 offset0:96 offset1:112
    ds_read2_b32 v[74:75], v11 offset0:128 offset1:144
    ds_read2_b32 v[104:105], v11 offset0:160 offset1:176
    ds_read2_b32 v[82:83], v11 offset0:192 offset1:208
    ds_read2_b32 v[106:107], v11 offset0:224 offset1:240
    v_add_u32 v11, 1024, v11
    ds_read2_b32 v[90:91], v11 offset0:0 offset1:16
    ds_read2_b32 v[108:109], v11 offset0:32 offset1:48
    s_waitcnt lgkmcnt(0)
    v_fmac_f32 v27, v24, v26
    v_fmac_f32 v35, v32, v34
    v_fmac_f32 v43, v40, v42
    v_fmac_f32 v51, v48, v50
    v_fmac_f32 v59, v56, v58
    v_fmac_f32 v67, v64, v66
    v_fmac_f32 v75, v72, v74
    v_fmac_f32 v83, v80, v82
    v_fmac_f32 v91, v88, v90
    v_fmac_f32_dpp v27, v26, v25 row_ror:8 row_mask:0xf bank_mask:0xf
    v_fmac_f32_dpp v35, v34, v33 row_ror:8 row_mask:0xf bank_mask:0xf
    v_fmac_f32_dpp v43, v42, v41 row_ror:8 row_mask:0xf bank_mask:0xf
    v_fmac_f32_dpp v51, v50, v49 row_ror:8 row_mask:0xf bank_mask:0xf
    v_fmac_f32_dpp v59, v58, v57 row_ror:8 row_mask:0xf bank_mask:0xf
    v_fmac_f32_dpp v67, v66, v65 row_ror:8 row_mask:0xf bank_mask:0xf
    v_fmac_f32_dpp v75, v74, v73 row_ror:8 row_mask:0xf bank_mask:0xf
    v_fmac_f32_dpp v83, v82, v81 row_ror:8 row_mask:0xf bank_mask:0xf
    v_fmac_f32_dpp v91, v90, v89 row_ror:8 row_mask:0xf bank_mask:0xf
    v_fmac_f32 v92, v24, v27
    v_fmac_f32 v94, v32, v35
    v_fmac_f32 v96, v40, v43
    v_fmac_f32 v98, v48, v51
    v_fmac_f32 v100, v56, v59
    v_fmac_f32 v102, v64, v67
    v_fmac_f32 v104, v72, v75
    v_fmac_f32 v106, v80, v83
    v_fmac_f32 v108, v88, v91
    v_fmac_f32_dpp v92, v27, v25 row_ror:8 row_mask:0xf bank_mask:0xf
    v_fmac_f32_dpp v94, v35, v33 row_ror:8 row_mask:0xf bank_mask:0xf
    v_fmac_f32_dpp v96, v43, v41 row_ror:8 row_mask:0xf bank_mask:0xf
    v_fmac_f32_dpp v98, v51, v49 row_ror:8 row_mask:0xf bank_mask:0xf
    v_fmac_f32_dpp v100, v59, v57 row_ror:8 row_mask:0xf bank_mask:0xf
    v_fmac_f32_dpp v102, v67, v65 row_ror:8 row_mask:0xf bank_mask:0xf
    v_fmac_f32_dpp v104, v75, v73 row_ror:8 row_mask:0xf bank_mask:0xf
    v_fmac_f32_dpp v106, v83, v81 row_ror:8 row_mask:0xf bank_mask:0xf
    v_fmac_f32_dpp v108, v91, v89 row_ror:8 row_mask:0xf bank_mask:0xf
    v_fmac_f32 v93, v24, v92
    v_fmac_f32 v95, v32, v94
    v_fmac_f32 v97, v40, v96
    v_fmac_f32 v99, v48, v98
    v_fmac_f32 v101, v56, v100
    v_fmac_f32 v103, v64, v102
    v_fmac_f32 v105, v72, v104
    v_fmac_f32 v107, v80, v106
    v_fmac_f32 v109, v88, v108
    v_fmac_f32_dpp v93, v92, v25 row_ror:8 row_mask:0xf bank_mask:0xf
    v_fmac_f32_dpp v95, v94, v33 row_ror:8 row_mask:0xf bank_mask:0xf
    v_fmac_f32_dpp v97, v96, v41 row_ror:8 row_mask:0xf bank_mask:0xf
    v_fmac_f32_dpp v99, v98, v49 row_ror:8 row_mask:0xf bank_mask:0xf
    v_fmac_f32_dpp v101, v100, v57 row_ror:8 row_mask:0xf bank_mask:0xf
    v_fmac_f32_dpp v103, v102, v65 row_ror:8 row_mask:0xf bank_mask:0xf
    v_fmac_f32_dpp v105, v104, v73 row_ror:8 row_mask:0xf bank_mask:0xf
    v_fmac_f32_dpp v107, v106, v81 row_ror:8 row_mask:0xf bank_mask:0xf
    v_fmac_f32_dpp v109, v108, v89 row_ror:8 row_mask:0xf bank_mask:0xf
    v_cndmask_b32 v12, v93, v101, s[86:87]
    v_cndmask_b32 v13, v95, v103, s[86:87]
    v_cndmask_b32 v14, v97, v105, s[86:87]
    v_cndmask_b32 v15, v99, v107, s[86:87]
    v_cndmask_b32 v12, v12, v109, s[88:89]
    buffer_store_dwordx4 v[12:15], v5, s[48:51], s15 offen sc1
    v_cndmask_b32 v24, 0, v26, s[86:87]
    v_cndmask_b32 v24, v24, v27, s[88:89]
    v_cndmask_b32 v24, v24, v92, s[90:91]
    v_cndmask_b32 v32, 0, v34, s[86:87]
    v_cndmask_b32 v32, v32, v35, s[88:89]
    v_cndmask_b32 v32, v32, v94, s[90:91]
    v_cndmask_b32 v40, 0, v42, s[86:87]
    v_cndmask_b32 v40, v40, v43, s[88:89]
    v_cndmask_b32 v40, v40, v96, s[90:91]
    v_cndmask_b32 v48, 0, v50, s[86:87]
    v_cndmask_b32 v48, v48, v51, s[88:89]
    v_cndmask_b32 v48, v48, v98, s[90:91]
    v_cndmask_b32 v56, 0, v58, s[86:87]
    v_cndmask_b32 v56, v56, v59, s[88:89]
    v_cndmask_b32 v56, v56, v100, s[90:91]
    v_cndmask_b32 v64, 0, v66, s[86:87]
    v_cndmask_b32 v64, v64, v67, s[88:89]
    v_cndmask_b32 v64, v64, v102, s[90:91]
    v_cndmask_b32 v72, 0, v74, s[86:87]
    v_cndmask_b32 v72, v72, v75, s[88:89]
    v_cndmask_b32 v72, v72, v104, s[90:91]
    v_cndmask_b32 v80, 0, v82, s[86:87]
    v_cndmask_b32 v80, v80, v83, s[88:89]
    v_cndmask_b32 v80, v80, v106, s[90:91]
    v_cndmask_b32 v88, 0, v90, s[86:87]
    v_cndmask_b32 v88, v88, v91, s[88:89]
    v_cndmask_b32 v88, v88, v108, s[90:91]
    ds_read_b64 v[26:27], v18 offset:24
    ds_read_b64 v[34:35], v18 offset:536
    ds_read_b64 v[42:43], v18 offset:1048
    ds_read_b64 v[50:51], v18 offset:1560
    ds_read_b64 v[58:59], v18 offset:2072
    ds_read_b64 v[66:67], v18 offset:2584
    ds_read_b64 v[74:75], v18 offset:3096
    ds_read_b64 v[82:83], v18 offset:3608
    ds_read_b64 v[90:91], v18 offset:4120
    v_mul_f32_dpp v92, v112, v23 row_ror:8 row_mask:0xf bank_mask:0xf
    v_mul_f32_dpp v94, v128, v31 row_ror:8 row_mask:0xf bank_mask:0xf
    v_mul_f32_dpp v96, v144, v39 row_ror:8 row_mask:0xf bank_mask:0xf
    v_mul_f32_dpp v98, v160, v47 row_ror:8 row_mask:0xf bank_mask:0xf
    v_mul_f32_dpp v100, v176, v55 row_ror:8 row_mask:0xf bank_mask:0xf
    v_mul_f32_dpp v102, v192, v63 row_ror:8 row_mask:0xf bank_mask:0xf
    v_mul_f32_dpp v104, v208, v71 row_ror:8 row_mask:0xf bank_mask:0xf
    v_mul_f32_dpp v106, v224, v79 row_ror:8 row_mask:0xf bank_mask:0xf
    v_mul_f32_dpp v108, v240, v87 row_ror:8 row_mask:0xf bank_mask:0xf
    v_fma_f32 v112, v22, v112, v92
    v_fma_f32 v128, v30, v128, v94
    v_fma_f32 v144, v38, v144, v96
    v_fma_f32 v160, v46, v160, v98
    v_fma_f32 v176, v54, v176, v100
    v_fma_f32 v192, v62, v192, v102
    v_fma_f32 v208, v70, v208, v104
    v_fma_f32 v224, v78, v224, v106
    v_fma_f32 v240, v86, v240, v108
    v_mul_f32_dpp v92, v113, v23 row_ror:8 row_mask:0xf bank_mask:0xf
    v_mul_f32_dpp v94, v129, v31 row_ror:8 row_mask:0xf bank_mask:0xf
    v_mul_f32_dpp v96, v145, v39 row_ror:8 row_mask:0xf bank_mask:0xf
    v_mul_f32_dpp v98, v161, v47 row_ror:8 row_mask:0xf bank_mask:0xf
    v_mul_f32_dpp v100, v177, v55 row_ror:8 row_mask:0xf bank_mask:0xf
    v_mul_f32_dpp v102, v193, v63 row_ror:8 row_mask:0xf bank_mask:0xf
    v_mul_f32_dpp v104, v209, v71 row_ror:8 row_mask:0xf bank_mask:0xf
    v_mul_f32_dpp v106, v225, v79 row_ror:8 row_mask:0xf bank_mask:0xf
    v_mul_f32_dpp v108, v241, v87 row_ror:8 row_mask:0xf bank_mask:0xf
    v_fma_f32 v113, v22, v113, v92
    v_fma_f32 v129, v30, v129, v94
    v_fma_f32 v145, v38, v145, v96
    v_fma_f32 v161, v46, v161, v98
    v_fma_f32 v177, v54, v177, v100
    v_fma_f32 v193, v62, v193, v102
    v_fma_f32 v209, v70, v209, v104
    v_fma_f32 v225, v78, v225, v106
    v_fma_f32 v241, v86, v241, v108
    v_mul_f32_dpp v92, v114, v23 row_ror:8 row_mask:0xf bank_mask:0xf
    v_mul_f32_dpp v94, v130, v31 row_ror:8 row_mask:0xf bank_mask:0xf
    v_mul_f32_dpp v96, v146, v39 row_ror:8 row_mask:0xf bank_mask:0xf
    v_mul_f32_dpp v98, v162, v47 row_ror:8 row_mask:0xf bank_mask:0xf
    v_mul_f32_dpp v100, v178, v55 row_ror:8 row_mask:0xf bank_mask:0xf
    v_mul_f32_dpp v102, v194, v63 row_ror:8 row_mask:0xf bank_mask:0xf
    v_mul_f32_dpp v104, v210, v71 row_ror:8 row_mask:0xf bank_mask:0xf
    v_mul_f32_dpp v106, v226, v79 row_ror:8 row_mask:0xf bank_mask:0xf
    v_mul_f32_dpp v108, v242, v87 row_ror:8 row_mask:0xf bank_mask:0xf
    v_fma_f32 v114, v22, v114, v92
    v_fma_f32 v130, v30, v130, v94
    v_fma_f32 v146, v38, v146, v96
    v_fma_f32 v162, v46, v162, v98
    v_fma_f32 v178, v54, v178, v100
    v_fma_f32 v194, v62, v194, v102
    v_fma_f32 v210, v70, v210, v104
    v_fma_f32 v226, v78, v226, v106
    v_fma_f32 v242, v86, v242, v108
    v_mul_f32_dpp v92, v115, v23 row_ror:8 row_mask:0xf bank_mask:0xf
    v_mul_f32_dpp v94, v131, v31 row_ror:8 row_mask:0xf bank_mask:0xf
    v_mul_f32_dpp v96, v147, v39 row_ror:8 row_mask:0xf bank_mask:0xf
    v_mul_f32_dpp v98, v163, v47 row_ror:8 row_mask:0xf bank_mask:0xf
    v_mul_f32_dpp v100, v179, v55 row_ror:8 row_mask:0xf bank_mask:0xf
    v_mul_f32_dpp v102, v195, v63 row_ror:8 row_mask:0xf bank_mask:0xf
    v_mul_f32_dpp v104, v211, v71 row_ror:8 row_mask:0xf bank_mask:0xf
    v_mul_f32_dpp v106, v227, v79 row_ror:8 row_mask:0xf bank_mask:0xf
    v_mul_f32_dpp v108, v243, v87 row_ror:8 row_mask:0xf bank_mask:0xf
    v_fma_f32 v115, v22, v115, v92
    v_fma_f32 v131, v30, v131, v94
    v_fma_f32 v147, v38, v147, v96
    v_fma_f32 v163, v46, v163, v98
    v_fma_f32 v179, v54, v179, v100
    v_fma_f32 v195, v62, v195, v102
    v_fma_f32 v211, v70, v211, v104
    v_fma_f32 v227, v78, v227, v106
    v_fma_f32 v243, v86, v243, v108
    v_mul_f32_dpp v92, v116, v23 row_ror:8 row_mask:0xf bank_mask:0xf
    v_mul_f32_dpp v94, v132, v31 row_ror:8 row_mask:0xf bank_mask:0xf
    v_mul_f32_dpp v96, v148, v39 row_ror:8 row_mask:0xf bank_mask:0xf
    v_mul_f32_dpp v98, v164, v47 row_ror:8 row_mask:0xf bank_mask:0xf
    v_mul_f32_dpp v100, v180, v55 row_ror:8 row_mask:0xf bank_mask:0xf
    v_mul_f32_dpp v102, v196, v63 row_ror:8 row_mask:0xf bank_mask:0xf
    v_mul_f32_dpp v104, v212, v71 row_ror:8 row_mask:0xf bank_mask:0xf
    v_mul_f32_dpp v106, v228, v79 row_ror:8 row_mask:0xf bank_mask:0xf
    v_mul_f32_dpp v108, v244, v87 row_ror:8 row_mask:0xf bank_mask:0xf
    v_fma_f32 v116, v22, v116, v92
    v_fma_f32 v132, v30, v132, v94
    v_fma_f32 v148, v38, v148, v96
    v_fma_f32 v164, v46, v164, v98
    v_fma_f32 v180, v54, v180, v100
    v_fma_f32 v196, v62, v196, v102
    v_fma_f32 v212, v70, v212, v104
    v_fma_f32 v228, v78, v228, v106
    v_fma_f32 v244, v86, v244, v108
    v_mul_f32_dpp v92, v117, v23 row_ror:8 row_mask:0xf bank_mask:0xf
    v_mul_f32_dpp v94, v133, v31 row_ror:8 row_mask:0xf bank_mask:0xf
    v_mul_f32_dpp v96, v149, v39 row_ror:8 row_mask:0xf bank_mask:0xf
    v_mul_f32_dpp v98, v165, v47 row_ror:8 row_mask:0xf bank_mask:0xf
    v_mul_f32_dpp v100, v181, v55 row_ror:8 row_mask:0xf bank_mask:0xf
    v_mul_f32_dpp v102, v197, v63 row_ror:8 row_mask:0xf bank_mask:0xf
    v_mul_f32_dpp v104, v213, v71 row_ror:8 row_mask:0xf bank_mask:0xf
    v_mul_f32_dpp v106, v229, v79 row_ror:8 row_mask:0xf bank_mask:0xf
    v_mul_f32_dpp v108, v245, v87 row_ror:8 row_mask:0xf bank_mask:0xf
    v_fma_f32 v117, v22, v117, v92
    v_fma_f32 v133, v30, v133, v94
    v_fma_f32 v149, v38, v149, v96
    v_fma_f32 v165, v46, v165, v98
    v_fma_f32 v181, v54, v181, v100
    v_fma_f32 v197, v62, v197, v102
    v_fma_f32 v213, v70, v213, v104
    v_fma_f32 v229, v78, v229, v106
    v_fma_f32 v245, v86, v245, v108
    v_mul_f32_dpp v92, v118, v23 row_ror:8 row_mask:0xf bank_mask:0xf
    v_mul_f32_dpp v94, v134, v31 row_ror:8 row_mask:0xf bank_mask:0xf
    v_mul_f32_dpp v96, v150, v39 row_ror:8 row_mask:0xf bank_mask:0xf
    v_mul_f32_dpp v98, v166, v47 row_ror:8 row_mask:0xf bank_mask:0xf
    v_mul_f32_dpp v100, v182, v55 row_ror:8 row_mask:0xf bank_mask:0xf
    v_mul_f32_dpp v102, v198, v63 row_ror:8 row_mask:0xf bank_mask:0xf
    v_mul_f32_dpp v104, v214, v71 row_ror:8 row_mask:0xf bank_mask:0xf
    v_mul_f32_dpp v106, v230, v79 row_ror:8 row_mask:0xf bank_mask:0xf
    v_mul_f32_dpp v108, v246, v87 row_ror:8 row_mask:0xf bank_mask:0xf
    v_fma_f32 v118, v22, v118, v92
    v_fma_f32 v134, v30, v134, v94
    v_fma_f32 v150, v38, v150, v96
    v_fma_f32 v166, v46, v166, v98
    v_fma_f32 v182, v54, v182, v100
    v_fma_f32 v198, v62, v198, v102
    v_fma_f32 v214, v70, v214, v104
    v_fma_f32 v230, v78, v230, v106
    v_fma_f32 v246, v86, v246, v108
    v_mov_b32 v17, s3
    v_mov_b32 v9, 0
    s_lshl_b32 s14, s8, 12
    s_add_u32 s14, s14, 65536
    s_lshl_b32 s19, s10, 7
    s_add_u32 s19, s19, s14
    s_waitcnt vmcnt(0)
    buffer_store_dword v17, v9, s[56:59], s19 offen sc1
    v_mul_f32_dpp v92, v119, v23 row_ror:8 row_mask:0xf bank_mask:0xf
    v_mul_f32_dpp v94, v135, v31 row_ror:8 row_mask:0xf bank_mask:0xf
    v_mul_f32_dpp v96, v151, v39 row_ror:8 row_mask:0xf bank_mask:0xf
    v_mul_f32_dpp v98, v167, v47 row_ror:8 row_mask:0xf bank_mask:0xf
    v_mul_f32_dpp v100, v183, v55 row_ror:8 row_mask:0xf bank_mask:0xf
    v_mul_f32_dpp v102, v199, v63 row_ror:8 row_mask:0xf bank_mask:0xf
    v_mul_f32_dpp v104, v215, v71 row_ror:8 row_mask:0xf bank_mask:0xf
    v_mul_f32_dpp v106, v231, v79 row_ror:8 row_mask:0xf bank_mask:0xf
    v_mul_f32_dpp v108, v247, v87 row_ror:8 row_mask:0xf bank_mask:0xf
    v_fma_f32 v119, v22, v119, v92
    v_fma_f32 v135, v30, v135, v94
    v_fma_f32 v151, v38, v151, v96
    v_fma_f32 v167, v46, v167, v98
    v_fma_f32 v183, v54, v183, v100
    v_fma_f32 v199, v62, v199, v102
    v_fma_f32 v215, v70, v215, v104
    v_fma_f32 v231, v78, v231, v106
    v_fma_f32 v247, v86, v247, v108
    v_mul_f32_dpp v92, v120, v23 row_ror:8 row_mask:0xf bank_mask:0xf
    v_mul_f32_dpp v94, v136, v31 row_ror:8 row_mask:0xf bank_mask:0xf
    v_mul_f32_dpp v96, v152, v39 row_ror:8 row_mask:0xf bank_mask:0xf
    v_mul_f32_dpp v98, v168, v47 row_ror:8 row_mask:0xf bank_mask:0xf
    v_mul_f32_dpp v100, v184, v55 row_ror:8 row_mask:0xf bank_mask:0xf
    v_mul_f32_dpp v102, v200, v63 row_ror:8 row_mask:0xf bank_mask:0xf
    v_mul_f32_dpp v104, v216, v71 row_ror:8 row_mask:0xf bank_mask:0xf
    v_mul_f32_dpp v106, v232, v79 row_ror:8 row_mask:0xf bank_mask:0xf
    v_mul_f32_dpp v108, v248, v87 row_ror:8 row_mask:0xf bank_mask:0xf
    v_fma_f32 v120, v22, v120, v92
    v_fma_f32 v136, v30, v136, v94
    v_fma_f32 v152, v38, v152, v96
    v_fma_f32 v168, v46, v168, v98
    v_fma_f32 v184, v54, v184, v100
    v_fma_f32 v200, v62, v200, v102
    v_fma_f32 v216, v70, v216, v104
    v_fma_f32 v232, v78, v232, v106
    v_fma_f32 v248, v86, v248, v108
    v_mul_f32_dpp v92, v121, v23 row_ror:8 row_mask:0xf bank_mask:0xf
    v_mul_f32_dpp v94, v137, v31 row_ror:8 row_mask:0xf bank_mask:0xf
    v_mul_f32_dpp v96, v153, v39 row_ror:8 row_mask:0xf bank_mask:0xf
    v_mul_f32_dpp v98, v169, v47 row_ror:8 row_mask:0xf bank_mask:0xf
    v_mul_f32_dpp v100, v185, v55 row_ror:8 row_mask:0xf bank_mask:0xf
    v_mul_f32_dpp v102, v201, v63 row_ror:8 row_mask:0xf bank_mask:0xf
    v_mul_f32_dpp v104, v217, v71 row_ror:8 row_mask:0xf bank_mask:0xf
    v_mul_f32_dpp v106, v233, v79 row_ror:8 row_mask:0xf bank_mask:0xf
    v_mul_f32_dpp v108, v249, v87 row_ror:8 row_mask:0xf bank_mask:0xf
    v_fma_f32 v121, v22, v121, v92
    v_fma_f32 v137, v30, v137, v94
    v_fma_f32 v153, v38, v153, v96
    v_fma_f32 v169, v46, v169, v98
    v_fma_f32 v185, v54, v185, v100
    v_fma_f32 v201, v62, v201, v102
    v_fma_f32 v217, v70, v217, v104
    v_fma_f32 v233, v78, v233, v106
    v_fma_f32 v249, v86, v249, v108
    v_mul_f32_dpp v92, v122, v23 row_ror:8 row_mask:0xf bank_mask:0xf
    v_mul_f32_dpp v94, v138, v31 row_ror:8 row_mask:0xf bank_mask:0xf
    v_mul_f32_dpp v96, v154, v39 row_ror:8 row_mask:0xf bank_mask:0xf
    v_mul_f32_dpp v98, v170, v47 row_ror:8 row_mask:0xf bank_mask:0xf
    v_mul_f32_dpp v100, v186, v55 row_ror:8 row_mask:0xf bank_mask:0xf
    v_mul_f32_dpp v102, v202, v63 row_ror:8 row_mask:0xf bank_mask:0xf
    v_mul_f32_dpp v104, v218, v71 row_ror:8 row_mask:0xf bank_mask:0xf
    v_mul_f32_dpp v106, v234, v79 row_ror:8 row_mask:0xf bank_mask:0xf
    v_mul_f32_dpp v108, v250, v87 row_ror:8 row_mask:0xf bank_mask:0xf
    v_fma_f32 v122, v22, v122, v92
    v_fma_f32 v138, v30, v138, v94
    v_fma_f32 v154, v38, v154, v96
    v_fma_f32 v170, v46, v170, v98
    v_fma_f32 v186, v54, v186, v100
    v_fma_f32 v202, v62, v202, v102
    v_fma_f32 v218, v70, v218, v104
    v_fma_f32 v234, v78, v234, v106
    v_fma_f32 v250, v86, v250, v108
    v_mul_f32_dpp v92, v123, v23 row_ror:8 row_mask:0xf bank_mask:0xf
    v_mul_f32_dpp v94, v139, v31 row_ror:8 row_mask:0xf bank_mask:0xf
    v_mul_f32_dpp v96, v155, v39 row_ror:8 row_mask:0xf bank_mask:0xf
    v_mul_f32_dpp v98, v171, v47 row_ror:8 row_mask:0xf bank_mask:0xf
    v_mul_f32_dpp v100, v187, v55 row_ror:8 row_mask:0xf bank_mask:0xf
    v_mul_f32_dpp v102, v203, v63 row_ror:8 row_mask:0xf bank_mask:0xf
    v_mul_f32_dpp v104, v219, v71 row_ror:8 row_mask:0xf bank_mask:0xf
    v_mul_f32_dpp v106, v235, v79 row_ror:8 row_mask:0xf bank_mask:0xf
    v_mul_f32_dpp v108, v251, v87 row_ror:8 row_mask:0xf bank_mask:0xf
    v_fma_f32 v123, v22, v123, v92
    v_fma_f32 v139, v30, v139, v94
    v_fma_f32 v155, v38, v155, v96
    v_fma_f32 v171, v46, v171, v98
    v_fma_f32 v187, v54, v187, v100
    v_fma_f32 v203, v62, v203, v102
    v_fma_f32 v219, v70, v219, v104
    v_fma_f32 v235, v78, v235, v106
    v_fma_f32 v251, v86, v251, v108
    v_mul_f32_dpp v92, v124, v23 row_ror:8 row_mask:0xf bank_mask:0xf
    v_mul_f32_dpp v94, v140, v31 row_ror:8 row_mask:0xf bank_mask:0xf
    v_mul_f32_dpp v96, v156, v39 row_ror:8 row_mask:0xf bank_mask:0xf
    v_mul_f32_dpp v98, v172, v47 row_ror:8 row_mask:0xf bank_mask:0xf
    v_mul_f32_dpp v100, v188, v55 row_ror:8 row_mask:0xf bank_mask:0xf
    v_mul_f32_dpp v102, v204, v63 row_ror:8 row_mask:0xf bank_mask:0xf
    v_mul_f32_dpp v104, v220, v71 row_ror:8 row_mask:0xf bank_mask:0xf
    v_mul_f32_dpp v106, v236, v79 row_ror:8 row_mask:0xf bank_mask:0xf
    v_mul_f32_dpp v108, v252, v87 row_ror:8 row_mask:0xf bank_mask:0xf
    v_fma_f32 v124, v22, v124, v92
    v_fma_f32 v140, v30, v140, v94
    v_fma_f32 v156, v38, v156, v96
    v_fma_f32 v172, v46, v172, v98
    v_fma_f32 v188, v54, v188, v100
    v_fma_f32 v204, v62, v204, v102
    v_fma_f32 v220, v70, v220, v104
    v_fma_f32 v236, v78, v236, v106
    v_fma_f32 v252, v86, v252, v108
    v_mul_f32_dpp v92, v125, v23 row_ror:8 row_mask:0xf bank_mask:0xf
    v_mul_f32_dpp v94, v141, v31 row_ror:8 row_mask:0xf bank_mask:0xf
    v_mul_f32_dpp v96, v157, v39 row_ror:8 row_mask:0xf bank_mask:0xf
    v_mul_f32_dpp v98, v173, v47 row_ror:8 row_mask:0xf bank_mask:0xf
    v_mul_f32_dpp v100, v189, v55 row_ror:8 row_mask:0xf bank_mask:0xf
    v_mul_f32_dpp v102, v205, v63 row_ror:8 row_mask:0xf bank_mask:0xf
    v_mul_f32_dpp v104, v221, v71 row_ror:8 row_mask:0xf bank_mask:0xf
    v_mul_f32_dpp v106, v237, v79 row_ror:8 row_mask:0xf bank_mask:0xf
    v_mul_f32_dpp v108, v253, v87 row_ror:8 row_mask:0xf bank_mask:0xf
    v_fma_f32 v125, v22, v125, v92
    v_fma_f32 v141, v30, v141, v94
    v_fma_f32 v157, v38, v157, v96
    v_fma_f32 v173, v46, v173, v98
    v_fma_f32 v189, v54, v189, v100
    v_fma_f32 v205, v62, v205, v102
    v_fma_f32 v221, v70, v221, v104
    v_fma_f32 v237, v78, v237, v106
    v_fma_f32 v253, v86, v253, v108
    v_mul_f32_dpp v92, v126, v23 row_ror:8 row_mask:0xf bank_mask:0xf
    v_mul_f32_dpp v94, v142, v31 row_ror:8 row_mask:0xf bank_mask:0xf
    v_mul_f32_dpp v96, v158, v39 row_ror:8 row_mask:0xf bank_mask:0xf
    v_mul_f32_dpp v98, v174, v47 row_ror:8 row_mask:0xf bank_mask:0xf
    v_mul_f32_dpp v100, v190, v55 row_ror:8 row_mask:0xf bank_mask:0xf
    v_mul_f32_dpp v102, v206, v63 row_ror:8 row_mask:0xf bank_mask:0xf
    v_mul_f32_dpp v104, v222, v71 row_ror:8 row_mask:0xf bank_mask:0xf
    v_mul_f32_dpp v106, v238, v79 row_ror:8 row_mask:0xf bank_mask:0xf
    v_mul_f32_dpp v108, v254, v87 row_ror:8 row_mask:0xf bank_mask:0xf
    v_fma_f32 v126, v22, v126, v92
    v_fma_f32 v142, v30, v142, v94
    v_fma_f32 v158, v38, v158, v96
    v_fma_f32 v174, v46, v174, v98
    v_fma_f32 v190, v54, v190, v100
    v_fma_f32 v206, v62, v206, v102
    v_fma_f32 v222, v70, v222, v104
    v_fma_f32 v238, v78, v238, v106
    v_fma_f32 v254, v86, v254, v108
    v_mul_f32_dpp v92, v127, v23 row_ror:8 row_mask:0xf bank_mask:0xf
    v_mul_f32_dpp v94, v143, v31 row_ror:8 row_mask:0xf bank_mask:0xf
    v_mul_f32_dpp v96, v159, v39 row_ror:8 row_mask:0xf bank_mask:0xf
    v_mul_f32_dpp v98, v175, v47 row_ror:8 row_mask:0xf bank_mask:0xf
    v_mul_f32_dpp v100, v191, v55 row_ror:8 row_mask:0xf bank_mask:0xf
    v_mul_f32_dpp v102, v207, v63 row_ror:8 row_mask:0xf bank_mask:0xf
    v_mul_f32_dpp v104, v223, v71 row_ror:8 row_mask:0xf bank_mask:0xf
    v_mul_f32_dpp v106, v239, v79 row_ror:8 row_mask:0xf bank_mask:0xf
    v_mul_f32_dpp v108, v255, v87 row_ror:8 row_mask:0xf bank_mask:0xf
    v_fma_f32 v127, v22, v127, v92
    v_fma_f32 v143, v30, v143, v94
    v_fma_f32 v159, v38, v159, v96
    v_fma_f32 v175, v46, v175, v98
    v_fma_f32 v191, v54, v191, v100
    v_fma_f32 v207, v62, v207, v102
    v_fma_f32 v223, v70, v223, v104
    v_fma_f32 v239, v78, v239, v106
    v_fma_f32 v255, v86, v255, v108
    s_barrier
    v_min_u32 v12, s10, v2
    v_lshlrev_b32 v12, 7, v12
    s_mov_b32 s19, 0
parallel_poll30:
    buffer_load_dword v13, v12, s[56:59], s14 offen sc1
    s_add_u32 s19, s19, 1
    s_cmp_gt_u32 s19, 131072
    s_cbranch_scc1 parallel_pollx31
    s_waitcnt vmcnt(0)
    v_cmp_ne_u32 vcc, s3, v13
    s_cbranch_vccnz parallel_poll30
parallel_pollx31:
    buffer_load_dwordx4 a[0:3], v8, s[48:51], 0 offen offset:0 sc1
    buffer_load_dwordx4 a[4:7], v8, s[48:51], 0 offen offset:256 sc1
    buffer_load_dwordx4 a[8:11], v8, s[48:51], 0 offen offset:512 sc1
    v_add_u32 v8, 1024, v8
    buffer_load_dwordx4 a[12:15], v8, s[48:51], 0 offen offset:0 sc1
    buffer_load_dwordx4 a[16:19], v8, s[48:51], 0 offen offset:256 sc1
    buffer_load_dwordx4 a[20:23], v8, s[48:51], 0 offen offset:512 sc1
    v_add_u32 v8, 1024, v8
    buffer_load_dwordx4 a[24:27], v8, s[48:51], 0 offen offset:0 sc1
    buffer_load_dwordx4 a[28:31], v8, s[48:51], 0 offen offset:256 sc1
    buffer_load_dwordx4 a[32:35], v8, s[48:51], 0 offen offset:512 sc1
    v_add_u32 v8, 1024, v8
    buffer_load_dwordx4 a[36:39], v8, s[48:51], 0 offen offset:0 sc1
    buffer_load_dwordx4 a[40:43], v8, s[48:51], 0 offen offset:256 sc1
    buffer_load_dwordx4 a[44:47], v8, s[48:51], 0 offen offset:512 sc1
    v_add_u32 v8, 1024, v8
    buffer_load_dwordx4 a[48:51], v8, s[48:51], 0 offen offset:0 sc1
    buffer_load_dwordx4 a[52:55], v8, s[48:51], 0 offen offset:256 sc1
    buffer_load_dwordx4 a[56:59], v8, s[48:51], 0 offen offset:512 sc1
    v_add_u32 v8, 1024, v8
    buffer_load_dwordx4 a[60:63], v8, s[48:51], 0 offen offset:0 sc1
    buffer_load_dwordx4 a[64:67], v8, s[48:51], 0 offen offset:256 sc1
    buffer_load_dwordx4 a[68:71], v8, s[48:51], 0 offen offset:512 sc1
    v_add_u32 v8, 1024, v8
    buffer_load_dwordx4 a[72:75], v8, s[48:51], 0 offen offset:0 sc1
    buffer_load_dwordx4 a[76:79], v8, s[48:51], 0 offen offset:256 sc1
    buffer_load_dwordx4 a[80:83], v8, s[48:51], 0 offen offset:512 sc1
    v_add_u32 v8, 1024, v8
    buffer_load_dwordx4 a[84:87], v8, s[48:51], 0 offen offset:0 sc1
    buffer_load_dwordx4 a[88:91], v8, s[48:51], 0 offen offset:256 sc1
    buffer_load_dwordx4 a[92:95], v8, s[48:51], 0 offen offset:512 sc1
    s_cmp_ge_u32 s7, 30
    s_cbranch_scc1 parallel_nf32
    v_lshrrev_b32 v6, 3, v2
    v_and_b32 v7, 7, v2
    v_lshrrev_b32 v13, 1, v6
    v_xor_b32 v7, v7, v13
    s_lshl_b32 s12, s4, 5
    v_add_u32 v6, s12, v6
    v_mul_u32_u24 v6, 1152, v6
    v_lshl_add_u32 v14, v7, 4, v6
    v_xor_b32 v7, 4, v7
    v_lshl_add_u32 v15, v7, 4, v6
    v_add_u32 v15, 8192, v15
    v_add_u32 v110, 16384, v14
    v_add_u32 v111, 16384, v15
    s_sub_u32 s12, s7, 24
    s_lshr_b32 s12, s12, 1
    s_mul_i32 s12, s12, 221184
    s_add_u32 s36, s20, s12
    s_addc_u32 s37, s21, 0
    s_mov_b32 s38, 0x36000
    s_mov_b32 s39, 0x20000
    s_add_u32 s52, s22, s12
    s_addc_u32 s53, s23, 0
    s_mov_b32 s54, 0x36000
    s_mov_b32 s55, 0x20000
    s_lshl_b32 s28, s4, 12
    s_add_u32 m0, s28, 0
    s_mov_b32 s30, 0
    buffer_load_dwordx4 v14, s[36:39], s30 offen offset:0 lds
    buffer_load_dwordx4 v15, s[36:39], s30 offen offset:1024 lds
    buffer_load_dwordx4 v110, s[36:39], s30 offen offset:2048 lds
    buffer_load_dwordx4 v111, s[36:39], s30 offen offset:3072 lds
    s_add_u32 m0, s28, 16384
    s_mov_b32 s30, 0
    buffer_load_dwordx4 v14, s[52:55], s30 offen offset:0 lds
    buffer_load_dwordx4 v15, s[52:55], s30 offen offset:1024 lds
    buffer_load_dwordx4 v110, s[52:55], s30 offen offset:2048 lds
    buffer_load_dwordx4 v111, s[52:55], s30 offen offset:3072 lds
    s_add_u32 m0, s28, 32768
    s_mov_b32 s30, 128
    buffer_load_dwordx4 v14, s[36:39], s30 offen offset:0 lds
    buffer_load_dwordx4 v15, s[36:39], s30 offen offset:1024 lds
    buffer_load_dwordx4 v110, s[36:39], s30 offen offset:2048 lds
    buffer_load_dwordx4 v111, s[36:39], s30 offen offset:3072 lds
    s_add_u32 m0, s28, 49152
    s_mov_b32 s30, 128
    buffer_load_dwordx4 v14, s[52:55], s30 offen offset:0 lds
    buffer_load_dwordx4 v15, s[52:55], s30 offen offset:1024 lds
    buffer_load_dwordx4 v110, s[52:55], s30 offen offset:2048 lds
    buffer_load_dwordx4 v111, s[52:55], s30 offen offset:3072 lds
    s_add_u32 m0, s28, 65536
    s_mov_b32 s30, 256
    buffer_load_dwordx4 v14, s[36:39], s30 offen offset:0 lds
    buffer_load_dwordx4 v15, s[36:39], s30 offen offset:1024 lds
    buffer_load_dwordx4 v110, s[36:39], s30 offen offset:2048 lds
    buffer_load_dwordx4 v111, s[36:39], s30 offen offset:3072 lds
    s_add_u32 m0, s28, 81920
    s_mov_b32 s30, 256
    buffer_load_dwordx4 v14, s[52:55], s30 offen offset:0 lds
    buffer_load_dwordx4 v15, s[52:55], s30 offen offset:1024 lds
    buffer_load_dwordx4 v110, s[52:55], s30 offen offset:2048 lds
    buffer_load_dwordx4 v111, s[52:55], s30 offen offset:3072 lds
    s_waitcnt vmcnt(24)
    s_branch parallel_nj33
parallel_nf32:
    s_waitcnt vmcnt(0)
parallel_nj33:
    v_mul_u32_u24 v10, 192, v3
    v_lshl_add_u32 v10, v4, 5, v10
    v_bfe_u32 v11, v0, 2, 2
    v_mul_u32_u24 v11, 192, v11
    v_lshl_add_u32 v11, v4, 3, v11
    v_and_b32 v12, 3, v0
    v_lshl_add_u32 v11, v12, 5, v11
    s_mul_i32 s13, s4, 6144
    s_add_u32 s13, s13, 98304
    v_add_u32 v10, s13, v10
    v_add_u32 v11, s13, v11
    v_lshrrev_b32 v12, 5, v2
    v_mul_u32_u24 v12, 368640, v12
    v_and_b32 v13, 31, v2
    v_lshl_add_u32 v12, v13, 4, v12
    s_mul_i32 s18, s10, 720
    s_mul_i32 s19, s8, 9
    s_add_u32 s18, s18, s19
    s_add_u32 s18, s18, 288
    s_lshl_b32 s18, s18, 10
    s_waitcnt lgkmcnt(0)
    v_accvgpr_read_b32 v92, a0
    v_accvgpr_read_b32 v94, a1
    v_accvgpr_read_b32 v96, a2
    v_accvgpr_read_b32 v98, a3
    v_accvgpr_read_b32 v100, a4
    v_accvgpr_read_b32 v102, a5
    v_accvgpr_read_b32 v104, a6
    v_accvgpr_read_b32 v106, a7
    v_accvgpr_read_b32 v108, a8
    v_accvgpr_read_b32 v25, a12
    v_accvgpr_read_b32 v33, a13
    v_accvgpr_read_b32 v41, a14
    v_accvgpr_read_b32 v49, a15
    v_accvgpr_read_b32 v57, a16
    v_accvgpr_read_b32 v65, a17
    v_accvgpr_read_b32 v73, a18
    v_accvgpr_read_b32 v81, a19
    v_accvgpr_read_b32 v89, a20
    v_fma_f32 v93, v26, v92, v25
    v_fma_f32 v95, v34, v94, v33
    v_fma_f32 v97, v42, v96, v41
    v_fma_f32 v99, v50, v98, v49
    v_fma_f32 v101, v58, v100, v57
    v_fma_f32 v103, v66, v102, v65
    v_fma_f32 v105, v74, v104, v73
    v_fma_f32 v107, v82, v106, v81
    v_fma_f32 v109, v90, v108, v89
    v_fmac_f32_dpp v93, v92, v27 row_ror:8 row_mask:0xf bank_mask:0xf
    v_fmac_f32_dpp v95, v94, v35 row_ror:8 row_mask:0xf bank_mask:0xf
    v_fmac_f32_dpp v97, v96, v43 row_ror:8 row_mask:0xf bank_mask:0xf
    v_fmac_f32_dpp v99, v98, v51 row_ror:8 row_mask:0xf bank_mask:0xf
    v_fmac_f32_dpp v101, v100, v59 row_ror:8 row_mask:0xf bank_mask:0xf
    v_fmac_f32_dpp v103, v102, v67 row_ror:8 row_mask:0xf bank_mask:0xf
    v_fmac_f32_dpp v105, v104, v75 row_ror:8 row_mask:0xf bank_mask:0xf
    v_fmac_f32_dpp v107, v106, v83 row_ror:8 row_mask:0xf bank_mask:0xf
    v_fmac_f32_dpp v109, v108, v91 row_ror:8 row_mask:0xf bank_mask:0xf
    v_accvgpr_read_b32 v25, a24
    v_accvgpr_read_b32 v33, a25
    v_accvgpr_read_b32 v41, a26
    v_accvgpr_read_b32 v49, a27
    v_accvgpr_read_b32 v57, a28
    v_accvgpr_read_b32 v65, a29
    v_accvgpr_read_b32 v73, a30
    v_accvgpr_read_b32 v81, a31
    v_accvgpr_read_b32 v89, a32
    v_fma_f32 v92, v26, v93, v25
    v_fma_f32 v94, v34, v95, v33
    v_fma_f32 v96, v42, v97, v41
    v_fma_f32 v98, v50, v99, v49
    v_fma_f32 v100, v58, v101, v57
    v_fma_f32 v102, v66, v103, v65
    v_fma_f32 v104, v74, v105, v73
    v_fma_f32 v106, v82, v107, v81
    v_fma_f32 v108, v90, v109, v89
    v_fmac_f32_dpp v92, v93, v27 row_ror:8 row_mask:0xf bank_mask:0xf
    v_fmac_f32_dpp v94, v95, v35 row_ror:8 row_mask:0xf bank_mask:0xf
    v_fmac_f32_dpp v96, v97, v43 row_ror:8 row_mask:0xf bank_mask:0xf
    v_fmac_f32_dpp v98, v99, v51 row_ror:8 row_mask:0xf bank_mask:0xf
    v_fmac_f32_dpp v100, v101, v59 row_ror:8 row_mask:0xf bank_mask:0xf
    v_fmac_f32_dpp v102, v103, v67 row_ror:8 row_mask:0xf bank_mask:0xf
    v_fmac_f32_dpp v104, v105, v75 row_ror:8 row_mask:0xf bank_mask:0xf
    v_fmac_f32_dpp v106, v107, v83 row_ror:8 row_mask:0xf bank_mask:0xf
    v_fmac_f32_dpp v108, v109, v91 row_ror:8 row_mask:0xf bank_mask:0xf
    v_accvgpr_read_b32 v25, a36
    v_accvgpr_read_b32 v33, a37
    v_accvgpr_read_b32 v41, a38
    v_accvgpr_read_b32 v49, a39
    v_accvgpr_read_b32 v57, a40
    v_accvgpr_read_b32 v65, a41
    v_accvgpr_read_b32 v73, a42
    v_accvgpr_read_b32 v81, a43
    v_accvgpr_read_b32 v89, a44
    v_fma_f32 v93, v26, v92, v25
    v_fma_f32 v95, v34, v94, v33
    v_fma_f32 v97, v42, v96, v41
    v_fma_f32 v99, v50, v98, v49
    v_fma_f32 v101, v58, v100, v57
    v_fma_f32 v103, v66, v102, v65
    v_fma_f32 v105, v74, v104, v73
    v_fma_f32 v107, v82, v106, v81
    v_fma_f32 v109, v90, v108, v89
    v_fmac_f32_dpp v93, v92, v27 row_ror:8 row_mask:0xf bank_mask:0xf
    v_fmac_f32_dpp v95, v94, v35 row_ror:8 row_mask:0xf bank_mask:0xf
    v_fmac_f32_dpp v97, v96, v43 row_ror:8 row_mask:0xf bank_mask:0xf
    v_fmac_f32_dpp v99, v98, v51 row_ror:8 row_mask:0xf bank_mask:0xf
    v_fmac_f32_dpp v101, v100, v59 row_ror:8 row_mask:0xf bank_mask:0xf
    v_fmac_f32_dpp v103, v102, v67 row_ror:8 row_mask:0xf bank_mask:0xf
    v_fmac_f32_dpp v105, v104, v75 row_ror:8 row_mask:0xf bank_mask:0xf
    v_fmac_f32_dpp v107, v106, v83 row_ror:8 row_mask:0xf bank_mask:0xf
    v_fmac_f32_dpp v109, v108, v91 row_ror:8 row_mask:0xf bank_mask:0xf
    v_accvgpr_read_b32 v25, a48
    v_accvgpr_read_b32 v33, a49
    v_accvgpr_read_b32 v41, a50
    v_accvgpr_read_b32 v49, a51
    v_accvgpr_read_b32 v57, a52
    v_accvgpr_read_b32 v65, a53
    v_accvgpr_read_b32 v73, a54
    v_accvgpr_read_b32 v81, a55
    v_accvgpr_read_b32 v89, a56
    v_fma_f32 v92, v26, v93, v25
    v_fma_f32 v94, v34, v95, v33
    v_fma_f32 v96, v42, v97, v41
    v_fma_f32 v98, v50, v99, v49
    v_fma_f32 v100, v58, v101, v57
    v_fma_f32 v102, v66, v103, v65
    v_fma_f32 v104, v74, v105, v73
    v_fma_f32 v106, v82, v107, v81
    v_fma_f32 v108, v90, v109, v89
    v_fmac_f32_dpp v92, v93, v27 row_ror:8 row_mask:0xf bank_mask:0xf
    v_fmac_f32_dpp v94, v95, v35 row_ror:8 row_mask:0xf bank_mask:0xf
    v_fmac_f32_dpp v96, v97, v43 row_ror:8 row_mask:0xf bank_mask:0xf
    v_fmac_f32_dpp v98, v99, v51 row_ror:8 row_mask:0xf bank_mask:0xf
    v_fmac_f32_dpp v100, v101, v59 row_ror:8 row_mask:0xf bank_mask:0xf
    v_fmac_f32_dpp v102, v103, v67 row_ror:8 row_mask:0xf bank_mask:0xf
    v_fmac_f32_dpp v104, v105, v75 row_ror:8 row_mask:0xf bank_mask:0xf
    v_fmac_f32_dpp v106, v107, v83 row_ror:8 row_mask:0xf bank_mask:0xf
    v_fmac_f32_dpp v108, v109, v91 row_ror:8 row_mask:0xf bank_mask:0xf
    v_accvgpr_read_b32 v25, a60
    v_accvgpr_read_b32 v33, a61
    v_accvgpr_read_b32 v41, a62
    v_accvgpr_read_b32 v49, a63
    v_accvgpr_read_b32 v57, a64
    v_accvgpr_read_b32 v65, a65
    v_accvgpr_read_b32 v73, a66
    v_accvgpr_read_b32 v81, a67
    v_accvgpr_read_b32 v89, a68
    v_fma_f32 v93, v26, v92, v25
    v_fma_f32 v95, v34, v94, v33
    v_fma_f32 v97, v42, v96, v41
    v_fma_f32 v99, v50, v98, v49
    v_fma_f32 v101, v58, v100, v57
    v_fma_f32 v103, v66, v102, v65
    v_fma_f32 v105, v74, v104, v73
    v_fma_f32 v107, v82, v106, v81
    v_fma_f32 v109, v90, v108, v89
    v_fmac_f32_dpp v93, v92, v27 row_ror:8 row_mask:0xf bank_mask:0xf
    v_fmac_f32_dpp v95, v94, v35 row_ror:8 row_mask:0xf bank_mask:0xf
    v_fmac_f32_dpp v97, v96, v43 row_ror:8 row_mask:0xf bank_mask:0xf
    v_fmac_f32_dpp v99, v98, v51 row_ror:8 row_mask:0xf bank_mask:0xf
    v_fmac_f32_dpp v101, v100, v59 row_ror:8 row_mask:0xf bank_mask:0xf
    v_fmac_f32_dpp v103, v102, v67 row_ror:8 row_mask:0xf bank_mask:0xf
    v_fmac_f32_dpp v105, v104, v75 row_ror:8 row_mask:0xf bank_mask:0xf
    v_fmac_f32_dpp v107, v106, v83 row_ror:8 row_mask:0xf bank_mask:0xf
    v_fmac_f32_dpp v109, v108, v91 row_ror:8 row_mask:0xf bank_mask:0xf
    v_accvgpr_read_b32 v25, a72
    v_accvgpr_read_b32 v33, a73
    v_accvgpr_read_b32 v41, a74
    v_accvgpr_read_b32 v49, a75
    v_accvgpr_read_b32 v57, a76
    v_accvgpr_read_b32 v65, a77
    v_accvgpr_read_b32 v73, a78
    v_accvgpr_read_b32 v81, a79
    v_accvgpr_read_b32 v89, a80
    v_fma_f32 v92, v26, v93, v25
    v_fma_f32 v94, v34, v95, v33
    v_fma_f32 v96, v42, v97, v41
    v_fma_f32 v98, v50, v99, v49
    v_fma_f32 v100, v58, v101, v57
    v_fma_f32 v102, v66, v103, v65
    v_fma_f32 v104, v74, v105, v73
    v_fma_f32 v106, v82, v107, v81
    v_fma_f32 v108, v90, v109, v89
    v_fmac_f32_dpp v92, v93, v27 row_ror:8 row_mask:0xf bank_mask:0xf
    v_fmac_f32_dpp v94, v95, v35 row_ror:8 row_mask:0xf bank_mask:0xf
    v_fmac_f32_dpp v96, v97, v43 row_ror:8 row_mask:0xf bank_mask:0xf
    v_fmac_f32_dpp v98, v99, v51 row_ror:8 row_mask:0xf bank_mask:0xf
    v_fmac_f32_dpp v100, v101, v59 row_ror:8 row_mask:0xf bank_mask:0xf
    v_fmac_f32_dpp v102, v103, v67 row_ror:8 row_mask:0xf bank_mask:0xf
    v_fmac_f32_dpp v104, v105, v75 row_ror:8 row_mask:0xf bank_mask:0xf
    v_fmac_f32_dpp v106, v107, v83 row_ror:8 row_mask:0xf bank_mask:0xf
    v_fmac_f32_dpp v108, v109, v91 row_ror:8 row_mask:0xf bank_mask:0xf
    v_accvgpr_read_b32 v25, a84
    v_accvgpr_read_b32 v33, a85
    v_accvgpr_read_b32 v41, a86
    v_accvgpr_read_b32 v49, a87
    v_accvgpr_read_b32 v57, a88
    v_accvgpr_read_b32 v65, a89
    v_accvgpr_read_b32 v73, a90
    v_accvgpr_read_b32 v81, a91
    v_accvgpr_read_b32 v89, a92
    v_fma_f32 v93, v26, v92, v25
    v_fma_f32 v95, v34, v94, v33
    v_fma_f32 v97, v42, v96, v41
    v_fma_f32 v99, v50, v98, v49
    v_fma_f32 v101, v58, v100, v57
    v_fma_f32 v103, v66, v102, v65
    v_fma_f32 v105, v74, v104, v73
    v_fma_f32 v107, v82, v106, v81
    v_fma_f32 v109, v90, v108, v89
    v_fmac_f32_dpp v93, v92, v27 row_ror:8 row_mask:0xf bank_mask:0xf
    v_fmac_f32_dpp v95, v94, v35 row_ror:8 row_mask:0xf bank_mask:0xf
    v_fmac_f32_dpp v97, v96, v43 row_ror:8 row_mask:0xf bank_mask:0xf
    v_fmac_f32_dpp v99, v98, v51 row_ror:8 row_mask:0xf bank_mask:0xf
    v_fmac_f32_dpp v101, v100, v59 row_ror:8 row_mask:0xf bank_mask:0xf
    v_fmac_f32_dpp v103, v102, v67 row_ror:8 row_mask:0xf bank_mask:0xf
    v_fmac_f32_dpp v105, v104, v75 row_ror:8 row_mask:0xf bank_mask:0xf
    v_fmac_f32_dpp v107, v106, v83 row_ror:8 row_mask:0xf bank_mask:0xf
    v_fmac_f32_dpp v109, v108, v91 row_ror:8 row_mask:0xf bank_mask:0xf
    ds_read_b64 v[26:27], v19 offset:8
    ds_read_b64 v[34:35], v19 offset:1032
    ds_read_b64 v[42:43], v19 offset:2056
    ds_read_b64 v[50:51], v19 offset:3080
    ds_read_b64 v[58:59], v19 offset:4104
    ds_read_b64 v[66:67], v19 offset:5128
    ds_read_b64 v[74:75], v19 offset:6152
    ds_read_b64 v[82:83], v19 offset:7176
    ds_read_b64 v[90:91], v19 offset:8200
    s_waitcnt lgkmcnt(0)
    v_mul_f32 v92, v26, v93
    v_mul_f32 v94, v34, v95
    v_mul_f32 v96, v42, v97
    v_mul_f32 v98, v50, v99
    v_mul_f32 v100, v58, v101
    v_mul_f32 v102, v66, v103
    v_mul_f32 v104, v74, v105
    v_mul_f32 v106, v82, v107
    v_mul_f32 v108, v90, v109
    v_fmac_f32_dpp v92, v93, v27 row_ror:8 row_mask:0xf bank_mask:0xf
    v_fmac_f32_dpp v94, v95, v35 row_ror:8 row_mask:0xf bank_mask:0xf
    v_fmac_f32_dpp v96, v97, v43 row_ror:8 row_mask:0xf bank_mask:0xf
    v_fmac_f32_dpp v98, v99, v51 row_ror:8 row_mask:0xf bank_mask:0xf
    v_fmac_f32_dpp v100, v101, v59 row_ror:8 row_mask:0xf bank_mask:0xf
    v_fmac_f32_dpp v102, v103, v67 row_ror:8 row_mask:0xf bank_mask:0xf
    v_fmac_f32_dpp v104, v105, v75 row_ror:8 row_mask:0xf bank_mask:0xf
    v_fmac_f32_dpp v106, v107, v83 row_ror:8 row_mask:0xf bank_mask:0xf
    v_fmac_f32_dpp v108, v109, v91 row_ror:8 row_mask:0xf bank_mask:0xf
    ds_read_b64 v[26:27], v19 offset:0
    ds_read_b64 v[34:35], v19 offset:1024
    ds_read_b64 v[42:43], v19 offset:2048
    ds_read_b64 v[50:51], v19 offset:3072
    ds_read_b64 v[58:59], v19 offset:4096
    ds_read_b64 v[66:67], v19 offset:5120
    ds_read_b64 v[74:75], v19 offset:6144
    ds_read_b64 v[82:83], v19 offset:7168
    ds_read_b64 v[90:91], v19 offset:8192
    v_mov_b32 v93, v92
    v_mov_b32 v95, v94
    v_mov_b32 v97, v96
    v_mov_b32 v99, v98
    v_mov_b32 v101, v100
    v_mov_b32 v103, v102
    v_mov_b32 v105, v104
    v_mov_b32 v107, v106
    v_mov_b32 v109, v108
    v_permlane16_swap_b32 v92, v93
    v_permlane16_swap_b32 v94, v95
    v_permlane16_swap_b32 v96, v97
    v_permlane16_swap_b32 v98, v99
    v_permlane16_swap_b32 v100, v101
    v_permlane16_swap_b32 v102, v103
    v_permlane16_swap_b32 v104, v105
    v_permlane16_swap_b32 v106, v107
    v_permlane16_swap_b32 v108, v109
    v_add_f32 v92, v92, v93
    v_add_f32 v94, v94, v95
    v_add_f32 v96, v96, v97
    v_add_f32 v98, v98, v99
    v_add_f32 v100, v100, v101
    v_add_f32 v102, v102, v103
    v_add_f32 v104, v104, v105
    v_add_f32 v106, v106, v107
    v_add_f32 v108, v108, v109
    v_mov_b32 v93, v92
    v_mov_b32 v95, v94
    v_mov_b32 v97, v96
    v_mov_b32 v99, v98
    v_mov_b32 v101, v100
    v_mov_b32 v103, v102
    v_mov_b32 v105, v104
    v_mov_b32 v107, v106
    v_mov_b32 v109, v108
    v_permlane32_swap_b32 v92, v93
    v_permlane32_swap_b32 v94, v95
    v_permlane32_swap_b32 v96, v97
    v_permlane32_swap_b32 v98, v99
    v_permlane32_swap_b32 v100, v101
    v_permlane32_swap_b32 v102, v103
    v_permlane32_swap_b32 v104, v105
    v_permlane32_swap_b32 v106, v107
    v_permlane32_swap_b32 v108, v109
    v_add_f32 v92, v92, v93
    v_add_f32 v94, v94, v95
    v_add_f32 v96, v96, v97
    v_add_f32 v98, v98, v99
    v_add_f32 v100, v100, v101
    v_add_f32 v102, v102, v103
    v_add_f32 v104, v104, v105
    v_add_f32 v106, v106, v107
    v_add_f32 v108, v108, v109
    s_waitcnt lgkmcnt(0)
    v_fmac_f32 v24, v26, v92
    v_fmac_f32 v32, v34, v94
    v_fmac_f32 v40, v42, v96
    v_fmac_f32 v48, v50, v98
    v_fmac_f32 v56, v58, v100
    v_fmac_f32 v64, v66, v102
    v_fmac_f32 v72, v74, v104
    v_fmac_f32 v80, v82, v106
    v_fmac_f32 v88, v90, v108
    v_fmac_f32_dpp v24, v92, v27 row_ror:8 row_mask:0xf bank_mask:0xf
    v_fmac_f32_dpp v32, v94, v35 row_ror:8 row_mask:0xf bank_mask:0xf
    v_fmac_f32_dpp v40, v96, v43 row_ror:8 row_mask:0xf bank_mask:0xf
    v_fmac_f32_dpp v48, v98, v51 row_ror:8 row_mask:0xf bank_mask:0xf
    v_fmac_f32_dpp v56, v100, v59 row_ror:8 row_mask:0xf bank_mask:0xf
    v_fmac_f32_dpp v64, v102, v67 row_ror:8 row_mask:0xf bank_mask:0xf
    v_fmac_f32_dpp v72, v104, v75 row_ror:8 row_mask:0xf bank_mask:0xf
    v_fmac_f32_dpp v80, v106, v83 row_ror:8 row_mask:0xf bank_mask:0xf
    v_fmac_f32_dpp v88, v108, v91 row_ror:8 row_mask:0xf bank_mask:0xf
    v_mul_f32 v25, v22, v24
    v_mul_f32 v33, v30, v32
    v_mul_f32 v41, v38, v40
    v_mul_f32 v49, v46, v48
    v_mul_f32 v57, v54, v56
    v_mul_f32 v65, v62, v64
    v_mul_f32 v73, v70, v72
    v_mul_f32 v81, v78, v80
    v_mul_f32 v89, v86, v88
    v_fmac_f32_dpp v25, v24, v23 row_ror:8 row_mask:0xf bank_mask:0xf
    v_fmac_f32_dpp v33, v32, v31 row_ror:8 row_mask:0xf bank_mask:0xf
    v_fmac_f32_dpp v41, v40, v39 row_ror:8 row_mask:0xf bank_mask:0xf
    v_fmac_f32_dpp v49, v48, v47 row_ror:8 row_mask:0xf bank_mask:0xf
    v_fmac_f32_dpp v57, v56, v55 row_ror:8 row_mask:0xf bank_mask:0xf
    v_fmac_f32_dpp v65, v64, v63 row_ror:8 row_mask:0xf bank_mask:0xf
    v_fmac_f32_dpp v73, v72, v71 row_ror:8 row_mask:0xf bank_mask:0xf
    v_fmac_f32_dpp v81, v80, v79 row_ror:8 row_mask:0xf bank_mask:0xf
    v_fmac_f32_dpp v89, v88, v87 row_ror:8 row_mask:0xf bank_mask:0xf
    v_fmac_f32 v112, v20, v25
    v_fmac_f32 v128, v28, v33
    v_fmac_f32 v144, v36, v41
    v_fmac_f32_dpp v112, v25, v21 row_ror:8 row_mask:0xf bank_mask:0xf
    v_fmac_f32_dpp v128, v33, v29 row_ror:8 row_mask:0xf bank_mask:0xf
    v_fmac_f32_dpp v144, v41, v37 row_ror:8 row_mask:0xf bank_mask:0xf
    v_fmac_f32 v113, v20, v112
    v_fmac_f32 v129, v28, v128
    v_fmac_f32 v145, v36, v144
    v_fmac_f32_dpp v113, v112, v21 row_ror:8 row_mask:0xf bank_mask:0xf
    v_fmac_f32_dpp v129, v128, v29 row_ror:8 row_mask:0xf bank_mask:0xf
    v_fmac_f32_dpp v145, v144, v37 row_ror:8 row_mask:0xf bank_mask:0xf
    v_fmac_f32 v114, v20, v113
    v_fmac_f32 v130, v28, v129
    v_fmac_f32 v146, v36, v145
    v_fmac_f32_dpp v114, v113, v21 row_ror:8 row_mask:0xf bank_mask:0xf
    v_fmac_f32_dpp v130, v129, v29 row_ror:8 row_mask:0xf bank_mask:0xf
    v_fmac_f32_dpp v146, v145, v37 row_ror:8 row_mask:0xf bank_mask:0xf
    v_fmac_f32 v115, v20, v114
    v_fmac_f32 v131, v28, v130
    v_fmac_f32 v147, v36, v146
    v_fmac_f32_dpp v115, v114, v21 row_ror:8 row_mask:0xf bank_mask:0xf
    v_fmac_f32_dpp v131, v130, v29 row_ror:8 row_mask:0xf bank_mask:0xf
    v_fmac_f32_dpp v147, v146, v37 row_ror:8 row_mask:0xf bank_mask:0xf
    v_fmac_f32 v116, v20, v115
    v_fmac_f32 v132, v28, v131
    v_fmac_f32 v148, v36, v147
    v_fmac_f32_dpp v116, v115, v21 row_ror:8 row_mask:0xf bank_mask:0xf
    v_fmac_f32_dpp v132, v131, v29 row_ror:8 row_mask:0xf bank_mask:0xf
    v_fmac_f32_dpp v148, v147, v37 row_ror:8 row_mask:0xf bank_mask:0xf
    v_fmac_f32 v117, v20, v116
    v_fmac_f32 v133, v28, v132
    v_fmac_f32 v149, v36, v148
    v_fmac_f32_dpp v117, v116, v21 row_ror:8 row_mask:0xf bank_mask:0xf
    v_fmac_f32_dpp v133, v132, v29 row_ror:8 row_mask:0xf bank_mask:0xf
    v_fmac_f32_dpp v149, v148, v37 row_ror:8 row_mask:0xf bank_mask:0xf
    v_fmac_f32 v118, v20, v117
    v_fmac_f32 v134, v28, v133
    v_fmac_f32 v150, v36, v149
    v_fmac_f32_dpp v118, v117, v21 row_ror:8 row_mask:0xf bank_mask:0xf
    v_fmac_f32_dpp v134, v133, v29 row_ror:8 row_mask:0xf bank_mask:0xf
    v_fmac_f32_dpp v150, v149, v37 row_ror:8 row_mask:0xf bank_mask:0xf
    v_fmac_f32 v119, v20, v118
    v_fmac_f32 v135, v28, v134
    v_fmac_f32 v151, v36, v150
    v_fmac_f32_dpp v119, v118, v21 row_ror:8 row_mask:0xf bank_mask:0xf
    v_fmac_f32_dpp v135, v134, v29 row_ror:8 row_mask:0xf bank_mask:0xf
    v_fmac_f32_dpp v151, v150, v37 row_ror:8 row_mask:0xf bank_mask:0xf
    v_fmac_f32 v120, v20, v119
    v_fmac_f32 v136, v28, v135
    v_fmac_f32 v152, v36, v151
    v_fmac_f32_dpp v120, v119, v21 row_ror:8 row_mask:0xf bank_mask:0xf
    v_fmac_f32_dpp v136, v135, v29 row_ror:8 row_mask:0xf bank_mask:0xf
    v_fmac_f32_dpp v152, v151, v37 row_ror:8 row_mask:0xf bank_mask:0xf
    v_fmac_f32 v121, v20, v120
    v_fmac_f32 v137, v28, v136
    v_fmac_f32 v153, v36, v152
    v_fmac_f32_dpp v121, v120, v21 row_ror:8 row_mask:0xf bank_mask:0xf
    v_fmac_f32_dpp v137, v136, v29 row_ror:8 row_mask:0xf bank_mask:0xf
    v_fmac_f32_dpp v153, v152, v37 row_ror:8 row_mask:0xf bank_mask:0xf
    v_fmac_f32 v122, v20, v121
    v_fmac_f32 v138, v28, v137
    v_fmac_f32 v154, v36, v153
    v_fmac_f32_dpp v122, v121, v21 row_ror:8 row_mask:0xf bank_mask:0xf
    v_fmac_f32_dpp v138, v137, v29 row_ror:8 row_mask:0xf bank_mask:0xf
    v_fmac_f32_dpp v154, v153, v37 row_ror:8 row_mask:0xf bank_mask:0xf
    v_fmac_f32 v123, v20, v122
    v_fmac_f32 v139, v28, v138
    v_fmac_f32 v155, v36, v154
    v_fmac_f32_dpp v123, v122, v21 row_ror:8 row_mask:0xf bank_mask:0xf
    v_fmac_f32_dpp v139, v138, v29 row_ror:8 row_mask:0xf bank_mask:0xf
    v_fmac_f32_dpp v155, v154, v37 row_ror:8 row_mask:0xf bank_mask:0xf
    v_fmac_f32 v124, v20, v123
    v_fmac_f32 v140, v28, v139
    v_fmac_f32 v156, v36, v155
    v_fmac_f32_dpp v124, v123, v21 row_ror:8 row_mask:0xf bank_mask:0xf
    v_fmac_f32_dpp v140, v139, v29 row_ror:8 row_mask:0xf bank_mask:0xf
    v_fmac_f32_dpp v156, v155, v37 row_ror:8 row_mask:0xf bank_mask:0xf
    v_fmac_f32 v125, v20, v124
    v_fmac_f32 v141, v28, v140
    v_fmac_f32 v157, v36, v156
    v_fmac_f32_dpp v125, v124, v21 row_ror:8 row_mask:0xf bank_mask:0xf
    v_fmac_f32_dpp v141, v140, v29 row_ror:8 row_mask:0xf bank_mask:0xf
    v_fmac_f32_dpp v157, v156, v37 row_ror:8 row_mask:0xf bank_mask:0xf
    v_fmac_f32 v126, v20, v125
    v_fmac_f32 v142, v28, v141
    v_fmac_f32 v158, v36, v157
    v_fmac_f32_dpp v126, v125, v21 row_ror:8 row_mask:0xf bank_mask:0xf
    v_fmac_f32_dpp v142, v141, v29 row_ror:8 row_mask:0xf bank_mask:0xf
    v_fmac_f32_dpp v158, v157, v37 row_ror:8 row_mask:0xf bank_mask:0xf
    v_fmac_f32 v127, v20, v126
    v_fmac_f32 v143, v28, v142
    v_fmac_f32 v159, v36, v158
    v_fmac_f32_dpp v127, v126, v21 row_ror:8 row_mask:0xf bank_mask:0xf
    v_fmac_f32_dpp v143, v142, v29 row_ror:8 row_mask:0xf bank_mask:0xf
    v_fmac_f32_dpp v159, v158, v37 row_ror:8 row_mask:0xf bank_mask:0xf
    v_cvt_pk_bf16_f32 v20, v112, v113
    v_cvt_pk_bf16_f32 v21, v114, v115
    v_cvt_pk_bf16_f32 v22, v116, v117
    v_cvt_pk_bf16_f32 v23, v118, v119
    v_cvt_pk_bf16_f32 v24, v120, v121
    v_cvt_pk_bf16_f32 v25, v122, v123
    v_cvt_pk_bf16_f32 v26, v124, v125
    v_cvt_pk_bf16_f32 v27, v126, v127
    ds_write_b128 v10, v[20:23] offset:0
    ds_write_b128 v10, v[24:27] offset:16
    ds_read_b64_tr_b16 v[112:113], v11 offset:0
    ds_read_b64_tr_b16 v[114:115], v11 offset:768
    ds_read_b64_tr_b16 v[116:117], v11 offset:1536
    ds_read_b64_tr_b16 v[118:119], v11 offset:2304
    v_cvt_pk_bf16_f32 v28, v128, v129
    v_cvt_pk_bf16_f32 v29, v130, v131
    v_cvt_pk_bf16_f32 v30, v132, v133
    v_cvt_pk_bf16_f32 v31, v134, v135
    v_cvt_pk_bf16_f32 v32, v136, v137
    v_cvt_pk_bf16_f32 v33, v138, v139
    v_cvt_pk_bf16_f32 v34, v140, v141
    v_cvt_pk_bf16_f32 v35, v142, v143
    ds_write_b128 v10, v[28:31] offset:3072
    ds_write_b128 v10, v[32:35] offset:3088
    ds_read_b64_tr_b16 v[128:129], v11 offset:3072
    ds_read_b64_tr_b16 v[130:131], v11 offset:3840
    ds_read_b64_tr_b16 v[132:133], v11 offset:4608
    ds_read_b64_tr_b16 v[134:135], v11 offset:5376
    v_cvt_pk_bf16_f32 v36, v144, v145
    v_cvt_pk_bf16_f32 v37, v146, v147
    v_cvt_pk_bf16_f32 v38, v148, v149
    v_cvt_pk_bf16_f32 v39, v150, v151
    v_cvt_pk_bf16_f32 v40, v152, v153
    v_cvt_pk_bf16_f32 v41, v154, v155
    v_cvt_pk_bf16_f32 v42, v156, v157
    v_cvt_pk_bf16_f32 v43, v158, v159
    ds_write_b128 v10, v[36:39] offset:0
    ds_write_b128 v10, v[40:43] offset:16
    ds_read_b64_tr_b16 v[144:145], v11 offset:0
    ds_read_b64_tr_b16 v[146:147], v11 offset:768
    ds_read_b64_tr_b16 v[148:149], v11 offset:1536
    ds_read_b64_tr_b16 v[150:151], v11 offset:2304
    v_fmac_f32 v160, v44, v49
    v_fmac_f32 v176, v52, v57
    v_fmac_f32 v192, v60, v65
    v_fmac_f32_dpp v160, v49, v45 row_ror:8 row_mask:0xf bank_mask:0xf
    v_fmac_f32_dpp v176, v57, v53 row_ror:8 row_mask:0xf bank_mask:0xf
    v_fmac_f32_dpp v192, v65, v61 row_ror:8 row_mask:0xf bank_mask:0xf
    v_fmac_f32 v161, v44, v160
    v_fmac_f32 v177, v52, v176
    v_fmac_f32 v193, v60, v192
    v_fmac_f32_dpp v161, v160, v45 row_ror:8 row_mask:0xf bank_mask:0xf
    v_fmac_f32_dpp v177, v176, v53 row_ror:8 row_mask:0xf bank_mask:0xf
    v_fmac_f32_dpp v193, v192, v61 row_ror:8 row_mask:0xf bank_mask:0xf
    v_fmac_f32 v162, v44, v161
    v_fmac_f32 v178, v52, v177
    v_fmac_f32 v194, v60, v193
    v_fmac_f32_dpp v162, v161, v45 row_ror:8 row_mask:0xf bank_mask:0xf
    v_fmac_f32_dpp v178, v177, v53 row_ror:8 row_mask:0xf bank_mask:0xf
    v_fmac_f32_dpp v194, v193, v61 row_ror:8 row_mask:0xf bank_mask:0xf
    v_fmac_f32 v163, v44, v162
    v_fmac_f32 v179, v52, v178
    v_fmac_f32 v195, v60, v194
    v_fmac_f32_dpp v163, v162, v45 row_ror:8 row_mask:0xf bank_mask:0xf
    v_fmac_f32_dpp v179, v178, v53 row_ror:8 row_mask:0xf bank_mask:0xf
    v_fmac_f32_dpp v195, v194, v61 row_ror:8 row_mask:0xf bank_mask:0xf
    s_waitcnt lgkmcnt(0)
    s_add_u32 s19, s18, 0
    buffer_store_dwordx4 v[112:115], v12, s[44:47], s19 offen offset:0 sc1
    buffer_store_dwordx4 v[116:119], v12, s[44:47], s19 offen offset:512 sc1
    v_fmac_f32 v164, v44, v163
    v_fmac_f32 v180, v52, v179
    v_fmac_f32 v196, v60, v195
    v_fmac_f32_dpp v164, v163, v45 row_ror:8 row_mask:0xf bank_mask:0xf
    v_fmac_f32_dpp v180, v179, v53 row_ror:8 row_mask:0xf bank_mask:0xf
    v_fmac_f32_dpp v196, v195, v61 row_ror:8 row_mask:0xf bank_mask:0xf
    v_fmac_f32 v165, v44, v164
    v_fmac_f32 v181, v52, v180
    v_fmac_f32 v197, v60, v196
    v_fmac_f32_dpp v165, v164, v45 row_ror:8 row_mask:0xf bank_mask:0xf
    v_fmac_f32_dpp v181, v180, v53 row_ror:8 row_mask:0xf bank_mask:0xf
    v_fmac_f32_dpp v197, v196, v61 row_ror:8 row_mask:0xf bank_mask:0xf
    v_fmac_f32 v166, v44, v165
    v_fmac_f32 v182, v52, v181
    v_fmac_f32 v198, v60, v197
    v_fmac_f32_dpp v166, v165, v45 row_ror:8 row_mask:0xf bank_mask:0xf
    v_fmac_f32_dpp v182, v181, v53 row_ror:8 row_mask:0xf bank_mask:0xf
    v_fmac_f32_dpp v198, v197, v61 row_ror:8 row_mask:0xf bank_mask:0xf
    s_add_u32 s19, s18, 1024
    buffer_store_dwordx4 v[128:131], v12, s[44:47], s19 offen offset:0 sc1
    buffer_store_dwordx4 v[132:135], v12, s[44:47], s19 offen offset:512 sc1
    v_fmac_f32 v167, v44, v166
    v_fmac_f32 v183, v52, v182
    v_fmac_f32 v199, v60, v198
    v_fmac_f32_dpp v167, v166, v45 row_ror:8 row_mask:0xf bank_mask:0xf
    v_fmac_f32_dpp v183, v182, v53 row_ror:8 row_mask:0xf bank_mask:0xf
    v_fmac_f32_dpp v199, v198, v61 row_ror:8 row_mask:0xf bank_mask:0xf
    v_fmac_f32 v168, v44, v167
    v_fmac_f32 v184, v52, v183
    v_fmac_f32 v200, v60, v199
    v_fmac_f32_dpp v168, v167, v45 row_ror:8 row_mask:0xf bank_mask:0xf
    v_fmac_f32_dpp v184, v183, v53 row_ror:8 row_mask:0xf bank_mask:0xf
    v_fmac_f32_dpp v200, v199, v61 row_ror:8 row_mask:0xf bank_mask:0xf
    v_fmac_f32 v169, v44, v168
    v_fmac_f32 v185, v52, v184
    v_fmac_f32 v201, v60, v200
    v_fmac_f32_dpp v169, v168, v45 row_ror:8 row_mask:0xf bank_mask:0xf
    v_fmac_f32_dpp v185, v184, v53 row_ror:8 row_mask:0xf bank_mask:0xf
    v_fmac_f32_dpp v201, v200, v61 row_ror:8 row_mask:0xf bank_mask:0xf
    s_add_u32 s19, s18, 2048
    buffer_store_dwordx4 v[144:147], v12, s[44:47], s19 offen offset:0 sc1
    buffer_store_dwordx4 v[148:151], v12, s[44:47], s19 offen offset:512 sc1
    v_fmac_f32 v170, v44, v169
    v_fmac_f32 v186, v52, v185
    v_fmac_f32 v202, v60, v201
    v_fmac_f32_dpp v170, v169, v45 row_ror:8 row_mask:0xf bank_mask:0xf
    v_fmac_f32_dpp v186, v185, v53 row_ror:8 row_mask:0xf bank_mask:0xf
    v_fmac_f32_dpp v202, v201, v61 row_ror:8 row_mask:0xf bank_mask:0xf
    v_fmac_f32 v171, v44, v170
    v_fmac_f32 v187, v52, v186
    v_fmac_f32 v203, v60, v202
    v_fmac_f32_dpp v171, v170, v45 row_ror:8 row_mask:0xf bank_mask:0xf
    v_fmac_f32_dpp v187, v186, v53 row_ror:8 row_mask:0xf bank_mask:0xf
    v_fmac_f32_dpp v203, v202, v61 row_ror:8 row_mask:0xf bank_mask:0xf
    v_fmac_f32 v172, v44, v171
    v_fmac_f32 v188, v52, v187
    v_fmac_f32 v204, v60, v203
    v_fmac_f32_dpp v172, v171, v45 row_ror:8 row_mask:0xf bank_mask:0xf
    v_fmac_f32_dpp v188, v187, v53 row_ror:8 row_mask:0xf bank_mask:0xf
    v_fmac_f32_dpp v204, v203, v61 row_ror:8 row_mask:0xf bank_mask:0xf
    v_fmac_f32 v173, v44, v172
    v_fmac_f32 v189, v52, v188
    v_fmac_f32 v205, v60, v204
    v_fmac_f32_dpp v173, v172, v45 row_ror:8 row_mask:0xf bank_mask:0xf
    v_fmac_f32_dpp v189, v188, v53 row_ror:8 row_mask:0xf bank_mask:0xf
    v_fmac_f32_dpp v205, v204, v61 row_ror:8 row_mask:0xf bank_mask:0xf
    v_fmac_f32 v174, v44, v173
    v_fmac_f32 v190, v52, v189
    v_fmac_f32 v206, v60, v205
    v_fmac_f32_dpp v174, v173, v45 row_ror:8 row_mask:0xf bank_mask:0xf
    v_fmac_f32_dpp v190, v189, v53 row_ror:8 row_mask:0xf bank_mask:0xf
    v_fmac_f32_dpp v206, v205, v61 row_ror:8 row_mask:0xf bank_mask:0xf
    v_fmac_f32 v175, v44, v174
    v_fmac_f32 v191, v52, v190
    v_fmac_f32 v207, v60, v206
    v_fmac_f32_dpp v175, v174, v45 row_ror:8 row_mask:0xf bank_mask:0xf
    v_fmac_f32_dpp v191, v190, v53 row_ror:8 row_mask:0xf bank_mask:0xf
    v_fmac_f32_dpp v207, v206, v61 row_ror:8 row_mask:0xf bank_mask:0xf
    v_cvt_pk_bf16_f32 v44, v160, v161
    v_cvt_pk_bf16_f32 v45, v162, v163
    v_cvt_pk_bf16_f32 v46, v164, v165
    v_cvt_pk_bf16_f32 v47, v166, v167
    v_cvt_pk_bf16_f32 v48, v168, v169
    v_cvt_pk_bf16_f32 v49, v170, v171
    v_cvt_pk_bf16_f32 v50, v172, v173
    v_cvt_pk_bf16_f32 v51, v174, v175
    ds_write_b128 v10, v[44:47] offset:3072
    ds_write_b128 v10, v[48:51] offset:3088
    ds_read_b64_tr_b16 v[160:161], v11 offset:3072
    ds_read_b64_tr_b16 v[162:163], v11 offset:3840
    ds_read_b64_tr_b16 v[164:165], v11 offset:4608
    ds_read_b64_tr_b16 v[166:167], v11 offset:5376
    v_cvt_pk_bf16_f32 v52, v176, v177
    v_cvt_pk_bf16_f32 v53, v178, v179
    v_cvt_pk_bf16_f32 v54, v180, v181
    v_cvt_pk_bf16_f32 v55, v182, v183
    v_cvt_pk_bf16_f32 v56, v184, v185
    v_cvt_pk_bf16_f32 v57, v186, v187
    v_cvt_pk_bf16_f32 v58, v188, v189
    v_cvt_pk_bf16_f32 v59, v190, v191
    ds_write_b128 v10, v[52:55] offset:0
    ds_write_b128 v10, v[56:59] offset:16
    ds_read_b64_tr_b16 v[176:177], v11 offset:0
    ds_read_b64_tr_b16 v[178:179], v11 offset:768
    ds_read_b64_tr_b16 v[180:181], v11 offset:1536
    ds_read_b64_tr_b16 v[182:183], v11 offset:2304
    v_cvt_pk_bf16_f32 v60, v192, v193
    v_cvt_pk_bf16_f32 v61, v194, v195
    v_cvt_pk_bf16_f32 v62, v196, v197
    v_cvt_pk_bf16_f32 v63, v198, v199
    v_cvt_pk_bf16_f32 v64, v200, v201
    v_cvt_pk_bf16_f32 v65, v202, v203
    v_cvt_pk_bf16_f32 v66, v204, v205
    v_cvt_pk_bf16_f32 v67, v206, v207
    ds_write_b128 v10, v[60:63] offset:3072
    ds_write_b128 v10, v[64:67] offset:3088
    ds_read_b64_tr_b16 v[192:193], v11 offset:3072
    ds_read_b64_tr_b16 v[194:195], v11 offset:3840
    ds_read_b64_tr_b16 v[196:197], v11 offset:4608
    ds_read_b64_tr_b16 v[198:199], v11 offset:5376
    v_fmac_f32 v208, v68, v73
    v_fmac_f32 v224, v76, v81
    v_fmac_f32 v240, v84, v89
    v_fmac_f32_dpp v208, v73, v69 row_ror:8 row_mask:0xf bank_mask:0xf
    v_fmac_f32_dpp v224, v81, v77 row_ror:8 row_mask:0xf bank_mask:0xf
    v_fmac_f32_dpp v240, v89, v85 row_ror:8 row_mask:0xf bank_mask:0xf
    v_fmac_f32 v209, v68, v208
    v_fmac_f32 v225, v76, v224
    v_fmac_f32 v241, v84, v240
    v_fmac_f32_dpp v209, v208, v69 row_ror:8 row_mask:0xf bank_mask:0xf
    v_fmac_f32_dpp v225, v224, v77 row_ror:8 row_mask:0xf bank_mask:0xf
    v_fmac_f32_dpp v241, v240, v85 row_ror:8 row_mask:0xf bank_mask:0xf
    v_fmac_f32 v210, v68, v209
    v_fmac_f32 v226, v76, v225
    v_fmac_f32 v242, v84, v241
    v_fmac_f32_dpp v210, v209, v69 row_ror:8 row_mask:0xf bank_mask:0xf
    v_fmac_f32_dpp v226, v225, v77 row_ror:8 row_mask:0xf bank_mask:0xf
    v_fmac_f32_dpp v242, v241, v85 row_ror:8 row_mask:0xf bank_mask:0xf
    v_fmac_f32 v211, v68, v210
    v_fmac_f32 v227, v76, v226
    v_fmac_f32 v243, v84, v242
    v_fmac_f32_dpp v211, v210, v69 row_ror:8 row_mask:0xf bank_mask:0xf
    v_fmac_f32_dpp v227, v226, v77 row_ror:8 row_mask:0xf bank_mask:0xf
    v_fmac_f32_dpp v243, v242, v85 row_ror:8 row_mask:0xf bank_mask:0xf
    s_waitcnt lgkmcnt(0)
    s_add_u32 s19, s18, 3072
    buffer_store_dwordx4 v[160:163], v12, s[44:47], s19 offen offset:0 sc1
    buffer_store_dwordx4 v[164:167], v12, s[44:47], s19 offen offset:512 sc1
    v_fmac_f32 v212, v68, v211
    v_fmac_f32 v228, v76, v227
    v_fmac_f32 v244, v84, v243
    v_fmac_f32_dpp v212, v211, v69 row_ror:8 row_mask:0xf bank_mask:0xf
    v_fmac_f32_dpp v228, v227, v77 row_ror:8 row_mask:0xf bank_mask:0xf
    v_fmac_f32_dpp v244, v243, v85 row_ror:8 row_mask:0xf bank_mask:0xf
    v_fmac_f32 v213, v68, v212
    v_fmac_f32 v229, v76, v228
    v_fmac_f32 v245, v84, v244
    v_fmac_f32_dpp v213, v212, v69 row_ror:8 row_mask:0xf bank_mask:0xf
    v_fmac_f32_dpp v229, v228, v77 row_ror:8 row_mask:0xf bank_mask:0xf
    v_fmac_f32_dpp v245, v244, v85 row_ror:8 row_mask:0xf bank_mask:0xf
    v_fmac_f32 v214, v68, v213
    v_fmac_f32 v230, v76, v229
    v_fmac_f32 v246, v84, v245
    v_fmac_f32_dpp v214, v213, v69 row_ror:8 row_mask:0xf bank_mask:0xf
    v_fmac_f32_dpp v230, v229, v77 row_ror:8 row_mask:0xf bank_mask:0xf
    v_fmac_f32_dpp v246, v245, v85 row_ror:8 row_mask:0xf bank_mask:0xf
    s_add_u32 s19, s18, 4096
    buffer_store_dwordx4 v[176:179], v12, s[44:47], s19 offen offset:0 sc1
    buffer_store_dwordx4 v[180:183], v12, s[44:47], s19 offen offset:512 sc1
    v_fmac_f32 v215, v68, v214
    v_fmac_f32 v231, v76, v230
    v_fmac_f32 v247, v84, v246
    v_fmac_f32_dpp v215, v214, v69 row_ror:8 row_mask:0xf bank_mask:0xf
    v_fmac_f32_dpp v231, v230, v77 row_ror:8 row_mask:0xf bank_mask:0xf
    v_fmac_f32_dpp v247, v246, v85 row_ror:8 row_mask:0xf bank_mask:0xf
    v_fmac_f32 v216, v68, v215
    v_fmac_f32 v232, v76, v231
    v_fmac_f32 v248, v84, v247
    v_fmac_f32_dpp v216, v215, v69 row_ror:8 row_mask:0xf bank_mask:0xf
    v_fmac_f32_dpp v232, v231, v77 row_ror:8 row_mask:0xf bank_mask:0xf
    v_fmac_f32_dpp v248, v247, v85 row_ror:8 row_mask:0xf bank_mask:0xf
    v_fmac_f32 v217, v68, v216
    v_fmac_f32 v233, v76, v232
    v_fmac_f32 v249, v84, v248
    v_fmac_f32_dpp v217, v216, v69 row_ror:8 row_mask:0xf bank_mask:0xf
    v_fmac_f32_dpp v233, v232, v77 row_ror:8 row_mask:0xf bank_mask:0xf
    v_fmac_f32_dpp v249, v248, v85 row_ror:8 row_mask:0xf bank_mask:0xf
    s_add_u32 s19, s18, 5120
    buffer_store_dwordx4 v[192:195], v12, s[44:47], s19 offen offset:0 sc1
    buffer_store_dwordx4 v[196:199], v12, s[44:47], s19 offen offset:512 sc1
    v_fmac_f32 v218, v68, v217
    v_fmac_f32 v234, v76, v233
    v_fmac_f32 v250, v84, v249
    v_fmac_f32_dpp v218, v217, v69 row_ror:8 row_mask:0xf bank_mask:0xf
    v_fmac_f32_dpp v234, v233, v77 row_ror:8 row_mask:0xf bank_mask:0xf
    v_fmac_f32_dpp v250, v249, v85 row_ror:8 row_mask:0xf bank_mask:0xf
    v_fmac_f32 v219, v68, v218
    v_fmac_f32 v235, v76, v234
    v_fmac_f32 v251, v84, v250
    v_fmac_f32_dpp v219, v218, v69 row_ror:8 row_mask:0xf bank_mask:0xf
    v_fmac_f32_dpp v235, v234, v77 row_ror:8 row_mask:0xf bank_mask:0xf
    v_fmac_f32_dpp v251, v250, v85 row_ror:8 row_mask:0xf bank_mask:0xf
    v_fmac_f32 v220, v68, v219
    v_fmac_f32 v236, v76, v235
    v_fmac_f32 v252, v84, v251
    v_fmac_f32_dpp v220, v219, v69 row_ror:8 row_mask:0xf bank_mask:0xf
    v_fmac_f32_dpp v236, v235, v77 row_ror:8 row_mask:0xf bank_mask:0xf
    v_fmac_f32_dpp v252, v251, v85 row_ror:8 row_mask:0xf bank_mask:0xf
    v_fmac_f32 v221, v68, v220
    v_fmac_f32 v237, v76, v236
    v_fmac_f32 v253, v84, v252
    v_fmac_f32_dpp v221, v220, v69 row_ror:8 row_mask:0xf bank_mask:0xf
    v_fmac_f32_dpp v237, v236, v77 row_ror:8 row_mask:0xf bank_mask:0xf
    v_fmac_f32_dpp v253, v252, v85 row_ror:8 row_mask:0xf bank_mask:0xf
    v_fmac_f32 v222, v68, v221
    v_fmac_f32 v238, v76, v237
    v_fmac_f32 v254, v84, v253
    v_fmac_f32_dpp v222, v221, v69 row_ror:8 row_mask:0xf bank_mask:0xf
    v_fmac_f32_dpp v238, v237, v77 row_ror:8 row_mask:0xf bank_mask:0xf
    v_fmac_f32_dpp v254, v253, v85 row_ror:8 row_mask:0xf bank_mask:0xf
    v_fmac_f32 v223, v68, v222
    v_fmac_f32 v239, v76, v238
    v_fmac_f32 v255, v84, v254
    v_fmac_f32_dpp v223, v222, v69 row_ror:8 row_mask:0xf bank_mask:0xf
    v_fmac_f32_dpp v239, v238, v77 row_ror:8 row_mask:0xf bank_mask:0xf
    v_fmac_f32_dpp v255, v254, v85 row_ror:8 row_mask:0xf bank_mask:0xf
    v_cvt_pk_bf16_f32 v68, v208, v209
    v_cvt_pk_bf16_f32 v69, v210, v211
    v_cvt_pk_bf16_f32 v70, v212, v213
    v_cvt_pk_bf16_f32 v71, v214, v215
    v_cvt_pk_bf16_f32 v72, v216, v217
    v_cvt_pk_bf16_f32 v73, v218, v219
    v_cvt_pk_bf16_f32 v74, v220, v221
    v_cvt_pk_bf16_f32 v75, v222, v223
    ds_write_b128 v10, v[68:71] offset:0
    ds_write_b128 v10, v[72:75] offset:16
    ds_read_b64_tr_b16 v[208:209], v11 offset:0
    ds_read_b64_tr_b16 v[210:211], v11 offset:768
    ds_read_b64_tr_b16 v[212:213], v11 offset:1536
    ds_read_b64_tr_b16 v[214:215], v11 offset:2304
    v_cvt_pk_bf16_f32 v76, v224, v225
    v_cvt_pk_bf16_f32 v77, v226, v227
    v_cvt_pk_bf16_f32 v78, v228, v229
    v_cvt_pk_bf16_f32 v79, v230, v231
    v_cvt_pk_bf16_f32 v80, v232, v233
    v_cvt_pk_bf16_f32 v81, v234, v235
    v_cvt_pk_bf16_f32 v82, v236, v237
    v_cvt_pk_bf16_f32 v83, v238, v239
    ds_write_b128 v10, v[76:79] offset:3072
    ds_write_b128 v10, v[80:83] offset:3088
    ds_read_b64_tr_b16 v[224:225], v11 offset:3072
    ds_read_b64_tr_b16 v[226:227], v11 offset:3840
    ds_read_b64_tr_b16 v[228:229], v11 offset:4608
    ds_read_b64_tr_b16 v[230:231], v11 offset:5376
    v_cvt_pk_bf16_f32 v84, v240, v241
    v_cvt_pk_bf16_f32 v85, v242, v243
    v_cvt_pk_bf16_f32 v86, v244, v245
    v_cvt_pk_bf16_f32 v87, v246, v247
    v_cvt_pk_bf16_f32 v88, v248, v249
    v_cvt_pk_bf16_f32 v89, v250, v251
    v_cvt_pk_bf16_f32 v90, v252, v253
    v_cvt_pk_bf16_f32 v91, v254, v255
    ds_write_b128 v10, v[84:87] offset:0
    ds_write_b128 v10, v[88:91] offset:16
    ds_read_b64_tr_b16 v[240:241], v11 offset:0
    ds_read_b64_tr_b16 v[242:243], v11 offset:768
    ds_read_b64_tr_b16 v[244:245], v11 offset:1536
    ds_read_b64_tr_b16 v[246:247], v11 offset:2304
    s_waitcnt lgkmcnt(0)
    s_add_u32 s19, s18, 6144
    buffer_store_dwordx4 v[208:211], v12, s[44:47], s19 offen offset:0 sc1
    buffer_store_dwordx4 v[212:215], v12, s[44:47], s19 offen offset:512 sc1
    s_add_u32 s19, s18, 7168
    buffer_store_dwordx4 v[224:227], v12, s[44:47], s19 offen offset:0 sc1
    buffer_store_dwordx4 v[228:231], v12, s[44:47], s19 offen offset:512 sc1
    s_add_u32 s19, s18, 8192
    buffer_store_dwordx4 v[240:243], v12, s[44:47], s19 offen offset:0 sc1
    buffer_store_dwordx4 v[244:247], v12, s[44:47], s19 offen offset:512 sc1
    s_lshl_b32 s19, s10, 5
    s_add_u32 s19, s19, s8
    s_add_u32 s19, s19, 24
    s_lshl_b32 s19, s19, 7
    s_add_u32 s19, s19, 262144
    v_mov_b32 v9, 0
    s_waitcnt vmcnt(0)
    buffer_store_dword v17, v9, s[56:59], s19 offen sc1
    s_cmp_ge_u32 s7, 30
    s_cbranch_scc1 parallel_nf34
    s_sub_u32 s12, s7, 24
    s_lshl_b32 s14, s5, 2
    s_add_u32 s14, s14, s6
    s_lshl_b32 s14, s14, 1
    s_and_b32 s15, s12, 1
    s_add_u32 s14, s14, s15
    s_lshr_b32 s15, s12, 1
    s_mul_i32 s14, s14, 3
    s_add_u32 s14, s14, s15
    s_mul_i32 s12, s14, 196608
    s_and_b32 s15, s4, 1
    s_lshl_b32 s15, s15, 1
    s_lshr_b32 s14, s4, 1
    s_add_u32 s15, s15, s14
    s_mul_i32 s15, s15, 3072
    s_add_u32 s12, s12, s15
    s_add_u32 s44, s32, 0x2400000
    s_addc_u32 s45, s33, 0
    s_add_u32 s44, s44, s12
    s_addc_u32 s45, s45, 0
    s_mov_b32 s46, 0x2dc00
    s_mov_b32 s47, 0x20000
    v_mov_b32 v20, -1
    v_mov_b32 v21, -1
    v_mov_b32 v22, -1
    v_mov_b32 v23, -1
    s_mov_b32 s12, 36864
    buffer_store_dwordx4 v[20:23], v5, s[44:47], s12 offen offset:0 sc1
    buffer_store_dwordx4 v[20:23], v5, s[44:47], s12 offen offset:1024 sc1
    buffer_store_dwordx4 v[20:23], v5, s[44:47], s12 offen offset:2048 sc1
    s_mov_b32 s12, 86016
    buffer_store_dwordx4 v[20:23], v5, s[44:47], s12 offen offset:0 sc1
    buffer_store_dwordx4 v[20:23], v5, s[44:47], s12 offen offset:1024 sc1
    buffer_store_dwordx4 v[20:23], v5, s[44:47], s12 offen offset:2048 sc1
    s_mov_b32 s12, 135168
    buffer_store_dwordx4 v[20:23], v5, s[44:47], s12 offen offset:0 sc1
    buffer_store_dwordx4 v[20:23], v5, s[44:47], s12 offen offset:1024 sc1
    buffer_store_dwordx4 v[20:23], v5, s[44:47], s12 offen offset:2048 sc1
    s_mov_b32 s12, 184320
    buffer_store_dwordx4 v[20:23], v5, s[44:47], s12 offen offset:0 sc1
    buffer_store_dwordx4 v[20:23], v5, s[44:47], s12 offen offset:1024 sc1
    buffer_store_dwordx4 v[20:23], v5, s[44:47], s12 offen offset:2048 sc1
parallel_nf34:
    s_lshl_b32 s84, s2, 7
    s_lshl_b32 s18, s4, 2
    s_add_u32 s84, s84, s18
    v_mov_b32 v58, s3
    v_mov_b32 v59, 0
    s_cmp_lt_u32 s7, 30
    s_cbranch_scc1 parallel_sp35
    buffer_store_dword v58, v59, s[56:59], s84 offen offset:16 sc1
    s_endpgm
parallel_sp35:
    s_load_dwordx4 s[16:19], s[0:1], 96
    s_load_dwordx4 s[20:23], s[0:1], 40
    v_and_b32 v2, 63, v0
    s_lshl_b32 s28, s4, 12
    s_add_u32 s48, s32, 0x2280000
    s_addc_u32 s49, s33, 0
    s_mov_b32 s50, 0x100000
    s_mov_b32 s51, 0x20000
    s_sub_u32 s11, s7, 24
    s_lshl_b32 s8, s5, 2
    s_add_u32 s8, s8, s6
    s_lshl_b32 s8, s8, 1
    s_and_b32 s9, s11, 1
    s_add_u32 s8, s8, s9
    s_lshr_b32 s9, s11, 1
    s_mov_b32 s10, 0
    s_mov_b32 s11, 4
    v_lshrrev_b32 v6, 3, v2
    v_and_b32 v7, 7, v2
    v_lshrrev_b32 v3, 1, v6
    v_xor_b32 v7, v7, v3
    v_mul_u32_u24 v6, 1152, v6
    v_lshl_add_u32 v12, v7, 4, v6
    v_xor_b32 v7, 4, v7
    v_lshl_add_u32 v13, v7, 4, v6
    v_add_u32 v13, 8192, v13
    v_add_u32 v14, 16384, v12
    v_add_u32 v15, 16384, v13
    s_mul_i32 s12, s4, 36864
    v_add_u32 v8, s12, v12
    v_add_u32 v9, s12, v13
    v_add_u32 v10, s12, v14
    v_add_u32 v11, s12, v15
    v_mov_b32 v36, v5
    s_mul_i32 s12, s9, 221184
    s_waitcnt lgkmcnt(0)
    s_add_u32 s36, s20, s12
    s_addc_u32 s37, s21, 0
    s_mov_b32 s38, 0x36000
    s_mov_b32 s39, 0x20000
    s_add_u32 s52, s22, s12
    s_addc_u32 s53, s23, 0
    s_mov_b32 s54, 0x36000
    s_mov_b32 s55, 0x20000
    s_lshl_b32 s14, s8, 2
    s_add_u32 s14, s14, s4
    s_mul_i32 s12, s14, 180
    s_mul_i32 s13, s11, 36
    s_add_u32 s12, s12, s13
    s_lshl_b32 s12, s12, 11
    s_add_u32 s40, s32, 0x300000
    s_addc_u32 s41, s33, 0
    s_add_u32 s40, s40, s12
    s_addc_u32 s41, s41, 0
    s_mov_b32 s42, 0x12000
    s_mov_b32 s43, 0x20000
    s_lshr_b32 s12, s14, 1
    s_lshl_b32 s12, s12, 5
    s_mul_i32 s13, s11, 6
    s_add_u32 s12, s12, s13
    s_lshl_b32 s82, s12, 7
    s_add_u32 s82, s82, 262144
    v_min_u32 v46, 7, v2
    v_lshlrev_b32 v46, 7, v46
    v_and_b32 v7, 31, v2
    v_and_b32 v43, 15, v2
    v_lshlrev_b32 v43, 4, v43
    v_lshrrev_b32 v44, 5, v2
    v_lshl_add_u32 v43, v44, 8, v43
    v_bfe_u32 v44, v2, 4, 1
    v_lshl_add_u32 v40, v44, 10, v43
    v_xor_b32 v41, 1024, v40
    v_mul_u32_u24 v44, 98304, v44
    v_add_u32 v42, v44, v43
    s_mov_b32 s60, 36864
    s_mov_b32 s61, 86016
    s_mov_b32 s62, 135168
    s_mov_b32 s63, 184320
    s_and_b32 s12, s4, 1
    s_mul_i32 s12, s12, 36864
    s_add_u32 s12, s12, 147456
    v_add_u32 v12, s12, v12
    v_add_u32 v13, s12, v13
    v_add_u32 v14, s12, v14
    v_add_u32 v15, s12, v15
    s_cmp_ge_u32 s4, 2
    s_cselect_b32 s56, s52, s36
    s_cselect_b32 s57, s53, s37
    s_mov_b32 s58, 221184
    s_mov_b32 s59, 0x20000
    v_lshrrev_b32 v6, 5, v2
    v_bfe_u32 v3, v2, 1, 3
    v_lshlrev_b32 v3, 4, v3
    v_lshl_add_u32 v3, v7, 7, v3
    v_lshl_add_u32 v16, v6, 14, v3
    v_lshl_add_u32 v17, v6, 13, v3
    buffer_load_dwordx4 v[60:63], v46, s[48:51], s82 offen sc1
    s_waitcnt vmcnt(0)
    buffer_store_dword v58, v59, s[48:51], s84 offen offset:16 sc1
    s_mov_b32 s81, 0
parallel_fc36:
    v_xor_b32 v57, s3, v60
    v_cmp_ne_u32 vcc, 0, v57
    s_cbranch_vccz parallel_fx37
    s_add_u32 s81, s81, 1
    s_cmp_gt_u32 s81, 131072
    s_cbranch_scc1 parallel_fx37
    buffer_load_dwordx4 v[60:63], v46, s[48:51], s82 offen sc1
    s_waitcnt vmcnt(0)
    s_branch parallel_fc36
parallel_fx37:
    s_mov_b32 s31, 0
    buffer_load_dwordx4 a[0:3], v36, s[40:43], s31 offen offset:0 sc1
    buffer_load_dwordx4 a[4:7], v36, s[40:43], s31 offen offset:1024 sc1
    buffer_load_dwordx4 a[8:11], v36, s[40:43], s31 offen offset:2048 sc1
    buffer_load_dwordx4 a[12:15], v36, s[40:43], s31 offen offset:3072 sc1
    s_mov_b32 s31, 4096
    buffer_load_dwordx4 a[16:19], v36, s[40:43], s31 offen offset:0 sc1
    buffer_load_dwordx4 a[20:23], v36, s[40:43], s31 offen offset:1024 sc1
    buffer_load_dwordx4 a[24:27], v36, s[40:43], s31 offen offset:2048 sc1
    buffer_load_dwordx4 a[28:31], v36, s[40:43], s31 offen offset:3072 sc1
    s_mov_b32 s31, 8192
    buffer_load_dwordx4 a[32:35], v36, s[40:43], s31 offen offset:0 sc1
    buffer_load_dwordx4 a[36:39], v36, s[40:43], s31 offen offset:1024 sc1
    buffer_load_dwordx4 a[40:43], v36, s[40:43], s31 offen offset:2048 sc1
    buffer_load_dwordx4 a[44:47], v36, s[40:43], s31 offen offset:3072 sc1
    s_mov_b32 s31, 12288
    buffer_load_dwordx4 a[48:51], v36, s[40:43], s31 offen offset:0 sc1
    buffer_load_dwordx4 a[52:55], v36, s[40:43], s31 offen offset:1024 sc1
    buffer_load_dwordx4 a[56:59], v36, s[40:43], s31 offen offset:2048 sc1
    buffer_load_dwordx4 a[60:63], v36, s[40:43], s31 offen offset:3072 sc1
    s_waitcnt vmcnt(32)
    s_barrier
    v_xor_b32 v18, 0x0, v16
    ds_read_b128 v[64:67], v18 offset:0
    ds_read_b128 v[68:71], v18 offset:4096
    ds_read_b128 v[72:75], v18 offset:8192
    ds_read_b128 v[76:79], v18 offset:12288
    v_xor_b32 v19, 0x10, v16
    ds_read_b128 v[80:83], v19 offset:0
    ds_read_b128 v[84:87], v19 offset:4096
    s_waitcnt vmcnt(15) lgkmcnt(5)
    v_mfma_f32_32x32x16_bf16 v[128:143], v[64:67], a[0:3], 0
    ds_read_b128 v[88:91], v19 offset:8192
    s_mov_b32 s31, 16384
    buffer_load_dwordx4 a[64:67], v36, s[40:43], s31 offen offset:0 sc1
    s_waitcnt lgkmcnt(5)
    v_mfma_f32_32x32x16_bf16 v[144:159], v[68:71], a[0:3], 0
    ds_read_b128 v[92:95], v19 offset:12288
    s_waitcnt lgkmcnt(5)
    v_mfma_f32_32x32x16_bf16 v[160:175], v[72:75], a[0:3], 0
    v_xor_b32 v18, 0x20, v16
    ds_read_b128 v[64:67], v18 offset:0
    s_add_u32 m0, s28, 98304
    s_mov_b32 s30, 384
    buffer_load_dwordx4 v8, s[36:39], s30 offen offset:0 lds
    s_waitcnt lgkmcnt(5)
    v_mfma_f32_32x32x16_bf16 v[176:191], v[76:79], a[0:3], 0
    ds_read_b128 v[68:71], v18 offset:4096
    s_waitcnt vmcnt(16) lgkmcnt(5)
    v_mfma_f32_32x32x16_bf16 v[128:143], v[80:83], a[4:7], v[128:143]
    ds_read_b128 v[72:75], v18 offset:8192
    buffer_load_dwordx4 a[68:71], v36, s[40:43], s31 offen offset:1024 sc1
    s_waitcnt lgkmcnt(5)
    v_mfma_f32_32x32x16_bf16 v[144:159], v[84:87], a[4:7], v[144:159]
    ds_read_b128 v[76:79], v18 offset:12288
    s_waitcnt lgkmcnt(5)
    v_mfma_f32_32x32x16_bf16 v[160:175], v[88:91], a[4:7], v[160:175]
    v_xor_b32 v19, 0x30, v16
    ds_read_b128 v[80:83], v19 offset:0
    buffer_load_dwordx4 v9, s[36:39], s30 offen offset:1024 lds
    s_waitcnt lgkmcnt(5)
    v_mfma_f32_32x32x16_bf16 v[176:191], v[92:95], a[4:7], v[176:191]
    ds_read_b128 v[84:87], v19 offset:4096
    s_waitcnt vmcnt(17) lgkmcnt(5)
    v_mfma_f32_32x32x16_bf16 v[128:143], v[64:67], a[8:11], v[128:143]
    ds_read_b128 v[88:91], v19 offset:8192
    buffer_load_dwordx4 a[72:75], v36, s[40:43], s31 offen offset:2048 sc1
    s_waitcnt lgkmcnt(5)
    v_mfma_f32_32x32x16_bf16 v[144:159], v[68:71], a[8:11], v[144:159]
    ds_read_b128 v[92:95], v19 offset:12288
    s_waitcnt lgkmcnt(5)
    v_mfma_f32_32x32x16_bf16 v[160:175], v[72:75], a[8:11], v[160:175]
    v_xor_b32 v18, 0x40, v16
    ds_read_b128 v[64:67], v18 offset:0
    buffer_load_dwordx4 v10, s[36:39], s30 offen offset:2048 lds
    s_waitcnt lgkmcnt(5)
    v_mfma_f32_32x32x16_bf16 v[176:191], v[76:79], a[8:11], v[176:191]
    ds_read_b128 v[68:71], v18 offset:4096
    s_waitcnt vmcnt(18) lgkmcnt(5)
    v_mfma_f32_32x32x16_bf16 v[128:143], v[80:83], a[12:15], v[128:143]
    ds_read_b128 v[72:75], v18 offset:8192
    buffer_load_dwordx4 a[76:79], v36, s[40:43], s31 offen offset:3072 sc1
    s_waitcnt lgkmcnt(5)
    v_mfma_f32_32x32x16_bf16 v[144:159], v[84:87], a[12:15], v[144:159]
    ds_read_b128 v[76:79], v18 offset:12288
    s_waitcnt lgkmcnt(5)
    v_mfma_f32_32x32x16_bf16 v[160:175], v[88:91], a[12:15], v[160:175]
    v_xor_b32 v19, 0x50, v16
    ds_read_b128 v[80:83], v19 offset:0
    buffer_load_dwordx4 v11, s[36:39], s30 offen offset:3072 lds
    s_waitcnt lgkmcnt(5)
    v_mfma_f32_32x32x16_bf16 v[176:191], v[92:95], a[12:15], v[176:191]
    ds_read_b128 v[84:87], v19 offset:4096
    s_waitcnt vmcnt(19) lgkmcnt(5)
    v_mfma_f32_32x32x16_bf16 v[128:143], v[64:67], a[16:19], v[128:143]
    ds_read_b128 v[88:91], v19 offset:8192
    s_mov_b32 s31, 20480
    buffer_load_dwordx4 a[80:83], v36, s[40:43], s31 offen offset:0 sc1
    s_waitcnt lgkmcnt(5)
    v_mfma_f32_32x32x16_bf16 v[144:159], v[68:71], a[16:19], v[144:159]
    ds_read_b128 v[92:95], v19 offset:12288
    s_waitcnt lgkmcnt(5)
    v_mfma_f32_32x32x16_bf16 v[160:175], v[72:75], a[16:19], v[160:175]
    v_xor_b32 v18, 0x60, v16
    ds_read_b128 v[64:67], v18 offset:0
    s_add_u32 m0, s28, 114688
    s_mov_b32 s30, 384
    buffer_load_dwordx4 v8, s[52:55], s30 offen offset:0 lds
    s_waitcnt lgkmcnt(5)
    v_mfma_f32_32x32x16_bf16 v[176:191], v[76:79], a[16:19], v[176:191]
    ds_read_b128 v[68:71], v18 offset:4096
    s_waitcnt vmcnt(20) lgkmcnt(5)
    v_mfma_f32_32x32x16_bf16 v[128:143], v[80:83], a[20:23], v[128:143]
    ds_read_b128 v[72:75], v18 offset:8192
    buffer_load_dwordx4 a[84:87], v36, s[40:43], s31 offen offset:1024 sc1
    s_waitcnt lgkmcnt(5)
    v_mfma_f32_32x32x16_bf16 v[144:159], v[84:87], a[20:23], v[144:159]
    ds_read_b128 v[76:79], v18 offset:12288
    s_waitcnt lgkmcnt(5)
    v_mfma_f32_32x32x16_bf16 v[160:175], v[88:91], a[20:23], v[160:175]
    v_xor_b32 v19, 0x70, v16
    ds_read_b128 v[80:83], v19 offset:0
    buffer_load_dwordx4 v9, s[52:55], s30 offen offset:1024 lds
    s_waitcnt lgkmcnt(5)
    v_mfma_f32_32x32x16_bf16 v[176:191], v[92:95], a[20:23], v[176:191]
    ds_read_b128 v[84:87], v19 offset:4096
    s_waitcnt vmcnt(21) lgkmcnt(5)
    v_mfma_f32_32x32x16_bf16 v[128:143], v[64:67], a[24:27], v[128:143]
    ds_read_b128 v[88:91], v19 offset:8192
    buffer_load_dwordx4 a[88:91], v36, s[40:43], s31 offen offset:2048 sc1
    s_waitcnt lgkmcnt(5)
    v_mfma_f32_32x32x16_bf16 v[144:159], v[68:71], a[24:27], v[144:159]
    ds_read_b128 v[92:95], v19 offset:12288
    s_waitcnt vmcnt(37)
    s_barrier
    s_waitcnt lgkmcnt(5)
    v_mfma_f32_32x32x16_bf16 v[160:175], v[72:75], a[24:27], v[160:175]
    v_xor_b32 v18, 0x8000, v16
    ds_read_b128 v[64:67], v18 offset:0
    buffer_load_dwordx4 v10, s[52:55], s30 offen offset:2048 lds
    s_waitcnt lgkmcnt(5)
    v_mfma_f32_32x32x16_bf16 v[176:191], v[76:79], a[24:27], v[176:191]
    ds_read_b128 v[68:71], v18 offset:4096
    s_waitcnt vmcnt(22) lgkmcnt(5)
    v_mfma_f32_32x32x16_bf16 v[128:143], v[80:83], a[28:31], v[128:143]
    ds_read_b128 v[72:75], v18 offset:8192
    buffer_load_dwordx4 a[92:95], v36, s[40:43], s31 offen offset:3072 sc1
    s_waitcnt lgkmcnt(5)
    v_mfma_f32_32x32x16_bf16 v[144:159], v[84:87], a[28:31], v[144:159]
    ds_read_b128 v[76:79], v18 offset:12288
    s_waitcnt lgkmcnt(5)
    v_mfma_f32_32x32x16_bf16 v[160:175], v[88:91], a[28:31], v[160:175]
    v_xor_b32 v19, 0x8010, v16
    ds_read_b128 v[80:83], v19 offset:0
    buffer_load_dwordx4 v11, s[52:55], s30 offen offset:3072 lds
    s_waitcnt lgkmcnt(5)
    v_mfma_f32_32x32x16_bf16 v[176:191], v[92:95], a[28:31], v[176:191]
    ds_read_b128 v[84:87], v19 offset:4096
    s_waitcnt vmcnt(23) lgkmcnt(5)
    v_mfma_f32_32x32x16_bf16 v[128:143], v[64:67], a[32:35], v[128:143]
    ds_read_b128 v[88:91], v19 offset:8192
    s_mov_b32 s31, 24576
    buffer_load_dwordx4 a[96:99], v36, s[40:43], s31 offen offset:0 sc1
    s_waitcnt lgkmcnt(5)
    v_mfma_f32_32x32x16_bf16 v[144:159], v[68:71], a[32:35], v[144:159]
    ds_read_b128 v[92:95], v19 offset:12288
    s_waitcnt lgkmcnt(5)
    v_mfma_f32_32x32x16_bf16 v[160:175], v[72:75], a[32:35], v[160:175]
    v_xor_b32 v18, 0x8020, v16
    ds_read_b128 v[64:67], v18 offset:0
    s_add_u32 m0, s28, 131072
    s_mov_b32 s30, 512
    buffer_load_dwordx4 v8, s[36:39], s30 offen offset:0 lds
    s_waitcnt lgkmcnt(5)
    v_mfma_f32_32x32x16_bf16 v[176:191], v[76:79], a[32:35], v[176:191]
    ds_read_b128 v[68:71], v18 offset:4096
    s_waitcnt vmcnt(24) lgkmcnt(5)
    v_mfma_f32_32x32x16_bf16 v[128:143], v[80:83], a[36:39], v[128:143]
    ds_read_b128 v[72:75], v18 offset:8192
    buffer_load_dwordx4 a[100:103], v36, s[40:43], s31 offen offset:1024 sc1
    s_waitcnt lgkmcnt(5)
    v_mfma_f32_32x32x16_bf16 v[144:159], v[84:87], a[36:39], v[144:159]
    ds_read_b128 v[76:79], v18 offset:12288
    s_waitcnt lgkmcnt(5)
    v_mfma_f32_32x32x16_bf16 v[160:175], v[88:91], a[36:39], v[160:175]
    v_xor_b32 v19, 0x8030, v16
    ds_read_b128 v[80:83], v19 offset:0
    buffer_load_dwordx4 v9, s[36:39], s30 offen offset:1024 lds
    s_waitcnt lgkmcnt(5)
    v_mfma_f32_32x32x16_bf16 v[176:191], v[92:95], a[36:39], v[176:191]
    ds_read_b128 v[84:87], v19 offset:4096
    s_waitcnt vmcnt(25) lgkmcnt(5)
    v_mfma_f32_32x32x16_bf16 v[128:143], v[64:67], a[40:43], v[128:143]
    ds_read_b128 v[88:91], v19 offset:8192
    buffer_load_dwordx4 a[104:107], v36, s[40:43], s31 offen offset:2048 sc1
    s_waitcnt lgkmcnt(5)
    v_mfma_f32_32x32x16_bf16 v[144:159], v[68:71], a[40:43], v[144:159]
    ds_read_b128 v[92:95], v19 offset:12288
    s_waitcnt lgkmcnt(5)
    v_mfma_f32_32x32x16_bf16 v[160:175], v[72:75], a[40:43], v[160:175]
    v_xor_b32 v18, 0x8040, v16
    ds_read_b128 v[64:67], v18 offset:0
    buffer_load_dwordx4 v10, s[36:39], s30 offen offset:2048 lds
    s_waitcnt lgkmcnt(5)
    v_mfma_f32_32x32x16_bf16 v[176:191], v[76:79], a[40:43], v[176:191]
    ds_read_b128 v[68:71], v18 offset:4096
    s_waitcnt vmcnt(26) lgkmcnt(5)
    v_mfma_f32_32x32x16_bf16 v[128:143], v[80:83], a[44:47], v[128:143]
    ds_read_b128 v[72:75], v18 offset:8192
    buffer_load_dwordx4 a[108:111], v36, s[40:43], s31 offen offset:3072 sc1
    s_waitcnt lgkmcnt(5)
    v_mfma_f32_32x32x16_bf16 v[144:159], v[84:87], a[44:47], v[144:159]
    ds_read_b128 v[76:79], v18 offset:12288
    s_waitcnt lgkmcnt(5)
    v_mfma_f32_32x32x16_bf16 v[160:175], v[88:91], a[44:47], v[160:175]
    v_xor_b32 v19, 0x8050, v16
    ds_read_b128 v[80:83], v19 offset:0
    buffer_load_dwordx4 v11, s[36:39], s30 offen offset:3072 lds
    s_waitcnt lgkmcnt(5)
    v_mfma_f32_32x32x16_bf16 v[176:191], v[92:95], a[44:47], v[176:191]
    ds_read_b128 v[84:87], v19 offset:4096
    s_waitcnt vmcnt(27) lgkmcnt(5)
    v_mfma_f32_32x32x16_bf16 v[128:143], v[64:67], a[48:51], v[128:143]
    ds_read_b128 v[88:91], v19 offset:8192
    s_mov_b32 s31, 28672
    buffer_load_dwordx4 a[112:115], v36, s[40:43], s31 offen offset:0 sc1
    s_waitcnt lgkmcnt(5)
    v_mfma_f32_32x32x16_bf16 v[144:159], v[68:71], a[48:51], v[144:159]
    ds_read_b128 v[92:95], v19 offset:12288
    s_waitcnt lgkmcnt(5)
    v_mfma_f32_32x32x16_bf16 v[160:175], v[72:75], a[48:51], v[160:175]
    v_xor_b32 v18, 0x8060, v16
    ds_read_b128 v[64:67], v18 offset:0
    s_add_u32 m0, s28, 147456
    s_mov_b32 s30, 512
    buffer_load_dwordx4 v8, s[52:55], s30 offen offset:0 lds
    s_waitcnt lgkmcnt(5)
    v_mfma_f32_32x32x16_bf16 v[176:191], v[76:79], a[48:51], v[176:191]
    ds_read_b128 v[68:71], v18 offset:4096
    s_waitcnt vmcnt(28) lgkmcnt(5)
    v_mfma_f32_32x32x16_bf16 v[128:143], v[80:83], a[52:55], v[128:143]
    ds_read_b128 v[72:75], v18 offset:8192
    buffer_load_dwordx4 a[116:119], v36, s[40:43], s31 offen offset:1024 sc1
    s_waitcnt lgkmcnt(5)
    v_mfma_f32_32x32x16_bf16 v[144:159], v[84:87], a[52:55], v[144:159]
    ds_read_b128 v[76:79], v18 offset:12288
    s_waitcnt lgkmcnt(5)
    v_mfma_f32_32x32x16_bf16 v[160:175], v[88:91], a[52:55], v[160:175]
    v_xor_b32 v19, 0x8070, v16
    ds_read_b128 v[80:83], v19 offset:0
    buffer_load_dwordx4 v9, s[52:55], s30 offen offset:1024 lds
    s_waitcnt lgkmcnt(5)
    v_mfma_f32_32x32x16_bf16 v[176:191], v[92:95], a[52:55], v[176:191]
    ds_read_b128 v[84:87], v19 offset:4096
    s_waitcnt vmcnt(29) lgkmcnt(5)
    v_mfma_f32_32x32x16_bf16 v[128:143], v[64:67], a[56:59], v[128:143]
    ds_read_b128 v[88:91], v19 offset:8192
    buffer_load_dwordx4 a[120:123], v36, s[40:43], s31 offen offset:2048 sc1
    s_waitcnt lgkmcnt(5)
    v_mfma_f32_32x32x16_bf16 v[144:159], v[68:71], a[56:59], v[144:159]
    ds_read_b128 v[92:95], v19 offset:12288
    s_waitcnt vmcnt(45)
    s_barrier
    s_waitcnt lgkmcnt(5)
    v_mfma_f32_32x32x16_bf16 v[160:175], v[72:75], a[56:59], v[160:175]
    v_xor_b32 v18, 0x10000, v16
    ds_read_b128 v[64:67], v18 offset:0
    buffer_load_dwordx4 v10, s[52:55], s30 offen offset:2048 lds
    s_waitcnt lgkmcnt(5)
    v_mfma_f32_32x32x16_bf16 v[176:191], v[76:79], a[56:59], v[176:191]
    ds_read_b128 v[68:71], v18 offset:4096
    s_waitcnt vmcnt(30) lgkmcnt(5)
    v_mfma_f32_32x32x16_bf16 v[128:143], v[80:83], a[60:63], v[128:143]
    ds_read_b128 v[72:75], v18 offset:8192
    buffer_load_dwordx4 a[124:127], v36, s[40:43], s31 offen offset:3072 sc1
    s_waitcnt lgkmcnt(5)
    v_mfma_f32_32x32x16_bf16 v[144:159], v[84:87], a[60:63], v[144:159]
    ds_read_b128 v[76:79], v18 offset:12288
    s_waitcnt lgkmcnt(5)
    v_mfma_f32_32x32x16_bf16 v[160:175], v[88:91], a[60:63], v[160:175]
    v_xor_b32 v19, 0x10010, v16
    ds_read_b128 v[80:83], v19 offset:0
    buffer_load_dwordx4 v11, s[52:55], s30 offen offset:3072 lds
    s_waitcnt lgkmcnt(5)
    v_mfma_f32_32x32x16_bf16 v[176:191], v[92:95], a[60:63], v[176:191]
    ds_read_b128 v[84:87], v19 offset:4096
    s_waitcnt vmcnt(31) lgkmcnt(5)
    v_mfma_f32_32x32x16_bf16 v[128:143], v[64:67], a[64:67], v[128:143]
    ds_read_b128 v[88:91], v19 offset:8192
    s_mov_b32 s31, 32768
    buffer_load_dwordx4 a[128:131], v36, s[40:43], s31 offen offset:0 sc1
    s_waitcnt lgkmcnt(5)
    v_mfma_f32_32x32x16_bf16 v[144:159], v[68:71], a[64:67], v[144:159]
    ds_read_b128 v[92:95], v19 offset:12288
    s_waitcnt lgkmcnt(5)
    v_mfma_f32_32x32x16_bf16 v[160:175], v[72:75], a[64:67], v[160:175]
    v_xor_b32 v18, 0x10020, v16
    ds_read_b128 v[64:67], v18 offset:0
    s_add_u32 m0, s28, 0
    s_mov_b32 s30, 640
    buffer_load_dwordx4 v8, s[36:39], s30 offen offset:0 lds
    s_waitcnt lgkmcnt(5)
    v_mfma_f32_32x32x16_bf16 v[176:191], v[76:79], a[64:67], v[176:191]
    ds_read_b128 v[68:71], v18 offset:4096
    s_waitcnt vmcnt(31) lgkmcnt(5)
    v_mfma_f32_32x32x16_bf16 v[128:143], v[80:83], a[68:71], v[128:143]
    ds_read_b128 v[72:75], v18 offset:8192
    buffer_load_dwordx4 a[132:135], v36, s[40:43], s31 offen offset:1024 sc1
    s_waitcnt lgkmcnt(5)
    v_mfma_f32_32x32x16_bf16 v[144:159], v[84:87], a[68:71], v[144:159]
    ds_read_b128 v[76:79], v18 offset:12288
    s_waitcnt lgkmcnt(5)
    v_mfma_f32_32x32x16_bf16 v[160:175], v[88:91], a[68:71], v[160:175]
    v_xor_b32 v19, 0x10030, v16
    ds_read_b128 v[80:83], v19 offset:0
    buffer_load_dwordx4 v9, s[36:39], s30 offen offset:1024 lds
    s_waitcnt lgkmcnt(5)
    v_mfma_f32_32x32x16_bf16 v[176:191], v[92:95], a[68:71], v[176:191]
    ds_read_b128 v[84:87], v19 offset:4096
    s_waitcnt vmcnt(31) lgkmcnt(5)
    v_mfma_f32_32x32x16_bf16 v[128:143], v[64:67], a[72:75], v[128:143]
    ds_read_b128 v[88:91], v19 offset:8192
    buffer_load_dwordx4 a[136:139], v36, s[40:43], s31 offen offset:2048 sc1
    s_waitcnt lgkmcnt(5)
    v_mfma_f32_32x32x16_bf16 v[144:159], v[68:71], a[72:75], v[144:159]
    ds_read_b128 v[92:95], v19 offset:12288
    s_waitcnt lgkmcnt(5)
    v_mfma_f32_32x32x16_bf16 v[160:175], v[72:75], a[72:75], v[160:175]
    v_xor_b32 v18, 0x10040, v16
    ds_read_b128 v[64:67], v18 offset:0
    buffer_load_dwordx4 v10, s[36:39], s30 offen offset:2048 lds
    s_waitcnt lgkmcnt(5)
    v_mfma_f32_32x32x16_bf16 v[176:191], v[76:79], a[72:75], v[176:191]
    ds_read_b128 v[68:71], v18 offset:4096
    s_waitcnt vmcnt(31) lgkmcnt(5)
    v_mfma_f32_32x32x16_bf16 v[128:143], v[80:83], a[76:79], v[128:143]
    ds_read_b128 v[72:75], v18 offset:8192
    buffer_load_dwordx4 a[140:143], v36, s[40:43], s31 offen offset:3072 sc1
    s_waitcnt lgkmcnt(5)
    v_mfma_f32_32x32x16_bf16 v[144:159], v[84:87], a[76:79], v[144:159]
    ds_read_b128 v[76:79], v18 offset:12288
    s_waitcnt lgkmcnt(5)
    v_mfma_f32_32x32x16_bf16 v[160:175], v[88:91], a[76:79], v[160:175]
    v_xor_b32 v19, 0x10050, v16
    ds_read_b128 v[80:83], v19 offset:0
    buffer_load_dwordx4 v11, s[36:39], s30 offen offset:3072 lds
    s_waitcnt lgkmcnt(5)
    v_mfma_f32_32x32x16_bf16 v[176:191], v[92:95], a[76:79], v[176:191]
    ds_read_b128 v[84:87], v19 offset:4096
    s_waitcnt vmcnt(31) lgkmcnt(5)
    v_mfma_f32_32x32x16_bf16 v[128:143], v[64:67], a[80:83], v[128:143]
    ds_read_b128 v[88:91], v19 offset:8192
    s_mov_b32 s31, 36864
    buffer_load_dwordx4 a[144:147], v36, s[40:43], s31 offen offset:0 sc1
    s_waitcnt lgkmcnt(5)
    v_mfma_f32_32x32x16_bf16 v[144:159], v[68:71], a[80:83], v[144:159]
    ds_read_b128 v[92:95], v19 offset:12288
    s_waitcnt lgkmcnt(5)
    v_mfma_f32_32x32x16_bf16 v[160:175], v[72:75], a[80:83], v[160:175]
    v_xor_b32 v18, 0x10060, v16
    ds_read_b128 v[64:67], v18 offset:0
    s_add_u32 m0, s28, 16384
    s_mov_b32 s30, 640
    buffer_load_dwordx4 v8, s[52:55], s30 offen offset:0 lds
    s_waitcnt lgkmcnt(5)
    v_mfma_f32_32x32x16_bf16 v[176:191], v[76:79], a[80:83], v[176:191]
    ds_read_b128 v[68:71], v18 offset:4096
    s_waitcnt vmcnt(31) lgkmcnt(5)
    v_mfma_f32_32x32x16_bf16 v[128:143], v[80:83], a[84:87], v[128:143]
    ds_read_b128 v[72:75], v18 offset:8192
    buffer_load_dwordx4 a[148:151], v36, s[40:43], s31 offen offset:1024 sc1
    s_waitcnt lgkmcnt(5)
    v_mfma_f32_32x32x16_bf16 v[144:159], v[84:87], a[84:87], v[144:159]
    ds_read_b128 v[76:79], v18 offset:12288
    s_waitcnt lgkmcnt(5)
    v_mfma_f32_32x32x16_bf16 v[160:175], v[88:91], a[84:87], v[160:175]
    v_xor_b32 v19, 0x10070, v16
    ds_read_b128 v[80:83], v19 offset:0
    buffer_load_dwordx4 v9, s[52:55], s30 offen offset:1024 lds
    s_waitcnt lgkmcnt(5)
    v_mfma_f32_32x32x16_bf16 v[176:191], v[92:95], a[84:87], v[176:191]
    ds_read_b128 v[84:87], v19 offset:4096
    s_waitcnt vmcnt(31) lgkmcnt(5)
    v_mfma_f32_32x32x16_bf16 v[128:143], v[64:67], a[88:91], v[128:143]
    ds_read_b128 v[88:91], v19 offset:8192
    buffer_load_dwordx4 a[152:155], v36, s[40:43], s31 offen offset:2048 sc1
    s_waitcnt lgkmcnt(5)
    v_mfma_f32_32x32x16_bf16 v[144:159], v[68:71], a[88:91], v[144:159]
    ds_read_b128 v[92:95], v19 offset:12288
    s_waitcnt vmcnt(29)
    s_barrier
    s_waitcnt lgkmcnt(5)
    v_mfma_f32_32x32x16_bf16 v[160:175], v[72:75], a[88:91], v[160:175]
    v_xor_b32 v18, 0x18000, v16
    ds_read_b128 v[64:67], v18 offset:0
    buffer_load_dwordx4 v10, s[52:55], s30 offen offset:2048 lds
    s_waitcnt lgkmcnt(5)
    v_mfma_f32_32x32x16_bf16 v[176:191], v[76:79], a[88:91], v[176:191]
    ds_read_b128 v[68:71], v18 offset:4096
    s_waitcnt vmcnt(31) lgkmcnt(5)
    v_mfma_f32_32x32x16_bf16 v[128:143], v[80:83], a[92:95], v[128:143]
    ds_read_b128 v[72:75], v18 offset:8192
    buffer_load_dwordx4 a[156:159], v36, s[40:43], s31 offen offset:3072 sc1
    s_waitcnt lgkmcnt(5)
    v_mfma_f32_32x32x16_bf16 v[144:159], v[84:87], a[92:95], v[144:159]
    ds_read_b128 v[76:79], v18 offset:12288
    s_waitcnt lgkmcnt(5)
    v_mfma_f32_32x32x16_bf16 v[160:175], v[88:91], a[92:95], v[160:175]
    v_xor_b32 v19, 0x18010, v16
    ds_read_b128 v[80:83], v19 offset:0
    buffer_load_dwordx4 v11, s[52:55], s30 offen offset:3072 lds
    s_waitcnt lgkmcnt(5)
    v_mfma_f32_32x32x16_bf16 v[176:191], v[92:95], a[92:95], v[176:191]
    ds_read_b128 v[84:87], v19 offset:4096
    s_waitcnt vmcnt(31) lgkmcnt(5)
    v_mfma_f32_32x32x16_bf16 v[128:143], v[64:67], a[96:99], v[128:143]
    ds_read_b128 v[88:91], v19 offset:8192
    s_mov_b32 s31, 40960
    buffer_load_dwordx4 a[160:163], v36, s[40:43], s31 offen offset:0 sc1
    s_waitcnt lgkmcnt(5)
    v_mfma_f32_32x32x16_bf16 v[144:159], v[68:71], a[96:99], v[144:159]
    ds_read_b128 v[92:95], v19 offset:12288
    s_waitcnt lgkmcnt(5)
    v_mfma_f32_32x32x16_bf16 v[160:175], v[72:75], a[96:99], v[160:175]
    v_xor_b32 v18, 0x18020, v16
    ds_read_b128 v[64:67], v18 offset:0
    s_add_u32 m0, s28, 32768
    s_mov_b32 s30, 768
    buffer_load_dwordx4 v8, s[36:39], s30 offen offset:0 lds
    s_waitcnt lgkmcnt(5)
    v_mfma_f32_32x32x16_bf16 v[176:191], v[76:79], a[96:99], v[176:191]
    ds_read_b128 v[68:71], v18 offset:4096
    s_waitcnt vmcnt(31) lgkmcnt(5)
    v_mfma_f32_32x32x16_bf16 v[128:143], v[80:83], a[100:103], v[128:143]
    ds_read_b128 v[72:75], v18 offset:8192
    buffer_load_dwordx4 a[164:167], v36, s[40:43], s31 offen offset:1024 sc1
    s_waitcnt lgkmcnt(5)
    v_mfma_f32_32x32x16_bf16 v[144:159], v[84:87], a[100:103], v[144:159]
    ds_read_b128 v[76:79], v18 offset:12288
    s_waitcnt lgkmcnt(5)
    v_mfma_f32_32x32x16_bf16 v[160:175], v[88:91], a[100:103], v[160:175]
    v_xor_b32 v19, 0x18030, v16
    ds_read_b128 v[80:83], v19 offset:0
    buffer_load_dwordx4 v9, s[36:39], s30 offen offset:1024 lds
    s_waitcnt lgkmcnt(5)
    v_mfma_f32_32x32x16_bf16 v[176:191], v[92:95], a[100:103], v[176:191]
    ds_read_b128 v[84:87], v19 offset:4096
    s_waitcnt vmcnt(31) lgkmcnt(5)
    v_mfma_f32_32x32x16_bf16 v[128:143], v[64:67], a[104:107], v[128:143]
    ds_read_b128 v[88:91], v19 offset:8192
    buffer_load_dwordx4 a[168:171], v36, s[40:43], s31 offen offset:2048 sc1
    s_waitcnt lgkmcnt(5)
    v_mfma_f32_32x32x16_bf16 v[144:159], v[68:71], a[104:107], v[144:159]
    ds_read_b128 v[92:95], v19 offset:12288
    s_waitcnt lgkmcnt(5)
    v_mfma_f32_32x32x16_bf16 v[160:175], v[72:75], a[104:107], v[160:175]
    v_xor_b32 v18, 0x18040, v16
    ds_read_b128 v[64:67], v18 offset:0
    buffer_load_dwordx4 v10, s[36:39], s30 offen offset:2048 lds
    s_waitcnt lgkmcnt(5)
    v_mfma_f32_32x32x16_bf16 v[176:191], v[76:79], a[104:107], v[176:191]
    ds_read_b128 v[68:71], v18 offset:4096
    s_waitcnt vmcnt(31) lgkmcnt(5)
    v_mfma_f32_32x32x16_bf16 v[128:143], v[80:83], a[108:111], v[128:143]
    ds_read_b128 v[72:75], v18 offset:8192
    buffer_load_dwordx4 a[172:175], v36, s[40:43], s31 offen offset:3072 sc1
    s_waitcnt lgkmcnt(5)
    v_mfma_f32_32x32x16_bf16 v[144:159], v[84:87], a[108:111], v[144:159]
    ds_read_b128 v[76:79], v18 offset:12288
    s_waitcnt lgkmcnt(5)
    v_mfma_f32_32x32x16_bf16 v[160:175], v[88:91], a[108:111], v[160:175]
    v_xor_b32 v19, 0x18050, v16
    ds_read_b128 v[80:83], v19 offset:0
    buffer_load_dwordx4 v11, s[36:39], s30 offen offset:3072 lds
    s_waitcnt lgkmcnt(5)
    v_mfma_f32_32x32x16_bf16 v[176:191], v[92:95], a[108:111], v[176:191]
    ds_read_b128 v[84:87], v19 offset:4096
    s_waitcnt vmcnt(31) lgkmcnt(5)
    v_mfma_f32_32x32x16_bf16 v[128:143], v[64:67], a[112:115], v[128:143]
    ds_read_b128 v[88:91], v19 offset:8192
    s_mov_b32 s31, 45056
    buffer_load_dwordx4 a[176:179], v36, s[40:43], s31 offen offset:0 sc1
    s_waitcnt lgkmcnt(5)
    v_mfma_f32_32x32x16_bf16 v[144:159], v[68:71], a[112:115], v[144:159]
    ds_read_b128 v[92:95], v19 offset:12288
    s_waitcnt lgkmcnt(5)
    v_mfma_f32_32x32x16_bf16 v[160:175], v[72:75], a[112:115], v[160:175]
    v_xor_b32 v18, 0x18060, v16
    ds_read_b128 v[64:67], v18 offset:0
    s_add_u32 m0, s28, 49152
    s_mov_b32 s30, 768
    buffer_load_dwordx4 v8, s[52:55], s30 offen offset:0 lds
    s_waitcnt lgkmcnt(5)
    v_mfma_f32_32x32x16_bf16 v[176:191], v[76:79], a[112:115], v[176:191]
    ds_read_b128 v[68:71], v18 offset:4096
    s_waitcnt vmcnt(31) lgkmcnt(5)
    v_mfma_f32_32x32x16_bf16 v[128:143], v[80:83], a[116:119], v[128:143]
    ds_read_b128 v[72:75], v18 offset:8192
    buffer_load_dwordx4 a[180:183], v36, s[40:43], s31 offen offset:1024 sc1
    s_waitcnt lgkmcnt(5)
    v_mfma_f32_32x32x16_bf16 v[144:159], v[84:87], a[116:119], v[144:159]
    ds_read_b128 v[76:79], v18 offset:12288
    s_waitcnt lgkmcnt(5)
    v_mfma_f32_32x32x16_bf16 v[160:175], v[88:91], a[116:119], v[160:175]
    v_xor_b32 v19, 0x18070, v16
    ds_read_b128 v[80:83], v19 offset:0
    buffer_load_dwordx4 v9, s[52:55], s30 offen offset:1024 lds
    s_waitcnt lgkmcnt(5)
    v_mfma_f32_32x32x16_bf16 v[176:191], v[92:95], a[116:119], v[176:191]
    ds_read_b128 v[84:87], v19 offset:4096
    s_waitcnt vmcnt(31) lgkmcnt(5)
    v_mfma_f32_32x32x16_bf16 v[128:143], v[64:67], a[120:123], v[128:143]
    ds_read_b128 v[88:91], v19 offset:8192
    buffer_load_dwordx4 a[184:187], v36, s[40:43], s31 offen offset:2048 sc1
    s_waitcnt lgkmcnt(5)
    v_mfma_f32_32x32x16_bf16 v[144:159], v[68:71], a[120:123], v[144:159]
    ds_read_b128 v[92:95], v19 offset:12288
    s_waitcnt vmcnt(29)
    s_barrier
    s_waitcnt lgkmcnt(5)
    v_mfma_f32_32x32x16_bf16 v[160:175], v[72:75], a[120:123], v[160:175]
    v_xor_b32 v18, 0x20000, v16
    ds_read_b128 v[64:67], v18 offset:0
    buffer_load_dwordx4 v10, s[52:55], s30 offen offset:2048 lds
    s_waitcnt lgkmcnt(5)
    v_mfma_f32_32x32x16_bf16 v[176:191], v[76:79], a[120:123], v[176:191]
    ds_read_b128 v[68:71], v18 offset:4096
    s_waitcnt vmcnt(31) lgkmcnt(5)
    v_mfma_f32_32x32x16_bf16 v[128:143], v[80:83], a[124:127], v[128:143]
    ds_read_b128 v[72:75], v18 offset:8192
    buffer_load_dwordx4 a[188:191], v36, s[40:43], s31 offen offset:3072 sc1
    s_waitcnt lgkmcnt(5)
    v_mfma_f32_32x32x16_bf16 v[144:159], v[84:87], a[124:127], v[144:159]
    ds_read_b128 v[76:79], v18 offset:12288
    s_waitcnt lgkmcnt(5)
    v_mfma_f32_32x32x16_bf16 v[160:175], v[88:91], a[124:127], v[160:175]
    v_xor_b32 v19, 0x20010, v16
    ds_read_b128 v[80:83], v19 offset:0
    buffer_load_dwordx4 v11, s[52:55], s30 offen offset:3072 lds
    s_waitcnt lgkmcnt(5)
    v_mfma_f32_32x32x16_bf16 v[176:191], v[92:95], a[124:127], v[176:191]
    ds_read_b128 v[84:87], v19 offset:4096
    s_waitcnt vmcnt(31) lgkmcnt(5)
    v_mfma_f32_32x32x16_bf16 v[128:143], v[64:67], a[128:131], v[128:143]
    ds_read_b128 v[88:91], v19 offset:8192
    s_mov_b32 s31, 49152
    buffer_load_dwordx4 a[192:195], v36, s[40:43], s31 offen offset:0 sc1
    s_waitcnt lgkmcnt(5)
    v_mfma_f32_32x32x16_bf16 v[144:159], v[68:71], a[128:131], v[144:159]
    ds_read_b128 v[92:95], v19 offset:12288
    s_waitcnt lgkmcnt(5)
    v_mfma_f32_32x32x16_bf16 v[160:175], v[72:75], a[128:131], v[160:175]
    v_xor_b32 v18, 0x20020, v16
    ds_read_b128 v[64:67], v18 offset:0
    s_add_u32 m0, s28, 65536
    s_mov_b32 s30, 896
    buffer_load_dwordx4 v8, s[36:39], s30 offen offset:0 lds
    s_waitcnt lgkmcnt(5)
    v_mfma_f32_32x32x16_bf16 v[176:191], v[76:79], a[128:131], v[176:191]
    ds_read_b128 v[68:71], v18 offset:4096
    s_waitcnt vmcnt(31) lgkmcnt(5)
    v_mfma_f32_32x32x16_bf16 v[128:143], v[80:83], a[132:135], v[128:143]
    ds_read_b128 v[72:75], v18 offset:8192
    buffer_load_dwordx4 a[196:199], v36, s[40:43], s31 offen offset:1024 sc1
    s_waitcnt lgkmcnt(5)
    v_mfma_f32_32x32x16_bf16 v[144:159], v[84:87], a[132:135], v[144:159]
    ds_read_b128 v[76:79], v18 offset:12288
    s_waitcnt lgkmcnt(5)
    v_mfma_f32_32x32x16_bf16 v[160:175], v[88:91], a[132:135], v[160:175]
    v_xor_b32 v19, 0x20030, v16
    ds_read_b128 v[80:83], v19 offset:0
    buffer_load_dwordx4 v9, s[36:39], s30 offen offset:1024 lds
    s_waitcnt lgkmcnt(5)
    v_mfma_f32_32x32x16_bf16 v[176:191], v[92:95], a[132:135], v[176:191]
    ds_read_b128 v[84:87], v19 offset:4096
    s_waitcnt vmcnt(31) lgkmcnt(5)
    v_mfma_f32_32x32x16_bf16 v[128:143], v[64:67], a[136:139], v[128:143]
    ds_read_b128 v[88:91], v19 offset:8192
    buffer_load_dwordx4 a[200:203], v36, s[40:43], s31 offen offset:2048 sc1
    s_waitcnt lgkmcnt(5)
    v_mfma_f32_32x32x16_bf16 v[144:159], v[68:71], a[136:139], v[144:159]
    ds_read_b128 v[92:95], v19 offset:12288
    s_waitcnt lgkmcnt(5)
    v_mfma_f32_32x32x16_bf16 v[160:175], v[72:75], a[136:139], v[160:175]
    v_xor_b32 v18, 0x20040, v16
    ds_read_b128 v[64:67], v18 offset:0
    buffer_load_dwordx4 v10, s[36:39], s30 offen offset:2048 lds
    s_waitcnt lgkmcnt(5)
    v_mfma_f32_32x32x16_bf16 v[176:191], v[76:79], a[136:139], v[176:191]
    ds_read_b128 v[68:71], v18 offset:4096
    s_waitcnt vmcnt(31) lgkmcnt(5)
    v_mfma_f32_32x32x16_bf16 v[128:143], v[80:83], a[140:143], v[128:143]
    ds_read_b128 v[72:75], v18 offset:8192
    buffer_load_dwordx4 a[204:207], v36, s[40:43], s31 offen offset:3072 sc1
    s_waitcnt lgkmcnt(5)
    v_mfma_f32_32x32x16_bf16 v[144:159], v[84:87], a[140:143], v[144:159]
    ds_read_b128 v[76:79], v18 offset:12288
    s_waitcnt lgkmcnt(5)
    v_mfma_f32_32x32x16_bf16 v[160:175], v[88:91], a[140:143], v[160:175]
    v_xor_b32 v19, 0x20050, v16
    ds_read_b128 v[80:83], v19 offset:0
    buffer_load_dwordx4 v11, s[36:39], s30 offen offset:3072 lds
    s_waitcnt lgkmcnt(5)
    v_mfma_f32_32x32x16_bf16 v[176:191], v[92:95], a[140:143], v[176:191]
    ds_read_b128 v[84:87], v19 offset:4096
    s_waitcnt vmcnt(31) lgkmcnt(5)
    v_mfma_f32_32x32x16_bf16 v[128:143], v[64:67], a[144:147], v[128:143]
    ds_read_b128 v[88:91], v19 offset:8192
    s_mov_b32 s31, 53248
    buffer_load_dwordx4 a[208:211], v36, s[40:43], s31 offen offset:0 sc1
    s_waitcnt lgkmcnt(5)
    v_mfma_f32_32x32x16_bf16 v[144:159], v[68:71], a[144:147], v[144:159]
    ds_read_b128 v[92:95], v19 offset:12288
    s_waitcnt lgkmcnt(5)
    v_mfma_f32_32x32x16_bf16 v[160:175], v[72:75], a[144:147], v[160:175]
    v_xor_b32 v18, 0x20060, v16
    ds_read_b128 v[64:67], v18 offset:0
    s_add_u32 m0, s28, 81920
    s_mov_b32 s30, 896
    buffer_load_dwordx4 v8, s[52:55], s30 offen offset:0 lds
    s_waitcnt lgkmcnt(5)
    v_mfma_f32_32x32x16_bf16 v[176:191], v[76:79], a[144:147], v[176:191]
    ds_read_b128 v[68:71], v18 offset:4096
    s_waitcnt vmcnt(31) lgkmcnt(5)
    v_mfma_f32_32x32x16_bf16 v[128:143], v[80:83], a[148:151], v[128:143]
    ds_read_b128 v[72:75], v18 offset:8192
    buffer_load_dwordx4 a[212:215], v36, s[40:43], s31 offen offset:1024 sc1
    s_waitcnt lgkmcnt(5)
    v_mfma_f32_32x32x16_bf16 v[144:159], v[84:87], a[148:151], v[144:159]
    ds_read_b128 v[76:79], v18 offset:12288
    s_waitcnt lgkmcnt(5)
    v_mfma_f32_32x32x16_bf16 v[160:175], v[88:91], a[148:151], v[160:175]
    v_xor_b32 v19, 0x20070, v16
    ds_read_b128 v[80:83], v19 offset:0
    buffer_load_dwordx4 v9, s[52:55], s30 offen offset:1024 lds
    s_waitcnt lgkmcnt(5)
    v_mfma_f32_32x32x16_bf16 v[176:191], v[92:95], a[148:151], v[176:191]
    ds_read_b128 v[84:87], v19 offset:4096
    s_waitcnt vmcnt(31) lgkmcnt(5)
    v_mfma_f32_32x32x16_bf16 v[128:143], v[64:67], a[152:155], v[128:143]
    ds_read_b128 v[88:91], v19 offset:8192
    buffer_load_dwordx4 a[216:219], v36, s[40:43], s31 offen offset:2048 sc1
    s_waitcnt lgkmcnt(5)
    v_mfma_f32_32x32x16_bf16 v[144:159], v[68:71], a[152:155], v[144:159]
    ds_read_b128 v[92:95], v19 offset:12288
    s_waitcnt vmcnt(29)
    s_barrier
    s_waitcnt lgkmcnt(5)
    v_mfma_f32_32x32x16_bf16 v[160:175], v[72:75], a[152:155], v[160:175]
    v_xor_b32 v18, 0x0, v16
    ds_read_b128 v[64:67], v18 offset:0
    buffer_load_dwordx4 v10, s[52:55], s30 offen offset:2048 lds
    s_waitcnt lgkmcnt(5)
    v_mfma_f32_32x32x16_bf16 v[176:191], v[76:79], a[152:155], v[176:191]
    ds_read_b128 v[68:71], v18 offset:4096
    s_waitcnt vmcnt(31) lgkmcnt(5)
    v_mfma_f32_32x32x16_bf16 v[128:143], v[80:83], a[156:159], v[128:143]
    ds_read_b128 v[72:75], v18 offset:8192
    buffer_load_dwordx4 a[220:223], v36, s[40:43], s31 offen offset:3072 sc1
    s_waitcnt lgkmcnt(5)
    v_mfma_f32_32x32x16_bf16 v[144:159], v[84:87], a[156:159], v[144:159]
    ds_read_b128 v[76:79], v18 offset:12288
    s_waitcnt lgkmcnt(5)
    v_mfma_f32_32x32x16_bf16 v[160:175], v[88:91], a[156:159], v[160:175]
    v_xor_b32 v19, 0x10, v16
    ds_read_b128 v[80:83], v19 offset:0
    buffer_load_dwordx4 v11, s[52:55], s30 offen offset:3072 lds
    s_waitcnt lgkmcnt(5)
    v_mfma_f32_32x32x16_bf16 v[176:191], v[92:95], a[156:159], v[176:191]
    ds_read_b128 v[84:87], v19 offset:4096
    s_waitcnt vmcnt(31) lgkmcnt(5)
    v_mfma_f32_32x32x16_bf16 v[128:143], v[64:67], a[160:163], v[128:143]
    ds_read_b128 v[88:91], v19 offset:8192
    s_mov_b32 s31, 57344
    buffer_load_dwordx4 a[224:227], v36, s[40:43], s31 offen offset:0 sc1
    s_waitcnt lgkmcnt(5)
    v_mfma_f32_32x32x16_bf16 v[144:159], v[68:71], a[160:163], v[144:159]
    ds_read_b128 v[92:95], v19 offset:12288
    s_waitcnt lgkmcnt(5)
    v_mfma_f32_32x32x16_bf16 v[160:175], v[72:75], a[160:163], v[160:175]
    v_xor_b32 v18, 0x20, v16
    ds_read_b128 v[64:67], v18 offset:0
    s_add_u32 m0, s28, 98304
    s_mov_b32 s30, 1024
    buffer_load_dwordx4 v8, s[36:39], s30 offen offset:0 lds
    s_waitcnt lgkmcnt(5)
    v_mfma_f32_32x32x16_bf16 v[176:191], v[76:79], a[160:163], v[176:191]
    ds_read_b128 v[68:71], v18 offset:4096
    s_waitcnt vmcnt(31) lgkmcnt(5)
    v_mfma_f32_32x32x16_bf16 v[128:143], v[80:83], a[164:167], v[128:143]
    ds_read_b128 v[72:75], v18 offset:8192
    buffer_load_dwordx4 a[228:231], v36, s[40:43], s31 offen offset:1024 sc1
    s_waitcnt lgkmcnt(5)
    v_mfma_f32_32x32x16_bf16 v[144:159], v[84:87], a[164:167], v[144:159]
    ds_read_b128 v[76:79], v18 offset:12288
    s_waitcnt lgkmcnt(5)
    v_mfma_f32_32x32x16_bf16 v[160:175], v[88:91], a[164:167], v[160:175]
    v_xor_b32 v19, 0x30, v16
    ds_read_b128 v[80:83], v19 offset:0
    buffer_load_dwordx4 v9, s[36:39], s30 offen offset:1024 lds
    s_waitcnt lgkmcnt(5)
    v_mfma_f32_32x32x16_bf16 v[176:191], v[92:95], a[164:167], v[176:191]
    ds_read_b128 v[84:87], v19 offset:4096
    s_waitcnt vmcnt(31) lgkmcnt(5)
    v_mfma_f32_32x32x16_bf16 v[128:143], v[64:67], a[168:171], v[128:143]
    ds_read_b128 v[88:91], v19 offset:8192
    buffer_load_dwordx4 a[232:235], v36, s[40:43], s31 offen offset:2048 sc1
    s_waitcnt lgkmcnt(5)
    v_mfma_f32_32x32x16_bf16 v[144:159], v[68:71], a[168:171], v[144:159]
    ds_read_b128 v[92:95], v19 offset:12288
    s_waitcnt lgkmcnt(5)
    v_mfma_f32_32x32x16_bf16 v[160:175], v[72:75], a[168:171], v[160:175]
    v_xor_b32 v18, 0x40, v16
    ds_read_b128 v[64:67], v18 offset:0
    buffer_load_dwordx4 v10, s[36:39], s30 offen offset:2048 lds
    s_waitcnt lgkmcnt(5)
    v_mfma_f32_32x32x16_bf16 v[176:191], v[76:79], a[168:171], v[176:191]
    ds_read_b128 v[68:71], v18 offset:4096
    s_waitcnt vmcnt(31) lgkmcnt(5)
    v_mfma_f32_32x32x16_bf16 v[128:143], v[80:83], a[172:175], v[128:143]
    ds_read_b128 v[72:75], v18 offset:8192
    buffer_load_dwordx4 a[236:239], v36, s[40:43], s31 offen offset:3072 sc1
    s_waitcnt lgkmcnt(5)
    v_mfma_f32_32x32x16_bf16 v[144:159], v[84:87], a[172:175], v[144:159]
    ds_read_b128 v[76:79], v18 offset:12288
    s_waitcnt lgkmcnt(5)
    v_mfma_f32_32x32x16_bf16 v[160:175], v[88:91], a[172:175], v[160:175]
    v_xor_b32 v19, 0x50, v16
    ds_read_b128 v[80:83], v19 offset:0
    buffer_load_dwordx4 v11, s[36:39], s30 offen offset:3072 lds
    s_waitcnt lgkmcnt(5)
    v_mfma_f32_32x32x16_bf16 v[176:191], v[92:95], a[172:175], v[176:191]
    ds_read_b128 v[84:87], v19 offset:4096
    s_waitcnt vmcnt(31) lgkmcnt(5)
    v_mfma_f32_32x32x16_bf16 v[128:143], v[64:67], a[176:179], v[128:143]
    ds_read_b128 v[88:91], v19 offset:8192
    s_mov_b32 s31, 61440
    buffer_load_dwordx4 a[240:243], v36, s[40:43], s31 offen offset:0 sc1
    s_waitcnt lgkmcnt(5)
    v_mfma_f32_32x32x16_bf16 v[144:159], v[68:71], a[176:179], v[144:159]
    ds_read_b128 v[92:95], v19 offset:12288
    s_waitcnt lgkmcnt(5)
    v_mfma_f32_32x32x16_bf16 v[160:175], v[72:75], a[176:179], v[160:175]
    v_xor_b32 v18, 0x60, v16
    ds_read_b128 v[64:67], v18 offset:0
    s_add_u32 m0, s28, 114688
    s_mov_b32 s30, 1024
    buffer_load_dwordx4 v8, s[52:55], s30 offen offset:0 lds
    s_waitcnt lgkmcnt(5)
    v_mfma_f32_32x32x16_bf16 v[176:191], v[76:79], a[176:179], v[176:191]
    ds_read_b128 v[68:71], v18 offset:4096
    s_waitcnt vmcnt(31) lgkmcnt(5)
    v_mfma_f32_32x32x16_bf16 v[128:143], v[80:83], a[180:183], v[128:143]
    ds_read_b128 v[72:75], v18 offset:8192
    buffer_load_dwordx4 a[244:247], v36, s[40:43], s31 offen offset:1024 sc1
    s_waitcnt lgkmcnt(5)
    v_mfma_f32_32x32x16_bf16 v[144:159], v[84:87], a[180:183], v[144:159]
    ds_read_b128 v[76:79], v18 offset:12288
    s_waitcnt lgkmcnt(5)
    v_mfma_f32_32x32x16_bf16 v[160:175], v[88:91], a[180:183], v[160:175]
    v_xor_b32 v19, 0x70, v16
    ds_read_b128 v[80:83], v19 offset:0
    buffer_load_dwordx4 v9, s[52:55], s30 offen offset:1024 lds
    s_waitcnt lgkmcnt(5)
    v_mfma_f32_32x32x16_bf16 v[176:191], v[92:95], a[180:183], v[176:191]
    ds_read_b128 v[84:87], v19 offset:4096
    s_waitcnt vmcnt(31) lgkmcnt(5)
    v_mfma_f32_32x32x16_bf16 v[128:143], v[64:67], a[184:187], v[128:143]
    ds_read_b128 v[88:91], v19 offset:8192
    buffer_load_dwordx4 a[248:251], v36, s[40:43], s31 offen offset:2048 sc1
    s_waitcnt lgkmcnt(5)
    v_mfma_f32_32x32x16_bf16 v[144:159], v[68:71], a[184:187], v[144:159]
    ds_read_b128 v[92:95], v19 offset:12288
    s_waitcnt vmcnt(29)
    s_barrier
    s_waitcnt lgkmcnt(5)
    v_mfma_f32_32x32x16_bf16 v[160:175], v[72:75], a[184:187], v[160:175]
    v_xor_b32 v18, 0x8000, v16
    ds_read_b128 v[64:67], v18 offset:0
    buffer_load_dwordx4 v10, s[52:55], s30 offen offset:2048 lds
    s_waitcnt lgkmcnt(5)
    v_mfma_f32_32x32x16_bf16 v[176:191], v[76:79], a[184:187], v[176:191]
    ds_read_b128 v[68:71], v18 offset:4096
    s_waitcnt vmcnt(31) lgkmcnt(5)
    v_mfma_f32_32x32x16_bf16 v[128:143], v[80:83], a[188:191], v[128:143]
    ds_read_b128 v[72:75], v18 offset:8192
    buffer_load_dwordx4 a[252:255], v36, s[40:43], s31 offen offset:3072 sc1
    s_waitcnt lgkmcnt(5)
    v_mfma_f32_32x32x16_bf16 v[144:159], v[84:87], a[188:191], v[144:159]
    ds_read_b128 v[76:79], v18 offset:12288
    s_waitcnt lgkmcnt(5)
    v_mfma_f32_32x32x16_bf16 v[160:175], v[88:91], a[188:191], v[160:175]
    v_xor_b32 v19, 0x8010, v16
    ds_read_b128 v[80:83], v19 offset:0
    buffer_load_dwordx4 v11, s[52:55], s30 offen offset:3072 lds
    s_waitcnt lgkmcnt(5)
    v_mfma_f32_32x32x16_bf16 v[176:191], v[92:95], a[188:191], v[176:191]
    ds_read_b128 v[84:87], v19 offset:4096
    s_waitcnt vmcnt(31) lgkmcnt(5)
    v_mfma_f32_32x32x16_bf16 v[128:143], v[64:67], a[192:195], v[128:143]
    ds_read_b128 v[88:91], v19 offset:8192
    s_mov_b32 s31, 65536
    buffer_load_dwordx4 v[224:227], v36, s[40:43], s31 offen offset:0 sc1
    s_waitcnt lgkmcnt(5)
    v_mfma_f32_32x32x16_bf16 v[144:159], v[68:71], a[192:195], v[144:159]
    ds_read_b128 v[92:95], v19 offset:12288
    s_waitcnt lgkmcnt(5)
    v_mfma_f32_32x32x16_bf16 v[160:175], v[72:75], a[192:195], v[160:175]
    v_xor_b32 v18, 0x8020, v16
    ds_read_b128 v[64:67], v18 offset:0
    s_add_u32 m0, s28, 131072
    s_mov_b32 s30, 0
    buffer_load_dwordx4 v12, s[56:59], s30 offen offset:0 lds
    s_waitcnt lgkmcnt(5)
    v_mfma_f32_32x32x16_bf16 v[176:191], v[76:79], a[192:195], v[176:191]
    ds_read_b128 v[68:71], v18 offset:4096
    s_waitcnt vmcnt(31) lgkmcnt(5)
    v_mfma_f32_32x32x16_bf16 v[128:143], v[80:83], a[196:199], v[128:143]
    ds_read_b128 v[72:75], v18 offset:8192
    buffer_load_dwordx4 v[228:231], v36, s[40:43], s31 offen offset:1024 sc1
    s_waitcnt lgkmcnt(5)
    v_mfma_f32_32x32x16_bf16 v[144:159], v[84:87], a[196:199], v[144:159]
    ds_read_b128 v[76:79], v18 offset:12288
    s_waitcnt lgkmcnt(5)
    v_mfma_f32_32x32x16_bf16 v[160:175], v[88:91], a[196:199], v[160:175]
    v_xor_b32 v19, 0x8030, v16
    ds_read_b128 v[80:83], v19 offset:0
    buffer_load_dwordx4 v13, s[56:59], s30 offen offset:1024 lds
    s_waitcnt lgkmcnt(5)
    v_mfma_f32_32x32x16_bf16 v[176:191], v[92:95], a[196:199], v[176:191]
    ds_read_b128 v[84:87], v19 offset:4096
    s_waitcnt vmcnt(31) lgkmcnt(5)
    v_mfma_f32_32x32x16_bf16 v[128:143], v[64:67], a[200:203], v[128:143]
    ds_read_b128 v[88:91], v19 offset:8192
    buffer_load_dwordx4 v[232:235], v36, s[40:43], s31 offen offset:2048 sc1
    s_waitcnt lgkmcnt(5)
    v_mfma_f32_32x32x16_bf16 v[144:159], v[68:71], a[200:203], v[144:159]
    ds_read_b128 v[92:95], v19 offset:12288
    s_waitcnt lgkmcnt(5)
    v_mfma_f32_32x32x16_bf16 v[160:175], v[72:75], a[200:203], v[160:175]
    v_xor_b32 v18, 0x8040, v16
    ds_read_b128 v[64:67], v18 offset:0
    buffer_load_dwordx4 v14, s[56:59], s30 offen offset:2048 lds
    s_waitcnt lgkmcnt(5)
    v_mfma_f32_32x32x16_bf16 v[176:191], v[76:79], a[200:203], v[176:191]
    ds_read_b128 v[68:71], v18 offset:4096
    s_waitcnt vmcnt(31) lgkmcnt(5)
    v_mfma_f32_32x32x16_bf16 v[128:143], v[80:83], a[204:207], v[128:143]
    ds_read_b128 v[72:75], v18 offset:8192
    buffer_load_dwordx4 v[236:239], v36, s[40:43], s31 offen offset:3072 sc1
    s_waitcnt lgkmcnt(5)
    v_mfma_f32_32x32x16_bf16 v[144:159], v[84:87], a[204:207], v[144:159]
    ds_read_b128 v[76:79], v18 offset:12288
    s_waitcnt lgkmcnt(5)
    v_mfma_f32_32x32x16_bf16 v[160:175], v[88:91], a[204:207], v[160:175]
    v_xor_b32 v19, 0x8050, v16
    ds_read_b128 v[80:83], v19 offset:0
    buffer_load_dwordx4 v15, s[56:59], s30 offen offset:3072 lds
    s_waitcnt lgkmcnt(5)
    v_mfma_f32_32x32x16_bf16 v[176:191], v[92:95], a[204:207], v[176:191]
    ds_read_b128 v[84:87], v19 offset:4096
    s_waitcnt vmcnt(31) lgkmcnt(5)
    v_mfma_f32_32x32x16_bf16 v[128:143], v[64:67], a[208:211], v[128:143]
    ds_read_b128 v[88:91], v19 offset:8192
    s_mov_b32 s31, 69632
    buffer_load_dwordx4 v[240:243], v36, s[40:43], s31 offen offset:0 sc1
    s_waitcnt lgkmcnt(5)
    v_mfma_f32_32x32x16_bf16 v[144:159], v[68:71], a[208:211], v[144:159]
    ds_read_b128 v[92:95], v19 offset:12288
    s_waitcnt lgkmcnt(5)
    v_mfma_f32_32x32x16_bf16 v[160:175], v[72:75], a[208:211], v[160:175]
    v_xor_b32 v18, 0x8060, v16
    ds_read_b128 v[64:67], v18 offset:0
    s_add_u32 m0, s28, 147456
    s_mov_b32 s30, 128
    buffer_load_dwordx4 v12, s[56:59], s30 offen offset:0 lds
    s_waitcnt lgkmcnt(5)
    v_mfma_f32_32x32x16_bf16 v[176:191], v[76:79], a[208:211], v[176:191]
    ds_read_b128 v[68:71], v18 offset:4096
    s_waitcnt vmcnt(31) lgkmcnt(5)
    v_mfma_f32_32x32x16_bf16 v[128:143], v[80:83], a[212:215], v[128:143]
    ds_read_b128 v[72:75], v18 offset:8192
    buffer_load_dwordx4 v[244:247], v36, s[40:43], s31 offen offset:1024 sc1
    s_waitcnt lgkmcnt(5)
    v_mfma_f32_32x32x16_bf16 v[144:159], v[84:87], a[212:215], v[144:159]
    ds_read_b128 v[76:79], v18 offset:12288
    s_waitcnt lgkmcnt(5)
    v_mfma_f32_32x32x16_bf16 v[160:175], v[88:91], a[212:215], v[160:175]
    v_xor_b32 v19, 0x8070, v16
    ds_read_b128 v[80:83], v19 offset:0
    buffer_load_dwordx4 v13, s[56:59], s30 offen offset:1024 lds
    s_waitcnt lgkmcnt(5)
    v_mfma_f32_32x32x16_bf16 v[176:191], v[92:95], a[212:215], v[176:191]
    ds_read_b128 v[84:87], v19 offset:4096
    s_waitcnt vmcnt(31) lgkmcnt(5)
    v_mfma_f32_32x32x16_bf16 v[128:143], v[64:67], a[216:219], v[128:143]
    ds_read_b128 v[88:91], v19 offset:8192
    buffer_load_dwordx4 v[248:251], v36, s[40:43], s31 offen offset:2048 sc1
    s_waitcnt lgkmcnt(5)
    v_mfma_f32_32x32x16_bf16 v[144:159], v[68:71], a[216:219], v[144:159]
    ds_read_b128 v[92:95], v19 offset:12288
    s_waitcnt vmcnt(29)
    s_barrier
    s_waitcnt lgkmcnt(5)
    v_mfma_f32_32x32x16_bf16 v[160:175], v[72:75], a[216:219], v[160:175]
    v_xor_b32 v18, 0x10000, v16
    ds_read_b128 v[64:67], v18 offset:0
    buffer_load_dwordx4 v14, s[56:59], s30 offen offset:2048 lds
    s_waitcnt lgkmcnt(5)
    v_mfma_f32_32x32x16_bf16 v[176:191], v[76:79], a[216:219], v[176:191]
    ds_read_b128 v[68:71], v18 offset:4096
    s_waitcnt vmcnt(31) lgkmcnt(5)
    v_mfma_f32_32x32x16_bf16 v[128:143], v[80:83], a[220:223], v[128:143]
    ds_read_b128 v[72:75], v18 offset:8192
    buffer_load_dwordx4 v[252:255], v36, s[40:43], s31 offen offset:3072 sc1
    s_waitcnt lgkmcnt(5)
    v_mfma_f32_32x32x16_bf16 v[144:159], v[84:87], a[220:223], v[144:159]
    ds_read_b128 v[76:79], v18 offset:12288
    s_waitcnt lgkmcnt(5)
    v_mfma_f32_32x32x16_bf16 v[160:175], v[88:91], a[220:223], v[160:175]
    v_xor_b32 v19, 0x10010, v16
    ds_read_b128 v[80:83], v19 offset:0
    buffer_load_dwordx4 v15, s[56:59], s30 offen offset:3072 lds
    s_waitcnt lgkmcnt(5)
    v_mfma_f32_32x32x16_bf16 v[176:191], v[92:95], a[220:223], v[176:191]
    ds_read_b128 v[84:87], v19 offset:4096
    s_waitcnt vmcnt(31) lgkmcnt(5)
    v_mfma_f32_32x32x16_bf16 v[128:143], v[64:67], a[224:227], v[128:143]
    ds_read_b128 v[88:91], v19 offset:8192
    s_add_u32 m0, s28, 0
    s_mov_b32 s30, 256
    buffer_load_dwordx4 v12, s[56:59], s30 offen offset:0 lds
    s_waitcnt lgkmcnt(5)
    v_mfma_f32_32x32x16_bf16 v[144:159], v[68:71], a[224:227], v[144:159]
    ds_read_b128 v[92:95], v19 offset:12288
    s_waitcnt lgkmcnt(5)
    v_mfma_f32_32x32x16_bf16 v[160:175], v[72:75], a[224:227], v[160:175]
    v_xor_b32 v18, 0x10020, v16
    ds_read_b128 v[64:67], v18 offset:0
    buffer_load_dwordx4 v13, s[56:59], s30 offen offset:1024 lds
    s_waitcnt lgkmcnt(5)
    v_mfma_f32_32x32x16_bf16 v[176:191], v[76:79], a[224:227], v[176:191]
    ds_read_b128 v[68:71], v18 offset:4096
    s_waitcnt vmcnt(31) lgkmcnt(5)
    v_mfma_f32_32x32x16_bf16 v[128:143], v[80:83], a[228:231], v[128:143]
    ds_read_b128 v[72:75], v18 offset:8192
    buffer_load_dwordx4 v14, s[56:59], s30 offen offset:2048 lds
    s_waitcnt lgkmcnt(5)
    v_mfma_f32_32x32x16_bf16 v[144:159], v[84:87], a[228:231], v[144:159]
    ds_read_b128 v[76:79], v18 offset:12288
    s_waitcnt lgkmcnt(5)
    v_mfma_f32_32x32x16_bf16 v[160:175], v[88:91], a[228:231], v[160:175]
    v_xor_b32 v19, 0x10030, v16
    ds_read_b128 v[80:83], v19 offset:0
    buffer_load_dwordx4 v15, s[56:59], s30 offen offset:3072 lds
    s_waitcnt lgkmcnt(5)
    v_mfma_f32_32x32x16_bf16 v[176:191], v[92:95], a[228:231], v[176:191]
    ds_read_b128 v[84:87], v19 offset:4096
    s_waitcnt vmcnt(31) lgkmcnt(5)
    v_mfma_f32_32x32x16_bf16 v[128:143], v[64:67], a[232:235], v[128:143]
    ds_read_b128 v[88:91], v19 offset:8192
    s_add_u32 m0, s28, 16384
    s_mov_b32 s30, 384
    buffer_load_dwordx4 v12, s[56:59], s30 offen offset:0 lds
    s_waitcnt lgkmcnt(5)
    v_mfma_f32_32x32x16_bf16 v[144:159], v[68:71], a[232:235], v[144:159]
    ds_read_b128 v[92:95], v19 offset:12288
    s_waitcnt lgkmcnt(5)
    v_mfma_f32_32x32x16_bf16 v[160:175], v[72:75], a[232:235], v[160:175]
    v_xor_b32 v18, 0x10040, v16
    ds_read_b128 v[64:67], v18 offset:0
    buffer_load_dwordx4 v13, s[56:59], s30 offen offset:1024 lds
    s_waitcnt lgkmcnt(5)
    v_mfma_f32_32x32x16_bf16 v[176:191], v[76:79], a[232:235], v[176:191]
    ds_read_b128 v[68:71], v18 offset:4096
    s_waitcnt vmcnt(31) lgkmcnt(5)
    v_mfma_f32_32x32x16_bf16 v[128:143], v[80:83], a[236:239], v[128:143]
    ds_read_b128 v[72:75], v18 offset:8192
    buffer_load_dwordx4 v14, s[56:59], s30 offen offset:2048 lds
    s_waitcnt lgkmcnt(5)
    v_mfma_f32_32x32x16_bf16 v[144:159], v[84:87], a[236:239], v[144:159]
    ds_read_b128 v[76:79], v18 offset:12288
    s_waitcnt lgkmcnt(5)
    v_mfma_f32_32x32x16_bf16 v[160:175], v[88:91], a[236:239], v[160:175]
    v_xor_b32 v19, 0x10050, v16
    ds_read_b128 v[80:83], v19 offset:0
    buffer_load_dwordx4 v15, s[56:59], s30 offen offset:3072 lds
    s_waitcnt lgkmcnt(5)
    v_mfma_f32_32x32x16_bf16 v[176:191], v[92:95], a[236:239], v[176:191]
    ds_read_b128 v[84:87], v19 offset:4096
    s_waitcnt vmcnt(31) lgkmcnt(5)
    v_mfma_f32_32x32x16_bf16 v[128:143], v[64:67], a[240:243], v[128:143]
    ds_read_b128 v[88:91], v19 offset:8192
    s_add_u32 m0, s28, 32768
    s_mov_b32 s30, 512
    buffer_load_dwordx4 v12, s[56:59], s30 offen offset:0 lds
    s_waitcnt lgkmcnt(5)
    v_mfma_f32_32x32x16_bf16 v[144:159], v[68:71], a[240:243], v[144:159]
    ds_read_b128 v[92:95], v19 offset:12288
    s_waitcnt lgkmcnt(5)
    v_mfma_f32_32x32x16_bf16 v[160:175], v[72:75], a[240:243], v[160:175]
    v_xor_b32 v18, 0x10060, v16
    ds_read_b128 v[64:67], v18 offset:0
    buffer_load_dwordx4 v13, s[56:59], s30 offen offset:1024 lds
    s_waitcnt lgkmcnt(5)
    v_mfma_f32_32x32x16_bf16 v[176:191], v[76:79], a[240:243], v[176:191]
    ds_read_b128 v[68:71], v18 offset:4096
    s_waitcnt vmcnt(31) lgkmcnt(5)
    v_mfma_f32_32x32x16_bf16 v[128:143], v[80:83], a[244:247], v[128:143]
    ds_read_b128 v[72:75], v18 offset:8192
    buffer_load_dwordx4 v14, s[56:59], s30 offen offset:2048 lds
    s_waitcnt lgkmcnt(5)
    v_mfma_f32_32x32x16_bf16 v[144:159], v[84:87], a[244:247], v[144:159]
    ds_read_b128 v[76:79], v18 offset:12288
    s_waitcnt lgkmcnt(5)
    v_mfma_f32_32x32x16_bf16 v[160:175], v[88:91], a[244:247], v[160:175]
    v_xor_b32 v19, 0x10070, v16
    ds_read_b128 v[80:83], v19 offset:0
    buffer_load_dwordx4 v15, s[56:59], s30 offen offset:3072 lds
    s_waitcnt lgkmcnt(5)
    v_mfma_f32_32x32x16_bf16 v[176:191], v[92:95], a[244:247], v[176:191]
    ds_read_b128 v[84:87], v19 offset:4096
    s_waitcnt vmcnt(31) lgkmcnt(5)
    v_mfma_f32_32x32x16_bf16 v[128:143], v[64:67], a[248:251], v[128:143]
    ds_read_b128 v[88:91], v19 offset:8192
    s_add_u32 m0, s28, 49152
    s_mov_b32 s30, 640
    buffer_load_dwordx4 v12, s[56:59], s30 offen offset:0 lds
    s_waitcnt lgkmcnt(5)
    v_mfma_f32_32x32x16_bf16 v[144:159], v[68:71], a[248:251], v[144:159]
    ds_read_b128 v[92:95], v19 offset:12288
    s_waitcnt vmcnt(29)
    s_barrier
    s_waitcnt lgkmcnt(5)
    v_mfma_f32_32x32x16_bf16 v[160:175], v[72:75], a[248:251], v[160:175]
    v_xor_b32 v18, 0x18000, v16
    ds_read_b128 v[64:67], v18 offset:0
    buffer_load_dwordx4 v13, s[56:59], s30 offen offset:1024 lds
    s_waitcnt lgkmcnt(5)
    v_mfma_f32_32x32x16_bf16 v[176:191], v[76:79], a[248:251], v[176:191]
    ds_read_b128 v[68:71], v18 offset:4096
    s_waitcnt vmcnt(31) lgkmcnt(5)
    v_mfma_f32_32x32x16_bf16 v[128:143], v[80:83], a[252:255], v[128:143]
    ds_read_b128 v[72:75], v18 offset:8192
    buffer_load_dwordx4 v14, s[56:59], s30 offen offset:2048 lds
    s_waitcnt lgkmcnt(5)
    v_mfma_f32_32x32x16_bf16 v[144:159], v[84:87], a[252:255], v[144:159]
    ds_read_b128 v[76:79], v18 offset:12288
    s_waitcnt lgkmcnt(5)
    v_mfma_f32_32x32x16_bf16 v[160:175], v[88:91], a[252:255], v[160:175]
    v_xor_b32 v19, 0x18010, v16
    ds_read_b128 v[80:83], v19 offset:0
    buffer_load_dwordx4 v15, s[56:59], s30 offen offset:3072 lds
    s_waitcnt lgkmcnt(5)
    v_mfma_f32_32x32x16_bf16 v[176:191], v[92:95], a[252:255], v[176:191]
    ds_read_b128 v[84:87], v19 offset:4096
    s_waitcnt vmcnt(31) lgkmcnt(5)
    v_mfma_f32_32x32x16_bf16 v[128:143], v[64:67], v[224:227], v[128:143]
    ds_read_b128 v[88:91], v19 offset:8192
    s_add_u32 m0, s28, 65536
    s_mov_b32 s30, 768
    buffer_load_dwordx4 v12, s[56:59], s30 offen offset:0 lds
    s_waitcnt lgkmcnt(5)
    v_mfma_f32_32x32x16_bf16 v[144:159], v[68:71], v[224:227], v[144:159]
    ds_read_b128 v[92:95], v19 offset:12288
    s_waitcnt lgkmcnt(5)
    v_mfma_f32_32x32x16_bf16 v[160:175], v[72:75], v[224:227], v[160:175]
    v_xor_b32 v18, 0x18020, v16
    ds_read_b128 v[64:67], v18 offset:0
    buffer_load_dwordx4 v13, s[56:59], s30 offen offset:1024 lds
    s_waitcnt lgkmcnt(5)
    v_mfma_f32_32x32x16_bf16 v[176:191], v[76:79], v[224:227], v[176:191]
    ds_read_b128 v[68:71], v18 offset:4096
    s_waitcnt vmcnt(31) lgkmcnt(5)
    v_mfma_f32_32x32x16_bf16 v[128:143], v[80:83], v[228:231], v[128:143]
    ds_read_b128 v[72:75], v18 offset:8192
    buffer_load_dwordx4 v14, s[56:59], s30 offen offset:2048 lds
    s_waitcnt lgkmcnt(5)
    v_mfma_f32_32x32x16_bf16 v[144:159], v[84:87], v[228:231], v[144:159]
    ds_read_b128 v[76:79], v18 offset:12288
    s_waitcnt lgkmcnt(5)
    v_mfma_f32_32x32x16_bf16 v[160:175], v[88:91], v[228:231], v[160:175]
    v_xor_b32 v19, 0x18030, v16
    ds_read_b128 v[80:83], v19 offset:0
    buffer_load_dwordx4 v15, s[56:59], s30 offen offset:3072 lds
    s_waitcnt lgkmcnt(5)
    v_mfma_f32_32x32x16_bf16 v[176:191], v[92:95], v[228:231], v[176:191]
    ds_read_b128 v[84:87], v19 offset:4096
    s_waitcnt vmcnt(31) lgkmcnt(5)
    v_mfma_f32_32x32x16_bf16 v[128:143], v[64:67], v[232:235], v[128:143]
    ds_read_b128 v[88:91], v19 offset:8192
    s_add_u32 m0, s28, 81920
    s_mov_b32 s30, 896
    buffer_load_dwordx4 v12, s[56:59], s30 offen offset:0 lds
    s_waitcnt lgkmcnt(5)
    v_mfma_f32_32x32x16_bf16 v[144:159], v[68:71], v[232:235], v[144:159]
    ds_read_b128 v[92:95], v19 offset:12288
    s_waitcnt lgkmcnt(5)
    v_mfma_f32_32x32x16_bf16 v[160:175], v[72:75], v[232:235], v[160:175]
    v_xor_b32 v18, 0x18040, v16
    ds_read_b128 v[64:67], v18 offset:0
    buffer_load_dwordx4 v13, s[56:59], s30 offen offset:1024 lds
    s_waitcnt lgkmcnt(5)
    v_mfma_f32_32x32x16_bf16 v[176:191], v[76:79], v[232:235], v[176:191]
    ds_read_b128 v[68:71], v18 offset:4096
    s_waitcnt vmcnt(31) lgkmcnt(5)
    v_mfma_f32_32x32x16_bf16 v[128:143], v[80:83], v[236:239], v[128:143]
    ds_read_b128 v[72:75], v18 offset:8192
    buffer_load_dwordx4 v14, s[56:59], s30 offen offset:2048 lds
    s_waitcnt lgkmcnt(5)
    v_mfma_f32_32x32x16_bf16 v[144:159], v[84:87], v[236:239], v[144:159]
    ds_read_b128 v[76:79], v18 offset:12288
    s_waitcnt lgkmcnt(5)
    v_mfma_f32_32x32x16_bf16 v[160:175], v[88:91], v[236:239], v[160:175]
    v_xor_b32 v19, 0x18050, v16
    ds_read_b128 v[80:83], v19 offset:0
    buffer_load_dwordx4 v15, s[56:59], s30 offen offset:3072 lds
    s_waitcnt lgkmcnt(5)
    v_mfma_f32_32x32x16_bf16 v[176:191], v[92:95], v[236:239], v[176:191]
    ds_read_b128 v[84:87], v19 offset:4096
    s_waitcnt vmcnt(31) lgkmcnt(5)
    v_mfma_f32_32x32x16_bf16 v[128:143], v[64:67], v[240:243], v[128:143]
    ds_read_b128 v[88:91], v19 offset:8192
    s_waitcnt lgkmcnt(5)
    v_mfma_f32_32x32x16_bf16 v[144:159], v[68:71], v[240:243], v[144:159]
    ds_read_b128 v[92:95], v19 offset:12288
    s_waitcnt lgkmcnt(5)
    v_mfma_f32_32x32x16_bf16 v[160:175], v[72:75], v[240:243], v[160:175]
    v_xor_b32 v18, 0x18060, v16
    ds_read_b128 v[64:67], v18 offset:0
    s_waitcnt lgkmcnt(5)
    v_mfma_f32_32x32x16_bf16 v[176:191], v[76:79], v[240:243], v[176:191]
    ds_read_b128 v[68:71], v18 offset:4096
    s_waitcnt vmcnt(29) lgkmcnt(5)
    v_mfma_f32_32x32x16_bf16 v[128:143], v[80:83], v[244:247], v[128:143]
    ds_read_b128 v[72:75], v18 offset:8192
    s_waitcnt lgkmcnt(5)
    v_mfma_f32_32x32x16_bf16 v[144:159], v[84:87], v[244:247], v[144:159]
    ds_read_b128 v[76:79], v18 offset:12288
    s_waitcnt lgkmcnt(5)
    v_mfma_f32_32x32x16_bf16 v[160:175], v[88:91], v[244:247], v[160:175]
    v_xor_b32 v19, 0x18070, v16
    ds_read_b128 v[80:83], v19 offset:0
    s_waitcnt lgkmcnt(5)
    v_mfma_f32_32x32x16_bf16 v[176:191], v[92:95], v[244:247], v[176:191]
    ds_read_b128 v[84:87], v19 offset:4096
    s_waitcnt vmcnt(27) lgkmcnt(5)
    v_mfma_f32_32x32x16_bf16 v[128:143], v[64:67], v[248:251], v[128:143]
    ds_read_b128 v[88:91], v19 offset:8192
    s_waitcnt lgkmcnt(5)
    v_mfma_f32_32x32x16_bf16 v[144:159], v[68:71], v[248:251], v[144:159]
    ds_read_b128 v[92:95], v19 offset:12288
    s_waitcnt vmcnt(24)
    s_barrier
    s_waitcnt lgkmcnt(5)
    v_mfma_f32_32x32x16_bf16 v[160:175], v[72:75], v[248:251], v[160:175]
    v_xor_b32 v18, 0x20000, v17
    ds_read_b128 v[64:67], v18 offset:0
    s_waitcnt lgkmcnt(5)
    v_mfma_f32_32x32x16_bf16 v[176:191], v[76:79], v[248:251], v[176:191]
    ds_read_b128 v[68:71], v18 offset:4096
    s_waitcnt vmcnt(25) lgkmcnt(5)
    v_mfma_f32_32x32x16_bf16 v[128:143], v[80:83], v[252:255], v[128:143]
    v_xor_b32 v19, 0x20010, v17
    ds_read_b128 v[72:75], v19 offset:0
    s_waitcnt lgkmcnt(5)
    v_mfma_f32_32x32x16_bf16 v[144:159], v[84:87], v[252:255], v[144:159]
    ds_read_b128 v[76:79], v19 offset:4096
    s_waitcnt lgkmcnt(5)
    v_mfma_f32_32x32x16_bf16 v[160:175], v[88:91], v[252:255], v[160:175]
    v_xor_b32 v18, 0x20020, v17
    ds_read_b128 v[80:83], v18 offset:0
    s_add_u32 m0, s28, 98304
    s_mov_b32 s30, 1024
    buffer_load_dwordx4 v12, s[56:59], s30 offen offset:0 lds
    s_waitcnt lgkmcnt(5)
    v_mfma_f32_32x32x16_bf16 v[176:191], v[92:95], v[252:255], v[176:191]
    ds_read_b128 v[84:87], v18 offset:4096
    s_waitcnt lgkmcnt(5)
    v_mfma_f32_32x32x16_bf16 v[192:207], v[64:67], a[0:3], 0
    v_xor_b32 v19, 0x20030, v17
    ds_read_b128 v[88:91], v19 offset:0
    buffer_load_dwordx4 v13, s[56:59], s30 offen offset:1024 lds
    s_waitcnt lgkmcnt(5)
    v_mfma_f32_32x32x16_bf16 v[208:223], v[68:71], a[0:3], 0
    ds_read_b128 v[92:95], v19 offset:4096
    buffer_load_dwordx4 v14, s[56:59], s30 offen offset:2048 lds
    s_waitcnt lgkmcnt(5)
    v_mfma_f32_32x32x16_bf16 v[192:207], v[72:75], a[4:7], v[192:207]
    v_xor_b32 v18, 0x20040, v17
    ds_read_b128 v[64:67], v18 offset:0
    buffer_load_dwordx4 v15, s[56:59], s30 offen offset:3072 lds
    s_waitcnt lgkmcnt(5)
    v_mfma_f32_32x32x16_bf16 v[208:223], v[76:79], a[4:7], v[208:223]
    ds_read_b128 v[68:71], v18 offset:4096
    v_cvt_pk_bf16_f32 v128, v128, v129
    v_cvt_pk_bf16_f32 v129, v130, v131
    v_cvt_pk_bf16_f32 v130, v136, v137
    s_waitcnt lgkmcnt(5)
    v_mfma_f32_32x32x16_bf16 v[192:207], v[80:83], a[8:11], v[192:207]
    v_xor_b32 v19, 0x20050, v17
    ds_read_b128 v[72:75], v19 offset:0
    v_cvt_pk_bf16_f32 v131, v138, v139
    v_cvt_pk_bf16_f32 v132, v132, v133
    v_cvt_pk_bf16_f32 v133, v134, v135
    s_waitcnt lgkmcnt(5)
    v_mfma_f32_32x32x16_bf16 v[208:223], v[84:87], a[8:11], v[208:223]
    ds_read_b128 v[76:79], v19 offset:4096
    v_cvt_pk_bf16_f32 v134, v140, v141
    v_cvt_pk_bf16_f32 v135, v142, v143
    v_cvt_pk_bf16_f32 v144, v144, v145
    s_waitcnt lgkmcnt(5)
    v_mfma_f32_32x32x16_bf16 v[192:207], v[88:91], a[12:15], v[192:207]
    v_xor_b32 v18, 0x20060, v17
    ds_read_b128 v[80:83], v18 offset:0
    v_cvt_pk_bf16_f32 v145, v146, v147
    v_cvt_pk_bf16_f32 v146, v152, v153
    v_cvt_pk_bf16_f32 v147, v154, v155
    s_waitcnt lgkmcnt(5)
    v_mfma_f32_32x32x16_bf16 v[208:223], v[92:95], a[12:15], v[208:223]
    ds_read_b128 v[84:87], v18 offset:4096
    v_cvt_pk_bf16_f32 v148, v148, v149
    v_cvt_pk_bf16_f32 v149, v150, v151
    v_cvt_pk_bf16_f32 v150, v156, v157
    s_waitcnt lgkmcnt(5)
    v_mfma_f32_32x32x16_bf16 v[192:207], v[64:67], a[16:19], v[192:207]
    v_xor_b32 v19, 0x20070, v17
    ds_read_b128 v[88:91], v19 offset:0
    v_cvt_pk_bf16_f32 v151, v158, v159
    v_cvt_pk_bf16_f32 v160, v160, v161
    v_cvt_pk_bf16_f32 v161, v162, v163
    s_waitcnt lgkmcnt(5)
    v_mfma_f32_32x32x16_bf16 v[208:223], v[68:71], a[16:19], v[208:223]
    ds_read_b128 v[92:95], v19 offset:4096
    v_cvt_pk_bf16_f32 v162, v168, v169
    v_cvt_pk_bf16_f32 v163, v170, v171
    v_cvt_pk_bf16_f32 v164, v164, v165
    s_waitcnt lgkmcnt(5)
    v_mfma_f32_32x32x16_bf16 v[192:207], v[72:75], a[20:23], v[192:207]
    v_xor_b32 v18, 0x24000, v17
    ds_read_b128 v[64:67], v18 offset:0
    v_cvt_pk_bf16_f32 v165, v166, v167
    v_cvt_pk_bf16_f32 v166, v172, v173
    v_cvt_pk_bf16_f32 v167, v174, v175
    s_waitcnt lgkmcnt(5)
    v_mfma_f32_32x32x16_bf16 v[208:223], v[76:79], a[20:23], v[208:223]
    ds_read_b128 v[68:71], v18 offset:4096
    v_cvt_pk_bf16_f32 v176, v176, v177
    v_cvt_pk_bf16_f32 v177, v178, v179
    v_cvt_pk_bf16_f32 v178, v184, v185
    s_waitcnt lgkmcnt(5)
    v_mfma_f32_32x32x16_bf16 v[192:207], v[80:83], a[24:27], v[192:207]
    v_xor_b32 v19, 0x24010, v17
    ds_read_b128 v[72:75], v19 offset:0
    v_cvt_pk_bf16_f32 v179, v186, v187
    v_cvt_pk_bf16_f32 v180, v180, v181
    v_cvt_pk_bf16_f32 v181, v182, v183
    s_waitcnt lgkmcnt(5)
    v_mfma_f32_32x32x16_bf16 v[208:223], v[84:87], a[24:27], v[208:223]
    ds_read_b128 v[76:79], v19 offset:4096
    v_cvt_pk_bf16_f32 v182, v188, v189
    v_cvt_pk_bf16_f32 v183, v190, v191
    buffer_store_dwordx4 v[128:131], v40, s[44:47], s60 offen offset:0 sc1
    s_waitcnt lgkmcnt(5)
    v_mfma_f32_32x32x16_bf16 v[192:207], v[88:91], a[28:31], v[192:207]
    v_xor_b32 v18, 0x24020, v17
    ds_read_b128 v[80:83], v18 offset:0
    buffer_store_dwordx4 v[132:135], v40, s[44:47], s60 offen offset:512 sc1
    s_waitcnt lgkmcnt(5)
    v_mfma_f32_32x32x16_bf16 v[208:223], v[92:95], a[28:31], v[208:223]
    ds_read_b128 v[84:87], v18 offset:4096
    buffer_store_dwordx4 v[144:147], v40, s[44:47], s61 offen offset:0 sc1
    s_waitcnt lgkmcnt(5)
    v_mfma_f32_32x32x16_bf16 v[192:207], v[64:67], a[32:35], v[192:207]
    v_xor_b32 v19, 0x24030, v17
    ds_read_b128 v[88:91], v19 offset:0
    buffer_store_dwordx4 v[148:151], v40, s[44:47], s61 offen offset:512 sc1
    s_waitcnt lgkmcnt(5)
    v_mfma_f32_32x32x16_bf16 v[208:223], v[68:71], a[32:35], v[208:223]
    ds_read_b128 v[92:95], v19 offset:4096
    buffer_store_dwordx4 v[160:163], v41, s[44:47], s62 offen offset:0 sc1
    s_waitcnt lgkmcnt(5)
    v_mfma_f32_32x32x16_bf16 v[192:207], v[72:75], a[36:39], v[192:207]
    v_xor_b32 v18, 0x24040, v17
    ds_read_b128 v[64:67], v18 offset:0
    buffer_store_dwordx4 v[164:167], v41, s[44:47], s62 offen offset:512 sc1
    s_waitcnt lgkmcnt(5)
    v_mfma_f32_32x32x16_bf16 v[208:223], v[76:79], a[36:39], v[208:223]
    ds_read_b128 v[68:71], v18 offset:4096
    buffer_store_dwordx4 v[176:179], v41, s[44:47], s63 offen offset:0 sc1
    s_waitcnt lgkmcnt(5)
    v_mfma_f32_32x32x16_bf16 v[192:207], v[80:83], a[40:43], v[192:207]
    v_xor_b32 v19, 0x24050, v17
    ds_read_b128 v[72:75], v19 offset:0
    buffer_store_dwordx4 v[180:183], v41, s[44:47], s63 offen offset:512 sc1
    s_waitcnt lgkmcnt(5)
    v_mfma_f32_32x32x16_bf16 v[208:223], v[84:87], a[40:43], v[208:223]
    ds_read_b128 v[76:79], v19 offset:4096
    s_waitcnt lgkmcnt(5)
    v_mfma_f32_32x32x16_bf16 v[192:207], v[88:91], a[44:47], v[192:207]
    v_xor_b32 v18, 0x24060, v17
    ds_read_b128 v[80:83], v18 offset:0
    s_waitcnt lgkmcnt(5)
    v_mfma_f32_32x32x16_bf16 v[208:223], v[92:95], a[44:47], v[208:223]
    ds_read_b128 v[84:87], v18 offset:4096
    s_waitcnt lgkmcnt(5)
    v_mfma_f32_32x32x16_bf16 v[192:207], v[64:67], a[48:51], v[192:207]
    v_xor_b32 v19, 0x24070, v17
    ds_read_b128 v[88:91], v19 offset:0
    s_waitcnt lgkmcnt(5)
    v_mfma_f32_32x32x16_bf16 v[208:223], v[68:71], a[48:51], v[208:223]
    ds_read_b128 v[92:95], v19 offset:4096
    s_waitcnt vmcnt(24)
    s_barrier
    s_waitcnt lgkmcnt(5)
    v_mfma_f32_32x32x16_bf16 v[192:207], v[72:75], a[52:55], v[192:207]
    v_xor_b32 v18, 0x0, v17
    ds_read_b128 v[64:67], v18 offset:0
    s_waitcnt lgkmcnt(5)
    v_mfma_f32_32x32x16_bf16 v[208:223], v[76:79], a[52:55], v[208:223]
    ds_read_b128 v[68:71], v18 offset:4096
    s_waitcnt lgkmcnt(5)
    v_mfma_f32_32x32x16_bf16 v[192:207], v[80:83], a[56:59], v[192:207]
    v_xor_b32 v19, 0x10, v17
    ds_read_b128 v[72:75], v19 offset:0
    s_waitcnt lgkmcnt(5)
    v_mfma_f32_32x32x16_bf16 v[208:223], v[84:87], a[56:59], v[208:223]
    ds_read_b128 v[76:79], v19 offset:4096
    s_waitcnt lgkmcnt(5)
    v_mfma_f32_32x32x16_bf16 v[192:207], v[88:91], a[60:63], v[192:207]
    v_xor_b32 v18, 0x20, v17
    ds_read_b128 v[80:83], v18 offset:0
    s_waitcnt lgkmcnt(5)
    v_mfma_f32_32x32x16_bf16 v[208:223], v[92:95], a[60:63], v[208:223]
    ds_read_b128 v[84:87], v18 offset:4096
    s_waitcnt lgkmcnt(5)
    v_mfma_f32_32x32x16_bf16 v[192:207], v[64:67], a[64:67], v[192:207]
    v_xor_b32 v19, 0x30, v17
    ds_read_b128 v[88:91], v19 offset:0
    s_waitcnt lgkmcnt(5)
    v_mfma_f32_32x32x16_bf16 v[208:223], v[68:71], a[64:67], v[208:223]
    ds_read_b128 v[92:95], v19 offset:4096
    s_waitcnt lgkmcnt(5)
    v_mfma_f32_32x32x16_bf16 v[192:207], v[72:75], a[68:71], v[192:207]
    v_xor_b32 v18, 0x40, v17
    ds_read_b128 v[64:67], v18 offset:0
    s_waitcnt lgkmcnt(5)
    v_mfma_f32_32x32x16_bf16 v[208:223], v[76:79], a[68:71], v[208:223]
    ds_read_b128 v[68:71], v18 offset:4096
    s_waitcnt lgkmcnt(5)
    v_mfma_f32_32x32x16_bf16 v[192:207], v[80:83], a[72:75], v[192:207]
    v_xor_b32 v19, 0x50, v17
    ds_read_b128 v[72:75], v19 offset:0
    s_waitcnt lgkmcnt(5)
    v_mfma_f32_32x32x16_bf16 v[208:223], v[84:87], a[72:75], v[208:223]
    ds_read_b128 v[76:79], v19 offset:4096
    s_waitcnt lgkmcnt(5)
    v_mfma_f32_32x32x16_bf16 v[192:207], v[88:91], a[76:79], v[192:207]
    v_xor_b32 v18, 0x60, v17
    ds_read_b128 v[80:83], v18 offset:0
    s_waitcnt lgkmcnt(5)
    v_mfma_f32_32x32x16_bf16 v[208:223], v[92:95], a[76:79], v[208:223]
    ds_read_b128 v[84:87], v18 offset:4096
    s_waitcnt lgkmcnt(5)
    v_mfma_f32_32x32x16_bf16 v[192:207], v[64:67], a[80:83], v[192:207]
    v_xor_b32 v19, 0x70, v17
    ds_read_b128 v[88:91], v19 offset:0
    s_waitcnt lgkmcnt(5)
    v_mfma_f32_32x32x16_bf16 v[208:223], v[68:71], a[80:83], v[208:223]
    ds_read_b128 v[92:95], v19 offset:4096
    s_waitcnt lgkmcnt(5)
    v_mfma_f32_32x32x16_bf16 v[192:207], v[72:75], a[84:87], v[192:207]
    v_xor_b32 v18, 0x4000, v17
    ds_read_b128 v[64:67], v18 offset:0
    s_waitcnt lgkmcnt(5)
    v_mfma_f32_32x32x16_bf16 v[208:223], v[76:79], a[84:87], v[208:223]
    ds_read_b128 v[68:71], v18 offset:4096
    s_waitcnt lgkmcnt(5)
    v_mfma_f32_32x32x16_bf16 v[192:207], v[80:83], a[88:91], v[192:207]
    v_xor_b32 v19, 0x4010, v17
    ds_read_b128 v[72:75], v19 offset:0
    s_waitcnt lgkmcnt(5)
    v_mfma_f32_32x32x16_bf16 v[208:223], v[84:87], a[88:91], v[208:223]
    ds_read_b128 v[76:79], v19 offset:4096
    s_waitcnt lgkmcnt(5)
    v_mfma_f32_32x32x16_bf16 v[192:207], v[88:91], a[92:95], v[192:207]
    v_xor_b32 v18, 0x4020, v17
    ds_read_b128 v[80:83], v18 offset:0
    s_waitcnt lgkmcnt(5)
    v_mfma_f32_32x32x16_bf16 v[208:223], v[92:95], a[92:95], v[208:223]
    ds_read_b128 v[84:87], v18 offset:4096
    s_waitcnt lgkmcnt(5)
    v_mfma_f32_32x32x16_bf16 v[192:207], v[64:67], a[96:99], v[192:207]
    v_xor_b32 v19, 0x4030, v17
    ds_read_b128 v[88:91], v19 offset:0
    s_waitcnt lgkmcnt(5)
    v_mfma_f32_32x32x16_bf16 v[208:223], v[68:71], a[96:99], v[208:223]
    ds_read_b128 v[92:95], v19 offset:4096
    s_waitcnt lgkmcnt(5)
    v_mfma_f32_32x32x16_bf16 v[192:207], v[72:75], a[100:103], v[192:207]
    v_xor_b32 v18, 0x4040, v17
    ds_read_b128 v[64:67], v18 offset:0
    s_waitcnt lgkmcnt(5)
    v_mfma_f32_32x32x16_bf16 v[208:223], v[76:79], a[100:103], v[208:223]
    ds_read_b128 v[68:71], v18 offset:4096
    s_waitcnt lgkmcnt(5)
    v_mfma_f32_32x32x16_bf16 v[192:207], v[80:83], a[104:107], v[192:207]
    v_xor_b32 v19, 0x4050, v17
    ds_read_b128 v[72:75], v19 offset:0
    s_waitcnt lgkmcnt(5)
    v_mfma_f32_32x32x16_bf16 v[208:223], v[84:87], a[104:107], v[208:223]
    ds_read_b128 v[76:79], v19 offset:4096
    s_waitcnt lgkmcnt(5)
    v_mfma_f32_32x32x16_bf16 v[192:207], v[88:91], a[108:111], v[192:207]
    v_xor_b32 v18, 0x4060, v17
    ds_read_b128 v[80:83], v18 offset:0
    s_waitcnt lgkmcnt(5)
    v_mfma_f32_32x32x16_bf16 v[208:223], v[92:95], a[108:111], v[208:223]
    ds_read_b128 v[84:87], v18 offset:4096
    s_waitcnt lgkmcnt(5)
    v_mfma_f32_32x32x16_bf16 v[192:207], v[64:67], a[112:115], v[192:207]
    v_xor_b32 v19, 0x4070, v17
    ds_read_b128 v[88:91], v19 offset:0
    s_waitcnt lgkmcnt(5)
    v_mfma_f32_32x32x16_bf16 v[208:223], v[68:71], a[112:115], v[208:223]
    ds_read_b128 v[92:95], v19 offset:4096
    s_waitcnt lgkmcnt(5)
    v_mfma_f32_32x32x16_bf16 v[192:207], v[72:75], a[116:119], v[192:207]
    v_xor_b32 v18, 0x8000, v17
    ds_read_b128 v[64:67], v18 offset:0
    s_waitcnt lgkmcnt(5)
    v_mfma_f32_32x32x16_bf16 v[208:223], v[76:79], a[116:119], v[208:223]
    ds_read_b128 v[68:71], v18 offset:4096
    s_waitcnt lgkmcnt(5)
    v_mfma_f32_32x32x16_bf16 v[192:207], v[80:83], a[120:123], v[192:207]
    v_xor_b32 v19, 0x8010, v17
    ds_read_b128 v[72:75], v19 offset:0
    s_waitcnt lgkmcnt(5)
    v_mfma_f32_32x32x16_bf16 v[208:223], v[84:87], a[120:123], v[208:223]
    ds_read_b128 v[76:79], v19 offset:4096
    s_waitcnt lgkmcnt(5)
    v_mfma_f32_32x32x16_bf16 v[192:207], v[88:91], a[124:127], v[192:207]
    v_xor_b32 v18, 0x8020, v17
    ds_read_b128 v[80:83], v18 offset:0
    s_waitcnt lgkmcnt(5)
    v_mfma_f32_32x32x16_bf16 v[208:223], v[92:95], a[124:127], v[208:223]
    ds_read_b128 v[84:87], v18 offset:4096
    s_waitcnt lgkmcnt(5)
    v_mfma_f32_32x32x16_bf16 v[192:207], v[64:67], a[128:131], v[192:207]
    v_xor_b32 v19, 0x8030, v17
    ds_read_b128 v[88:91], v19 offset:0
    s_waitcnt lgkmcnt(5)
    v_mfma_f32_32x32x16_bf16 v[208:223], v[68:71], a[128:131], v[208:223]
    ds_read_b128 v[92:95], v19 offset:4096
    s_waitcnt lgkmcnt(5)
    v_mfma_f32_32x32x16_bf16 v[192:207], v[72:75], a[132:135], v[192:207]
    v_xor_b32 v18, 0x8040, v17
    ds_read_b128 v[64:67], v18 offset:0
    s_waitcnt lgkmcnt(5)
    v_mfma_f32_32x32x16_bf16 v[208:223], v[76:79], a[132:135], v[208:223]
    ds_read_b128 v[68:71], v18 offset:4096
    s_waitcnt lgkmcnt(5)
    v_mfma_f32_32x32x16_bf16 v[192:207], v[80:83], a[136:139], v[192:207]
    v_xor_b32 v19, 0x8050, v17
    ds_read_b128 v[72:75], v19 offset:0
    s_waitcnt lgkmcnt(5)
    v_mfma_f32_32x32x16_bf16 v[208:223], v[84:87], a[136:139], v[208:223]
    ds_read_b128 v[76:79], v19 offset:4096
    s_waitcnt lgkmcnt(5)
    v_mfma_f32_32x32x16_bf16 v[192:207], v[88:91], a[140:143], v[192:207]
    v_xor_b32 v18, 0x8060, v17
    ds_read_b128 v[80:83], v18 offset:0
    s_waitcnt lgkmcnt(5)
    v_mfma_f32_32x32x16_bf16 v[208:223], v[92:95], a[140:143], v[208:223]
    ds_read_b128 v[84:87], v18 offset:4096
    s_waitcnt lgkmcnt(5)
    v_mfma_f32_32x32x16_bf16 v[192:207], v[64:67], a[144:147], v[192:207]
    v_xor_b32 v19, 0x8070, v17
    ds_read_b128 v[88:91], v19 offset:0
    s_waitcnt lgkmcnt(5)
    v_mfma_f32_32x32x16_bf16 v[208:223], v[68:71], a[144:147], v[208:223]
    ds_read_b128 v[92:95], v19 offset:4096
    s_waitcnt vmcnt(8)
    s_barrier
    s_waitcnt lgkmcnt(5)
    v_mfma_f32_32x32x16_bf16 v[192:207], v[72:75], a[148:151], v[192:207]
    v_xor_b32 v18, 0xc000, v17
    ds_read_b128 v[64:67], v18 offset:0
    s_waitcnt lgkmcnt(5)
    v_mfma_f32_32x32x16_bf16 v[208:223], v[76:79], a[148:151], v[208:223]
    ds_read_b128 v[68:71], v18 offset:4096
    s_waitcnt lgkmcnt(5)
    v_mfma_f32_32x32x16_bf16 v[192:207], v[80:83], a[152:155], v[192:207]
    v_xor_b32 v19, 0xc010, v17
    ds_read_b128 v[72:75], v19 offset:0
    s_waitcnt lgkmcnt(5)
    v_mfma_f32_32x32x16_bf16 v[208:223], v[84:87], a[152:155], v[208:223]
    ds_read_b128 v[76:79], v19 offset:4096
    s_waitcnt lgkmcnt(5)
    v_mfma_f32_32x32x16_bf16 v[192:207], v[88:91], a[156:159], v[192:207]
    v_xor_b32 v18, 0xc020, v17
    ds_read_b128 v[80:83], v18 offset:0
    s_waitcnt lgkmcnt(5)
    v_mfma_f32_32x32x16_bf16 v[208:223], v[92:95], a[156:159], v[208:223]
    ds_read_b128 v[84:87], v18 offset:4096
    s_waitcnt lgkmcnt(5)
    v_mfma_f32_32x32x16_bf16 v[192:207], v[64:67], a[160:163], v[192:207]
    v_xor_b32 v19, 0xc030, v17
    ds_read_b128 v[88:91], v19 offset:0
    s_waitcnt lgkmcnt(5)
    v_mfma_f32_32x32x16_bf16 v[208:223], v[68:71], a[160:163], v[208:223]
    ds_read_b128 v[92:95], v19 offset:4096
    s_waitcnt lgkmcnt(5)
    v_mfma_f32_32x32x16_bf16 v[192:207], v[72:75], a[164:167], v[192:207]
    v_xor_b32 v18, 0xc040, v17
    ds_read_b128 v[64:67], v18 offset:0
    s_waitcnt lgkmcnt(5)
    v_mfma_f32_32x32x16_bf16 v[208:223], v[76:79], a[164:167], v[208:223]
    ds_read_b128 v[68:71], v18 offset:4096
    s_waitcnt lgkmcnt(5)
    v_mfma_f32_32x32x16_bf16 v[192:207], v[80:83], a[168:171], v[192:207]
    v_xor_b32 v19, 0xc050, v17
    ds_read_b128 v[72:75], v19 offset:0
    s_waitcnt lgkmcnt(5)
    v_mfma_f32_32x32x16_bf16 v[208:223], v[84:87], a[168:171], v[208:223]
    ds_read_b128 v[76:79], v19 offset:4096
    s_waitcnt lgkmcnt(5)
    v_mfma_f32_32x32x16_bf16 v[192:207], v[88:91], a[172:175], v[192:207]
    v_xor_b32 v18, 0xc060, v17
    ds_read_b128 v[80:83], v18 offset:0
    s_waitcnt lgkmcnt(5)
    v_mfma_f32_32x32x16_bf16 v[208:223], v[92:95], a[172:175], v[208:223]
    ds_read_b128 v[84:87], v18 offset:4096
    s_waitcnt lgkmcnt(5)
    v_mfma_f32_32x32x16_bf16 v[192:207], v[64:67], a[176:179], v[192:207]
    v_xor_b32 v19, 0xc070, v17
    ds_read_b128 v[88:91], v19 offset:0
    s_waitcnt lgkmcnt(5)
    v_mfma_f32_32x32x16_bf16 v[208:223], v[68:71], a[176:179], v[208:223]
    ds_read_b128 v[92:95], v19 offset:4096
    s_waitcnt lgkmcnt(5)
    v_mfma_f32_32x32x16_bf16 v[192:207], v[72:75], a[180:183], v[192:207]
    v_xor_b32 v18, 0x10000, v17
    ds_read_b128 v[64:67], v18 offset:0
    s_waitcnt lgkmcnt(5)
    v_mfma_f32_32x32x16_bf16 v[208:223], v[76:79], a[180:183], v[208:223]
    ds_read_b128 v[68:71], v18 offset:4096
    s_waitcnt lgkmcnt(5)
    v_mfma_f32_32x32x16_bf16 v[192:207], v[80:83], a[184:187], v[192:207]
    v_xor_b32 v19, 0x10010, v17
    ds_read_b128 v[72:75], v19 offset:0
    s_waitcnt lgkmcnt(5)
    v_mfma_f32_32x32x16_bf16 v[208:223], v[84:87], a[184:187], v[208:223]
    ds_read_b128 v[76:79], v19 offset:4096
    s_waitcnt lgkmcnt(5)
    v_mfma_f32_32x32x16_bf16 v[192:207], v[88:91], a[188:191], v[192:207]
    v_xor_b32 v18, 0x10020, v17
    ds_read_b128 v[80:83], v18 offset:0
    s_waitcnt lgkmcnt(5)
    v_mfma_f32_32x32x16_bf16 v[208:223], v[92:95], a[188:191], v[208:223]
    ds_read_b128 v[84:87], v18 offset:4096
    s_waitcnt lgkmcnt(5)
    v_mfma_f32_32x32x16_bf16 v[192:207], v[64:67], a[192:195], v[192:207]
    v_xor_b32 v19, 0x10030, v17
    ds_read_b128 v[88:91], v19 offset:0
    s_waitcnt lgkmcnt(5)
    v_mfma_f32_32x32x16_bf16 v[208:223], v[68:71], a[192:195], v[208:223]
    ds_read_b128 v[92:95], v19 offset:4096
    s_waitcnt lgkmcnt(5)
    v_mfma_f32_32x32x16_bf16 v[192:207], v[72:75], a[196:199], v[192:207]
    v_xor_b32 v18, 0x10040, v17
    ds_read_b128 v[64:67], v18 offset:0
    s_waitcnt lgkmcnt(5)
    v_mfma_f32_32x32x16_bf16 v[208:223], v[76:79], a[196:199], v[208:223]
    ds_read_b128 v[68:71], v18 offset:4096
    s_waitcnt lgkmcnt(5)
    v_mfma_f32_32x32x16_bf16 v[192:207], v[80:83], a[200:203], v[192:207]
    v_xor_b32 v19, 0x10050, v17
    ds_read_b128 v[72:75], v19 offset:0
    s_waitcnt lgkmcnt(5)
    v_mfma_f32_32x32x16_bf16 v[208:223], v[84:87], a[200:203], v[208:223]
    ds_read_b128 v[76:79], v19 offset:4096
    s_waitcnt lgkmcnt(5)
    v_mfma_f32_32x32x16_bf16 v[192:207], v[88:91], a[204:207], v[192:207]
    v_xor_b32 v18, 0x10060, v17
    ds_read_b128 v[80:83], v18 offset:0
    s_waitcnt lgkmcnt(5)
    v_mfma_f32_32x32x16_bf16 v[208:223], v[92:95], a[204:207], v[208:223]
    ds_read_b128 v[84:87], v18 offset:4096
    s_waitcnt lgkmcnt(5)
    v_mfma_f32_32x32x16_bf16 v[192:207], v[64:67], a[208:211], v[192:207]
    v_xor_b32 v19, 0x10070, v17
    ds_read_b128 v[88:91], v19 offset:0
    s_waitcnt lgkmcnt(5)
    v_mfma_f32_32x32x16_bf16 v[208:223], v[68:71], a[208:211], v[208:223]
    ds_read_b128 v[92:95], v19 offset:4096
    s_waitcnt lgkmcnt(5)
    v_mfma_f32_32x32x16_bf16 v[192:207], v[72:75], a[212:215], v[192:207]
    v_xor_b32 v18, 0x14000, v17
    ds_read_b128 v[64:67], v18 offset:0
    s_waitcnt lgkmcnt(5)
    v_mfma_f32_32x32x16_bf16 v[208:223], v[76:79], a[212:215], v[208:223]
    ds_read_b128 v[68:71], v18 offset:4096
    s_waitcnt lgkmcnt(5)
    v_mfma_f32_32x32x16_bf16 v[192:207], v[80:83], a[216:219], v[192:207]
    v_xor_b32 v19, 0x14010, v17
    ds_read_b128 v[72:75], v19 offset:0
    s_waitcnt lgkmcnt(5)
    v_mfma_f32_32x32x16_bf16 v[208:223], v[84:87], a[216:219], v[208:223]
    ds_read_b128 v[76:79], v19 offset:4096
    s_waitcnt lgkmcnt(5)
    v_mfma_f32_32x32x16_bf16 v[192:207], v[88:91], a[220:223], v[192:207]
    v_xor_b32 v18, 0x14020, v17
    ds_read_b128 v[80:83], v18 offset:0
    s_waitcnt lgkmcnt(5)
    v_mfma_f32_32x32x16_bf16 v[208:223], v[92:95], a[220:223], v[208:223]
    ds_read_b128 v[84:87], v18 offset:4096
    s_waitcnt lgkmcnt(5)
    v_mfma_f32_32x32x16_bf16 v[192:207], v[64:67], a[224:227], v[192:207]
    v_xor_b32 v19, 0x14030, v17
    ds_read_b128 v[88:91], v19 offset:0
    s_waitcnt lgkmcnt(5)
    v_mfma_f32_32x32x16_bf16 v[208:223], v[68:71], a[224:227], v[208:223]
    ds_read_b128 v[92:95], v19 offset:4096
    s_waitcnt lgkmcnt(5)
    v_mfma_f32_32x32x16_bf16 v[192:207], v[72:75], a[228:231], v[192:207]
    v_xor_b32 v18, 0x14040, v17
    ds_read_b128 v[64:67], v18 offset:0
    s_waitcnt lgkmcnt(5)
    v_mfma_f32_32x32x16_bf16 v[208:223], v[76:79], a[228:231], v[208:223]
    ds_read_b128 v[68:71], v18 offset:4096
    s_waitcnt lgkmcnt(5)
    v_mfma_f32_32x32x16_bf16 v[192:207], v[80:83], a[232:235], v[192:207]
    v_xor_b32 v19, 0x14050, v17
    ds_read_b128 v[72:75], v19 offset:0
    s_waitcnt lgkmcnt(5)
    v_mfma_f32_32x32x16_bf16 v[208:223], v[84:87], a[232:235], v[208:223]
    ds_read_b128 v[76:79], v19 offset:4096
    s_waitcnt lgkmcnt(5)
    v_mfma_f32_32x32x16_bf16 v[192:207], v[88:91], a[236:239], v[192:207]
    v_xor_b32 v18, 0x14060, v17
    ds_read_b128 v[80:83], v18 offset:0
    s_waitcnt lgkmcnt(5)
    v_mfma_f32_32x32x16_bf16 v[208:223], v[92:95], a[236:239], v[208:223]
    ds_read_b128 v[84:87], v18 offset:4096
    s_waitcnt lgkmcnt(5)
    v_mfma_f32_32x32x16_bf16 v[192:207], v[64:67], a[240:243], v[192:207]
    v_xor_b32 v19, 0x14070, v17
    ds_read_b128 v[88:91], v19 offset:0
    s_waitcnt lgkmcnt(5)
    v_mfma_f32_32x32x16_bf16 v[208:223], v[68:71], a[240:243], v[208:223]
    ds_read_b128 v[92:95], v19 offset:4096
    s_waitcnt lgkmcnt(5)
    v_mfma_f32_32x32x16_bf16 v[192:207], v[72:75], a[244:247], v[192:207]
    v_xor_b32 v18, 0x18000, v17
    ds_read_b128 v[64:67], v18 offset:0
    s_waitcnt lgkmcnt(5)
    v_mfma_f32_32x32x16_bf16 v[208:223], v[76:79], a[244:247], v[208:223]
    ds_read_b128 v[68:71], v18 offset:4096
    s_waitcnt lgkmcnt(5)
    v_mfma_f32_32x32x16_bf16 v[192:207], v[80:83], a[248:251], v[192:207]
    v_xor_b32 v19, 0x18010, v17
    ds_read_b128 v[72:75], v19 offset:0
    s_waitcnt lgkmcnt(5)
    v_mfma_f32_32x32x16_bf16 v[208:223], v[84:87], a[248:251], v[208:223]
    ds_read_b128 v[76:79], v19 offset:4096
    s_waitcnt lgkmcnt(5)
    v_mfma_f32_32x32x16_bf16 v[192:207], v[88:91], a[252:255], v[192:207]
    v_xor_b32 v18, 0x18020, v17
    ds_read_b128 v[80:83], v18 offset:0
    s_waitcnt lgkmcnt(5)
    v_mfma_f32_32x32x16_bf16 v[208:223], v[92:95], a[252:255], v[208:223]
    ds_read_b128 v[84:87], v18 offset:4096
    s_waitcnt lgkmcnt(5)
    v_mfma_f32_32x32x16_bf16 v[192:207], v[64:67], v[224:227], v[192:207]
    v_xor_b32 v19, 0x18030, v17
    ds_read_b128 v[88:91], v19 offset:0
    s_waitcnt lgkmcnt(5)
    v_mfma_f32_32x32x16_bf16 v[208:223], v[68:71], v[224:227], v[208:223]
    ds_read_b128 v[92:95], v19 offset:4096
    s_waitcnt lgkmcnt(5)
    v_mfma_f32_32x32x16_bf16 v[192:207], v[72:75], v[228:231], v[192:207]
    v_xor_b32 v18, 0x18040, v17
    ds_read_b128 v[64:67], v18 offset:0
    s_waitcnt lgkmcnt(5)
    v_mfma_f32_32x32x16_bf16 v[208:223], v[76:79], v[228:231], v[208:223]
    ds_read_b128 v[68:71], v18 offset:4096
    s_waitcnt lgkmcnt(5)
    v_mfma_f32_32x32x16_bf16 v[192:207], v[80:83], v[232:235], v[192:207]
    v_xor_b32 v19, 0x18050, v17
    ds_read_b128 v[72:75], v19 offset:0
    s_waitcnt lgkmcnt(5)
    v_mfma_f32_32x32x16_bf16 v[208:223], v[84:87], v[232:235], v[208:223]
    ds_read_b128 v[76:79], v19 offset:4096
    s_waitcnt lgkmcnt(5)
    v_mfma_f32_32x32x16_bf16 v[192:207], v[88:91], v[236:239], v[192:207]
    v_xor_b32 v18, 0x18060, v17
    ds_read_b128 v[80:83], v18 offset:0
    s_waitcnt lgkmcnt(5)
    v_mfma_f32_32x32x16_bf16 v[208:223], v[92:95], v[236:239], v[208:223]
    ds_read_b128 v[84:87], v18 offset:4096
    s_waitcnt lgkmcnt(5)
    v_mfma_f32_32x32x16_bf16 v[192:207], v[64:67], v[240:243], v[192:207]
    v_xor_b32 v19, 0x18070, v17
    ds_read_b128 v[88:91], v19 offset:0
    s_waitcnt lgkmcnt(5)
    v_mfma_f32_32x32x16_bf16 v[208:223], v[68:71], v[240:243], v[208:223]
    ds_read_b128 v[92:95], v19 offset:4096
    s_waitcnt lgkmcnt(5)
    v_mfma_f32_32x32x16_bf16 v[192:207], v[72:75], v[244:247], v[192:207]
    s_waitcnt lgkmcnt(4)
    v_mfma_f32_32x32x16_bf16 v[208:223], v[76:79], v[244:247], v[208:223]
    s_waitcnt lgkmcnt(3)
    v_mfma_f32_32x32x16_bf16 v[192:207], v[80:83], v[248:251], v[192:207]
    s_waitcnt lgkmcnt(2)
    v_mfma_f32_32x32x16_bf16 v[208:223], v[84:87], v[248:251], v[208:223]
    s_waitcnt lgkmcnt(1)
    v_mfma_f32_32x32x16_bf16 v[192:207], v[88:91], v[252:255], v[192:207]
    s_waitcnt lgkmcnt(0)
    v_mfma_f32_32x32x16_bf16 v[208:223], v[92:95], v[252:255], v[208:223]
    s_nop 9
    v_cvt_pk_bf16_f32 v192, v192, v193
    v_cvt_pk_bf16_f32 v193, v194, v195
    v_cvt_pk_bf16_f32 v194, v200, v201
    v_cvt_pk_bf16_f32 v195, v202, v203
    buffer_store_dwordx4 v[192:195], v42, s[44:47], s60 offen offset:2048 sc1
    v_cvt_pk_bf16_f32 v196, v196, v197
    v_cvt_pk_bf16_f32 v197, v198, v199
    v_cvt_pk_bf16_f32 v198, v204, v205
    v_cvt_pk_bf16_f32 v199, v206, v207
    buffer_store_dwordx4 v[196:199], v42, s[44:47], s60 offen offset:2560 sc1
    v_cvt_pk_bf16_f32 v208, v208, v209
    v_cvt_pk_bf16_f32 v209, v210, v211
    v_cvt_pk_bf16_f32 v210, v216, v217
    v_cvt_pk_bf16_f32 v211, v218, v219
    buffer_store_dwordx4 v[208:211], v42, s[44:47], s61 offen offset:2048 sc1
    v_cvt_pk_bf16_f32 v212, v212, v213
    v_cvt_pk_bf16_f32 v213, v214, v215
    v_cvt_pk_bf16_f32 v214, v220, v221
    v_cvt_pk_bf16_f32 v215, v222, v223
    buffer_store_dwordx4 v[212:215], v42, s[44:47], s61 offen offset:2560 sc1
parallel_end1:
    s_endpgm
code_end:
.section .rodata,"a"
.p2align 6
.amdhsa_kernel parallel_sum__ssm_conv_s5__glu_gated_bilinear__prompt_kernel
  .amdhsa_next_free_vgpr 512
  .amdhsa_next_free_sgpr 102
  .amdhsa_accum_offset 256
  .amdhsa_group_segment_fixed_size 0
  .amdhsa_kernarg_size 128
  .amdhsa_user_sgpr_count 2
  .amdhsa_user_sgpr_kernarg_segment_ptr 1
  .amdhsa_system_sgpr_workgroup_id_x 1
.end_amdhsa_kernel
```
